```python
import torch

def _softmax(x, axis=-1):
    return torch.softmax(x, dim=axis)
def _gelu(x):
    return torch.nn.functional.gelu(x, approximate="tanh")
def _silu(x):
    return torch.nn.functional.silu(x)
def _sigmoid(x):
    return torch.sigmoid(x)
def _layernorm(x, axis=-1, eps=1e-5):
    m = x.mean(dim=axis, keepdim=True)
    v = x.var(dim=axis, keepdim=True, unbiased=False)
    return (x - m) / torch.sqrt(v + eps)
def _scatter_add(tgt, idx, src, axis=0):
    return tgt.clone().index_add_(axis, idx, src)
def _segment_sum(src, seg, n):
    out = torch.zeros((n,) + src.shape[1:], dtype=src.dtype)
    return out.index_add_(0, seg, src)
def _pad(x, pw):
    flat = tuple(v for pair in reversed(pw) for v in pair)
    return torch.nn.functional.pad(x, flat)

kernel_name = 'gated_mix__linear_attn_block__mixer_s_mlp__prompt'

def setup_inputs():

    _w = (lambda a: (lambda t: t.to(torch.bfloat16) if t.is_floating_point() else t)(torch.as_tensor(a)))
    def _A_setup():
        B, S, D = 1, 2048, 1024
        return {
            "x": _w((lambda *s: torch.randn(*s, dtype=torch.bfloat16) * 0.05)(B, S, D)),
            "wqkv": _w((lambda *s: torch.randn(*s, dtype=torch.bfloat16) * 3.2)(D, 3 * D)),
            "wo": _w((lambda *s: torch.randn(*s, dtype=torch.bfloat16) * 1.6)(D, D)),
        }
    _A_in = _A_setup()

    def _B_setup():
        B, S, D, F = 1, 2048, 1024, 3584
        return {
            "x":  _w((lambda *s: torch.randn(*s, dtype=torch.bfloat16) * 0.05)(B, S, D)),
            "w1": _w((lambda *s: torch.randn(*s, dtype=torch.bfloat16) * 3.2)(D, D) * (D ** -0.5)),
            "w2": _w((lambda *s: torch.randn(*s, dtype=torch.bfloat16) * 3.2)(D, D) * (D ** -0.5)),
            "w3": _w((lambda *s: torch.randn(*s, dtype=torch.bfloat16) * 3.2)(D, F) * (D ** -0.5)),
            "w4": _w((lambda *s: torch.randn(*s, dtype=torch.bfloat16) * 1.6)(F, D) * (F ** -0.5)),
        }
    _B_in = _B_setup()

    return {
        "A_x": _A_in["x"],
        "A_wqkv": _A_in["wqkv"],
        "A_wo": _A_in["wo"],
        "B_x": _B_in["x"],
        "B_w1": _B_in["w1"],
        "B_w2": _B_in["w2"],
        "B_w3": _B_in["w3"],
        "B_w4": _B_in["w4"],
        "gate_w": _w((lambda *s: torch.randn(*s, dtype=torch.bfloat16) * 0.05)(1024) * 16.0),
    }

def reference(A_x, A_wqkv, A_wo, B_x, B_w1, B_w2, B_w3, B_w4, gate_w):
    def _A_ref(x, wqkv, wo):
        B, S, D = x.shape
        H = 32; Dh = D // H
        qkv = (lambda x, *d: x.permute(*d))((x @ wqkv).reshape(B, S, 3, H, Dh), 2, 0, 3, 1, 4)
        q, k, v = qkv[0], qkv[1], qkv[2]
        phi = lambda t: torch.where(t > 0, t + 1, torch.exp(t)) + 1e-6
        pq, pk = phi(q), phi(k)
        kv = torch.einsum("bhsd,bhse->bhde", pk, v)
        z = torch.einsum("bhsd->bhd", pk)
        num = torch.einsum("bhqd,bhde->bhqe", pq, kv)
        den = torch.einsum("bhqd,bhd->bhq", pq, z)[..., None] + 1e-6
        o = num / den
        return (lambda x, *d: x.permute(*d))(o, 0, 2, 1, 3).reshape(B, S, D) @ wo

    def _B_ref(x, w1, w2, w3, w4):
        B, S, D = x.shape
        h = _gelu(_layernorm(x, axis=-1) @ w1)
        c = D // 4
        g0 = _pad(h[:, :, 0*c:1*c], ((0, 0), (1, 0), (0, 0)))[:, :S, :]
        g1 = _pad(h[:, :, 1*c:2*c], ((0, 0), (0, 1), (0, 0)))[:, 1:, :]
        g2 = _pad(h[:, :, 2*c:3*c], ((0, 0), (2, 0), (0, 0)))[:, :S, :]
        g3 = _pad(h[:, :, 3*c:   ], ((0, 0), (0, 2), (0, 0)))[:, 2:, :]
        hs = torch.concatenate([g0, g1, g2, g3], axis=-1) @ w2
        x1 = x + hs
        h2 = _gelu(_layernorm(x1, axis=-1) @ w3) @ w4
        return x1 + h2

    x = A_x
    g = _sigmoid((x * gate_w).sum(-1, keepdims=True))
    a = _A_ref(x, A_wqkv, A_wo)
    b = _B_ref(x, B_w1, B_w2, B_w3, B_w4)
    return g * a + (1 - g) * b
```

```asm
; @launch grid=(256,1,1) block=(512,1,1) lds=162368
.amdgcn_target "amdgcn-amd-amdhsa--gfx950"
.text
.globl gated_mix__linear_attn_block__mixer_s_mlp__prompt_kernel
.p2align 8
.type gated_mix__linear_attn_block__mixer_s_mlp__prompt_kernel,@function
gated_mix__linear_attn_block__mixer_s_mlp__prompt_kernel:
s_cmp_ge_u32 s2, 256
s_cbranch_scc1 L_end
s_load_dwordx16 s[64:79], s[0:1], 0
s_load_dwordx8 s[80:87], s[0:1], 64
v_lshrrev_b32 v1, 6, v0
v_and_b32 v254, 63, v0
v_readfirstlane_b32 s20, v1
s_getpc_b64 s[44:45]
L_pc:
s_sub_u32 s44, s44, L_pc-gated_mix__linear_attn_block__mixer_s_mlp__prompt_kernel
s_subb_u32 s45, s45, 0
s_mov_b32 s46, L_text_end-gated_mix__linear_attn_block__mixer_s_mlp__prompt_kernel
s_mov_b32 s47, 0x20000
s_cmp_lg_u32 s20, 3
s_cbranch_scc1 L_ncpf
s_lshr_b32 s3, s2, 3
s_and_b32 s3, s3, 15
s_lshl_b32 s3, s3, 13
v_lshlrev_b32 v2, 7, v254
buffer_load_dword v255, v2, s[44:47], s3 offen
L_ncpf:
s_waitcnt lgkmcnt(0)
s_mov_b32 s16, s86
s_mov_b32 s17, s87
s_mov_b32 s18, 268435456
s_mov_b32 s19, 0x20000
s_mov_b32 s40, s84
s_mov_b32 s41, s85
s_mov_b32 s42, 256
s_mov_b32 s43, 0x20000
s_bitcmp1_b32 s2, 0
s_cbranch_scc1 L_pa
s_bfe_u32 s5, s2, 0x20001
s_lshr_b32 s4, s2, 3
s_lshr_b32 s7, s4, 3
s_and_b32 s4, s4, 7
s_lshl_b32 s5, s5, 2
s_add_u32 s58, s5, s7
s_mov_b32 s59, s4
s_mul_i32 s3, s7, 1
s_mul_i32 s31, s4, 0
s_add_u32 s3, s3, s31
s_lshl_b32 s21, s58, 7
s_lshl_b32 s22, s59, 8
s_mov_b32 s26, 2048
s_mov_b32 s27, 0
s_mov_b32 s28, 0
s_mov_b32 s25, 2048
s_mov_b32 s23, 128
s_mov_b32 s24, 64
s_mov_b32 s35, 131072
s_mov_b32 s8, s64
s_mov_b32 s9, s65
s_mov_b32 s10, 4194304
s_mov_b32 s11, 0x20000
s_mov_b32 s12, s72
s_mov_b32 s13, s73
s_mov_b32 s14, 2097152
s_mov_b32 s15, 0x20000
s_branch L_pb
L_pa:
s_bfe_u32 s5, s2, 0x10002
s_bfe_u32 s6, s2, 0x10001
s_lshr_b32 s4, s2, 3
s_lshr_b32 s7, s4, 2
s_and_b32 s4, s4, 3
s_lshl_b32 s5, s5, 3
s_add_u32 s58, s5, s7
s_lshl_b32 s6, s6, 2
s_add_u32 s59, s6, s4
s_mul_i32 s3, s7, 1
s_mul_i32 s31, s4, 0
s_add_u32 s3, s3, s31
s_lshl_b32 s21, s58, 7
s_lshl_b32 s22, s59, 8
s_mov_b32 s26, 2048
s_mov_b32 s27, 0
s_mov_b32 s28, 0
s_mov_b32 s25, 6144
s_mov_b32 s23, 128
s_mov_b32 s24, 64
s_mov_b32 s35, 393216
s_mov_b32 s8, s64
s_mov_b32 s9, s65
s_mov_b32 s10, 4194304
s_mov_b32 s11, 0x20000
s_mov_b32 s12, s66
s_mov_b32 s13, s67
s_mov_b32 s14, 6291456
s_mov_b32 s15, 0x20000
s_mov_b32 s28, 2048
L_pb:
s_cmp_ge_u32 s20, 4
s_cbranch_scc1 L_loader
s_setprio 2
s_lshl_b32 s31, s2, 3
s_lshl_b32 s32, s20, 1
s_add_u32 s60, s31, s32
s_lshl_b32 s31, s60, 11
v_lshlrev_b32 v200, 4, v254
buffer_load_dwordx4 v[0:3], v200, s[8:11], s31 offen offset:0
buffer_load_dwordx4 v[4:7], v200, s[8:11], s31 offen offset:1024
buffer_load_dwordx4 v[8:11], v200, s[8:11], s31 offen offset:2048
buffer_load_dwordx4 v[12:15], v200, s[8:11], s31 offen offset:3072
s_mov_b32 s44, s80
s_mov_b32 s45, s81
s_mov_b32 s46, 2048
s_mov_b32 s47, 0x20000
buffer_load_dwordx4 v[16:19], v200, s[44:47], 0 offen offset:0
buffer_load_dwordx4 v[20:23], v200, s[44:47], 0 offen offset:1024
s_bitcmp0_b32 s2, 0
s_cbranch_scc1 L_m1_nocs0_1
s_bitcmp1_b32 s20, 0
s_cbranch_scc1 L_m1_nocs0_1
s_lshr_b32 s32, s20, 1
s_sub_u32 s32, s2, s32
s_lshl_b32 s62, s32, 8
s_add_u32 s62, s62, 36765696
s_lshr_b32 s61, s32, 4
s_lshl_b32 s61, s61, 6
s_and_b32 s63, s32, 15
s_lshl_b32 s63, s63, 7
s_mov_b32 s52, s72
s_mov_b32 s53, s73
s_mov_b32 s54, 2097152
s_mov_b32 s55, 0x20000
v_lshrrev_b32 v136, 3, v254
v_add_u32 v136, s61, v136
v_mul_u32_u24 v136, 2048, v136
v_and_b32 v137, 7, v254
v_lshl_add_u32 v136, v137, 4, v136
v_add_u32 v136, s63, v136
s_mov_b32 s34, 0
buffer_load_dwordx4 v[140:143], v136, s[52:55], s34 offen
s_mov_b32 s34, 16384
buffer_load_dwordx4 v[144:147], v136, s[52:55], s34 offen
s_mov_b32 s34, 32768
buffer_load_dwordx4 v[148:151], v136, s[52:55], s34 offen
s_mov_b32 s34, 49152
buffer_load_dwordx4 v[152:155], v136, s[52:55], s34 offen
s_mov_b32 s34, 65536
buffer_load_dwordx4 v[156:159], v136, s[52:55], s34 offen
s_mov_b32 s34, 81920
buffer_load_dwordx4 v[160:163], v136, s[52:55], s34 offen
s_mov_b32 s34, 98304
buffer_load_dwordx4 v[164:167], v136, s[52:55], s34 offen
s_mov_b32 s34, 114688
buffer_load_dwordx4 v[168:171], v136, s[52:55], s34 offen
L_m1_nocs0_1:
s_cmp_lg_u32 s20, 1
s_cbranch_scc1 L_m1_noz_2
s_cmp_ge_u32 s2, 16
s_cbranch_scc1 L_m1_noz_2
s_mul_i32 s32, s2, 8192
s_add_u32 s32, s32, 38797312
v_mov_b32 v204, 0
v_mov_b32 v205, 0
v_mov_b32 v206, 0
v_mov_b32 v207, 0
buffer_store_dwordx4 v[204:207], v200, s[16:19], s32 offen sc0 sc1
s_add_u32 s32, s32, 1024
buffer_store_dwordx4 v[204:207], v200, s[16:19], s32 offen sc0 sc1
s_add_u32 s32, s32, 1024
buffer_store_dwordx4 v[204:207], v200, s[16:19], s32 offen sc0 sc1
s_add_u32 s32, s32, 1024
buffer_store_dwordx4 v[204:207], v200, s[16:19], s32 offen sc0 sc1
s_add_u32 s32, s32, 1024
buffer_store_dwordx4 v[204:207], v200, s[16:19], s32 offen sc0 sc1
s_add_u32 s32, s32, 1024
buffer_store_dwordx4 v[204:207], v200, s[16:19], s32 offen sc0 sc1
s_add_u32 s32, s32, 1024
buffer_store_dwordx4 v[204:207], v200, s[16:19], s32 offen sc0 sc1
s_add_u32 s32, s32, 1024
buffer_store_dwordx4 v[204:207], v200, s[16:19], s32 offen sc0 sc1
s_add_u32 s32, s32, 1024
L_m1_noz_2:
v_mov_b32 v201, 150016
v_mov_b32 v202, 0
v_mov_b32 v203, 0
ds_write_b64 v201, v[202:203] offset:0
ds_write_b64 v201, v[202:203] offset:8
ds_write_b64 v201, v[202:203] offset:16
ds_write_b64 v201, v[202:203] offset:24
ds_write_b64 v201, v[202:203] offset:32
ds_write_b64 v201, v[202:203] offset:40
ds_write_b64 v201, v[202:203] offset:48
ds_write_b64 v201, v[202:203] offset:56
s_bitcmp1_b32 s2, 0
s_cbranch_scc1 L_c_sa_3
v_and_b32 v204, 63, v254
s_lshr_b32 s31, s20, 1
s_and_b32 s32, s20, 1
v_and_b32 v205, 15, v204
s_mul_i32 s33, s31, 64
v_add_u32 v205, s33, v205
v_bfe_u32 v206, v205, 1, 3
v_lshrrev_b32 v207, 4, v204
v_xor_b32 v206, v206, v207
v_lshlrev_b32 v206, 4, v206
v_lshl_add_u32 v128, v205, 7, v206
v_xor_b32 v129, 64, v128
v_lshrrev_b32 v205, 4, v204
v_bfe_u32 v206, v204, 2, 2
v_and_b32 v207, 3, v204
v_lshl_add_u32 v208, v205, 3, v206
v_lshlrev_b32 v207, 3, v207
v_and_b32 v205, 3, v208
v_bfe_u32 v206, v208, 3, 1
v_lshl_or_b32 v205, v206, 2, v205
v_lshlrev_b32 v205, 1, v205
v_lshlrev_b32 v205, 4, v205
v_mul_u32_u24 v208, 256, v208
v_add_u32 v208, 16384, v208
s_mul_i32 s33, s32, 128
s_add_u32 s33, s33, 0
v_add_u32 v206, s33, v207
v_xor_b32 v206, v206, v205
v_add_u32 v130, v206, v208
s_mul_i32 s33, s32, 128
s_add_u32 s33, s33, 32
v_add_u32 v206, s33, v207
v_xor_b32 v206, v206, v205
v_add_u32 v131, v206, v208
s_mul_i32 s33, s32, 128
s_add_u32 s33, s33, 64
v_add_u32 v206, s33, v207
v_xor_b32 v206, v206, v205
v_add_u32 v132, v206, v208
s_mul_i32 s33, s32, 128
s_add_u32 s33, s33, 96
v_add_u32 v206, s33, v207
v_xor_b32 v206, v206, v205
v_add_u32 v133, v206, v208
s_branch L_c_sb_4
L_c_sa_3:
v_and_b32 v204, 63, v254
s_lshr_b32 s31, s20, 1
s_and_b32 s32, s20, 1
v_and_b32 v205, 15, v204
s_mul_i32 s33, s31, 64
v_add_u32 v205, s33, v205
v_bfe_u32 v206, v205, 1, 3
v_lshrrev_b32 v207, 4, v204
v_xor_b32 v206, v206, v207
v_lshlrev_b32 v206, 4, v206
v_lshl_add_u32 v224, v205, 7, v206
v_xor_b32 v225, 64, v224
v_lshrrev_b32 v205, 4, v204
v_bfe_u32 v206, v204, 2, 2
v_and_b32 v207, 3, v204
v_lshl_add_u32 v208, v205, 3, v206
v_lshlrev_b32 v207, 3, v207
v_and_b32 v205, 3, v208
v_bfe_u32 v206, v208, 3, 1
v_lshl_or_b32 v205, v206, 2, v205
v_lshlrev_b32 v205, 1, v205
v_lshlrev_b32 v205, 4, v205
v_mul_u32_u24 v208, 512, v208
v_add_u32 v208, 16384, v208
s_mul_i32 s33, s32, 128
s_add_u32 s33, s33, 0
v_add_u32 v206, s33, v207
v_xor_b32 v206, v206, v205
v_add_u32 v226, v206, v208
s_mul_i32 s33, s32, 128
s_add_u32 s33, s33, 32
v_add_u32 v206, s33, v207
v_xor_b32 v206, v206, v205
v_add_u32 v227, v206, v208
s_mul_i32 s33, s32, 128
s_add_u32 s33, s33, 256
v_add_u32 v206, s33, v207
v_xor_b32 v206, v206, v205
v_add_u32 v228, v206, v208
s_mul_i32 s33, s32, 128
s_add_u32 s33, s33, 288
v_add_u32 v206, s33, v207
v_xor_b32 v206, v206, v205
v_add_u32 v229, v206, v208
s_mul_i32 s33, s32, 128
s_add_u32 s33, s33, 64
v_add_u32 v206, s33, v207
v_xor_b32 v206, v206, v205
v_add_u32 v230, v206, v208
s_mul_i32 s33, s32, 128
s_add_u32 s33, s33, 96
v_add_u32 v206, s33, v207
v_xor_b32 v206, v206, v205
v_add_u32 v231, v206, v208
s_mul_i32 s33, s32, 128
s_add_u32 s33, s33, 320
v_add_u32 v206, s33, v207
v_xor_b32 v206, v206, v205
v_add_u32 v232, v206, v208
s_mul_i32 s33, s32, 128
s_add_u32 s33, s33, 352
v_add_u32 v206, s33, v207
v_xor_b32 v206, v206, v205
v_add_u32 v233, v206, v208
L_c_sb_4:
s_waitcnt vmcnt(0)
s_cmp_lg_u32 s20, 1
s_cbranch_scc1 L_m1_noz2_5
s_cmp_ge_u32 s2, 16
s_cbranch_scc1 L_m1_noz2_5
v_mov_b32 v201, 1
v_mov_b32 v202, 0
s_lshl_b32 s32, s2, 4
s_mov_b64 exec, 1
buffer_store_dword v201, v202, s[40:43], s32 offen sc0 sc1
s_mov_b64 exec, -1
L_m1_noz2_5:
v_lshlrev_b32 v24, 16, v0
v_and_b32 v25, 0xffff0000, v0
v_lshlrev_b32 v26, 16, v1
v_and_b32 v27, 0xffff0000, v1
v_lshlrev_b32 v28, 16, v2
v_and_b32 v29, 0xffff0000, v2
v_lshlrev_b32 v30, 16, v3
v_and_b32 v31, 0xffff0000, v3
v_lshlrev_b32 v40, 16, v8
v_and_b32 v41, 0xffff0000, v8
v_lshlrev_b32 v42, 16, v9
v_and_b32 v43, 0xffff0000, v9
v_lshlrev_b32 v44, 16, v10
v_and_b32 v45, 0xffff0000, v10
v_lshlrev_b32 v46, 16, v11
v_and_b32 v47, 0xffff0000, v11
v_lshlrev_b32 v56, 16, v16
v_and_b32 v57, 0xffff0000, v16
v_lshlrev_b32 v58, 16, v17
v_and_b32 v59, 0xffff0000, v17
v_lshlrev_b32 v60, 16, v18
v_and_b32 v61, 0xffff0000, v18
v_lshlrev_b32 v62, 16, v19
v_and_b32 v63, 0xffff0000, v19
v_lshlrev_b32 v32, 16, v4
v_and_b32 v33, 0xffff0000, v4
v_lshlrev_b32 v34, 16, v5
v_and_b32 v35, 0xffff0000, v5
v_lshlrev_b32 v36, 16, v6
v_and_b32 v37, 0xffff0000, v6
v_lshlrev_b32 v38, 16, v7
v_and_b32 v39, 0xffff0000, v7
v_lshlrev_b32 v48, 16, v12
v_and_b32 v49, 0xffff0000, v12
v_lshlrev_b32 v50, 16, v13
v_and_b32 v51, 0xffff0000, v13
v_lshlrev_b32 v52, 16, v14
v_and_b32 v53, 0xffff0000, v14
v_lshlrev_b32 v54, 16, v15
v_and_b32 v55, 0xffff0000, v15
v_lshlrev_b32 v64, 16, v20
v_and_b32 v65, 0xffff0000, v20
v_lshlrev_b32 v66, 16, v21
v_and_b32 v67, 0xffff0000, v21
v_lshlrev_b32 v68, 16, v22
v_and_b32 v69, 0xffff0000, v22
v_lshlrev_b32 v70, 16, v23
v_and_b32 v71, 0xffff0000, v23
v_pk_add_f32 v[0:1], v[24:25], v[26:27]
v_pk_add_f32 v[2:3], v[40:41], v[42:43]
v_pk_mul_f32 v[4:5], v[24:25], v[56:57]
v_pk_mul_f32 v[6:7], v[40:41], v[56:57]
v_pk_fma_f32 v[4:5], v[26:27], v[58:59], v[4:5]
v_pk_fma_f32 v[6:7], v[42:43], v[58:59], v[6:7]
v_pk_add_f32 v[0:1], v[0:1], v[28:29]
v_pk_add_f32 v[2:3], v[2:3], v[44:45]
v_pk_fma_f32 v[4:5], v[28:29], v[60:61], v[4:5]
v_pk_fma_f32 v[6:7], v[44:45], v[60:61], v[6:7]
v_pk_add_f32 v[0:1], v[0:1], v[30:31]
v_pk_add_f32 v[2:3], v[2:3], v[46:47]
v_pk_fma_f32 v[4:5], v[30:31], v[62:63], v[4:5]
v_pk_fma_f32 v[6:7], v[46:47], v[62:63], v[6:7]
v_pk_add_f32 v[0:1], v[0:1], v[32:33]
v_pk_add_f32 v[2:3], v[2:3], v[48:49]
v_pk_fma_f32 v[4:5], v[32:33], v[64:65], v[4:5]
v_pk_fma_f32 v[6:7], v[48:49], v[64:65], v[6:7]
v_pk_add_f32 v[0:1], v[0:1], v[34:35]
v_pk_add_f32 v[2:3], v[2:3], v[50:51]
v_pk_fma_f32 v[4:5], v[34:35], v[66:67], v[4:5]
v_pk_fma_f32 v[6:7], v[50:51], v[66:67], v[6:7]
v_pk_add_f32 v[0:1], v[0:1], v[36:37]
v_pk_add_f32 v[2:3], v[2:3], v[52:53]
v_pk_fma_f32 v[4:5], v[36:37], v[68:69], v[4:5]
v_pk_fma_f32 v[6:7], v[52:53], v[68:69], v[6:7]
v_pk_add_f32 v[0:1], v[0:1], v[38:39]
v_pk_add_f32 v[2:3], v[2:3], v[54:55]
v_pk_fma_f32 v[4:5], v[38:39], v[70:71], v[4:5]
v_pk_fma_f32 v[6:7], v[54:55], v[70:71], v[6:7]
v_add_f32 v0, v0, v1
v_add_f32 v2, v2, v3
v_add_f32 v4, v4, v5
v_add_f32 v6, v6, v7
v_add_f32_dpp v0, v0, v0 quad_perm:[1,0,3,2] row_mask:0xf bank_mask:0xf
v_add_f32_dpp v2, v2, v2 quad_perm:[1,0,3,2] row_mask:0xf bank_mask:0xf
v_add_f32_dpp v4, v4, v4 quad_perm:[1,0,3,2] row_mask:0xf bank_mask:0xf
v_add_f32_dpp v6, v6, v6 quad_perm:[1,0,3,2] row_mask:0xf bank_mask:0xf
v_add_f32_dpp v0, v0, v0 quad_perm:[2,3,0,1] row_mask:0xf bank_mask:0xf
v_add_f32_dpp v2, v2, v2 quad_perm:[2,3,0,1] row_mask:0xf bank_mask:0xf
v_add_f32_dpp v4, v4, v4 quad_perm:[2,3,0,1] row_mask:0xf bank_mask:0xf
v_add_f32_dpp v6, v6, v6 quad_perm:[2,3,0,1] row_mask:0xf bank_mask:0xf
v_add_f32_dpp v0, v0, v0 row_half_mirror row_mask:0xf bank_mask:0xf
v_add_f32_dpp v2, v2, v2 row_half_mirror row_mask:0xf bank_mask:0xf
v_add_f32_dpp v4, v4, v4 row_half_mirror row_mask:0xf bank_mask:0xf
v_add_f32_dpp v6, v6, v6 row_half_mirror row_mask:0xf bank_mask:0xf
v_add_f32_dpp v0, v0, v0 row_mirror row_mask:0xf bank_mask:0xf
v_add_f32_dpp v2, v2, v2 row_mirror row_mask:0xf bank_mask:0xf
v_add_f32_dpp v4, v4, v4 row_mirror row_mask:0xf bank_mask:0xf
v_add_f32_dpp v6, v6, v6 row_mirror row_mask:0xf bank_mask:0xf
v_mov_b32 v8, v0
v_mov_b32 v9, v2
v_mov_b32 v10, v4
v_mov_b32 v11, v6
s_nop 1
v_permlane16_swap_b32 v0, v8
v_permlane16_swap_b32 v2, v9
v_permlane16_swap_b32 v4, v10
v_permlane16_swap_b32 v6, v11
s_nop 1
v_add_f32 v0, v0, v8
v_add_f32 v2, v2, v9
v_add_f32 v4, v4, v10
v_add_f32 v6, v6, v11
v_mov_b32 v8, v0
v_mov_b32 v9, v2
v_mov_b32 v10, v4
v_mov_b32 v11, v6
s_nop 1
v_permlane32_swap_b32 v0, v8
v_permlane32_swap_b32 v2, v9
v_permlane32_swap_b32 v4, v10
v_permlane32_swap_b32 v6, v11
s_nop 1
v_add_f32 v0, v0, v8
v_add_f32 v2, v2, v9
v_add_f32 v4, v4, v10
v_add_f32 v6, v6, v11
v_mul_f32 v0, 981467136, v0
v_mul_f32 v2, 981467136, v2
v_pk_add_f32 v[24:25], v[24:25], v[0:1] op_sel_hi:[1,0] neg_lo:[0,1] neg_hi:[0,1]
v_pk_add_f32 v[40:41], v[40:41], v[2:3] op_sel_hi:[1,0] neg_lo:[0,1] neg_hi:[0,1]
v_pk_add_f32 v[26:27], v[26:27], v[0:1] op_sel_hi:[1,0] neg_lo:[0,1] neg_hi:[0,1]
v_pk_add_f32 v[42:43], v[42:43], v[2:3] op_sel_hi:[1,0] neg_lo:[0,1] neg_hi:[0,1]
v_pk_add_f32 v[28:29], v[28:29], v[0:1] op_sel_hi:[1,0] neg_lo:[0,1] neg_hi:[0,1]
v_pk_add_f32 v[44:45], v[44:45], v[2:3] op_sel_hi:[1,0] neg_lo:[0,1] neg_hi:[0,1]
v_pk_add_f32 v[30:31], v[30:31], v[0:1] op_sel_hi:[1,0] neg_lo:[0,1] neg_hi:[0,1]
v_pk_add_f32 v[46:47], v[46:47], v[2:3] op_sel_hi:[1,0] neg_lo:[0,1] neg_hi:[0,1]
v_pk_add_f32 v[32:33], v[32:33], v[0:1] op_sel_hi:[1,0] neg_lo:[0,1] neg_hi:[0,1]
v_pk_add_f32 v[48:49], v[48:49], v[2:3] op_sel_hi:[1,0] neg_lo:[0,1] neg_hi:[0,1]
v_pk_add_f32 v[34:35], v[34:35], v[0:1] op_sel_hi:[1,0] neg_lo:[0,1] neg_hi:[0,1]
v_pk_add_f32 v[50:51], v[50:51], v[2:3] op_sel_hi:[1,0] neg_lo:[0,1] neg_hi:[0,1]
v_pk_add_f32 v[36:37], v[36:37], v[0:1] op_sel_hi:[1,0] neg_lo:[0,1] neg_hi:[0,1]
v_pk_add_f32 v[52:53], v[52:53], v[2:3] op_sel_hi:[1,0] neg_lo:[0,1] neg_hi:[0,1]
v_pk_add_f32 v[38:39], v[38:39], v[0:1] op_sel_hi:[1,0] neg_lo:[0,1] neg_hi:[0,1]
v_pk_add_f32 v[54:55], v[54:55], v[2:3] op_sel_hi:[1,0] neg_lo:[0,1] neg_hi:[0,1]
v_pk_mul_f32 v[12:13], v[24:25], v[24:25]
v_pk_mul_f32 v[14:15], v[40:41], v[40:41]
v_pk_fma_f32 v[12:13], v[26:27], v[26:27], v[12:13]
v_pk_fma_f32 v[14:15], v[42:43], v[42:43], v[14:15]
v_pk_fma_f32 v[12:13], v[28:29], v[28:29], v[12:13]
v_pk_fma_f32 v[14:15], v[44:45], v[44:45], v[14:15]
v_pk_fma_f32 v[12:13], v[30:31], v[30:31], v[12:13]
v_pk_fma_f32 v[14:15], v[46:47], v[46:47], v[14:15]
v_pk_fma_f32 v[12:13], v[32:33], v[32:33], v[12:13]
v_pk_fma_f32 v[14:15], v[48:49], v[48:49], v[14:15]
v_pk_fma_f32 v[12:13], v[34:35], v[34:35], v[12:13]
v_pk_fma_f32 v[14:15], v[50:51], v[50:51], v[14:15]
v_pk_fma_f32 v[12:13], v[36:37], v[36:37], v[12:13]
v_pk_fma_f32 v[14:15], v[52:53], v[52:53], v[14:15]
v_pk_fma_f32 v[12:13], v[38:39], v[38:39], v[12:13]
v_pk_fma_f32 v[14:15], v[54:55], v[54:55], v[14:15]
v_add_f32 v12, v12, v13
v_add_f32 v14, v14, v15
s_nop 0
v_add_f32_dpp v12, v12, v12 quad_perm:[1,0,3,2] row_mask:0xf bank_mask:0xf
v_add_f32_dpp v14, v14, v14 quad_perm:[1,0,3,2] row_mask:0xf bank_mask:0xf
s_nop 0
v_add_f32_dpp v12, v12, v12 quad_perm:[2,3,0,1] row_mask:0xf bank_mask:0xf
v_add_f32_dpp v14, v14, v14 quad_perm:[2,3,0,1] row_mask:0xf bank_mask:0xf
s_nop 0
v_add_f32_dpp v12, v12, v12 row_half_mirror row_mask:0xf bank_mask:0xf
v_add_f32_dpp v14, v14, v14 row_half_mirror row_mask:0xf bank_mask:0xf
s_nop 0
v_add_f32_dpp v12, v12, v12 row_mirror row_mask:0xf bank_mask:0xf
v_add_f32_dpp v14, v14, v14 row_mirror row_mask:0xf bank_mask:0xf
v_mov_b32 v8, v12
v_mov_b32 v9, v14
s_nop 1
v_permlane16_swap_b32 v12, v8
v_permlane16_swap_b32 v14, v9
s_nop 1
v_add_f32 v12, v12, v8
v_add_f32 v14, v14, v9
v_mov_b32 v8, v12
v_mov_b32 v9, v14
s_nop 1
v_permlane32_swap_b32 v12, v8
v_permlane32_swap_b32 v14, v9
s_nop 1
v_add_f32 v12, v12, v8
v_add_f32 v14, v14, v9
v_mov_b32 v8, 925353388
v_fmac_f32 v8, 981467136, v12
v_mov_b32 v9, 925353388
v_fmac_f32 v9, 981467136, v14
v_mul_f32 v4, 3216550459, v4
v_mul_f32 v6, 3216550459, v6
v_rsq_f32 v16, v8
v_rsq_f32 v20, v9
v_exp_f32 v4, v4
v_exp_f32 v6, v6
s_nop 0
v_mov_b32 v17, v0
v_mov_b32 v21, v2
v_add_f32 v4, 1.0, v4
v_add_f32 v6, 1.0, v6
v_rcp_f32 v18, v4
v_rcp_f32 v22, v6
v_mov_b32 v19, 0
v_mov_b32 v23, 0
s_lshl_b32 s31, s60, 4
s_add_u32 s31, s31, 36700160
v_mov_b32 v200, 0
s_mov_b64 exec, 1
buffer_store_dwordx4 v[16:19], v200, s[16:19], s31 offen sc0 sc1
buffer_store_dwordx4 v[20:23], v200, s[16:19], s31 offen offset:16 sc0 sc1
s_mov_b64 exec, -1
s_bitcmp0_b32 s2, 0
s_cbranch_scc1 L_s1_nocs_6
s_bitcmp1_b32 s20, 0
s_cbranch_scc1 L_s1_nocs_6
v_lshlrev_b32 v184, 16, v140
v_and_b32 v185, 0xffff0000, v140
v_lshlrev_b32 v186, 16, v141
v_and_b32 v187, 0xffff0000, v141
v_lshlrev_b32 v188, 16, v142
v_and_b32 v189, 0xffff0000, v142
v_lshlrev_b32 v190, 16, v143
v_and_b32 v191, 0xffff0000, v143
v_lshlrev_b32 v176, 16, v144
v_and_b32 v177, 0xffff0000, v144
v_lshlrev_b32 v178, 16, v145
v_and_b32 v179, 0xffff0000, v145
v_lshlrev_b32 v180, 16, v146
v_and_b32 v181, 0xffff0000, v146
v_lshlrev_b32 v182, 16, v147
v_and_b32 v183, 0xffff0000, v147
v_pk_add_f32 v[184:185], v[184:185], v[176:177]
v_pk_add_f32 v[186:187], v[186:187], v[178:179]
v_pk_add_f32 v[188:189], v[188:189], v[180:181]
v_pk_add_f32 v[190:191], v[190:191], v[182:183]
v_lshlrev_b32 v176, 16, v148
v_and_b32 v177, 0xffff0000, v148
v_lshlrev_b32 v178, 16, v149
v_and_b32 v179, 0xffff0000, v149
v_lshlrev_b32 v180, 16, v150
v_and_b32 v181, 0xffff0000, v150
v_lshlrev_b32 v182, 16, v151
v_and_b32 v183, 0xffff0000, v151
v_pk_add_f32 v[184:185], v[184:185], v[176:177]
v_pk_add_f32 v[186:187], v[186:187], v[178:179]
v_pk_add_f32 v[188:189], v[188:189], v[180:181]
v_pk_add_f32 v[190:191], v[190:191], v[182:183]
v_lshlrev_b32 v176, 16, v152
v_and_b32 v177, 0xffff0000, v152
v_lshlrev_b32 v178, 16, v153
v_and_b32 v179, 0xffff0000, v153
v_lshlrev_b32 v180, 16, v154
v_and_b32 v181, 0xffff0000, v154
v_lshlrev_b32 v182, 16, v155
v_and_b32 v183, 0xffff0000, v155
v_pk_add_f32 v[184:185], v[184:185], v[176:177]
v_pk_add_f32 v[186:187], v[186:187], v[178:179]
v_pk_add_f32 v[188:189], v[188:189], v[180:181]
v_pk_add_f32 v[190:191], v[190:191], v[182:183]
v_lshlrev_b32 v176, 16, v156
v_and_b32 v177, 0xffff0000, v156
v_lshlrev_b32 v178, 16, v157
v_and_b32 v179, 0xffff0000, v157
v_lshlrev_b32 v180, 16, v158
v_and_b32 v181, 0xffff0000, v158
v_lshlrev_b32 v182, 16, v159
v_and_b32 v183, 0xffff0000, v159
v_pk_add_f32 v[184:185], v[184:185], v[176:177]
v_pk_add_f32 v[186:187], v[186:187], v[178:179]
v_pk_add_f32 v[188:189], v[188:189], v[180:181]
v_pk_add_f32 v[190:191], v[190:191], v[182:183]
v_lshlrev_b32 v176, 16, v160
v_and_b32 v177, 0xffff0000, v160
v_lshlrev_b32 v178, 16, v161
v_and_b32 v179, 0xffff0000, v161
v_lshlrev_b32 v180, 16, v162
v_and_b32 v181, 0xffff0000, v162
v_lshlrev_b32 v182, 16, v163
v_and_b32 v183, 0xffff0000, v163
v_pk_add_f32 v[184:185], v[184:185], v[176:177]
v_pk_add_f32 v[186:187], v[186:187], v[178:179]
v_pk_add_f32 v[188:189], v[188:189], v[180:181]
v_pk_add_f32 v[190:191], v[190:191], v[182:183]
v_lshlrev_b32 v176, 16, v164
v_and_b32 v177, 0xffff0000, v164
v_lshlrev_b32 v178, 16, v165
v_and_b32 v179, 0xffff0000, v165
v_lshlrev_b32 v180, 16, v166
v_and_b32 v181, 0xffff0000, v166
v_lshlrev_b32 v182, 16, v167
v_and_b32 v183, 0xffff0000, v167
v_pk_add_f32 v[184:185], v[184:185], v[176:177]
v_pk_add_f32 v[186:187], v[186:187], v[178:179]
v_pk_add_f32 v[188:189], v[188:189], v[180:181]
v_pk_add_f32 v[190:191], v[190:191], v[182:183]
v_lshlrev_b32 v176, 16, v168
v_and_b32 v177, 0xffff0000, v168
v_lshlrev_b32 v178, 16, v169
v_and_b32 v179, 0xffff0000, v169
v_lshlrev_b32 v180, 16, v170
v_and_b32 v181, 0xffff0000, v170
v_lshlrev_b32 v182, 16, v171
v_and_b32 v183, 0xffff0000, v171
v_pk_add_f32 v[184:185], v[184:185], v[176:177]
v_pk_add_f32 v[186:187], v[186:187], v[178:179]
v_pk_add_f32 v[188:189], v[188:189], v[180:181]
v_pk_add_f32 v[190:191], v[190:191], v[182:183]
v_add_f32_dpp v184, v184, v184 row_ror:8 row_mask:0xf bank_mask:0xf
v_add_f32_dpp v185, v185, v185 row_ror:8 row_mask:0xf bank_mask:0xf
v_add_f32_dpp v186, v186, v186 row_ror:8 row_mask:0xf bank_mask:0xf
v_add_f32_dpp v187, v187, v187 row_ror:8 row_mask:0xf bank_mask:0xf
v_add_f32_dpp v188, v188, v188 row_ror:8 row_mask:0xf bank_mask:0xf
v_add_f32_dpp v189, v189, v189 row_ror:8 row_mask:0xf bank_mask:0xf
v_add_f32_dpp v190, v190, v190 row_ror:8 row_mask:0xf bank_mask:0xf
v_add_f32_dpp v191, v191, v191 row_ror:8 row_mask:0xf bank_mask:0xf
v_mov_b32 v192, v184
v_mov_b32 v193, v185
v_mov_b32 v194, v186
v_mov_b32 v195, v187
v_mov_b32 v196, v188
v_mov_b32 v197, v189
v_mov_b32 v198, v190
v_mov_b32 v199, v191
s_nop 1
v_permlane16_swap_b32 v184, v192
v_permlane16_swap_b32 v185, v193
v_permlane16_swap_b32 v186, v194
v_permlane16_swap_b32 v187, v195
v_permlane16_swap_b32 v188, v196
v_permlane16_swap_b32 v189, v197
v_permlane16_swap_b32 v190, v198
v_permlane16_swap_b32 v191, v199
s_nop 1
v_add_f32 v184, v184, v192
v_add_f32 v185, v185, v193
v_add_f32 v186, v186, v194
v_add_f32 v187, v187, v195
v_add_f32 v188, v188, v196
v_add_f32 v189, v189, v197
v_add_f32 v190, v190, v198
v_add_f32 v191, v191, v199
v_mov_b32 v192, v184
v_mov_b32 v193, v185
v_mov_b32 v194, v186
v_mov_b32 v195, v187
v_mov_b32 v196, v188
v_mov_b32 v197, v189
v_mov_b32 v198, v190
v_mov_b32 v199, v191
s_nop 1
v_permlane32_swap_b32 v184, v192
v_permlane32_swap_b32 v185, v193
v_permlane32_swap_b32 v186, v194
v_permlane32_swap_b32 v187, v195
v_permlane32_swap_b32 v188, v196
v_permlane32_swap_b32 v189, v197
v_permlane32_swap_b32 v190, v198
v_permlane32_swap_b32 v191, v199
s_nop 1
v_add_f32 v184, v184, v192
v_add_f32 v185, v185, v193
v_add_f32 v186, v186, v194
v_add_f32 v187, v187, v195
v_add_f32 v188, v188, v196
v_add_f32 v189, v189, v197
v_add_f32 v190, v190, v198
v_add_f32 v191, v191, v199
v_lshlrev_b32 v136, 5, v254
s_mov_b64 exec, 0xff
buffer_store_dwordx4 v[184:187], v136, s[16:19], s62 offen sc0 sc1
buffer_store_dwordx4 v[188:191], v136, s[16:19], s62 offen offset:16 sc0 sc1
s_mov_b64 exec, -1
L_s1_nocs_6:
s_nop 1
v_mov_b32 v0, 0
v_mov_b32 v1, 0
v_mov_b32 v2, 0
v_mov_b32 v3, 0
v_mov_b32 v4, 0
v_mov_b32 v5, 0
v_mov_b32 v6, 0
v_mov_b32 v7, 0
v_mov_b32 v8, 0
v_mov_b32 v9, 0
v_mov_b32 v10, 0
v_mov_b32 v11, 0
v_mov_b32 v12, 0
v_mov_b32 v13, 0
v_mov_b32 v14, 0
v_mov_b32 v15, 0
v_mov_b32 v16, 0
v_mov_b32 v17, 0
v_mov_b32 v18, 0
v_mov_b32 v19, 0
v_mov_b32 v20, 0
v_mov_b32 v21, 0
v_mov_b32 v22, 0
v_mov_b32 v23, 0
v_mov_b32 v24, 0
v_mov_b32 v25, 0
v_mov_b32 v26, 0
v_mov_b32 v27, 0
v_mov_b32 v28, 0
v_mov_b32 v29, 0
v_mov_b32 v30, 0
v_mov_b32 v31, 0
v_mov_b32 v32, 0
v_mov_b32 v33, 0
v_mov_b32 v34, 0
v_mov_b32 v35, 0
v_mov_b32 v36, 0
v_mov_b32 v37, 0
v_mov_b32 v38, 0
v_mov_b32 v39, 0
v_mov_b32 v40, 0
v_mov_b32 v41, 0
v_mov_b32 v42, 0
v_mov_b32 v43, 0
v_mov_b32 v44, 0
v_mov_b32 v45, 0
v_mov_b32 v46, 0
v_mov_b32 v47, 0
v_mov_b32 v48, 0
v_mov_b32 v49, 0
v_mov_b32 v50, 0
v_mov_b32 v51, 0
v_mov_b32 v52, 0
v_mov_b32 v53, 0
v_mov_b32 v54, 0
v_mov_b32 v55, 0
v_mov_b32 v56, 0
v_mov_b32 v57, 0
v_mov_b32 v58, 0
v_mov_b32 v59, 0
v_mov_b32 v60, 0
v_mov_b32 v61, 0
v_mov_b32 v62, 0
v_mov_b32 v63, 0
v_mov_b32 v64, 0
v_mov_b32 v65, 0
v_mov_b32 v66, 0
v_mov_b32 v67, 0
v_mov_b32 v68, 0
v_mov_b32 v69, 0
v_mov_b32 v70, 0
v_mov_b32 v71, 0
v_mov_b32 v72, 0
v_mov_b32 v73, 0
v_mov_b32 v74, 0
v_mov_b32 v75, 0
v_mov_b32 v76, 0
v_mov_b32 v77, 0
v_mov_b32 v78, 0
v_mov_b32 v79, 0
v_mov_b32 v80, 0
v_mov_b32 v81, 0
v_mov_b32 v82, 0
v_mov_b32 v83, 0
v_mov_b32 v84, 0
v_mov_b32 v85, 0
v_mov_b32 v86, 0
v_mov_b32 v87, 0
v_mov_b32 v88, 0
v_mov_b32 v89, 0
v_mov_b32 v90, 0
v_mov_b32 v91, 0
v_mov_b32 v92, 0
v_mov_b32 v93, 0
v_mov_b32 v94, 0
v_mov_b32 v95, 0
v_mov_b32 v96, 0
v_mov_b32 v97, 0
v_mov_b32 v98, 0
v_mov_b32 v99, 0
v_mov_b32 v100, 0
v_mov_b32 v101, 0
v_mov_b32 v102, 0
v_mov_b32 v103, 0
v_mov_b32 v104, 0
v_mov_b32 v105, 0
v_mov_b32 v106, 0
v_mov_b32 v107, 0
v_mov_b32 v108, 0
v_mov_b32 v109, 0
v_mov_b32 v110, 0
v_mov_b32 v111, 0
v_mov_b32 v112, 0
v_mov_b32 v113, 0
v_mov_b32 v114, 0
v_mov_b32 v115, 0
v_mov_b32 v116, 0
v_mov_b32 v117, 0
v_mov_b32 v118, 0
v_mov_b32 v119, 0
v_mov_b32 v120, 0
v_mov_b32 v121, 0
v_mov_b32 v122, 0
v_mov_b32 v123, 0
v_mov_b32 v124, 0
v_mov_b32 v125, 0
v_mov_b32 v126, 0
v_mov_b32 v127, 0
s_waitcnt lgkmcnt(0)
s_bitcmp1_b32 s2, 0
s_cbranch_scc1 L_c_att_7
s_and_b32 s31, s20, 1
s_lshl_b32 s32, s59, 1
s_add_u32 s32, s32, s31
s_sub_u32 s33, s32, s3
s_and_b32 s33, s33, 3
s_andn2_b32 s32, s32, 3
s_or_b32 s97, s32, s33
s_add_u32 s97, s97, 1
v_bfe_u32 v138, v254, 4, 1
v_bfe_u32 v139, v254, 5, 1
v_lshl_or_b32 v138, v138, 1, v139
v_bfe_u32 v139, v254, 1, 3
v_xor_b32 v138, v138, v139
v_and_b32 v139, 15, v254
v_lshlrev_b32 v139, 7, v139
v_lshl_add_u32 v138, v138, 4, v139
s_mov_b32 s92, 8
s_mov_b32 s93, 0
s_bitset1_b64 s[92:93], s97
s_mov_b32 s30, 0
s_mov_b32 s29, 1
s_barrier
ds_read_b64_tr_b16 v[96:97], v130 offset:0
ds_read_b64_tr_b16 v[98:99], v130 offset:1024
ds_read_b128 v[64:67], v128 offset:0
ds_read_b64_tr_b16 v[100:101], v131 offset:0
ds_read_b64_tr_b16 v[102:103], v131 offset:1024
ds_read_b64_tr_b16 v[104:105], v132 offset:0
ds_read_b64_tr_b16 v[106:107], v132 offset:1024
ds_read_b64_tr_b16 v[108:109], v133 offset:0
ds_read_b64_tr_b16 v[110:111], v133 offset:1024
ds_read_b128 v[68:71], v128 offset:2048
ds_read_b128 v[72:75], v128 offset:4096
ds_read_b128 v[76:79], v128 offset:6144
.p2align 6
L_h_mm_9:
s_bitcmp1_b64 s[92:93], s29
s_cbranch_scc1 L_h_H_10
L_h_B_11:
s_waitcnt lgkmcnt(9)
v_mfma_f32_16x16x32_bf16 v[0:3], v[96:99], v[64:67], v[0:3]
ds_read_b64_tr_b16 v[112:113], v130 offset:8192
ds_read_b64_tr_b16 v[114:115], v130 offset:9216
s_waitcnt lgkmcnt(9)
v_mfma_f32_16x16x32_bf16 v[4:7], v[100:103], v[64:67], v[4:7]
ds_read_b128 v[80:83], v129 offset:0
ds_read_b64_tr_b16 v[116:117], v131 offset:8192
s_waitcnt lgkmcnt(9)
v_mfma_f32_16x16x32_bf16 v[8:11], v[104:107], v[64:67], v[8:11]
ds_read_b64_tr_b16 v[118:119], v131 offset:9216
ds_read_b64_tr_b16 v[120:121], v132 offset:8192
s_waitcnt lgkmcnt(9)
v_mfma_f32_16x16x32_bf16 v[12:15], v[108:111], v[64:67], v[12:15]
ds_read_b64_tr_b16 v[122:123], v132 offset:9216
ds_read_b64_tr_b16 v[124:125], v133 offset:8192
s_waitcnt lgkmcnt(10)
v_mfma_f32_16x16x32_bf16 v[16:19], v[96:99], v[68:71], v[16:19]
ds_read_b64_tr_b16 v[126:127], v133 offset:9216
ds_read_b128 v[84:87], v129 offset:2048
v_mfma_f32_16x16x32_bf16 v[20:23], v[100:103], v[68:71], v[20:23]
ds_read_b128 v[88:91], v129 offset:4096
ds_read_b128 v[92:95], v129 offset:6144
v_mfma_f32_16x16x32_bf16 v[24:27], v[104:107], v[68:71], v[24:27]
s_add_u32 s30, s30, 1
s_cmp_eq_u32 s30, 4
v_mfma_f32_16x16x32_bf16 v[28:31], v[108:111], v[68:71], v[28:31]
s_cselect_b32 s30, 0, s30
s_mov_b32 s38, 32768
s_waitcnt lgkmcnt(13)
v_mfma_f32_16x16x32_bf16 v[32:35], v[96:99], v[72:75], v[32:35]
s_cmov_b32 s38, 4294868992
s_add_u32 s29, s29, 1
v_mfma_f32_16x16x32_bf16 v[36:39], v[100:103], v[72:75], v[36:39]
v_add_u32 v128, s38, v128
v_add_u32 v129, s38, v129
v_mfma_f32_16x16x32_bf16 v[40:43], v[104:107], v[72:75], v[40:43]
v_add_u32 v130, s38, v130
v_add_u32 v131, s38, v131
v_mfma_f32_16x16x32_bf16 v[44:47], v[108:111], v[72:75], v[44:47]
v_add_u32 v132, s38, v132
v_add_u32 v133, s38, v133
s_waitcnt lgkmcnt(12)
v_mfma_f32_16x16x32_bf16 v[48:51], v[96:99], v[76:79], v[48:51]
v_mfma_f32_16x16x32_bf16 v[52:55], v[100:103], v[76:79], v[52:55]
v_mfma_f32_16x16x32_bf16 v[56:59], v[104:107], v[76:79], v[56:59]
v_mfma_f32_16x16x32_bf16 v[60:63], v[108:111], v[76:79], v[60:63]
s_waitcnt lgkmcnt(9)
v_mfma_f32_16x16x32_bf16 v[0:3], v[112:115], v[80:83], v[0:3]
s_waitcnt lgkmcnt(7)
v_mfma_f32_16x16x32_bf16 v[4:7], v[116:119], v[80:83], v[4:7]
s_waitcnt lgkmcnt(5)
v_mfma_f32_16x16x32_bf16 v[8:11], v[120:123], v[80:83], v[8:11]
s_waitcnt lgkmcnt(3)
v_mfma_f32_16x16x32_bf16 v[12:15], v[124:127], v[80:83], v[12:15]
s_waitcnt lgkmcnt(2)
v_mfma_f32_16x16x32_bf16 v[16:19], v[112:115], v[84:87], v[16:19]
s_waitcnt lgkmcnt(0)
s_barrier
ds_read_b64_tr_b16 v[96:97], v130 offset:0
ds_read_b64_tr_b16 v[98:99], v130 offset:1024
v_mfma_f32_16x16x32_bf16 v[20:23], v[116:119], v[84:87], v[20:23]
ds_read_b128 v[64:67], v128 offset:0
ds_read_b64_tr_b16 v[100:101], v131 offset:0
v_mfma_f32_16x16x32_bf16 v[24:27], v[120:123], v[84:87], v[24:27]
ds_read_b64_tr_b16 v[102:103], v131 offset:1024
ds_read_b64_tr_b16 v[104:105], v132 offset:0
v_mfma_f32_16x16x32_bf16 v[28:31], v[124:127], v[84:87], v[28:31]
ds_read_b64_tr_b16 v[106:107], v132 offset:1024
ds_read_b64_tr_b16 v[108:109], v133 offset:0
v_mfma_f32_16x16x32_bf16 v[32:35], v[112:115], v[88:91], v[32:35]
ds_read_b64_tr_b16 v[110:111], v133 offset:1024
ds_read_b128 v[68:71], v128 offset:2048
v_mfma_f32_16x16x32_bf16 v[36:39], v[116:119], v[88:91], v[36:39]
ds_read_b128 v[72:75], v128 offset:4096
ds_read_b128 v[76:79], v128 offset:6144
v_mfma_f32_16x16x32_bf16 v[40:43], v[120:123], v[88:91], v[40:43]
v_mfma_f32_16x16x32_bf16 v[44:47], v[124:127], v[88:91], v[44:47]
v_mfma_f32_16x16x32_bf16 v[48:51], v[112:115], v[92:95], v[48:51]
v_mfma_f32_16x16x32_bf16 v[52:55], v[116:119], v[92:95], v[52:55]
v_mfma_f32_16x16x32_bf16 v[56:59], v[120:123], v[92:95], v[56:59]
v_mfma_f32_16x16x32_bf16 v[60:63], v[124:127], v[92:95], v[60:63]
s_bitcmp1_b64 s[92:93], s29
s_cbranch_scc1 L_h_H_12
L_h_B_13:
s_waitcnt lgkmcnt(9)
v_mfma_f32_16x16x32_bf16 v[0:3], v[96:99], v[64:67], v[0:3]
ds_read_b64_tr_b16 v[112:113], v130 offset:8192
ds_read_b64_tr_b16 v[114:115], v130 offset:9216
s_waitcnt lgkmcnt(9)
v_mfma_f32_16x16x32_bf16 v[4:7], v[100:103], v[64:67], v[4:7]
ds_read_b128 v[80:83], v129 offset:0
ds_read_b64_tr_b16 v[116:117], v131 offset:8192
s_waitcnt lgkmcnt(9)
v_mfma_f32_16x16x32_bf16 v[8:11], v[104:107], v[64:67], v[8:11]
ds_read_b64_tr_b16 v[118:119], v131 offset:9216
ds_read_b64_tr_b16 v[120:121], v132 offset:8192
s_waitcnt lgkmcnt(9)
v_mfma_f32_16x16x32_bf16 v[12:15], v[108:111], v[64:67], v[12:15]
ds_read_b64_tr_b16 v[122:123], v132 offset:9216
ds_read_b64_tr_b16 v[124:125], v133 offset:8192
s_waitcnt lgkmcnt(10)
v_mfma_f32_16x16x32_bf16 v[16:19], v[96:99], v[68:71], v[16:19]
ds_read_b64_tr_b16 v[126:127], v133 offset:9216
ds_read_b128 v[84:87], v129 offset:2048
v_mfma_f32_16x16x32_bf16 v[20:23], v[100:103], v[68:71], v[20:23]
ds_read_b128 v[88:91], v129 offset:4096
ds_read_b128 v[92:95], v129 offset:6144
v_mfma_f32_16x16x32_bf16 v[24:27], v[104:107], v[68:71], v[24:27]
s_add_u32 s30, s30, 1
s_cmp_eq_u32 s30, 4
v_mfma_f32_16x16x32_bf16 v[28:31], v[108:111], v[68:71], v[28:31]
s_cselect_b32 s30, 0, s30
s_mov_b32 s38, 32768
s_waitcnt lgkmcnt(13)
v_mfma_f32_16x16x32_bf16 v[32:35], v[96:99], v[72:75], v[32:35]
s_cmov_b32 s38, 4294868992
s_add_u32 s29, s29, 1
v_mfma_f32_16x16x32_bf16 v[36:39], v[100:103], v[72:75], v[36:39]
v_add_u32 v128, s38, v128
v_add_u32 v129, s38, v129
v_mfma_f32_16x16x32_bf16 v[40:43], v[104:107], v[72:75], v[40:43]
v_add_u32 v130, s38, v130
v_add_u32 v131, s38, v131
v_mfma_f32_16x16x32_bf16 v[44:47], v[108:111], v[72:75], v[44:47]
v_add_u32 v132, s38, v132
v_add_u32 v133, s38, v133
s_waitcnt lgkmcnt(12)
v_mfma_f32_16x16x32_bf16 v[48:51], v[96:99], v[76:79], v[48:51]
v_mfma_f32_16x16x32_bf16 v[52:55], v[100:103], v[76:79], v[52:55]
v_mfma_f32_16x16x32_bf16 v[56:59], v[104:107], v[76:79], v[56:59]
v_mfma_f32_16x16x32_bf16 v[60:63], v[108:111], v[76:79], v[60:63]
s_waitcnt lgkmcnt(9)
v_mfma_f32_16x16x32_bf16 v[0:3], v[112:115], v[80:83], v[0:3]
s_waitcnt lgkmcnt(7)
v_mfma_f32_16x16x32_bf16 v[4:7], v[116:119], v[80:83], v[4:7]
s_waitcnt lgkmcnt(5)
v_mfma_f32_16x16x32_bf16 v[8:11], v[120:123], v[80:83], v[8:11]
s_waitcnt lgkmcnt(3)
v_mfma_f32_16x16x32_bf16 v[12:15], v[124:127], v[80:83], v[12:15]
s_waitcnt lgkmcnt(2)
v_mfma_f32_16x16x32_bf16 v[16:19], v[112:115], v[84:87], v[16:19]
s_waitcnt lgkmcnt(0)
s_barrier
ds_read_b64_tr_b16 v[96:97], v130 offset:0
ds_read_b64_tr_b16 v[98:99], v130 offset:1024
v_mfma_f32_16x16x32_bf16 v[20:23], v[116:119], v[84:87], v[20:23]
ds_read_b128 v[64:67], v128 offset:0
ds_read_b64_tr_b16 v[100:101], v131 offset:0
v_mfma_f32_16x16x32_bf16 v[24:27], v[120:123], v[84:87], v[24:27]
ds_read_b64_tr_b16 v[102:103], v131 offset:1024
ds_read_b64_tr_b16 v[104:105], v132 offset:0
v_mfma_f32_16x16x32_bf16 v[28:31], v[124:127], v[84:87], v[28:31]
ds_read_b64_tr_b16 v[106:107], v132 offset:1024
ds_read_b64_tr_b16 v[108:109], v133 offset:0
v_mfma_f32_16x16x32_bf16 v[32:35], v[112:115], v[88:91], v[32:35]
ds_read_b64_tr_b16 v[110:111], v133 offset:1024
ds_read_b128 v[68:71], v128 offset:2048
v_mfma_f32_16x16x32_bf16 v[36:39], v[116:119], v[88:91], v[36:39]
ds_read_b128 v[72:75], v128 offset:4096
ds_read_b128 v[76:79], v128 offset:6144
v_mfma_f32_16x16x32_bf16 v[40:43], v[120:123], v[88:91], v[40:43]
v_mfma_f32_16x16x32_bf16 v[44:47], v[124:127], v[88:91], v[44:47]
v_mfma_f32_16x16x32_bf16 v[48:51], v[112:115], v[92:95], v[48:51]
v_mfma_f32_16x16x32_bf16 v[52:55], v[116:119], v[92:95], v[52:55]
v_mfma_f32_16x16x32_bf16 v[56:59], v[120:123], v[92:95], v[56:59]
s_cmp_lt_u32 s29, 15
v_mfma_f32_16x16x32_bf16 v[60:63], v[124:127], v[92:95], v[60:63]
s_cbranch_scc1 L_h_mm_9
s_bitcmp1_b64 s[92:93], s29
s_cbranch_scc1 L_h_H_14
L_h_B_15:
s_waitcnt lgkmcnt(9)
v_mfma_f32_16x16x32_bf16 v[0:3], v[96:99], v[64:67], v[0:3]
ds_read_b64_tr_b16 v[112:113], v130 offset:8192
ds_read_b64_tr_b16 v[114:115], v130 offset:9216
s_waitcnt lgkmcnt(9)
v_mfma_f32_16x16x32_bf16 v[4:7], v[100:103], v[64:67], v[4:7]
ds_read_b128 v[80:83], v129 offset:0
ds_read_b64_tr_b16 v[116:117], v131 offset:8192
s_waitcnt lgkmcnt(9)
v_mfma_f32_16x16x32_bf16 v[8:11], v[104:107], v[64:67], v[8:11]
ds_read_b64_tr_b16 v[118:119], v131 offset:9216
ds_read_b64_tr_b16 v[120:121], v132 offset:8192
s_waitcnt lgkmcnt(9)
v_mfma_f32_16x16x32_bf16 v[12:15], v[108:111], v[64:67], v[12:15]
ds_read_b64_tr_b16 v[122:123], v132 offset:9216
ds_read_b64_tr_b16 v[124:125], v133 offset:8192
s_waitcnt lgkmcnt(10)
v_mfma_f32_16x16x32_bf16 v[16:19], v[96:99], v[68:71], v[16:19]
ds_read_b64_tr_b16 v[126:127], v133 offset:9216
ds_read_b128 v[84:87], v129 offset:2048
v_mfma_f32_16x16x32_bf16 v[20:23], v[100:103], v[68:71], v[20:23]
ds_read_b128 v[88:91], v129 offset:4096
ds_read_b128 v[92:95], v129 offset:6144
v_mfma_f32_16x16x32_bf16 v[24:27], v[104:107], v[68:71], v[24:27]
s_add_u32 s30, s30, 1
s_cmp_eq_u32 s30, 4
v_mfma_f32_16x16x32_bf16 v[28:31], v[108:111], v[68:71], v[28:31]
s_cselect_b32 s30, 0, s30
s_mov_b32 s38, 32768
s_waitcnt lgkmcnt(13)
v_mfma_f32_16x16x32_bf16 v[32:35], v[96:99], v[72:75], v[32:35]
s_cmov_b32 s38, 4294868992
s_add_u32 s29, s29, 1
v_mfma_f32_16x16x32_bf16 v[36:39], v[100:103], v[72:75], v[36:39]
v_add_u32 v128, s38, v128
v_add_u32 v129, s38, v129
v_mfma_f32_16x16x32_bf16 v[40:43], v[104:107], v[72:75], v[40:43]
v_add_u32 v130, s38, v130
v_add_u32 v131, s38, v131
v_mfma_f32_16x16x32_bf16 v[44:47], v[108:111], v[72:75], v[44:47]
v_add_u32 v132, s38, v132
v_add_u32 v133, s38, v133
s_waitcnt lgkmcnt(12)
v_mfma_f32_16x16x32_bf16 v[48:51], v[96:99], v[76:79], v[48:51]
v_mfma_f32_16x16x32_bf16 v[52:55], v[100:103], v[76:79], v[52:55]
v_mfma_f32_16x16x32_bf16 v[56:59], v[104:107], v[76:79], v[56:59]
v_mfma_f32_16x16x32_bf16 v[60:63], v[108:111], v[76:79], v[60:63]
s_waitcnt lgkmcnt(9)
v_mfma_f32_16x16x32_bf16 v[0:3], v[112:115], v[80:83], v[0:3]
s_waitcnt lgkmcnt(7)
v_mfma_f32_16x16x32_bf16 v[4:7], v[116:119], v[80:83], v[4:7]
s_waitcnt lgkmcnt(5)
v_mfma_f32_16x16x32_bf16 v[8:11], v[120:123], v[80:83], v[8:11]
s_waitcnt lgkmcnt(3)
v_mfma_f32_16x16x32_bf16 v[12:15], v[124:127], v[80:83], v[12:15]
s_waitcnt lgkmcnt(2)
v_mfma_f32_16x16x32_bf16 v[16:19], v[112:115], v[84:87], v[16:19]
s_waitcnt lgkmcnt(0)
s_barrier
ds_read_b64_tr_b16 v[96:97], v130 offset:0
ds_read_b64_tr_b16 v[98:99], v130 offset:1024
v_mfma_f32_16x16x32_bf16 v[20:23], v[116:119], v[84:87], v[20:23]
ds_read_b128 v[64:67], v128 offset:0
ds_read_b64_tr_b16 v[100:101], v131 offset:0
v_mfma_f32_16x16x32_bf16 v[24:27], v[120:123], v[84:87], v[24:27]
ds_read_b64_tr_b16 v[102:103], v131 offset:1024
ds_read_b64_tr_b16 v[104:105], v132 offset:0
v_mfma_f32_16x16x32_bf16 v[28:31], v[124:127], v[84:87], v[28:31]
ds_read_b64_tr_b16 v[106:107], v132 offset:1024
ds_read_b64_tr_b16 v[108:109], v133 offset:0
v_mfma_f32_16x16x32_bf16 v[32:35], v[112:115], v[88:91], v[32:35]
ds_read_b64_tr_b16 v[110:111], v133 offset:1024
ds_read_b128 v[68:71], v128 offset:2048
v_mfma_f32_16x16x32_bf16 v[36:39], v[116:119], v[88:91], v[36:39]
ds_read_b128 v[72:75], v128 offset:4096
ds_read_b128 v[76:79], v128 offset:6144
v_mfma_f32_16x16x32_bf16 v[40:43], v[120:123], v[88:91], v[40:43]
v_mfma_f32_16x16x32_bf16 v[44:47], v[124:127], v[88:91], v[44:47]
v_mfma_f32_16x16x32_bf16 v[48:51], v[112:115], v[92:95], v[48:51]
v_mfma_f32_16x16x32_bf16 v[52:55], v[116:119], v[92:95], v[52:55]
v_mfma_f32_16x16x32_bf16 v[56:59], v[120:123], v[92:95], v[56:59]
v_mfma_f32_16x16x32_bf16 v[60:63], v[124:127], v[92:95], v[60:63]
s_bitcmp1_b64 s[92:93], s29
s_cbranch_scc1 L_h_H_16
L_h_B_17:
s_waitcnt lgkmcnt(9)
v_mfma_f32_16x16x32_bf16 v[0:3], v[96:99], v[64:67], v[0:3]
ds_read_b64_tr_b16 v[112:113], v130 offset:8192
s_waitcnt lgkmcnt(8)
v_mfma_f32_16x16x32_bf16 v[4:7], v[100:103], v[64:67], v[4:7]
ds_read_b64_tr_b16 v[114:115], v130 offset:9216
s_waitcnt lgkmcnt(7)
v_mfma_f32_16x16x32_bf16 v[8:11], v[104:107], v[64:67], v[8:11]
ds_read_b128 v[80:83], v129 offset:0
s_waitcnt lgkmcnt(6)
v_mfma_f32_16x16x32_bf16 v[12:15], v[108:111], v[64:67], v[12:15]
ds_read_b64_tr_b16 v[116:117], v131 offset:8192
s_waitcnt lgkmcnt(6)
v_mfma_f32_16x16x32_bf16 v[16:19], v[96:99], v[68:71], v[16:19]
ds_read_b64_tr_b16 v[118:119], v131 offset:9216
v_mfma_f32_16x16x32_bf16 v[20:23], v[100:103], v[68:71], v[20:23]
ds_read_b64_tr_b16 v[120:121], v132 offset:8192
v_mfma_f32_16x16x32_bf16 v[24:27], v[104:107], v[68:71], v[24:27]
ds_read_b64_tr_b16 v[122:123], v132 offset:9216
v_mfma_f32_16x16x32_bf16 v[28:31], v[108:111], v[68:71], v[28:31]
ds_read_b64_tr_b16 v[124:125], v133 offset:8192
s_waitcnt lgkmcnt(9)
v_mfma_f32_16x16x32_bf16 v[32:35], v[96:99], v[72:75], v[32:35]
ds_read_b64_tr_b16 v[126:127], v133 offset:9216
v_mfma_f32_16x16x32_bf16 v[36:39], v[100:103], v[72:75], v[36:39]
ds_read_b128 v[84:87], v129 offset:2048
v_mfma_f32_16x16x32_bf16 v[40:43], v[104:107], v[72:75], v[40:43]
ds_read_b128 v[88:91], v129 offset:4096
v_mfma_f32_16x16x32_bf16 v[44:47], v[108:111], v[72:75], v[44:47]
ds_read_b128 v[92:95], v129 offset:6144
s_waitcnt lgkmcnt(12)
v_mfma_f32_16x16x32_bf16 v[48:51], v[96:99], v[76:79], v[48:51]
v_mfma_f32_16x16x32_bf16 v[52:55], v[100:103], v[76:79], v[52:55]
v_mfma_f32_16x16x32_bf16 v[56:59], v[104:107], v[76:79], v[56:59]
v_mfma_f32_16x16x32_bf16 v[60:63], v[108:111], v[76:79], v[60:63]
s_waitcnt lgkmcnt(9)
v_mfma_f32_16x16x32_bf16 v[0:3], v[112:115], v[80:83], v[0:3]
s_waitcnt lgkmcnt(7)
v_mfma_f32_16x16x32_bf16 v[4:7], v[116:119], v[80:83], v[4:7]
s_waitcnt lgkmcnt(5)
v_mfma_f32_16x16x32_bf16 v[8:11], v[120:123], v[80:83], v[8:11]
s_waitcnt lgkmcnt(3)
v_mfma_f32_16x16x32_bf16 v[12:15], v[124:127], v[80:83], v[12:15]
s_waitcnt lgkmcnt(2)
v_mfma_f32_16x16x32_bf16 v[16:19], v[112:115], v[84:87], v[16:19]
s_waitcnt lgkmcnt(0)
s_barrier
v_mfma_f32_16x16x32_bf16 v[20:23], v[116:119], v[84:87], v[20:23]
v_mfma_f32_16x16x32_bf16 v[24:27], v[120:123], v[84:87], v[24:27]
v_mfma_f32_16x16x32_bf16 v[28:31], v[124:127], v[84:87], v[28:31]
v_mfma_f32_16x16x32_bf16 v[32:35], v[112:115], v[88:91], v[32:35]
v_mfma_f32_16x16x32_bf16 v[36:39], v[116:119], v[88:91], v[36:39]
v_mfma_f32_16x16x32_bf16 v[40:43], v[120:123], v[88:91], v[40:43]
v_mfma_f32_16x16x32_bf16 v[44:47], v[124:127], v[88:91], v[44:47]
v_mfma_f32_16x16x32_bf16 v[48:51], v[112:115], v[92:95], v[48:51]
v_mfma_f32_16x16x32_bf16 v[52:55], v[116:119], v[92:95], v[52:55]
v_mfma_f32_16x16x32_bf16 v[56:59], v[120:123], v[92:95], v[56:59]
v_mfma_f32_16x16x32_bf16 v[60:63], v[124:127], v[92:95], v[60:63]
s_lshr_b32 s31, s20, 1
s_and_b32 s32, s20, 1
s_lshl_b32 s33, s31, 10
s_add_u32 s33, s33, 147456
v_and_b32 v136, 15, v254
v_lshl_add_u32 v136, v136, 4, s33
s_lshl_b32 s33, s32, 8
s_add_u32 s33, s33, 149504
v_and_b32 v137, 48, v254
v_add_u32 v137, s33, v137
ds_read_b64 v[64:65], v136 offset:0
ds_read_b64 v[66:67], v136 offset:256
ds_read_b64 v[68:69], v136 offset:512
ds_read_b64 v[70:71], v136 offset:768
ds_read_b128 v[104:107], v137 offset:0
ds_read_b128 v[108:111], v137 offset:64
ds_read_b128 v[112:115], v137 offset:128
ds_read_b128 v[116:119], v137 offset:192
s_lshr_b32 s31, s20, 1
s_and_b32 s32, s20, 1
s_mul_i32 s31, s31, 64
s_add_u32 s31, s31, s21
s_mul_i32 s32, s32, 128
s_add_u32 s32, s32, s22
v_and_b32 v134, 15, v254
v_add_u32 v134, s31, v134
v_mul_u32_u24 v134, 2048, v134
v_add_u32 v134, s32, v134
v_bfe_u32 v138, v254, 5, 1
v_lshl_add_u32 v134, v138, 4, v134
v_bfe_u32 v138, v254, 4, 1
v_lshl_add_u32 v134, v138, 5, v134
s_waitcnt lgkmcnt(0)
v_sub_f32 v148, 0, v65
v_rcp_f32 v149, v64
v_mul_f32 v150, v64, v64
v_mul_f32 v151, 3222493025, v64
v_sub_f32 v152, 0, v67
v_rcp_f32 v153, v66
v_mul_f32 v154, v66, v66
v_mul_f32 v155, 3222493025, v66
v_sub_f32 v156, 0, v69
v_rcp_f32 v157, v68
v_mul_f32 v158, v68, v68
v_mul_f32 v159, 3222493025, v68
v_sub_f32 v160, 0, v71
v_rcp_f32 v161, v70
v_mul_f32 v162, v70, v70
v_mul_f32 v163, 3222493025, v70
v_mul_f32 v150, v150, v64
v_mul_f32 v150, 3184710632, v150
v_mul_f32 v154, v154, v66
v_mul_f32 v154, 3184710632, v154
v_mul_f32 v158, v158, v68
v_mul_f32 v158, 3184710632, v158
v_mul_f32 v162, v162, v70
v_mul_f32 v162, 3184710632, v162
v_pk_fma_f32 v[0:1], v[104:105], v[148:149], v[0:1] op_sel_hi:[1,0,1]
v_pk_fma_f32 v[2:3], v[106:107], v[148:149], v[2:3] op_sel_hi:[1,0,1]
v_pk_fma_f32 v[4:5], v[108:109], v[148:149], v[4:5] op_sel_hi:[1,0,1]
v_pk_fma_f32 v[6:7], v[110:111], v[148:149], v[6:7] op_sel_hi:[1,0,1]
v_pk_mul_f32 v[72:73], v[0:1], v[0:1]
v_pk_mul_f32 v[74:75], v[2:3], v[2:3]
v_pk_mul_f32 v[76:77], v[4:5], v[4:5]
v_pk_mul_f32 v[78:79], v[6:7], v[6:7]
v_pk_fma_f32 v[72:73], v[72:73], v[150:151], v[150:151] op_sel:[0,0,1] op_sel_hi:[1,0,1]
v_pk_fma_f32 v[74:75], v[74:75], v[150:151], v[150:151] op_sel:[0,0,1] op_sel_hi:[1,0,1]
v_pk_fma_f32 v[76:77], v[76:77], v[150:151], v[150:151] op_sel:[0,0,1] op_sel_hi:[1,0,1]
v_pk_fma_f32 v[78:79], v[78:79], v[150:151], v[150:151] op_sel:[0,0,1] op_sel_hi:[1,0,1]
v_pk_mul_f32 v[72:73], v[72:73], v[0:1]
v_pk_mul_f32 v[74:75], v[74:75], v[2:3]
v_pk_mul_f32 v[76:77], v[76:77], v[4:5]
v_pk_mul_f32 v[78:79], v[78:79], v[6:7]
v_exp_f32 v72, v72
v_exp_f32 v73, v73
v_exp_f32 v74, v74
v_exp_f32 v75, v75
v_exp_f32 v76, v76
v_exp_f32 v77, v77
v_exp_f32 v78, v78
v_exp_f32 v79, v79
v_pk_fma_f32 v[72:73], v[72:73], v[148:149], v[148:149] op_sel:[0,1,1] op_sel_hi:[1,1,1]
v_pk_fma_f32 v[74:75], v[74:75], v[148:149], v[148:149] op_sel:[0,1,1] op_sel_hi:[1,1,1]
v_pk_fma_f32 v[76:77], v[76:77], v[148:149], v[148:149] op_sel:[0,1,1] op_sel_hi:[1,1,1]
v_pk_fma_f32 v[78:79], v[78:79], v[148:149], v[148:149] op_sel:[0,1,1] op_sel_hi:[1,1,1]
v_rcp_f32 v72, v72
v_rcp_f32 v73, v73
v_rcp_f32 v74, v74
v_rcp_f32 v75, v75
v_rcp_f32 v76, v76
v_rcp_f32 v77, v77
v_rcp_f32 v78, v78
v_rcp_f32 v79, v79
v_pk_mul_f32 v[0:1], v[0:1], v[72:73]
v_pk_mul_f32 v[2:3], v[2:3], v[74:75]
v_pk_mul_f32 v[4:5], v[4:5], v[76:77]
v_pk_mul_f32 v[6:7], v[6:7], v[78:79]
v_pk_fma_f32 v[8:9], v[112:113], v[148:149], v[8:9] op_sel_hi:[1,0,1]
v_pk_fma_f32 v[10:11], v[114:115], v[148:149], v[10:11] op_sel_hi:[1,0,1]
v_pk_fma_f32 v[12:13], v[116:117], v[148:149], v[12:13] op_sel_hi:[1,0,1]
v_cvt_pk_bf16_f32 v80, v0, v1
v_pk_fma_f32 v[14:15], v[118:119], v[148:149], v[14:15] op_sel_hi:[1,0,1]
v_pk_mul_f32 v[72:73], v[8:9], v[8:9]
v_pk_mul_f32 v[74:75], v[10:11], v[10:11]
v_cvt_pk_bf16_f32 v81, v2, v3
v_pk_mul_f32 v[76:77], v[12:13], v[12:13]
v_pk_mul_f32 v[78:79], v[14:15], v[14:15]
v_pk_fma_f32 v[72:73], v[72:73], v[150:151], v[150:151] op_sel:[0,0,1] op_sel_hi:[1,0,1]
v_cvt_pk_bf16_f32 v82, v4, v5
v_pk_fma_f32 v[74:75], v[74:75], v[150:151], v[150:151] op_sel:[0,0,1] op_sel_hi:[1,0,1]
v_pk_fma_f32 v[76:77], v[76:77], v[150:151], v[150:151] op_sel:[0,0,1] op_sel_hi:[1,0,1]
v_pk_fma_f32 v[78:79], v[78:79], v[150:151], v[150:151] op_sel:[0,0,1] op_sel_hi:[1,0,1]
v_cvt_pk_bf16_f32 v83, v6, v7
v_pk_mul_f32 v[72:73], v[72:73], v[8:9]
v_pk_mul_f32 v[74:75], v[74:75], v[10:11]
v_pk_mul_f32 v[76:77], v[76:77], v[12:13]
s_mov_b32 s34, 4194304
v_pk_mul_f32 v[78:79], v[78:79], v[14:15]
v_exp_f32 v72, v72
v_exp_f32 v73, v73
v_permlane16_swap_b32 v80, v82
v_exp_f32 v74, v74
v_exp_f32 v75, v75
v_exp_f32 v76, v76
v_permlane16_swap_b32 v81, v83
v_exp_f32 v77, v77
v_exp_f32 v78, v78
v_exp_f32 v79, v79
buffer_store_dwordx4 v[80:83], v134, s[16:19], s34 offen offset:0 sc0 sc1
v_pk_fma_f32 v[72:73], v[72:73], v[148:149], v[148:149] op_sel:[0,1,1] op_sel_hi:[1,1,1]
v_pk_fma_f32 v[74:75], v[74:75], v[148:149], v[148:149] op_sel:[0,1,1] op_sel_hi:[1,1,1]
v_pk_fma_f32 v[76:77], v[76:77], v[148:149], v[148:149] op_sel:[0,1,1] op_sel_hi:[1,1,1]
v_pk_fma_f32 v[78:79], v[78:79], v[148:149], v[148:149] op_sel:[0,1,1] op_sel_hi:[1,1,1]
v_rcp_f32 v72, v72
v_rcp_f32 v73, v73
v_rcp_f32 v74, v74
v_rcp_f32 v75, v75
v_rcp_f32 v76, v76
v_rcp_f32 v77, v77
v_rcp_f32 v78, v78
v_rcp_f32 v79, v79
v_pk_mul_f32 v[8:9], v[8:9], v[72:73]
v_pk_mul_f32 v[10:11], v[10:11], v[74:75]
v_pk_mul_f32 v[12:13], v[12:13], v[76:77]
v_pk_mul_f32 v[14:15], v[14:15], v[78:79]
v_pk_fma_f32 v[16:17], v[104:105], v[152:153], v[16:17] op_sel_hi:[1,0,1]
v_pk_fma_f32 v[18:19], v[106:107], v[152:153], v[18:19] op_sel_hi:[1,0,1]
v_pk_fma_f32 v[20:21], v[108:109], v[152:153], v[20:21] op_sel_hi:[1,0,1]
v_cvt_pk_bf16_f32 v84, v8, v9
v_pk_fma_f32 v[22:23], v[110:111], v[152:153], v[22:23] op_sel_hi:[1,0,1]
v_pk_mul_f32 v[72:73], v[16:17], v[16:17]
v_pk_mul_f32 v[74:75], v[18:19], v[18:19]
v_cvt_pk_bf16_f32 v85, v10, v11
v_pk_mul_f32 v[76:77], v[20:21], v[20:21]
v_pk_mul_f32 v[78:79], v[22:23], v[22:23]
v_pk_fma_f32 v[72:73], v[72:73], v[154:155], v[154:155] op_sel:[0,0,1] op_sel_hi:[1,0,1]
v_cvt_pk_bf16_f32 v86, v12, v13
v_pk_fma_f32 v[74:75], v[74:75], v[154:155], v[154:155] op_sel:[0,0,1] op_sel_hi:[1,0,1]
v_pk_fma_f32 v[76:77], v[76:77], v[154:155], v[154:155] op_sel:[0,0,1] op_sel_hi:[1,0,1]
v_pk_fma_f32 v[78:79], v[78:79], v[154:155], v[154:155] op_sel:[0,0,1] op_sel_hi:[1,0,1]
v_cvt_pk_bf16_f32 v87, v14, v15
v_pk_mul_f32 v[72:73], v[72:73], v[16:17]
v_pk_mul_f32 v[74:75], v[74:75], v[18:19]
v_pk_mul_f32 v[76:77], v[76:77], v[20:21]
s_mov_b32 s34, 4194304
v_pk_mul_f32 v[78:79], v[78:79], v[22:23]
v_exp_f32 v72, v72
v_exp_f32 v73, v73
v_permlane16_swap_b32 v84, v86
v_exp_f32 v74, v74
v_exp_f32 v75, v75
v_exp_f32 v76, v76
v_permlane16_swap_b32 v85, v87
v_exp_f32 v77, v77
v_exp_f32 v78, v78
v_exp_f32 v79, v79
buffer_store_dwordx4 v[84:87], v134, s[16:19], s34 offen offset:64 sc0 sc1
v_pk_fma_f32 v[72:73], v[72:73], v[152:153], v[152:153] op_sel:[0,1,1] op_sel_hi:[1,1,1]
v_pk_fma_f32 v[74:75], v[74:75], v[152:153], v[152:153] op_sel:[0,1,1] op_sel_hi:[1,1,1]
v_pk_fma_f32 v[76:77], v[76:77], v[152:153], v[152:153] op_sel:[0,1,1] op_sel_hi:[1,1,1]
v_pk_fma_f32 v[78:79], v[78:79], v[152:153], v[152:153] op_sel:[0,1,1] op_sel_hi:[1,1,1]
v_rcp_f32 v72, v72
v_rcp_f32 v73, v73
v_rcp_f32 v74, v74
v_rcp_f32 v75, v75
v_rcp_f32 v76, v76
v_rcp_f32 v77, v77
v_rcp_f32 v78, v78
v_rcp_f32 v79, v79
v_pk_mul_f32 v[16:17], v[16:17], v[72:73]
v_pk_mul_f32 v[18:19], v[18:19], v[74:75]
v_pk_mul_f32 v[20:21], v[20:21], v[76:77]
v_pk_mul_f32 v[22:23], v[22:23], v[78:79]
v_pk_fma_f32 v[24:25], v[112:113], v[152:153], v[24:25] op_sel_hi:[1,0,1]
v_pk_fma_f32 v[26:27], v[114:115], v[152:153], v[26:27] op_sel_hi:[1,0,1]
v_pk_fma_f32 v[28:29], v[116:117], v[152:153], v[28:29] op_sel_hi:[1,0,1]
v_cvt_pk_bf16_f32 v88, v16, v17
v_pk_fma_f32 v[30:31], v[118:119], v[152:153], v[30:31] op_sel_hi:[1,0,1]
v_pk_mul_f32 v[72:73], v[24:25], v[24:25]
v_pk_mul_f32 v[74:75], v[26:27], v[26:27]
v_cvt_pk_bf16_f32 v89, v18, v19
v_pk_mul_f32 v[76:77], v[28:29], v[28:29]
v_pk_mul_f32 v[78:79], v[30:31], v[30:31]
v_pk_fma_f32 v[72:73], v[72:73], v[154:155], v[154:155] op_sel:[0,0,1] op_sel_hi:[1,0,1]
v_cvt_pk_bf16_f32 v90, v20, v21
v_pk_fma_f32 v[74:75], v[74:75], v[154:155], v[154:155] op_sel:[0,0,1] op_sel_hi:[1,0,1]
v_pk_fma_f32 v[76:77], v[76:77], v[154:155], v[154:155] op_sel:[0,0,1] op_sel_hi:[1,0,1]
v_pk_fma_f32 v[78:79], v[78:79], v[154:155], v[154:155] op_sel:[0,0,1] op_sel_hi:[1,0,1]
v_cvt_pk_bf16_f32 v91, v22, v23
v_pk_mul_f32 v[72:73], v[72:73], v[24:25]
v_pk_mul_f32 v[74:75], v[74:75], v[26:27]
v_pk_mul_f32 v[76:77], v[76:77], v[28:29]
s_mov_b32 s34, 4227072
v_pk_mul_f32 v[78:79], v[78:79], v[30:31]
v_exp_f32 v72, v72
v_exp_f32 v73, v73
v_permlane16_swap_b32 v88, v90
v_exp_f32 v74, v74
v_exp_f32 v75, v75
v_exp_f32 v76, v76
v_permlane16_swap_b32 v89, v91
v_exp_f32 v77, v77
v_exp_f32 v78, v78
v_exp_f32 v79, v79
buffer_store_dwordx4 v[88:91], v134, s[16:19], s34 offen offset:0 sc0 sc1
v_pk_fma_f32 v[72:73], v[72:73], v[152:153], v[152:153] op_sel:[0,1,1] op_sel_hi:[1,1,1]
v_pk_fma_f32 v[74:75], v[74:75], v[152:153], v[152:153] op_sel:[0,1,1] op_sel_hi:[1,1,1]
v_pk_fma_f32 v[76:77], v[76:77], v[152:153], v[152:153] op_sel:[0,1,1] op_sel_hi:[1,1,1]
v_pk_fma_f32 v[78:79], v[78:79], v[152:153], v[152:153] op_sel:[0,1,1] op_sel_hi:[1,1,1]
v_rcp_f32 v72, v72
v_rcp_f32 v73, v73
v_rcp_f32 v74, v74
v_rcp_f32 v75, v75
v_rcp_f32 v76, v76
v_rcp_f32 v77, v77
v_rcp_f32 v78, v78
v_rcp_f32 v79, v79
v_pk_mul_f32 v[24:25], v[24:25], v[72:73]
v_pk_mul_f32 v[26:27], v[26:27], v[74:75]
v_pk_mul_f32 v[28:29], v[28:29], v[76:77]
v_pk_mul_f32 v[30:31], v[30:31], v[78:79]
v_pk_fma_f32 v[32:33], v[104:105], v[156:157], v[32:33] op_sel_hi:[1,0,1]
v_pk_fma_f32 v[34:35], v[106:107], v[156:157], v[34:35] op_sel_hi:[1,0,1]
v_pk_fma_f32 v[36:37], v[108:109], v[156:157], v[36:37] op_sel_hi:[1,0,1]
v_cvt_pk_bf16_f32 v92, v24, v25
v_pk_fma_f32 v[38:39], v[110:111], v[156:157], v[38:39] op_sel_hi:[1,0,1]
v_pk_mul_f32 v[72:73], v[32:33], v[32:33]
v_pk_mul_f32 v[74:75], v[34:35], v[34:35]
v_cvt_pk_bf16_f32 v93, v26, v27
v_pk_mul_f32 v[76:77], v[36:37], v[36:37]
v_pk_mul_f32 v[78:79], v[38:39], v[38:39]
v_pk_fma_f32 v[72:73], v[72:73], v[158:159], v[158:159] op_sel:[0,0,1] op_sel_hi:[1,0,1]
v_cvt_pk_bf16_f32 v94, v28, v29
v_pk_fma_f32 v[74:75], v[74:75], v[158:159], v[158:159] op_sel:[0,0,1] op_sel_hi:[1,0,1]
v_pk_fma_f32 v[76:77], v[76:77], v[158:159], v[158:159] op_sel:[0,0,1] op_sel_hi:[1,0,1]
v_pk_fma_f32 v[78:79], v[78:79], v[158:159], v[158:159] op_sel:[0,0,1] op_sel_hi:[1,0,1]
v_cvt_pk_bf16_f32 v95, v30, v31
v_pk_mul_f32 v[72:73], v[72:73], v[32:33]
v_pk_mul_f32 v[74:75], v[74:75], v[34:35]
v_pk_mul_f32 v[76:77], v[76:77], v[36:37]
s_mov_b32 s34, 4227072
v_pk_mul_f32 v[78:79], v[78:79], v[38:39]
v_exp_f32 v72, v72
v_exp_f32 v73, v73
v_permlane16_swap_b32 v92, v94
v_exp_f32 v74, v74
v_exp_f32 v75, v75
v_exp_f32 v76, v76
v_permlane16_swap_b32 v93, v95
v_exp_f32 v77, v77
v_exp_f32 v78, v78
v_exp_f32 v79, v79
buffer_store_dwordx4 v[92:95], v134, s[16:19], s34 offen offset:64 sc0 sc1
v_pk_fma_f32 v[72:73], v[72:73], v[156:157], v[156:157] op_sel:[0,1,1] op_sel_hi:[1,1,1]
v_pk_fma_f32 v[74:75], v[74:75], v[156:157], v[156:157] op_sel:[0,1,1] op_sel_hi:[1,1,1]
v_pk_fma_f32 v[76:77], v[76:77], v[156:157], v[156:157] op_sel:[0,1,1] op_sel_hi:[1,1,1]
v_pk_fma_f32 v[78:79], v[78:79], v[156:157], v[156:157] op_sel:[0,1,1] op_sel_hi:[1,1,1]
v_rcp_f32 v72, v72
v_rcp_f32 v73, v73
v_rcp_f32 v74, v74
v_rcp_f32 v75, v75
v_rcp_f32 v76, v76
v_rcp_f32 v77, v77
v_rcp_f32 v78, v78
v_rcp_f32 v79, v79
v_pk_mul_f32 v[32:33], v[32:33], v[72:73]
v_pk_mul_f32 v[34:35], v[34:35], v[74:75]
v_pk_mul_f32 v[36:37], v[36:37], v[76:77]
v_pk_mul_f32 v[38:39], v[38:39], v[78:79]
v_pk_fma_f32 v[40:41], v[112:113], v[156:157], v[40:41] op_sel_hi:[1,0,1]
v_pk_fma_f32 v[42:43], v[114:115], v[156:157], v[42:43] op_sel_hi:[1,0,1]
v_pk_fma_f32 v[44:45], v[116:117], v[156:157], v[44:45] op_sel_hi:[1,0,1]
v_cvt_pk_bf16_f32 v80, v32, v33
v_pk_fma_f32 v[46:47], v[118:119], v[156:157], v[46:47] op_sel_hi:[1,0,1]
v_pk_mul_f32 v[72:73], v[40:41], v[40:41]
v_pk_mul_f32 v[74:75], v[42:43], v[42:43]
v_cvt_pk_bf16_f32 v81, v34, v35
v_pk_mul_f32 v[76:77], v[44:45], v[44:45]
v_pk_mul_f32 v[78:79], v[46:47], v[46:47]
v_pk_fma_f32 v[72:73], v[72:73], v[158:159], v[158:159] op_sel:[0,0,1] op_sel_hi:[1,0,1]
v_cvt_pk_bf16_f32 v82, v36, v37
v_pk_fma_f32 v[74:75], v[74:75], v[158:159], v[158:159] op_sel:[0,0,1] op_sel_hi:[1,0,1]
v_pk_fma_f32 v[76:77], v[76:77], v[158:159], v[158:159] op_sel:[0,0,1] op_sel_hi:[1,0,1]
v_pk_fma_f32 v[78:79], v[78:79], v[158:159], v[158:159] op_sel:[0,0,1] op_sel_hi:[1,0,1]
v_cvt_pk_bf16_f32 v83, v38, v39
v_pk_mul_f32 v[72:73], v[72:73], v[40:41]
v_pk_mul_f32 v[74:75], v[74:75], v[42:43]
v_pk_mul_f32 v[76:77], v[76:77], v[44:45]
s_mov_b32 s34, 4259840
v_pk_mul_f32 v[78:79], v[78:79], v[46:47]
v_exp_f32 v72, v72
v_exp_f32 v73, v73
v_permlane16_swap_b32 v80, v82
v_exp_f32 v74, v74
v_exp_f32 v75, v75
v_exp_f32 v76, v76
v_permlane16_swap_b32 v81, v83
v_exp_f32 v77, v77
v_exp_f32 v78, v78
v_exp_f32 v79, v79
buffer_store_dwordx4 v[80:83], v134, s[16:19], s34 offen offset:0 sc0 sc1
v_pk_fma_f32 v[72:73], v[72:73], v[156:157], v[156:157] op_sel:[0,1,1] op_sel_hi:[1,1,1]
v_pk_fma_f32 v[74:75], v[74:75], v[156:157], v[156:157] op_sel:[0,1,1] op_sel_hi:[1,1,1]
v_pk_fma_f32 v[76:77], v[76:77], v[156:157], v[156:157] op_sel:[0,1,1] op_sel_hi:[1,1,1]
v_pk_fma_f32 v[78:79], v[78:79], v[156:157], v[156:157] op_sel:[0,1,1] op_sel_hi:[1,1,1]
v_rcp_f32 v72, v72
v_rcp_f32 v73, v73
v_rcp_f32 v74, v74
v_rcp_f32 v75, v75
v_rcp_f32 v76, v76
v_rcp_f32 v77, v77
v_rcp_f32 v78, v78
v_rcp_f32 v79, v79
v_pk_mul_f32 v[40:41], v[40:41], v[72:73]
v_pk_mul_f32 v[42:43], v[42:43], v[74:75]
v_pk_mul_f32 v[44:45], v[44:45], v[76:77]
v_pk_mul_f32 v[46:47], v[46:47], v[78:79]
v_pk_fma_f32 v[48:49], v[104:105], v[160:161], v[48:49] op_sel_hi:[1,0,1]
v_pk_fma_f32 v[50:51], v[106:107], v[160:161], v[50:51] op_sel_hi:[1,0,1]
v_pk_fma_f32 v[52:53], v[108:109], v[160:161], v[52:53] op_sel_hi:[1,0,1]
v_cvt_pk_bf16_f32 v84, v40, v41
v_pk_fma_f32 v[54:55], v[110:111], v[160:161], v[54:55] op_sel_hi:[1,0,1]
v_pk_mul_f32 v[72:73], v[48:49], v[48:49]
v_pk_mul_f32 v[74:75], v[50:51], v[50:51]
v_cvt_pk_bf16_f32 v85, v42, v43
v_pk_mul_f32 v[76:77], v[52:53], v[52:53]
v_pk_mul_f32 v[78:79], v[54:55], v[54:55]
v_pk_fma_f32 v[72:73], v[72:73], v[162:163], v[162:163] op_sel:[0,0,1] op_sel_hi:[1,0,1]
v_cvt_pk_bf16_f32 v86, v44, v45
v_pk_fma_f32 v[74:75], v[74:75], v[162:163], v[162:163] op_sel:[0,0,1] op_sel_hi:[1,0,1]
v_pk_fma_f32 v[76:77], v[76:77], v[162:163], v[162:163] op_sel:[0,0,1] op_sel_hi:[1,0,1]
v_pk_fma_f32 v[78:79], v[78:79], v[162:163], v[162:163] op_sel:[0,0,1] op_sel_hi:[1,0,1]
v_cvt_pk_bf16_f32 v87, v46, v47
v_pk_mul_f32 v[72:73], v[72:73], v[48:49]
v_pk_mul_f32 v[74:75], v[74:75], v[50:51]
v_pk_mul_f32 v[76:77], v[76:77], v[52:53]
s_mov_b32 s34, 4259840
v_pk_mul_f32 v[78:79], v[78:79], v[54:55]
v_exp_f32 v72, v72
v_exp_f32 v73, v73
v_permlane16_swap_b32 v84, v86
v_exp_f32 v74, v74
v_exp_f32 v75, v75
v_exp_f32 v76, v76
v_permlane16_swap_b32 v85, v87
v_exp_f32 v77, v77
v_exp_f32 v78, v78
v_exp_f32 v79, v79
buffer_store_dwordx4 v[84:87], v134, s[16:19], s34 offen offset:64 sc0 sc1
v_pk_fma_f32 v[72:73], v[72:73], v[160:161], v[160:161] op_sel:[0,1,1] op_sel_hi:[1,1,1]
v_pk_fma_f32 v[74:75], v[74:75], v[160:161], v[160:161] op_sel:[0,1,1] op_sel_hi:[1,1,1]
v_pk_fma_f32 v[76:77], v[76:77], v[160:161], v[160:161] op_sel:[0,1,1] op_sel_hi:[1,1,1]
v_pk_fma_f32 v[78:79], v[78:79], v[160:161], v[160:161] op_sel:[0,1,1] op_sel_hi:[1,1,1]
v_rcp_f32 v72, v72
v_rcp_f32 v73, v73
v_rcp_f32 v74, v74
v_rcp_f32 v75, v75
v_rcp_f32 v76, v76
v_rcp_f32 v77, v77
v_rcp_f32 v78, v78
v_rcp_f32 v79, v79
v_pk_mul_f32 v[48:49], v[48:49], v[72:73]
v_pk_mul_f32 v[50:51], v[50:51], v[74:75]
v_pk_mul_f32 v[52:53], v[52:53], v[76:77]
v_pk_mul_f32 v[54:55], v[54:55], v[78:79]
v_pk_fma_f32 v[56:57], v[112:113], v[160:161], v[56:57] op_sel_hi:[1,0,1]
v_pk_fma_f32 v[58:59], v[114:115], v[160:161], v[58:59] op_sel_hi:[1,0,1]
v_pk_fma_f32 v[60:61], v[116:117], v[160:161], v[60:61] op_sel_hi:[1,0,1]
v_cvt_pk_bf16_f32 v88, v48, v49
v_pk_fma_f32 v[62:63], v[118:119], v[160:161], v[62:63] op_sel_hi:[1,0,1]
v_pk_mul_f32 v[72:73], v[56:57], v[56:57]
v_pk_mul_f32 v[74:75], v[58:59], v[58:59]
v_cvt_pk_bf16_f32 v89, v50, v51
v_pk_mul_f32 v[76:77], v[60:61], v[60:61]
v_pk_mul_f32 v[78:79], v[62:63], v[62:63]
v_pk_fma_f32 v[72:73], v[72:73], v[162:163], v[162:163] op_sel:[0,0,1] op_sel_hi:[1,0,1]
v_cvt_pk_bf16_f32 v90, v52, v53
v_pk_fma_f32 v[74:75], v[74:75], v[162:163], v[162:163] op_sel:[0,0,1] op_sel_hi:[1,0,1]
v_pk_fma_f32 v[76:77], v[76:77], v[162:163], v[162:163] op_sel:[0,0,1] op_sel_hi:[1,0,1]
v_pk_fma_f32 v[78:79], v[78:79], v[162:163], v[162:163] op_sel:[0,0,1] op_sel_hi:[1,0,1]
v_cvt_pk_bf16_f32 v91, v54, v55
v_pk_mul_f32 v[72:73], v[72:73], v[56:57]
v_pk_mul_f32 v[74:75], v[74:75], v[58:59]
v_pk_mul_f32 v[76:77], v[76:77], v[60:61]
s_mov_b32 s34, 4292608
v_pk_mul_f32 v[78:79], v[78:79], v[62:63]
v_exp_f32 v72, v72
v_exp_f32 v73, v73
v_permlane16_swap_b32 v88, v90
v_exp_f32 v74, v74
v_exp_f32 v75, v75
v_exp_f32 v76, v76
v_permlane16_swap_b32 v89, v91
v_exp_f32 v77, v77
v_exp_f32 v78, v78
v_exp_f32 v79, v79
buffer_store_dwordx4 v[88:91], v134, s[16:19], s34 offen offset:0 sc0 sc1
v_pk_fma_f32 v[72:73], v[72:73], v[160:161], v[160:161] op_sel:[0,1,1] op_sel_hi:[1,1,1]
v_pk_fma_f32 v[74:75], v[74:75], v[160:161], v[160:161] op_sel:[0,1,1] op_sel_hi:[1,1,1]
v_pk_fma_f32 v[76:77], v[76:77], v[160:161], v[160:161] op_sel:[0,1,1] op_sel_hi:[1,1,1]
v_pk_fma_f32 v[78:79], v[78:79], v[160:161], v[160:161] op_sel:[0,1,1] op_sel_hi:[1,1,1]
v_rcp_f32 v72, v72
v_rcp_f32 v73, v73
v_rcp_f32 v74, v74
v_rcp_f32 v75, v75
v_rcp_f32 v76, v76
v_rcp_f32 v77, v77
v_rcp_f32 v78, v78
v_rcp_f32 v79, v79
v_pk_mul_f32 v[56:57], v[56:57], v[72:73]
v_pk_mul_f32 v[58:59], v[58:59], v[74:75]
v_pk_mul_f32 v[60:61], v[60:61], v[76:77]
v_pk_mul_f32 v[62:63], v[62:63], v[78:79]
v_cvt_pk_bf16_f32 v92, v56, v57
v_cvt_pk_bf16_f32 v93, v58, v59
v_cvt_pk_bf16_f32 v94, v60, v61
v_cvt_pk_bf16_f32 v95, v62, v63
s_mov_b32 s34, 4292608
s_nop 0
v_permlane16_swap_b32 v92, v94
v_permlane16_swap_b32 v93, v95
buffer_store_dwordx4 v[92:95], v134, s[16:19], s34 offen offset:64 sc0 sc1
s_lshl_b32 s63, s58, 4
s_add_u32 s63, s63, s59
s_lshl_b32 s63, s63, 2
s_add_u32 s63, s63, s20
s_lshl_b32 s63, s63, 4
s_add_u32 s63, s63, 38797312
v_and_b32 v136, 63, v254
s_lshr_b32 s31, s20, 1
s_and_b32 s32, s20, 1
v_and_b32 v137, 15, v136
s_mul_i32 s33, s31, 64
v_add_u32 v137, s33, v137
v_bfe_u32 v138, v137, 1, 3
v_lshrrev_b32 v139, 4, v136
v_xor_b32 v138, v138, v139
v_lshlrev_b32 v138, 4, v138
v_lshl_add_u32 v128, v137, 7, v138
v_xor_b32 v129, 64, v128
v_lshrrev_b32 v137, 4, v136
v_bfe_u32 v138, v136, 2, 2
v_and_b32 v139, 3, v136
v_lshl_add_u32 v140, v137, 3, v138
v_lshlrev_b32 v139, 3, v139
v_and_b32 v137, 3, v140
v_bfe_u32 v138, v140, 3, 1
v_lshl_or_b32 v137, v138, 2, v137
v_lshlrev_b32 v137, 1, v137
v_lshlrev_b32 v137, 4, v137
v_mul_u32_u24 v140, 256, v140
v_add_u32 v140, 16384, v140
s_mul_i32 s33, s32, 128
s_add_u32 s33, s33, 0
v_add_u32 v138, s33, v139
v_xor_b32 v138, v138, v137
v_add_u32 v130, v138, v140
s_mul_i32 s33, s32, 128
s_add_u32 s33, s33, 32
v_add_u32 v138, s33, v139
v_xor_b32 v138, v138, v137
v_add_u32 v131, v138, v140
s_mul_i32 s33, s32, 128
s_add_u32 s33, s33, 64
v_add_u32 v138, s33, v139
v_xor_b32 v138, v138, v137
v_add_u32 v132, v138, v140
s_mul_i32 s33, s32, 128
s_add_u32 s33, s33, 96
v_add_u32 v138, s33, v139
v_xor_b32 v138, v138, v137
v_add_u32 v133, v138, v140
s_waitcnt vmcnt(0)
v_mov_b32 v136, 1
v_mov_b32 v137, 0
s_mov_b64 exec, 1
buffer_store_dword v136, v137, s[16:19], s63 offen sc0 sc1
s_mov_b64 exec, -1
s_lshr_b32 s60, s2, 1
s_lshl_b32 s60, s60, 2
s_add_u32 s60, s60, s20
s_lshl_b32 s60, s60, 1
s_add_u32 s60, s60, 0
s_mul_i32 s61, s60, 1171
s_lshr_b32 s61, s61, 16
s_mul_i32 s62, s61, 56
s_sub_u32 s62, s60, s62
s_mul_i32 s63, s61, 14336
s_lshl_b32 s32, s62, 8
s_add_u32 s63, s63, s32
s_add_u32 s63, s63, 36962304
s_lshl_b32 s61, s61, 6
s_lshl_b32 s62, s62, 7
s_cmp_ge_u32 s60, 896
s_cbranch_scc1 L_h_nocs_23
s_mov_b32 s52, s76
s_mov_b32 s53, s77
s_mov_b32 s54, 7340032
s_mov_b32 s55, 0x20000
v_lshrrev_b32 v0, 3, v254
v_add_u32 v0, s61, v0
v_mul_u32_u24 v0, 7168, v0
v_and_b32 v1, 7, v254
v_lshl_add_u32 v0, v1, 4, v0
v_add_u32 v0, s62, v0
s_mov_b32 s34, 0
buffer_load_dwordx4 v[4:7], v0, s[52:55], s34 offen
s_mov_b32 s34, 57344
buffer_load_dwordx4 v[8:11], v0, s[52:55], s34 offen
s_mov_b32 s34, 114688
buffer_load_dwordx4 v[12:15], v0, s[52:55], s34 offen
s_mov_b32 s34, 172032
buffer_load_dwordx4 v[16:19], v0, s[52:55], s34 offen
s_mov_b32 s34, 229376
buffer_load_dwordx4 v[20:23], v0, s[52:55], s34 offen
s_mov_b32 s34, 286720
buffer_load_dwordx4 v[24:27], v0, s[52:55], s34 offen
s_mov_b32 s34, 344064
buffer_load_dwordx4 v[28:31], v0, s[52:55], s34 offen
s_mov_b32 s34, 401408
buffer_load_dwordx4 v[32:35], v0, s[52:55], s34 offen
s_lshr_b32 s60, s2, 1
s_lshl_b32 s60, s60, 2
s_add_u32 s60, s60, s20
s_lshl_b32 s60, s60, 1
s_add_u32 s60, s60, 1
s_mul_i32 s61, s60, 1171
s_lshr_b32 s61, s61, 16
s_mul_i32 s62, s61, 56
s_sub_u32 s62, s60, s62
s_mul_i32 s63, s61, 14336
s_lshl_b32 s32, s62, 8
s_add_u32 s63, s63, s32
s_add_u32 s63, s63, 36962304
s_lshl_b32 s61, s61, 6
s_lshl_b32 s62, s62, 7
v_lshrrev_b32 v64, 3, v254
v_add_u32 v64, s61, v64
v_mul_u32_u24 v64, 7168, v64
v_and_b32 v65, 7, v254
v_lshl_add_u32 v64, v65, 4, v64
v_add_u32 v64, s62, v64
s_mov_b32 s34, 0
buffer_load_dwordx4 v[68:71], v64, s[52:55], s34 offen
s_mov_b32 s34, 57344
buffer_load_dwordx4 v[72:75], v64, s[52:55], s34 offen
s_mov_b32 s34, 114688
buffer_load_dwordx4 v[76:79], v64, s[52:55], s34 offen
s_mov_b32 s34, 172032
buffer_load_dwordx4 v[80:83], v64, s[52:55], s34 offen
s_mov_b32 s34, 229376
buffer_load_dwordx4 v[84:87], v64, s[52:55], s34 offen
s_mov_b32 s34, 286720
buffer_load_dwordx4 v[88:91], v64, s[52:55], s34 offen
s_mov_b32 s34, 344064
buffer_load_dwordx4 v[92:95], v64, s[52:55], s34 offen
s_mov_b32 s34, 401408
buffer_load_dwordx4 v[96:99], v64, s[52:55], s34 offen
s_lshr_b32 s60, s2, 1
s_lshl_b32 s60, s60, 2
s_add_u32 s60, s60, s20
s_lshl_b32 s60, s60, 1
s_add_u32 s60, s60, 0
s_mul_i32 s61, s60, 1171
s_lshr_b32 s61, s61, 16
s_mul_i32 s62, s61, 56
s_sub_u32 s62, s60, s62
s_mul_i32 s63, s61, 14336
s_lshl_b32 s32, s62, 8
s_add_u32 s63, s63, s32
s_add_u32 s63, s63, 36962304
s_lshl_b32 s61, s61, 6
s_lshl_b32 s62, s62, 7
s_waitcnt vmcnt(8)
v_lshlrev_b32 v48, 16, v4
v_and_b32 v49, 0xffff0000, v4
v_lshlrev_b32 v50, 16, v5
v_and_b32 v51, 0xffff0000, v5
v_lshlrev_b32 v52, 16, v6
v_and_b32 v53, 0xffff0000, v6
v_lshlrev_b32 v54, 16, v7
v_and_b32 v55, 0xffff0000, v7
v_lshlrev_b32 v40, 16, v8
v_and_b32 v41, 0xffff0000, v8
v_lshlrev_b32 v42, 16, v9
v_and_b32 v43, 0xffff0000, v9
v_lshlrev_b32 v44, 16, v10
v_and_b32 v45, 0xffff0000, v10
v_lshlrev_b32 v46, 16, v11
v_and_b32 v47, 0xffff0000, v11
v_pk_add_f32 v[48:49], v[48:49], v[40:41]
v_pk_add_f32 v[50:51], v[50:51], v[42:43]
v_pk_add_f32 v[52:53], v[52:53], v[44:45]
v_pk_add_f32 v[54:55], v[54:55], v[46:47]
v_lshlrev_b32 v40, 16, v12
v_and_b32 v41, 0xffff0000, v12
v_lshlrev_b32 v42, 16, v13
v_and_b32 v43, 0xffff0000, v13
v_lshlrev_b32 v44, 16, v14
v_and_b32 v45, 0xffff0000, v14
v_lshlrev_b32 v46, 16, v15
v_and_b32 v47, 0xffff0000, v15
v_pk_add_f32 v[48:49], v[48:49], v[40:41]
v_pk_add_f32 v[50:51], v[50:51], v[42:43]
v_pk_add_f32 v[52:53], v[52:53], v[44:45]
v_pk_add_f32 v[54:55], v[54:55], v[46:47]
v_lshlrev_b32 v40, 16, v16
v_and_b32 v41, 0xffff0000, v16
v_lshlrev_b32 v42, 16, v17
v_and_b32 v43, 0xffff0000, v17
v_lshlrev_b32 v44, 16, v18
v_and_b32 v45, 0xffff0000, v18
v_lshlrev_b32 v46, 16, v19
v_and_b32 v47, 0xffff0000, v19
v_pk_add_f32 v[48:49], v[48:49], v[40:41]
v_pk_add_f32 v[50:51], v[50:51], v[42:43]
v_pk_add_f32 v[52:53], v[52:53], v[44:45]
v_pk_add_f32 v[54:55], v[54:55], v[46:47]
v_lshlrev_b32 v40, 16, v20
v_and_b32 v41, 0xffff0000, v20
v_lshlrev_b32 v42, 16, v21
v_and_b32 v43, 0xffff0000, v21
v_lshlrev_b32 v44, 16, v22
v_and_b32 v45, 0xffff0000, v22
v_lshlrev_b32 v46, 16, v23
v_and_b32 v47, 0xffff0000, v23
v_pk_add_f32 v[48:49], v[48:49], v[40:41]
v_pk_add_f32 v[50:51], v[50:51], v[42:43]
v_pk_add_f32 v[52:53], v[52:53], v[44:45]
v_pk_add_f32 v[54:55], v[54:55], v[46:47]
v_lshlrev_b32 v40, 16, v24
v_and_b32 v41, 0xffff0000, v24
v_lshlrev_b32 v42, 16, v25
v_and_b32 v43, 0xffff0000, v25
v_lshlrev_b32 v44, 16, v26
v_and_b32 v45, 0xffff0000, v26
v_lshlrev_b32 v46, 16, v27
v_and_b32 v47, 0xffff0000, v27
v_pk_add_f32 v[48:49], v[48:49], v[40:41]
v_pk_add_f32 v[50:51], v[50:51], v[42:43]
v_pk_add_f32 v[52:53], v[52:53], v[44:45]
v_pk_add_f32 v[54:55], v[54:55], v[46:47]
v_lshlrev_b32 v40, 16, v28
v_and_b32 v41, 0xffff0000, v28
v_lshlrev_b32 v42, 16, v29
v_and_b32 v43, 0xffff0000, v29
v_lshlrev_b32 v44, 16, v30
v_and_b32 v45, 0xffff0000, v30
v_lshlrev_b32 v46, 16, v31
v_and_b32 v47, 0xffff0000, v31
v_pk_add_f32 v[48:49], v[48:49], v[40:41]
v_pk_add_f32 v[50:51], v[50:51], v[42:43]
v_pk_add_f32 v[52:53], v[52:53], v[44:45]
v_pk_add_f32 v[54:55], v[54:55], v[46:47]
v_lshlrev_b32 v40, 16, v32
v_and_b32 v41, 0xffff0000, v32
v_lshlrev_b32 v42, 16, v33
v_and_b32 v43, 0xffff0000, v33
v_lshlrev_b32 v44, 16, v34
v_and_b32 v45, 0xffff0000, v34
v_lshlrev_b32 v46, 16, v35
v_and_b32 v47, 0xffff0000, v35
v_pk_add_f32 v[48:49], v[48:49], v[40:41]
v_pk_add_f32 v[50:51], v[50:51], v[42:43]
v_pk_add_f32 v[52:53], v[52:53], v[44:45]
v_pk_add_f32 v[54:55], v[54:55], v[46:47]
v_add_f32_dpp v48, v48, v48 row_ror:8 row_mask:0xf bank_mask:0xf
v_add_f32_dpp v49, v49, v49 row_ror:8 row_mask:0xf bank_mask:0xf
v_add_f32_dpp v50, v50, v50 row_ror:8 row_mask:0xf bank_mask:0xf
v_add_f32_dpp v51, v51, v51 row_ror:8 row_mask:0xf bank_mask:0xf
v_add_f32_dpp v52, v52, v52 row_ror:8 row_mask:0xf bank_mask:0xf
v_add_f32_dpp v53, v53, v53 row_ror:8 row_mask:0xf bank_mask:0xf
v_add_f32_dpp v54, v54, v54 row_ror:8 row_mask:0xf bank_mask:0xf
v_add_f32_dpp v55, v55, v55 row_ror:8 row_mask:0xf bank_mask:0xf
v_mov_b32 v56, v48
v_mov_b32 v57, v49
v_mov_b32 v58, v50
v_mov_b32 v59, v51
v_mov_b32 v60, v52
v_mov_b32 v61, v53
v_mov_b32 v62, v54
v_mov_b32 v63, v55
s_nop 1
v_permlane16_swap_b32 v48, v56
v_permlane16_swap_b32 v49, v57
v_permlane16_swap_b32 v50, v58
v_permlane16_swap_b32 v51, v59
v_permlane16_swap_b32 v52, v60
v_permlane16_swap_b32 v53, v61
v_permlane16_swap_b32 v54, v62
v_permlane16_swap_b32 v55, v63
s_nop 1
v_add_f32 v48, v48, v56
v_add_f32 v49, v49, v57
v_add_f32 v50, v50, v58
v_add_f32 v51, v51, v59
v_add_f32 v52, v52, v60
v_add_f32 v53, v53, v61
v_add_f32 v54, v54, v62
v_add_f32 v55, v55, v63
v_mov_b32 v56, v48
v_mov_b32 v57, v49
v_mov_b32 v58, v50
v_mov_b32 v59, v51
v_mov_b32 v60, v52
v_mov_b32 v61, v53
v_mov_b32 v62, v54
v_mov_b32 v63, v55
s_nop 1
v_permlane32_swap_b32 v48, v56
v_permlane32_swap_b32 v49, v57
v_permlane32_swap_b32 v50, v58
v_permlane32_swap_b32 v51, v59
v_permlane32_swap_b32 v52, v60
v_permlane32_swap_b32 v53, v61
v_permlane32_swap_b32 v54, v62
v_permlane32_swap_b32 v55, v63
s_nop 1
v_add_f32 v48, v48, v56
v_add_f32 v49, v49, v57
v_add_f32 v50, v50, v58
v_add_f32 v51, v51, v59
v_add_f32 v52, v52, v60
v_add_f32 v53, v53, v61
v_add_f32 v54, v54, v62
v_add_f32 v55, v55, v63
v_lshlrev_b32 v0, 5, v254
s_mov_b64 exec, 0xff
buffer_store_dwordx4 v[48:51], v0, s[16:19], s63 offen sc0 sc1
buffer_store_dwordx4 v[52:55], v0, s[16:19], s63 offen offset:16 sc0 sc1
s_mov_b64 exec, -1
s_lshr_b32 s60, s2, 1
s_lshl_b32 s60, s60, 2
s_add_u32 s60, s60, s20
s_lshl_b32 s60, s60, 1
s_add_u32 s60, s60, 1
s_mul_i32 s61, s60, 1171
s_lshr_b32 s61, s61, 16
s_mul_i32 s62, s61, 56
s_sub_u32 s62, s60, s62
s_mul_i32 s63, s61, 14336
s_lshl_b32 s32, s62, 8
s_add_u32 s63, s63, s32
s_add_u32 s63, s63, 36962304
s_lshl_b32 s61, s61, 6
s_lshl_b32 s62, s62, 7
s_waitcnt vmcnt(2)
v_lshlrev_b32 v112, 16, v68
v_and_b32 v113, 0xffff0000, v68
v_lshlrev_b32 v114, 16, v69
v_and_b32 v115, 0xffff0000, v69
v_lshlrev_b32 v116, 16, v70
v_and_b32 v117, 0xffff0000, v70
v_lshlrev_b32 v118, 16, v71
v_and_b32 v119, 0xffff0000, v71
v_lshlrev_b32 v104, 16, v72
v_and_b32 v105, 0xffff0000, v72
v_lshlrev_b32 v106, 16, v73
v_and_b32 v107, 0xffff0000, v73
v_lshlrev_b32 v108, 16, v74
v_and_b32 v109, 0xffff0000, v74
v_lshlrev_b32 v110, 16, v75
v_and_b32 v111, 0xffff0000, v75
v_pk_add_f32 v[112:113], v[112:113], v[104:105]
v_pk_add_f32 v[114:115], v[114:115], v[106:107]
v_pk_add_f32 v[116:117], v[116:117], v[108:109]
v_pk_add_f32 v[118:119], v[118:119], v[110:111]
v_lshlrev_b32 v104, 16, v76
v_and_b32 v105, 0xffff0000, v76
v_lshlrev_b32 v106, 16, v77
v_and_b32 v107, 0xffff0000, v77
v_lshlrev_b32 v108, 16, v78
v_and_b32 v109, 0xffff0000, v78
v_lshlrev_b32 v110, 16, v79
v_and_b32 v111, 0xffff0000, v79
v_pk_add_f32 v[112:113], v[112:113], v[104:105]
v_pk_add_f32 v[114:115], v[114:115], v[106:107]
v_pk_add_f32 v[116:117], v[116:117], v[108:109]
v_pk_add_f32 v[118:119], v[118:119], v[110:111]
v_lshlrev_b32 v104, 16, v80
v_and_b32 v105, 0xffff0000, v80
v_lshlrev_b32 v106, 16, v81
v_and_b32 v107, 0xffff0000, v81
v_lshlrev_b32 v108, 16, v82
v_and_b32 v109, 0xffff0000, v82
v_lshlrev_b32 v110, 16, v83
v_and_b32 v111, 0xffff0000, v83
v_pk_add_f32 v[112:113], v[112:113], v[104:105]
v_pk_add_f32 v[114:115], v[114:115], v[106:107]
v_pk_add_f32 v[116:117], v[116:117], v[108:109]
v_pk_add_f32 v[118:119], v[118:119], v[110:111]
v_lshlrev_b32 v104, 16, v84
v_and_b32 v105, 0xffff0000, v84
v_lshlrev_b32 v106, 16, v85
v_and_b32 v107, 0xffff0000, v85
v_lshlrev_b32 v108, 16, v86
v_and_b32 v109, 0xffff0000, v86
v_lshlrev_b32 v110, 16, v87
v_and_b32 v111, 0xffff0000, v87
v_pk_add_f32 v[112:113], v[112:113], v[104:105]
v_pk_add_f32 v[114:115], v[114:115], v[106:107]
v_pk_add_f32 v[116:117], v[116:117], v[108:109]
v_pk_add_f32 v[118:119], v[118:119], v[110:111]
v_lshlrev_b32 v104, 16, v88
v_and_b32 v105, 0xffff0000, v88
v_lshlrev_b32 v106, 16, v89
v_and_b32 v107, 0xffff0000, v89
v_lshlrev_b32 v108, 16, v90
v_and_b32 v109, 0xffff0000, v90
v_lshlrev_b32 v110, 16, v91
v_and_b32 v111, 0xffff0000, v91
v_pk_add_f32 v[112:113], v[112:113], v[104:105]
v_pk_add_f32 v[114:115], v[114:115], v[106:107]
v_pk_add_f32 v[116:117], v[116:117], v[108:109]
v_pk_add_f32 v[118:119], v[118:119], v[110:111]
v_lshlrev_b32 v104, 16, v92
v_and_b32 v105, 0xffff0000, v92
v_lshlrev_b32 v106, 16, v93
v_and_b32 v107, 0xffff0000, v93
v_lshlrev_b32 v108, 16, v94
v_and_b32 v109, 0xffff0000, v94
v_lshlrev_b32 v110, 16, v95
v_and_b32 v111, 0xffff0000, v95
v_pk_add_f32 v[112:113], v[112:113], v[104:105]
v_pk_add_f32 v[114:115], v[114:115], v[106:107]
v_pk_add_f32 v[116:117], v[116:117], v[108:109]
v_pk_add_f32 v[118:119], v[118:119], v[110:111]
v_lshlrev_b32 v104, 16, v96
v_and_b32 v105, 0xffff0000, v96
v_lshlrev_b32 v106, 16, v97
v_and_b32 v107, 0xffff0000, v97
v_lshlrev_b32 v108, 16, v98
v_and_b32 v109, 0xffff0000, v98
v_lshlrev_b32 v110, 16, v99
v_and_b32 v111, 0xffff0000, v99
v_pk_add_f32 v[112:113], v[112:113], v[104:105]
v_pk_add_f32 v[114:115], v[114:115], v[106:107]
v_pk_add_f32 v[116:117], v[116:117], v[108:109]
v_pk_add_f32 v[118:119], v[118:119], v[110:111]
v_add_f32_dpp v112, v112, v112 row_ror:8 row_mask:0xf bank_mask:0xf
v_add_f32_dpp v113, v113, v113 row_ror:8 row_mask:0xf bank_mask:0xf
v_add_f32_dpp v114, v114, v114 row_ror:8 row_mask:0xf bank_mask:0xf
v_add_f32_dpp v115, v115, v115 row_ror:8 row_mask:0xf bank_mask:0xf
v_add_f32_dpp v116, v116, v116 row_ror:8 row_mask:0xf bank_mask:0xf
v_add_f32_dpp v117, v117, v117 row_ror:8 row_mask:0xf bank_mask:0xf
v_add_f32_dpp v118, v118, v118 row_ror:8 row_mask:0xf bank_mask:0xf
v_add_f32_dpp v119, v119, v119 row_ror:8 row_mask:0xf bank_mask:0xf
v_mov_b32 v120, v112
v_mov_b32 v121, v113
v_mov_b32 v122, v114
v_mov_b32 v123, v115
v_mov_b32 v124, v116
v_mov_b32 v125, v117
v_mov_b32 v126, v118
v_mov_b32 v127, v119
s_nop 1
v_permlane16_swap_b32 v112, v120
v_permlane16_swap_b32 v113, v121
v_permlane16_swap_b32 v114, v122
v_permlane16_swap_b32 v115, v123
v_permlane16_swap_b32 v116, v124
v_permlane16_swap_b32 v117, v125
v_permlane16_swap_b32 v118, v126
v_permlane16_swap_b32 v119, v127
s_nop 1
v_add_f32 v112, v112, v120
v_add_f32 v113, v113, v121
v_add_f32 v114, v114, v122
v_add_f32 v115, v115, v123
v_add_f32 v116, v116, v124
v_add_f32 v117, v117, v125
v_add_f32 v118, v118, v126
v_add_f32 v119, v119, v127
v_mov_b32 v120, v112
v_mov_b32 v121, v113
v_mov_b32 v122, v114
v_mov_b32 v123, v115
v_mov_b32 v124, v116
v_mov_b32 v125, v117
v_mov_b32 v126, v118
v_mov_b32 v127, v119
s_nop 1
v_permlane32_swap_b32 v112, v120
v_permlane32_swap_b32 v113, v121
v_permlane32_swap_b32 v114, v122
v_permlane32_swap_b32 v115, v123
v_permlane32_swap_b32 v116, v124
v_permlane32_swap_b32 v117, v125
v_permlane32_swap_b32 v118, v126
v_permlane32_swap_b32 v119, v127
s_nop 1
v_add_f32 v112, v112, v120
v_add_f32 v113, v113, v121
v_add_f32 v114, v114, v122
v_add_f32 v115, v115, v123
v_add_f32 v116, v116, v124
v_add_f32 v117, v117, v125
v_add_f32 v118, v118, v126
v_add_f32 v119, v119, v127
v_lshlrev_b32 v64, 5, v254
s_mov_b64 exec, 0xff
buffer_store_dwordx4 v[112:115], v64, s[16:19], s63 offen sc0 sc1
buffer_store_dwordx4 v[116:119], v64, s[16:19], s63 offen offset:16 sc0 sc1
s_mov_b64 exec, -1
L_h_nocs_23:
s_nop 1
v_mov_b32 v0, 0
v_mov_b32 v1, 0
v_mov_b32 v2, 0
v_mov_b32 v3, 0
v_mov_b32 v4, 0
v_mov_b32 v5, 0
v_mov_b32 v6, 0
v_mov_b32 v7, 0
v_mov_b32 v8, 0
v_mov_b32 v9, 0
v_mov_b32 v10, 0
v_mov_b32 v11, 0
v_mov_b32 v12, 0
v_mov_b32 v13, 0
v_mov_b32 v14, 0
v_mov_b32 v15, 0
v_mov_b32 v16, 0
v_mov_b32 v17, 0
v_mov_b32 v18, 0
v_mov_b32 v19, 0
v_mov_b32 v20, 0
v_mov_b32 v21, 0
v_mov_b32 v22, 0
v_mov_b32 v23, 0
v_mov_b32 v24, 0
v_mov_b32 v25, 0
v_mov_b32 v26, 0
v_mov_b32 v27, 0
v_mov_b32 v28, 0
v_mov_b32 v29, 0
v_mov_b32 v30, 0
v_mov_b32 v31, 0
v_mov_b32 v32, 0
v_mov_b32 v33, 0
v_mov_b32 v34, 0
v_mov_b32 v35, 0
v_mov_b32 v36, 0
v_mov_b32 v37, 0
v_mov_b32 v38, 0
v_mov_b32 v39, 0
v_mov_b32 v40, 0
v_mov_b32 v41, 0
v_mov_b32 v42, 0
v_mov_b32 v43, 0
v_mov_b32 v44, 0
v_mov_b32 v45, 0
v_mov_b32 v46, 0
v_mov_b32 v47, 0
v_mov_b32 v48, 0
v_mov_b32 v49, 0
v_mov_b32 v50, 0
v_mov_b32 v51, 0
v_mov_b32 v52, 0
v_mov_b32 v53, 0
v_mov_b32 v54, 0
v_mov_b32 v55, 0
v_mov_b32 v56, 0
v_mov_b32 v57, 0
v_mov_b32 v58, 0
v_mov_b32 v59, 0
v_mov_b32 v60, 0
v_mov_b32 v61, 0
v_mov_b32 v62, 0
v_mov_b32 v63, 0
s_mov_b32 s52, s64
s_mov_b32 s53, s65
s_mov_b32 s54, 4194304
s_mov_b32 s55, 0x20000
s_mov_b32 s92, 64
s_mov_b32 s93, 0
s_mov_b32 s30, 0
s_mov_b32 s29, 1
s_barrier
ds_read_b64_tr_b16 v[96:97], v130 offset:0
ds_read_b64_tr_b16 v[98:99], v130 offset:1024
ds_read_b128 v[64:67], v128 offset:0
ds_read_b64_tr_b16 v[100:101], v131 offset:0
ds_read_b64_tr_b16 v[102:103], v131 offset:1024
ds_read_b64_tr_b16 v[104:105], v132 offset:0
ds_read_b64_tr_b16 v[106:107], v132 offset:1024
ds_read_b64_tr_b16 v[108:109], v133 offset:0
ds_read_b64_tr_b16 v[110:111], v133 offset:1024
ds_read_b128 v[68:71], v128 offset:2048
ds_read_b128 v[72:75], v128 offset:4096
ds_read_b128 v[76:79], v128 offset:6144
.p2align 6
L_x1_mm_24:
s_waitcnt lgkmcnt(9)
v_mfma_f32_16x16x32_bf16 v[0:3], v[96:99], v[64:67], v[0:3]
ds_read_b64_tr_b16 v[112:113], v130 offset:8192
ds_read_b64_tr_b16 v[114:115], v130 offset:9216
s_waitcnt lgkmcnt(9)
v_mfma_f32_16x16x32_bf16 v[4:7], v[100:103], v[64:67], v[4:7]
ds_read_b128 v[80:83], v129 offset:0
ds_read_b64_tr_b16 v[116:117], v131 offset:8192
s_waitcnt lgkmcnt(9)
v_mfma_f32_16x16x32_bf16 v[8:11], v[104:107], v[64:67], v[8:11]
ds_read_b64_tr_b16 v[118:119], v131 offset:9216
ds_read_b64_tr_b16 v[120:121], v132 offset:8192
s_waitcnt lgkmcnt(9)
v_mfma_f32_16x16x32_bf16 v[12:15], v[108:111], v[64:67], v[12:15]
ds_read_b64_tr_b16 v[122:123], v132 offset:9216
ds_read_b64_tr_b16 v[124:125], v133 offset:8192
s_waitcnt lgkmcnt(10)
v_mfma_f32_16x16x32_bf16 v[16:19], v[96:99], v[68:71], v[16:19]
ds_read_b64_tr_b16 v[126:127], v133 offset:9216
ds_read_b128 v[84:87], v129 offset:2048
v_mfma_f32_16x16x32_bf16 v[20:23], v[100:103], v[68:71], v[20:23]
ds_read_b128 v[88:91], v129 offset:4096
ds_read_b128 v[92:95], v129 offset:6144
v_mfma_f32_16x16x32_bf16 v[24:27], v[104:107], v[68:71], v[24:27]
s_add_u32 s30, s30, 1
s_cmp_eq_u32 s30, 4
v_mfma_f32_16x16x32_bf16 v[28:31], v[108:111], v[68:71], v[28:31]
s_cselect_b32 s30, 0, s30
s_mov_b32 s38, 32768
s_waitcnt lgkmcnt(13)
v_mfma_f32_16x16x32_bf16 v[32:35], v[96:99], v[72:75], v[32:35]
s_cmov_b32 s38, 4294868992
s_add_u32 s29, s29, 1
v_mfma_f32_16x16x32_bf16 v[36:39], v[100:103], v[72:75], v[36:39]
v_add_u32 v128, s38, v128
v_add_u32 v129, s38, v129
v_mfma_f32_16x16x32_bf16 v[40:43], v[104:107], v[72:75], v[40:43]
v_add_u32 v130, s38, v130
v_add_u32 v131, s38, v131
v_mfma_f32_16x16x32_bf16 v[44:47], v[108:111], v[72:75], v[44:47]
v_add_u32 v132, s38, v132
v_add_u32 v133, s38, v133
s_waitcnt lgkmcnt(12)
v_mfma_f32_16x16x32_bf16 v[48:51], v[96:99], v[76:79], v[48:51]
v_mfma_f32_16x16x32_bf16 v[52:55], v[100:103], v[76:79], v[52:55]
v_mfma_f32_16x16x32_bf16 v[56:59], v[104:107], v[76:79], v[56:59]
v_mfma_f32_16x16x32_bf16 v[60:63], v[108:111], v[76:79], v[60:63]
s_waitcnt lgkmcnt(9)
v_mfma_f32_16x16x32_bf16 v[0:3], v[112:115], v[80:83], v[0:3]
s_waitcnt lgkmcnt(7)
v_mfma_f32_16x16x32_bf16 v[4:7], v[116:119], v[80:83], v[4:7]
s_waitcnt lgkmcnt(5)
v_mfma_f32_16x16x32_bf16 v[8:11], v[120:123], v[80:83], v[8:11]
s_waitcnt lgkmcnt(3)
v_mfma_f32_16x16x32_bf16 v[12:15], v[124:127], v[80:83], v[12:15]
s_waitcnt lgkmcnt(2)
v_mfma_f32_16x16x32_bf16 v[16:19], v[112:115], v[84:87], v[16:19]
s_waitcnt lgkmcnt(0)
s_barrier
ds_read_b64_tr_b16 v[96:97], v130 offset:0
ds_read_b64_tr_b16 v[98:99], v130 offset:1024
v_mfma_f32_16x16x32_bf16 v[20:23], v[116:119], v[84:87], v[20:23]
ds_read_b128 v[64:67], v128 offset:0
ds_read_b64_tr_b16 v[100:101], v131 offset:0
v_mfma_f32_16x16x32_bf16 v[24:27], v[120:123], v[84:87], v[24:27]
ds_read_b64_tr_b16 v[102:103], v131 offset:1024
ds_read_b64_tr_b16 v[104:105], v132 offset:0
v_mfma_f32_16x16x32_bf16 v[28:31], v[124:127], v[84:87], v[28:31]
ds_read_b64_tr_b16 v[106:107], v132 offset:1024
ds_read_b64_tr_b16 v[108:109], v133 offset:0
v_mfma_f32_16x16x32_bf16 v[32:35], v[112:115], v[88:91], v[32:35]
ds_read_b64_tr_b16 v[110:111], v133 offset:1024
ds_read_b128 v[68:71], v128 offset:2048
v_mfma_f32_16x16x32_bf16 v[36:39], v[116:119], v[88:91], v[36:39]
ds_read_b128 v[72:75], v128 offset:4096
ds_read_b128 v[76:79], v128 offset:6144
v_mfma_f32_16x16x32_bf16 v[40:43], v[120:123], v[88:91], v[40:43]
v_mfma_f32_16x16x32_bf16 v[44:47], v[124:127], v[88:91], v[44:47]
v_mfma_f32_16x16x32_bf16 v[48:51], v[112:115], v[92:95], v[48:51]
v_mfma_f32_16x16x32_bf16 v[52:55], v[116:119], v[92:95], v[52:55]
v_mfma_f32_16x16x32_bf16 v[56:59], v[120:123], v[92:95], v[56:59]
v_mfma_f32_16x16x32_bf16 v[60:63], v[124:127], v[92:95], v[60:63]
s_bitcmp1_b64 s[92:93], s29
s_cbranch_scc1 L_x1_H_25
L_x1_B_26:
s_waitcnt lgkmcnt(9)
v_mfma_f32_16x16x32_bf16 v[0:3], v[96:99], v[64:67], v[0:3]
ds_read_b64_tr_b16 v[112:113], v130 offset:8192
ds_read_b64_tr_b16 v[114:115], v130 offset:9216
s_waitcnt lgkmcnt(9)
v_mfma_f32_16x16x32_bf16 v[4:7], v[100:103], v[64:67], v[4:7]
ds_read_b128 v[80:83], v129 offset:0
ds_read_b64_tr_b16 v[116:117], v131 offset:8192
s_waitcnt lgkmcnt(9)
v_mfma_f32_16x16x32_bf16 v[8:11], v[104:107], v[64:67], v[8:11]
ds_read_b64_tr_b16 v[118:119], v131 offset:9216
ds_read_b64_tr_b16 v[120:121], v132 offset:8192
s_waitcnt lgkmcnt(9)
v_mfma_f32_16x16x32_bf16 v[12:15], v[108:111], v[64:67], v[12:15]
ds_read_b64_tr_b16 v[122:123], v132 offset:9216
ds_read_b64_tr_b16 v[124:125], v133 offset:8192
s_waitcnt lgkmcnt(10)
v_mfma_f32_16x16x32_bf16 v[16:19], v[96:99], v[68:71], v[16:19]
ds_read_b64_tr_b16 v[126:127], v133 offset:9216
ds_read_b128 v[84:87], v129 offset:2048
v_mfma_f32_16x16x32_bf16 v[20:23], v[100:103], v[68:71], v[20:23]
ds_read_b128 v[88:91], v129 offset:4096
ds_read_b128 v[92:95], v129 offset:6144
v_mfma_f32_16x16x32_bf16 v[24:27], v[104:107], v[68:71], v[24:27]
s_add_u32 s30, s30, 1
s_cmp_eq_u32 s30, 4
v_mfma_f32_16x16x32_bf16 v[28:31], v[108:111], v[68:71], v[28:31]
s_cselect_b32 s30, 0, s30
s_mov_b32 s38, 32768
s_waitcnt lgkmcnt(13)
v_mfma_f32_16x16x32_bf16 v[32:35], v[96:99], v[72:75], v[32:35]
s_cmov_b32 s38, 4294868992
s_add_u32 s29, s29, 1
v_mfma_f32_16x16x32_bf16 v[36:39], v[100:103], v[72:75], v[36:39]
v_add_u32 v128, s38, v128
v_add_u32 v129, s38, v129
v_mfma_f32_16x16x32_bf16 v[40:43], v[104:107], v[72:75], v[40:43]
v_add_u32 v130, s38, v130
v_add_u32 v131, s38, v131
v_mfma_f32_16x16x32_bf16 v[44:47], v[108:111], v[72:75], v[44:47]
v_add_u32 v132, s38, v132
v_add_u32 v133, s38, v133
s_waitcnt lgkmcnt(12)
v_mfma_f32_16x16x32_bf16 v[48:51], v[96:99], v[76:79], v[48:51]
v_mfma_f32_16x16x32_bf16 v[52:55], v[100:103], v[76:79], v[52:55]
v_mfma_f32_16x16x32_bf16 v[56:59], v[104:107], v[76:79], v[56:59]
v_mfma_f32_16x16x32_bf16 v[60:63], v[108:111], v[76:79], v[60:63]
s_waitcnt lgkmcnt(9)
v_mfma_f32_16x16x32_bf16 v[0:3], v[112:115], v[80:83], v[0:3]
s_waitcnt lgkmcnt(7)
v_mfma_f32_16x16x32_bf16 v[4:7], v[116:119], v[80:83], v[4:7]
s_waitcnt lgkmcnt(5)
v_mfma_f32_16x16x32_bf16 v[8:11], v[120:123], v[80:83], v[8:11]
s_waitcnt lgkmcnt(3)
v_mfma_f32_16x16x32_bf16 v[12:15], v[124:127], v[80:83], v[12:15]
s_waitcnt lgkmcnt(2)
v_mfma_f32_16x16x32_bf16 v[16:19], v[112:115], v[84:87], v[16:19]
s_waitcnt lgkmcnt(0)
s_barrier
ds_read_b64_tr_b16 v[96:97], v130 offset:0
ds_read_b64_tr_b16 v[98:99], v130 offset:1024
v_mfma_f32_16x16x32_bf16 v[20:23], v[116:119], v[84:87], v[20:23]
ds_read_b128 v[64:67], v128 offset:0
ds_read_b64_tr_b16 v[100:101], v131 offset:0
v_mfma_f32_16x16x32_bf16 v[24:27], v[120:123], v[84:87], v[24:27]
ds_read_b64_tr_b16 v[102:103], v131 offset:1024
ds_read_b64_tr_b16 v[104:105], v132 offset:0
v_mfma_f32_16x16x32_bf16 v[28:31], v[124:127], v[84:87], v[28:31]
ds_read_b64_tr_b16 v[106:107], v132 offset:1024
ds_read_b64_tr_b16 v[108:109], v133 offset:0
v_mfma_f32_16x16x32_bf16 v[32:35], v[112:115], v[88:91], v[32:35]
ds_read_b64_tr_b16 v[110:111], v133 offset:1024
ds_read_b128 v[68:71], v128 offset:2048
v_mfma_f32_16x16x32_bf16 v[36:39], v[116:119], v[88:91], v[36:39]
ds_read_b128 v[72:75], v128 offset:4096
ds_read_b128 v[76:79], v128 offset:6144
v_mfma_f32_16x16x32_bf16 v[40:43], v[120:123], v[88:91], v[40:43]
v_mfma_f32_16x16x32_bf16 v[44:47], v[124:127], v[88:91], v[44:47]
v_mfma_f32_16x16x32_bf16 v[48:51], v[112:115], v[92:95], v[48:51]
v_mfma_f32_16x16x32_bf16 v[52:55], v[116:119], v[92:95], v[52:55]
v_mfma_f32_16x16x32_bf16 v[56:59], v[120:123], v[92:95], v[56:59]
s_cmp_lt_u32 s29, 15
v_mfma_f32_16x16x32_bf16 v[60:63], v[124:127], v[92:95], v[60:63]
s_cbranch_scc1 L_x1_mm_24
s_waitcnt lgkmcnt(9)
v_mfma_f32_16x16x32_bf16 v[0:3], v[96:99], v[64:67], v[0:3]
ds_read_b64_tr_b16 v[112:113], v130 offset:8192
ds_read_b64_tr_b16 v[114:115], v130 offset:9216
s_waitcnt lgkmcnt(9)
v_mfma_f32_16x16x32_bf16 v[4:7], v[100:103], v[64:67], v[4:7]
ds_read_b128 v[80:83], v129 offset:0
ds_read_b64_tr_b16 v[116:117], v131 offset:8192
s_waitcnt lgkmcnt(9)
v_mfma_f32_16x16x32_bf16 v[8:11], v[104:107], v[64:67], v[8:11]
ds_read_b64_tr_b16 v[118:119], v131 offset:9216
ds_read_b64_tr_b16 v[120:121], v132 offset:8192
s_waitcnt lgkmcnt(9)
v_mfma_f32_16x16x32_bf16 v[12:15], v[108:111], v[64:67], v[12:15]
ds_read_b64_tr_b16 v[122:123], v132 offset:9216
ds_read_b64_tr_b16 v[124:125], v133 offset:8192
s_waitcnt lgkmcnt(10)
v_mfma_f32_16x16x32_bf16 v[16:19], v[96:99], v[68:71], v[16:19]
ds_read_b64_tr_b16 v[126:127], v133 offset:9216
ds_read_b128 v[84:87], v129 offset:2048
v_mfma_f32_16x16x32_bf16 v[20:23], v[100:103], v[68:71], v[20:23]
ds_read_b128 v[88:91], v129 offset:4096
ds_read_b128 v[92:95], v129 offset:6144
v_mfma_f32_16x16x32_bf16 v[24:27], v[104:107], v[68:71], v[24:27]
s_add_u32 s30, s30, 1
s_cmp_eq_u32 s30, 4
v_mfma_f32_16x16x32_bf16 v[28:31], v[108:111], v[68:71], v[28:31]
s_cselect_b32 s30, 0, s30
s_mov_b32 s38, 32768
s_waitcnt lgkmcnt(13)
v_mfma_f32_16x16x32_bf16 v[32:35], v[96:99], v[72:75], v[32:35]
s_cmov_b32 s38, 4294868992
s_add_u32 s29, s29, 1
v_mfma_f32_16x16x32_bf16 v[36:39], v[100:103], v[72:75], v[36:39]
v_add_u32 v128, s38, v128
v_add_u32 v129, s38, v129
v_mfma_f32_16x16x32_bf16 v[40:43], v[104:107], v[72:75], v[40:43]
v_add_u32 v130, s38, v130
v_add_u32 v131, s38, v131
v_mfma_f32_16x16x32_bf16 v[44:47], v[108:111], v[72:75], v[44:47]
v_add_u32 v132, s38, v132
v_add_u32 v133, s38, v133
s_waitcnt lgkmcnt(12)
v_mfma_f32_16x16x32_bf16 v[48:51], v[96:99], v[76:79], v[48:51]
v_mfma_f32_16x16x32_bf16 v[52:55], v[100:103], v[76:79], v[52:55]
v_mfma_f32_16x16x32_bf16 v[56:59], v[104:107], v[76:79], v[56:59]
v_mfma_f32_16x16x32_bf16 v[60:63], v[108:111], v[76:79], v[60:63]
s_waitcnt lgkmcnt(9)
v_mfma_f32_16x16x32_bf16 v[0:3], v[112:115], v[80:83], v[0:3]
s_waitcnt lgkmcnt(7)
v_mfma_f32_16x16x32_bf16 v[4:7], v[116:119], v[80:83], v[4:7]
s_waitcnt lgkmcnt(5)
v_mfma_f32_16x16x32_bf16 v[8:11], v[120:123], v[80:83], v[8:11]
s_waitcnt lgkmcnt(3)
v_mfma_f32_16x16x32_bf16 v[12:15], v[124:127], v[80:83], v[12:15]
s_waitcnt lgkmcnt(2)
v_mfma_f32_16x16x32_bf16 v[16:19], v[112:115], v[84:87], v[16:19]
s_waitcnt lgkmcnt(0)
s_barrier
ds_read_b64_tr_b16 v[96:97], v130 offset:0
ds_read_b64_tr_b16 v[98:99], v130 offset:1024
v_mfma_f32_16x16x32_bf16 v[20:23], v[116:119], v[84:87], v[20:23]
ds_read_b128 v[64:67], v128 offset:0
ds_read_b64_tr_b16 v[100:101], v131 offset:0
v_mfma_f32_16x16x32_bf16 v[24:27], v[120:123], v[84:87], v[24:27]
ds_read_b64_tr_b16 v[102:103], v131 offset:1024
ds_read_b64_tr_b16 v[104:105], v132 offset:0
v_mfma_f32_16x16x32_bf16 v[28:31], v[124:127], v[84:87], v[28:31]
ds_read_b64_tr_b16 v[106:107], v132 offset:1024
ds_read_b64_tr_b16 v[108:109], v133 offset:0
v_mfma_f32_16x16x32_bf16 v[32:35], v[112:115], v[88:91], v[32:35]
ds_read_b64_tr_b16 v[110:111], v133 offset:1024
ds_read_b128 v[68:71], v128 offset:2048
v_mfma_f32_16x16x32_bf16 v[36:39], v[116:119], v[88:91], v[36:39]
ds_read_b128 v[72:75], v128 offset:4096
ds_read_b128 v[76:79], v128 offset:6144
v_mfma_f32_16x16x32_bf16 v[40:43], v[120:123], v[88:91], v[40:43]
v_mfma_f32_16x16x32_bf16 v[44:47], v[124:127], v[88:91], v[44:47]
v_mfma_f32_16x16x32_bf16 v[48:51], v[112:115], v[92:95], v[48:51]
v_mfma_f32_16x16x32_bf16 v[52:55], v[116:119], v[92:95], v[52:55]
v_mfma_f32_16x16x32_bf16 v[56:59], v[120:123], v[92:95], v[56:59]
v_mfma_f32_16x16x32_bf16 v[60:63], v[124:127], v[92:95], v[60:63]
s_waitcnt lgkmcnt(9)
v_mfma_f32_16x16x32_bf16 v[0:3], v[96:99], v[64:67], v[0:3]
ds_read_b64_tr_b16 v[112:113], v130 offset:8192
s_waitcnt lgkmcnt(8)
v_mfma_f32_16x16x32_bf16 v[4:7], v[100:103], v[64:67], v[4:7]
ds_read_b64_tr_b16 v[114:115], v130 offset:9216
s_waitcnt lgkmcnt(7)
v_mfma_f32_16x16x32_bf16 v[8:11], v[104:107], v[64:67], v[8:11]
ds_read_b128 v[80:83], v129 offset:0
s_waitcnt lgkmcnt(6)
v_mfma_f32_16x16x32_bf16 v[12:15], v[108:111], v[64:67], v[12:15]
ds_read_b64_tr_b16 v[116:117], v131 offset:8192
s_waitcnt lgkmcnt(6)
v_mfma_f32_16x16x32_bf16 v[16:19], v[96:99], v[68:71], v[16:19]
ds_read_b64_tr_b16 v[118:119], v131 offset:9216
v_mfma_f32_16x16x32_bf16 v[20:23], v[100:103], v[68:71], v[20:23]
ds_read_b64_tr_b16 v[120:121], v132 offset:8192
v_mfma_f32_16x16x32_bf16 v[24:27], v[104:107], v[68:71], v[24:27]
ds_read_b64_tr_b16 v[122:123], v132 offset:9216
v_mfma_f32_16x16x32_bf16 v[28:31], v[108:111], v[68:71], v[28:31]
ds_read_b64_tr_b16 v[124:125], v133 offset:8192
s_waitcnt lgkmcnt(9)
v_mfma_f32_16x16x32_bf16 v[32:35], v[96:99], v[72:75], v[32:35]
ds_read_b64_tr_b16 v[126:127], v133 offset:9216
v_mfma_f32_16x16x32_bf16 v[36:39], v[100:103], v[72:75], v[36:39]
ds_read_b128 v[84:87], v129 offset:2048
v_mfma_f32_16x16x32_bf16 v[40:43], v[104:107], v[72:75], v[40:43]
ds_read_b128 v[88:91], v129 offset:4096
v_mfma_f32_16x16x32_bf16 v[44:47], v[108:111], v[72:75], v[44:47]
ds_read_b128 v[92:95], v129 offset:6144
s_waitcnt lgkmcnt(12)
v_mfma_f32_16x16x32_bf16 v[48:51], v[96:99], v[76:79], v[48:51]
v_mfma_f32_16x16x32_bf16 v[52:55], v[100:103], v[76:79], v[52:55]
v_mfma_f32_16x16x32_bf16 v[56:59], v[104:107], v[76:79], v[56:59]
v_mfma_f32_16x16x32_bf16 v[60:63], v[108:111], v[76:79], v[60:63]
s_waitcnt lgkmcnt(9)
v_mfma_f32_16x16x32_bf16 v[0:3], v[112:115], v[80:83], v[0:3]
s_waitcnt lgkmcnt(7)
v_mfma_f32_16x16x32_bf16 v[4:7], v[116:119], v[80:83], v[4:7]
s_waitcnt lgkmcnt(5)
v_mfma_f32_16x16x32_bf16 v[8:11], v[120:123], v[80:83], v[8:11]
s_waitcnt lgkmcnt(3)
v_mfma_f32_16x16x32_bf16 v[12:15], v[124:127], v[80:83], v[12:15]
s_waitcnt lgkmcnt(2)
v_mfma_f32_16x16x32_bf16 v[16:19], v[112:115], v[84:87], v[16:19]
s_waitcnt lgkmcnt(0)
s_barrier
v_mfma_f32_16x16x32_bf16 v[20:23], v[116:119], v[84:87], v[20:23]
v_mfma_f32_16x16x32_bf16 v[24:27], v[120:123], v[84:87], v[24:27]
v_mfma_f32_16x16x32_bf16 v[28:31], v[124:127], v[84:87], v[28:31]
v_mfma_f32_16x16x32_bf16 v[32:35], v[112:115], v[88:91], v[32:35]
v_mfma_f32_16x16x32_bf16 v[36:39], v[116:119], v[88:91], v[36:39]
v_mfma_f32_16x16x32_bf16 v[40:43], v[120:123], v[88:91], v[40:43]
v_mfma_f32_16x16x32_bf16 v[44:47], v[124:127], v[88:91], v[44:47]
v_mfma_f32_16x16x32_bf16 v[48:51], v[112:115], v[92:95], v[48:51]
v_mfma_f32_16x16x32_bf16 v[52:55], v[116:119], v[92:95], v[52:55]
v_mfma_f32_16x16x32_bf16 v[56:59], v[120:123], v[92:95], v[56:59]
v_mfma_f32_16x16x32_bf16 v[60:63], v[124:127], v[92:95], v[60:63]
s_waitcnt vmcnt(0)
s_nop 4
v_permlane16_swap_b32 v164, v166
v_permlane16_swap_b32 v165, v167
s_nop 0
v_lshlrev_b32 v64, 16, v164
v_and_b32 v65, 0xffff0000, v164
v_lshlrev_b32 v66, 16, v165
v_and_b32 v67, 0xffff0000, v165
v_lshlrev_b32 v68, 16, v166
v_and_b32 v69, 0xffff0000, v166
v_lshlrev_b32 v70, 16, v167
v_and_b32 v71, 0xffff0000, v167
v_pk_add_f32 v[0:1], v[0:1], v[64:65]
v_pk_add_f32 v[2:3], v[2:3], v[66:67]
v_pk_add_f32 v[4:5], v[4:5], v[68:69]
v_pk_add_f32 v[6:7], v[6:7], v[70:71]
v_cvt_pk_bf16_f32 v80, v0, v1
v_cvt_pk_bf16_f32 v81, v2, v3
v_cvt_pk_bf16_f32 v82, v4, v5
v_cvt_pk_bf16_f32 v83, v6, v7
s_mov_b32 s34, 12582912
s_nop 0
v_permlane16_swap_b32 v80, v82
v_permlane16_swap_b32 v81, v83
buffer_store_dwordx4 v[80:83], v134, s[16:19], s34 offen offset:0 sc0 sc1
v_permlane16_swap_b32 v168, v170
v_permlane16_swap_b32 v169, v171
s_nop 0
v_lshlrev_b32 v64, 16, v168
v_and_b32 v65, 0xffff0000, v168
v_lshlrev_b32 v66, 16, v169
v_and_b32 v67, 0xffff0000, v169
v_lshlrev_b32 v68, 16, v170
v_and_b32 v69, 0xffff0000, v170
v_lshlrev_b32 v70, 16, v171
v_and_b32 v71, 0xffff0000, v171
v_pk_add_f32 v[8:9], v[8:9], v[64:65]
v_pk_add_f32 v[10:11], v[10:11], v[66:67]
v_pk_add_f32 v[12:13], v[12:13], v[68:69]
v_pk_add_f32 v[14:15], v[14:15], v[70:71]
v_cvt_pk_bf16_f32 v84, v8, v9
v_cvt_pk_bf16_f32 v85, v10, v11
v_cvt_pk_bf16_f32 v86, v12, v13
v_cvt_pk_bf16_f32 v87, v14, v15
s_mov_b32 s34, 12582912
s_nop 0
v_permlane16_swap_b32 v84, v86
v_permlane16_swap_b32 v85, v87
buffer_store_dwordx4 v[84:87], v134, s[16:19], s34 offen offset:64 sc0 sc1
v_permlane16_swap_b32 v172, v174
v_permlane16_swap_b32 v173, v175
s_nop 0
v_lshlrev_b32 v64, 16, v172
v_and_b32 v65, 0xffff0000, v172
v_lshlrev_b32 v66, 16, v173
v_and_b32 v67, 0xffff0000, v173
v_lshlrev_b32 v68, 16, v174
v_and_b32 v69, 0xffff0000, v174
v_lshlrev_b32 v70, 16, v175
v_and_b32 v71, 0xffff0000, v175
v_pk_add_f32 v[16:17], v[16:17], v[64:65]
v_pk_add_f32 v[18:19], v[18:19], v[66:67]
v_pk_add_f32 v[20:21], v[20:21], v[68:69]
v_pk_add_f32 v[22:23], v[22:23], v[70:71]
v_cvt_pk_bf16_f32 v88, v16, v17
v_cvt_pk_bf16_f32 v89, v18, v19
v_cvt_pk_bf16_f32 v90, v20, v21
v_cvt_pk_bf16_f32 v91, v22, v23
s_mov_b32 s34, 12615680
s_nop 0
v_permlane16_swap_b32 v88, v90
v_permlane16_swap_b32 v89, v91
buffer_store_dwordx4 v[88:91], v134, s[16:19], s34 offen offset:0 sc0 sc1
v_permlane16_swap_b32 v176, v178
v_permlane16_swap_b32 v177, v179
s_nop 0
v_lshlrev_b32 v64, 16, v176
v_and_b32 v65, 0xffff0000, v176
v_lshlrev_b32 v66, 16, v177
v_and_b32 v67, 0xffff0000, v177
v_lshlrev_b32 v68, 16, v178
v_and_b32 v69, 0xffff0000, v178
v_lshlrev_b32 v70, 16, v179
v_and_b32 v71, 0xffff0000, v179
v_pk_add_f32 v[24:25], v[24:25], v[64:65]
v_pk_add_f32 v[26:27], v[26:27], v[66:67]
v_pk_add_f32 v[28:29], v[28:29], v[68:69]
v_pk_add_f32 v[30:31], v[30:31], v[70:71]
v_cvt_pk_bf16_f32 v92, v24, v25
v_cvt_pk_bf16_f32 v93, v26, v27
v_cvt_pk_bf16_f32 v94, v28, v29
v_cvt_pk_bf16_f32 v95, v30, v31
s_mov_b32 s34, 12615680
s_nop 0
v_permlane16_swap_b32 v92, v94
v_permlane16_swap_b32 v93, v95
buffer_store_dwordx4 v[92:95], v134, s[16:19], s34 offen offset:64 sc0 sc1
v_permlane16_swap_b32 v180, v182
v_permlane16_swap_b32 v181, v183
s_nop 0
v_lshlrev_b32 v64, 16, v180
v_and_b32 v65, 0xffff0000, v180
v_lshlrev_b32 v66, 16, v181
v_and_b32 v67, 0xffff0000, v181
v_lshlrev_b32 v68, 16, v182
v_and_b32 v69, 0xffff0000, v182
v_lshlrev_b32 v70, 16, v183
v_and_b32 v71, 0xffff0000, v183
v_pk_add_f32 v[32:33], v[32:33], v[64:65]
v_pk_add_f32 v[34:35], v[34:35], v[66:67]
v_pk_add_f32 v[36:37], v[36:37], v[68:69]
v_pk_add_f32 v[38:39], v[38:39], v[70:71]
v_cvt_pk_bf16_f32 v80, v32, v33
v_cvt_pk_bf16_f32 v81, v34, v35
v_cvt_pk_bf16_f32 v82, v36, v37
v_cvt_pk_bf16_f32 v83, v38, v39
s_mov_b32 s34, 12648448
s_nop 0
v_permlane16_swap_b32 v80, v82
v_permlane16_swap_b32 v81, v83
buffer_store_dwordx4 v[80:83], v134, s[16:19], s34 offen offset:0 sc0 sc1
v_permlane16_swap_b32 v184, v186
v_permlane16_swap_b32 v185, v187
s_nop 0
v_lshlrev_b32 v64, 16, v184
v_and_b32 v65, 0xffff0000, v184
v_lshlrev_b32 v66, 16, v185
v_and_b32 v67, 0xffff0000, v185
v_lshlrev_b32 v68, 16, v186
v_and_b32 v69, 0xffff0000, v186
v_lshlrev_b32 v70, 16, v187
v_and_b32 v71, 0xffff0000, v187
v_pk_add_f32 v[40:41], v[40:41], v[64:65]
v_pk_add_f32 v[42:43], v[42:43], v[66:67]
v_pk_add_f32 v[44:45], v[44:45], v[68:69]
v_pk_add_f32 v[46:47], v[46:47], v[70:71]
v_cvt_pk_bf16_f32 v84, v40, v41
v_cvt_pk_bf16_f32 v85, v42, v43
v_cvt_pk_bf16_f32 v86, v44, v45
v_cvt_pk_bf16_f32 v87, v46, v47
s_mov_b32 s34, 12648448
s_nop 0
v_permlane16_swap_b32 v84, v86
v_permlane16_swap_b32 v85, v87
buffer_store_dwordx4 v[84:87], v134, s[16:19], s34 offen offset:64 sc0 sc1
v_permlane16_swap_b32 v188, v190
v_permlane16_swap_b32 v189, v191
s_nop 0
v_lshlrev_b32 v64, 16, v188
v_and_b32 v65, 0xffff0000, v188
v_lshlrev_b32 v66, 16, v189
v_and_b32 v67, 0xffff0000, v189
v_lshlrev_b32 v68, 16, v190
v_and_b32 v69, 0xffff0000, v190
v_lshlrev_b32 v70, 16, v191
v_and_b32 v71, 0xffff0000, v191
v_pk_add_f32 v[48:49], v[48:49], v[64:65]
v_pk_add_f32 v[50:51], v[50:51], v[66:67]
v_pk_add_f32 v[52:53], v[52:53], v[68:69]
v_pk_add_f32 v[54:55], v[54:55], v[70:71]
v_cvt_pk_bf16_f32 v88, v48, v49
v_cvt_pk_bf16_f32 v89, v50, v51
v_cvt_pk_bf16_f32 v90, v52, v53
v_cvt_pk_bf16_f32 v91, v54, v55
s_mov_b32 s34, 12681216
s_nop 0
v_permlane16_swap_b32 v88, v90
v_permlane16_swap_b32 v89, v91
buffer_store_dwordx4 v[88:91], v134, s[16:19], s34 offen offset:0 sc0 sc1
v_permlane16_swap_b32 v192, v194
v_permlane16_swap_b32 v193, v195
s_nop 0
v_lshlrev_b32 v64, 16, v192
v_and_b32 v65, 0xffff0000, v192
v_lshlrev_b32 v66, 16, v193
v_and_b32 v67, 0xffff0000, v193
v_lshlrev_b32 v68, 16, v194
v_and_b32 v69, 0xffff0000, v194
v_lshlrev_b32 v70, 16, v195
v_and_b32 v71, 0xffff0000, v195
v_pk_add_f32 v[56:57], v[56:57], v[64:65]
v_pk_add_f32 v[58:59], v[58:59], v[66:67]
v_pk_add_f32 v[60:61], v[60:61], v[68:69]
v_pk_add_f32 v[62:63], v[62:63], v[70:71]
v_cvt_pk_bf16_f32 v92, v56, v57
v_cvt_pk_bf16_f32 v93, v58, v59
v_cvt_pk_bf16_f32 v94, v60, v61
v_cvt_pk_bf16_f32 v95, v62, v63
s_mov_b32 s34, 12681216
s_nop 0
v_permlane16_swap_b32 v92, v94
v_permlane16_swap_b32 v93, v95
buffer_store_dwordx4 v[92:95], v134, s[16:19], s34 offen offset:64 sc0 sc1
v_pk_add_f32 v[72:73], v[0:1], v[2:3]
v_pk_add_f32 v[72:73], v[72:73], v[4:5]
v_pk_add_f32 v[72:73], v[72:73], v[6:7]
v_pk_add_f32 v[72:73], v[72:73], v[8:9]
v_pk_add_f32 v[72:73], v[72:73], v[10:11]
v_pk_add_f32 v[72:73], v[72:73], v[12:13]
v_pk_add_f32 v[72:73], v[72:73], v[14:15]
v_add_f32 v96, v72, v73
v_pk_add_f32 v[72:73], v[16:17], v[18:19]
v_pk_add_f32 v[72:73], v[72:73], v[20:21]
v_pk_add_f32 v[72:73], v[72:73], v[22:23]
v_pk_add_f32 v[72:73], v[72:73], v[24:25]
v_pk_add_f32 v[72:73], v[72:73], v[26:27]
v_pk_add_f32 v[72:73], v[72:73], v[28:29]
v_pk_add_f32 v[72:73], v[72:73], v[30:31]
v_add_f32 v97, v72, v73
v_pk_add_f32 v[72:73], v[32:33], v[34:35]
v_pk_add_f32 v[72:73], v[72:73], v[36:37]
v_pk_add_f32 v[72:73], v[72:73], v[38:39]
v_pk_add_f32 v[72:73], v[72:73], v[40:41]
v_pk_add_f32 v[72:73], v[72:73], v[42:43]
v_pk_add_f32 v[72:73], v[72:73], v[44:45]
v_pk_add_f32 v[72:73], v[72:73], v[46:47]
v_add_f32 v98, v72, v73
v_pk_add_f32 v[72:73], v[48:49], v[50:51]
v_pk_add_f32 v[72:73], v[72:73], v[52:53]
v_pk_add_f32 v[72:73], v[72:73], v[54:55]
v_pk_add_f32 v[72:73], v[72:73], v[56:57]
v_pk_add_f32 v[72:73], v[72:73], v[58:59]
v_pk_add_f32 v[72:73], v[72:73], v[60:61]
v_pk_add_f32 v[72:73], v[72:73], v[62:63]
v_add_f32 v99, v72, v73
v_mov_b32 v104, v96
v_mov_b32 v105, v97
v_mov_b32 v106, v98
v_mov_b32 v107, v99
v_permlane16_swap_b32 v96, v104
v_permlane16_swap_b32 v97, v105
v_permlane16_swap_b32 v98, v106
v_permlane16_swap_b32 v99, v107
v_add_f32 v96, v96, v104
v_add_f32 v97, v97, v105
v_add_f32 v98, v98, v106
v_add_f32 v99, v99, v107
v_mov_b32 v104, v96
v_mov_b32 v105, v97
v_mov_b32 v106, v98
v_mov_b32 v107, v99
v_permlane32_swap_b32 v96, v104
v_permlane32_swap_b32 v97, v105
v_permlane32_swap_b32 v98, v106
v_permlane32_swap_b32 v99, v107
v_add_f32 v96, v96, v104
v_add_f32 v97, v97, v105
v_add_f32 v98, v98, v106
v_add_f32 v99, v99, v107
v_mul_f32 v72, 1015021568, v96
v_pk_add_f32 v[0:1], v[0:1], v[72:73] op_sel_hi:[1,0] neg_lo:[0,1] neg_hi:[0,1]
v_pk_add_f32 v[2:3], v[2:3], v[72:73] op_sel_hi:[1,0] neg_lo:[0,1] neg_hi:[0,1]
v_pk_add_f32 v[4:5], v[4:5], v[72:73] op_sel_hi:[1,0] neg_lo:[0,1] neg_hi:[0,1]
v_pk_add_f32 v[6:7], v[6:7], v[72:73] op_sel_hi:[1,0] neg_lo:[0,1] neg_hi:[0,1]
v_pk_add_f32 v[8:9], v[8:9], v[72:73] op_sel_hi:[1,0] neg_lo:[0,1] neg_hi:[0,1]
v_pk_add_f32 v[10:11], v[10:11], v[72:73] op_sel_hi:[1,0] neg_lo:[0,1] neg_hi:[0,1]
v_pk_add_f32 v[12:13], v[12:13], v[72:73] op_sel_hi:[1,0] neg_lo:[0,1] neg_hi:[0,1]
v_pk_add_f32 v[14:15], v[14:15], v[72:73] op_sel_hi:[1,0] neg_lo:[0,1] neg_hi:[0,1]
v_pk_mul_f32 v[74:75], v[0:1], v[0:1]
v_pk_fma_f32 v[74:75], v[2:3], v[2:3], v[74:75]
v_pk_fma_f32 v[74:75], v[4:5], v[4:5], v[74:75]
v_pk_fma_f32 v[74:75], v[6:7], v[6:7], v[74:75]
v_pk_fma_f32 v[74:75], v[8:9], v[8:9], v[74:75]
v_pk_fma_f32 v[74:75], v[10:11], v[10:11], v[74:75]
v_pk_fma_f32 v[74:75], v[12:13], v[12:13], v[74:75]
v_pk_fma_f32 v[74:75], v[14:15], v[14:15], v[74:75]
v_add_f32 v100, v74, v75
v_mul_f32 v72, 1015021568, v97
v_pk_add_f32 v[16:17], v[16:17], v[72:73] op_sel_hi:[1,0] neg_lo:[0,1] neg_hi:[0,1]
v_pk_add_f32 v[18:19], v[18:19], v[72:73] op_sel_hi:[1,0] neg_lo:[0,1] neg_hi:[0,1]
v_pk_add_f32 v[20:21], v[20:21], v[72:73] op_sel_hi:[1,0] neg_lo:[0,1] neg_hi:[0,1]
v_pk_add_f32 v[22:23], v[22:23], v[72:73] op_sel_hi:[1,0] neg_lo:[0,1] neg_hi:[0,1]
v_pk_add_f32 v[24:25], v[24:25], v[72:73] op_sel_hi:[1,0] neg_lo:[0,1] neg_hi:[0,1]
v_pk_add_f32 v[26:27], v[26:27], v[72:73] op_sel_hi:[1,0] neg_lo:[0,1] neg_hi:[0,1]
v_pk_add_f32 v[28:29], v[28:29], v[72:73] op_sel_hi:[1,0] neg_lo:[0,1] neg_hi:[0,1]
v_pk_add_f32 v[30:31], v[30:31], v[72:73] op_sel_hi:[1,0] neg_lo:[0,1] neg_hi:[0,1]
v_pk_mul_f32 v[74:75], v[16:17], v[16:17]
v_pk_fma_f32 v[74:75], v[18:19], v[18:19], v[74:75]
v_pk_fma_f32 v[74:75], v[20:21], v[20:21], v[74:75]
v_pk_fma_f32 v[74:75], v[22:23], v[22:23], v[74:75]
v_pk_fma_f32 v[74:75], v[24:25], v[24:25], v[74:75]
v_pk_fma_f32 v[74:75], v[26:27], v[26:27], v[74:75]
v_pk_fma_f32 v[74:75], v[28:29], v[28:29], v[74:75]
v_pk_fma_f32 v[74:75], v[30:31], v[30:31], v[74:75]
v_add_f32 v101, v74, v75
v_mul_f32 v72, 1015021568, v98
v_pk_add_f32 v[32:33], v[32:33], v[72:73] op_sel_hi:[1,0] neg_lo:[0,1] neg_hi:[0,1]
v_pk_add_f32 v[34:35], v[34:35], v[72:73] op_sel_hi:[1,0] neg_lo:[0,1] neg_hi:[0,1]
v_pk_add_f32 v[36:37], v[36:37], v[72:73] op_sel_hi:[1,0] neg_lo:[0,1] neg_hi:[0,1]
v_pk_add_f32 v[38:39], v[38:39], v[72:73] op_sel_hi:[1,0] neg_lo:[0,1] neg_hi:[0,1]
v_pk_add_f32 v[40:41], v[40:41], v[72:73] op_sel_hi:[1,0] neg_lo:[0,1] neg_hi:[0,1]
v_pk_add_f32 v[42:43], v[42:43], v[72:73] op_sel_hi:[1,0] neg_lo:[0,1] neg_hi:[0,1]
v_pk_add_f32 v[44:45], v[44:45], v[72:73] op_sel_hi:[1,0] neg_lo:[0,1] neg_hi:[0,1]
v_pk_add_f32 v[46:47], v[46:47], v[72:73] op_sel_hi:[1,0] neg_lo:[0,1] neg_hi:[0,1]
v_pk_mul_f32 v[74:75], v[32:33], v[32:33]
v_pk_fma_f32 v[74:75], v[34:35], v[34:35], v[74:75]
v_pk_fma_f32 v[74:75], v[36:37], v[36:37], v[74:75]
v_pk_fma_f32 v[74:75], v[38:39], v[38:39], v[74:75]
v_pk_fma_f32 v[74:75], v[40:41], v[40:41], v[74:75]
v_pk_fma_f32 v[74:75], v[42:43], v[42:43], v[74:75]
v_pk_fma_f32 v[74:75], v[44:45], v[44:45], v[74:75]
v_pk_fma_f32 v[74:75], v[46:47], v[46:47], v[74:75]
v_add_f32 v102, v74, v75
v_mul_f32 v72, 1015021568, v99
v_pk_add_f32 v[48:49], v[48:49], v[72:73] op_sel_hi:[1,0] neg_lo:[0,1] neg_hi:[0,1]
v_pk_add_f32 v[50:51], v[50:51], v[72:73] op_sel_hi:[1,0] neg_lo:[0,1] neg_hi:[0,1]
v_pk_add_f32 v[52:53], v[52:53], v[72:73] op_sel_hi:[1,0] neg_lo:[0,1] neg_hi:[0,1]
v_pk_add_f32 v[54:55], v[54:55], v[72:73] op_sel_hi:[1,0] neg_lo:[0,1] neg_hi:[0,1]
v_pk_add_f32 v[56:57], v[56:57], v[72:73] op_sel_hi:[1,0] neg_lo:[0,1] neg_hi:[0,1]
v_pk_add_f32 v[58:59], v[58:59], v[72:73] op_sel_hi:[1,0] neg_lo:[0,1] neg_hi:[0,1]
v_pk_add_f32 v[60:61], v[60:61], v[72:73] op_sel_hi:[1,0] neg_lo:[0,1] neg_hi:[0,1]
v_pk_add_f32 v[62:63], v[62:63], v[72:73] op_sel_hi:[1,0] neg_lo:[0,1] neg_hi:[0,1]
v_pk_mul_f32 v[74:75], v[48:49], v[48:49]
v_pk_fma_f32 v[74:75], v[50:51], v[50:51], v[74:75]
v_pk_fma_f32 v[74:75], v[52:53], v[52:53], v[74:75]
v_pk_fma_f32 v[74:75], v[54:55], v[54:55], v[74:75]
v_pk_fma_f32 v[74:75], v[56:57], v[56:57], v[74:75]
v_pk_fma_f32 v[74:75], v[58:59], v[58:59], v[74:75]
v_pk_fma_f32 v[74:75], v[60:61], v[60:61], v[74:75]
v_pk_fma_f32 v[74:75], v[62:63], v[62:63], v[74:75]
v_add_f32 v103, v74, v75
v_mov_b32 v104, v100
v_mov_b32 v105, v101
v_mov_b32 v106, v102
v_mov_b32 v107, v103
v_permlane16_swap_b32 v100, v104
v_permlane16_swap_b32 v101, v105
v_permlane16_swap_b32 v102, v106
v_permlane16_swap_b32 v103, v107
v_add_f32 v100, v100, v104
v_add_f32 v101, v101, v105
v_add_f32 v102, v102, v106
v_add_f32 v103, v103, v107
v_mov_b32 v104, v100
v_mov_b32 v105, v101
v_mov_b32 v106, v102
v_mov_b32 v107, v103
v_permlane32_swap_b32 v100, v104
v_permlane32_swap_b32 v101, v105
v_permlane32_swap_b32 v102, v106
v_permlane32_swap_b32 v103, v107
v_add_f32 v100, v100, v104
v_add_f32 v101, v101, v105
v_add_f32 v102, v102, v106
v_add_f32 v103, v103, v107
s_lshr_b32 s31, s20, 1
s_lshl_b32 s31, s31, 6
s_add_u32 s31, s31, s21
s_lshl_b32 s31, s31, 3
s_and_b32 s33, s20, 1
s_lshl_b32 s32, s59, 1
s_add_u32 s32, s32, s33
s_lshl_b32 s32, s32, 14
s_add_u32 s31, s31, s32
s_add_u32 s31, s31, 37748736
v_lshlrev_b32 v136, 3, v254
v_mov_b32 v148, v96
v_mov_b32 v149, v100
v_mov_b32 v150, v97
v_mov_b32 v151, v101
v_mov_b32 v152, v98
v_mov_b32 v153, v102
v_mov_b32 v154, v99
v_mov_b32 v155, v103
s_mov_b64 exec, 0xffff
buffer_store_dwordx2 v[148:149], v136, s[16:19], s31 offen offset:0 sc0 sc1
buffer_store_dwordx2 v[150:151], v136, s[16:19], s31 offen offset:128 sc0 sc1
buffer_store_dwordx2 v[152:153], v136, s[16:19], s31 offen offset:256 sc0 sc1
buffer_store_dwordx2 v[154:155], v136, s[16:19], s31 offen offset:384 sc0 sc1
s_mov_b64 exec, -1
s_lshl_b32 s63, s58, 4
s_add_u32 s63, s63, s59
s_lshl_b32 s63, s63, 2
s_add_u32 s63, s63, s20
s_lshl_b32 s63, s63, 4
s_add_u32 s63, s63, 38813696
s_waitcnt vmcnt(0)
v_mov_b32 v136, 1
v_mov_b32 v137, 0
s_mov_b64 exec, 1
buffer_store_dword v136, v137, s[16:19], s63 offen sc0 sc1
s_mov_b64 exec, -1
s_bfe_u32 s5, s2, 0x10002
s_bfe_u32 s6, s2, 0x10001
s_lshr_b32 s4, s2, 3
s_lshr_b32 s7, s4, 2
s_and_b32 s4, s4, 3
s_lshl_b32 s5, s5, 3
s_add_u32 s58, s5, s7
s_lshl_b32 s6, s6, 2
s_add_u32 s59, s6, s4
s_mul_i32 s3, s7, 1
s_mul_i32 s31, s4, 0
s_add_u32 s3, s3, s31
s_lshl_b32 s21, s58, 7
s_lshl_b32 s22, s59, 8
s_lshl_b32 s22, s59, 9
s_nop 1
v_and_b32 v236, 63, v254
s_lshr_b32 s31, s20, 1
s_and_b32 s32, s20, 1
v_and_b32 v237, 15, v236
s_mul_i32 s33, s31, 64
v_add_u32 v237, s33, v237
v_bfe_u32 v238, v237, 1, 3
v_lshrrev_b32 v239, 4, v236
v_xor_b32 v238, v238, v239
v_lshlrev_b32 v238, 4, v238
v_lshl_add_u32 v224, v237, 7, v238
v_xor_b32 v225, 64, v224
v_lshrrev_b32 v237, 4, v236
v_bfe_u32 v238, v236, 2, 2
v_and_b32 v239, 3, v236
v_lshl_add_u32 v240, v237, 3, v238
v_lshlrev_b32 v239, 3, v239
v_and_b32 v237, 3, v240
v_bfe_u32 v238, v240, 3, 1
v_lshl_or_b32 v237, v238, 2, v237
v_lshlrev_b32 v237, 1, v237
v_lshlrev_b32 v237, 4, v237
v_mul_u32_u24 v240, 512, v240
v_add_u32 v240, 16384, v240
s_mul_i32 s33, s32, 256
s_add_u32 s33, s33, 0
v_add_u32 v238, s33, v239
v_xor_b32 v238, v238, v237
v_add_u32 v226, v238, v240
s_mul_i32 s33, s32, 256
s_add_u32 s33, s33, 32
v_add_u32 v238, s33, v239
v_xor_b32 v238, v238, v237
v_add_u32 v227, v238, v240
s_mul_i32 s33, s32, 256
s_add_u32 s33, s33, 64
v_add_u32 v238, s33, v239
v_xor_b32 v238, v238, v237
v_add_u32 v228, v238, v240
s_mul_i32 s33, s32, 256
s_add_u32 s33, s33, 96
v_add_u32 v238, s33, v239
v_xor_b32 v238, v238, v237
v_add_u32 v229, v238, v240
s_mul_i32 s33, s32, 256
s_add_u32 s33, s33, 128
v_add_u32 v238, s33, v239
v_xor_b32 v238, v238, v237
v_add_u32 v230, v238, v240
s_mul_i32 s33, s32, 256
s_add_u32 s33, s33, 160
v_add_u32 v238, s33, v239
v_xor_b32 v238, v238, v237
v_add_u32 v231, v238, v240
s_mul_i32 s33, s32, 256
s_add_u32 s33, s33, 192
v_add_u32 v238, s33, v239
v_xor_b32 v238, v238, v237
v_add_u32 v232, v238, v240
s_mul_i32 s33, s32, 256
s_add_u32 s33, s33, 224
v_add_u32 v238, s33, v239
v_xor_b32 v238, v238, v237
v_add_u32 v233, v238, v240
v_mov_b32 v0, 0
v_mov_b32 v1, 0
v_mov_b32 v2, 0
v_mov_b32 v3, 0
v_mov_b32 v4, 0
v_mov_b32 v5, 0
v_mov_b32 v6, 0
v_mov_b32 v7, 0
v_mov_b32 v8, 0
v_mov_b32 v9, 0
v_mov_b32 v10, 0
v_mov_b32 v11, 0
v_mov_b32 v12, 0
v_mov_b32 v13, 0
v_mov_b32 v14, 0
v_mov_b32 v15, 0
v_mov_b32 v16, 0
v_mov_b32 v17, 0
v_mov_b32 v18, 0
v_mov_b32 v19, 0
v_mov_b32 v20, 0
v_mov_b32 v21, 0
v_mov_b32 v22, 0
v_mov_b32 v23, 0
v_mov_b32 v24, 0
v_mov_b32 v25, 0
v_mov_b32 v26, 0
v_mov_b32 v27, 0
v_mov_b32 v28, 0
v_mov_b32 v29, 0
v_mov_b32 v30, 0
v_mov_b32 v31, 0
v_mov_b32 v32, 0
v_mov_b32 v33, 0
v_mov_b32 v34, 0
v_mov_b32 v35, 0
v_mov_b32 v36, 0
v_mov_b32 v37, 0
v_mov_b32 v38, 0
v_mov_b32 v39, 0
v_mov_b32 v40, 0
v_mov_b32 v41, 0
v_mov_b32 v42, 0
v_mov_b32 v43, 0
v_mov_b32 v44, 0
v_mov_b32 v45, 0
v_mov_b32 v46, 0
v_mov_b32 v47, 0
v_mov_b32 v48, 0
v_mov_b32 v49, 0
v_mov_b32 v50, 0
v_mov_b32 v51, 0
v_mov_b32 v52, 0
v_mov_b32 v53, 0
v_mov_b32 v54, 0
v_mov_b32 v55, 0
v_mov_b32 v56, 0
v_mov_b32 v57, 0
v_mov_b32 v58, 0
v_mov_b32 v59, 0
v_mov_b32 v60, 0
v_mov_b32 v61, 0
v_mov_b32 v62, 0
v_mov_b32 v63, 0
v_mov_b32 v64, 0
v_mov_b32 v65, 0
v_mov_b32 v66, 0
v_mov_b32 v67, 0
v_mov_b32 v68, 0
v_mov_b32 v69, 0
v_mov_b32 v70, 0
v_mov_b32 v71, 0
v_mov_b32 v72, 0
v_mov_b32 v73, 0
v_mov_b32 v74, 0
v_mov_b32 v75, 0
v_mov_b32 v76, 0
v_mov_b32 v77, 0
v_mov_b32 v78, 0
v_mov_b32 v79, 0
v_mov_b32 v80, 0
v_mov_b32 v81, 0
v_mov_b32 v82, 0
v_mov_b32 v83, 0
v_mov_b32 v84, 0
v_mov_b32 v85, 0
v_mov_b32 v86, 0
v_mov_b32 v87, 0
v_mov_b32 v88, 0
v_mov_b32 v89, 0
v_mov_b32 v90, 0
v_mov_b32 v91, 0
v_mov_b32 v92, 0
v_mov_b32 v93, 0
v_mov_b32 v94, 0
v_mov_b32 v95, 0
v_mov_b32 v96, 0
v_mov_b32 v97, 0
v_mov_b32 v98, 0
v_mov_b32 v99, 0
v_mov_b32 v100, 0
v_mov_b32 v101, 0
v_mov_b32 v102, 0
v_mov_b32 v103, 0
v_mov_b32 v104, 0
v_mov_b32 v105, 0
v_mov_b32 v106, 0
v_mov_b32 v107, 0
v_mov_b32 v108, 0
v_mov_b32 v109, 0
v_mov_b32 v110, 0
v_mov_b32 v111, 0
v_mov_b32 v112, 0
v_mov_b32 v113, 0
v_mov_b32 v114, 0
v_mov_b32 v115, 0
v_mov_b32 v116, 0
v_mov_b32 v117, 0
v_mov_b32 v118, 0
v_mov_b32 v119, 0
v_mov_b32 v120, 0
v_mov_b32 v121, 0
v_mov_b32 v122, 0
v_mov_b32 v123, 0
v_mov_b32 v124, 0
v_mov_b32 v125, 0
v_mov_b32 v126, 0
v_mov_b32 v127, 0
s_mov_b32 s92, 0
s_mov_b32 s93, 0
s_mov_b32 s30, 0
s_mov_b32 s29, 1
s_barrier
ds_read_b64_tr_b16 v[160:161], v226 offset:0
ds_read_b64_tr_b16 v[162:163], v226 offset:2048
ds_read_b128 v[128:131], v224 offset:0
ds_read_b64_tr_b16 v[164:165], v227 offset:0
ds_read_b64_tr_b16 v[166:167], v227 offset:2048
ds_read_b64_tr_b16 v[168:169], v228 offset:0
ds_read_b64_tr_b16 v[170:171], v228 offset:2048
ds_read_b64_tr_b16 v[172:173], v229 offset:0
ds_read_b64_tr_b16 v[174:175], v229 offset:2048
ds_read_b64_tr_b16 v[176:177], v230 offset:0
ds_read_b64_tr_b16 v[178:179], v230 offset:2048
ds_read_b64_tr_b16 v[180:181], v231 offset:0
ds_read_b64_tr_b16 v[182:183], v231 offset:2048
ds_read_b64_tr_b16 v[184:185], v232 offset:0
ds_read_b64_tr_b16 v[186:187], v232 offset:2048
ds_read_b64_tr_b16 v[188:189], v233 offset:0
ds_read_b64_tr_b16 v[190:191], v233 offset:2048
ds_read_b128 v[132:135], v224 offset:2048
ds_read_b128 v[136:139], v224 offset:4096
ds_read_b128 v[140:143], v224 offset:6144
.p2align 6
L_s5_mm_29:
s_waitcnt lgkmcnt(15)
v_mfma_f32_16x16x32_bf16 v[0:3], v[160:163], v[128:131], v[0:3]
ds_read_b64_tr_b16 v[192:193], v226 offset:16384
ds_read_b64_tr_b16 v[194:195], v226 offset:18432
v_mfma_f32_16x16x32_bf16 v[4:7], v[164:167], v[128:131], v[4:7]
ds_read_b128 v[144:147], v225 offset:0
ds_read_b64_tr_b16 v[196:197], v227 offset:16384
s_waitcnt lgkmcnt(15)
v_mfma_f32_16x16x32_bf16 v[8:11], v[168:171], v[128:131], v[8:11]
ds_read_b64_tr_b16 v[198:199], v227 offset:18432
ds_read_b64_tr_b16 v[200:201], v228 offset:16384
v_mfma_f32_16x16x32_bf16 v[12:15], v[172:175], v[128:131], v[12:15]
ds_read_b64_tr_b16 v[202:203], v228 offset:18432
ds_read_b64_tr_b16 v[204:205], v229 offset:16384
s_waitcnt lgkmcnt(15)
v_mfma_f32_16x16x32_bf16 v[16:19], v[176:179], v[128:131], v[16:19]
ds_read_b64_tr_b16 v[206:207], v229 offset:18432
ds_read_b64_tr_b16 v[208:209], v230 offset:16384
v_mfma_f32_16x16x32_bf16 v[20:23], v[180:183], v[128:131], v[20:23]
ds_read_b64_tr_b16 v[210:211], v230 offset:18432
ds_read_b64_tr_b16 v[212:213], v231 offset:16384
s_waitcnt lgkmcnt(15)
v_mfma_f32_16x16x32_bf16 v[24:27], v[184:187], v[128:131], v[24:27]
ds_read_b64_tr_b16 v[214:215], v231 offset:18432
ds_read_b64_tr_b16 v[216:217], v232 offset:16384
v_mfma_f32_16x16x32_bf16 v[28:31], v[188:191], v[128:131], v[28:31]
ds_read_b64_tr_b16 v[218:219], v232 offset:18432
ds_read_b64_tr_b16 v[220:221], v233 offset:16384
s_waitcnt lgkmcnt(15)
v_mfma_f32_16x16x32_bf16 v[32:35], v[160:163], v[132:135], v[32:35]
ds_read_b64_tr_b16 v[222:223], v233 offset:18432
ds_read_b128 v[148:151], v225 offset:2048
v_mfma_f32_16x16x32_bf16 v[36:39], v[164:167], v[132:135], v[36:39]
ds_read_b128 v[152:155], v225 offset:4096
ds_read_b128 v[156:159], v225 offset:6144
v_mfma_f32_16x16x32_bf16 v[40:43], v[168:171], v[132:135], v[40:43]
s_add_u32 s30, s30, 1
s_cmp_eq_u32 s30, 3
v_mfma_f32_16x16x32_bf16 v[44:47], v[172:175], v[132:135], v[44:47]
s_cselect_b32 s30, 0, s30
s_mov_b32 s38, 49152
v_mfma_f32_16x16x32_bf16 v[48:51], v[176:179], v[132:135], v[48:51]
s_cmov_b32 s38, 4294868992
s_add_u32 s29, s29, 1
v_mfma_f32_16x16x32_bf16 v[52:55], v[180:183], v[132:135], v[52:55]
v_add_u32 v224, s38, v224
v_add_u32 v225, s38, v225
v_mfma_f32_16x16x32_bf16 v[56:59], v[184:187], v[132:135], v[56:59]
v_add_u32 v226, s38, v226
v_add_u32 v227, s38, v227
v_mfma_f32_16x16x32_bf16 v[60:63], v[188:191], v[132:135], v[60:63]
v_add_u32 v228, s38, v228
v_add_u32 v229, s38, v229
v_mfma_f32_16x16x32_bf16 v[64:67], v[160:163], v[136:139], v[64:67]
v_add_u32 v230, s38, v230
v_add_u32 v231, s38, v231
v_mfma_f32_16x16x32_bf16 v[68:71], v[164:167], v[136:139], v[68:71]
v_add_u32 v232, s38, v232
v_add_u32 v233, s38, v233
v_mfma_f32_16x16x32_bf16 v[72:75], v[168:171], v[136:139], v[72:75]
v_mfma_f32_16x16x32_bf16 v[76:79], v[172:175], v[136:139], v[76:79]
v_mfma_f32_16x16x32_bf16 v[80:83], v[176:179], v[136:139], v[80:83]
v_mfma_f32_16x16x32_bf16 v[84:87], v[180:183], v[136:139], v[84:87]
v_mfma_f32_16x16x32_bf16 v[88:91], v[184:187], v[136:139], v[88:91]
v_mfma_f32_16x16x32_bf16 v[92:95], v[188:191], v[136:139], v[92:95]
v_mfma_f32_16x16x32_bf16 v[96:99], v[160:163], v[140:143], v[96:99]
v_mfma_f32_16x16x32_bf16 v[100:103], v[164:167], v[140:143], v[100:103]
v_mfma_f32_16x16x32_bf16 v[104:107], v[168:171], v[140:143], v[104:107]
v_mfma_f32_16x16x32_bf16 v[108:111], v[172:175], v[140:143], v[108:111]
v_mfma_f32_16x16x32_bf16 v[112:115], v[176:179], v[140:143], v[112:115]
v_mfma_f32_16x16x32_bf16 v[116:119], v[180:183], v[140:143], v[116:119]
v_mfma_f32_16x16x32_bf16 v[120:123], v[184:187], v[140:143], v[120:123]
v_mfma_f32_16x16x32_bf16 v[124:127], v[188:191], v[140:143], v[124:127]
s_waitcnt lgkmcnt(15)
v_mfma_f32_16x16x32_bf16 v[0:3], v[192:195], v[144:147], v[0:3]
v_mfma_f32_16x16x32_bf16 v[4:7], v[196:199], v[144:147], v[4:7]
s_waitcnt lgkmcnt(13)
v_mfma_f32_16x16x32_bf16 v[8:11], v[200:203], v[144:147], v[8:11]
s_waitcnt lgkmcnt(11)
v_mfma_f32_16x16x32_bf16 v[12:15], v[204:207], v[144:147], v[12:15]
s_waitcnt lgkmcnt(9)
v_mfma_f32_16x16x32_bf16 v[16:19], v[208:211], v[144:147], v[16:19]
s_waitcnt lgkmcnt(7)
v_mfma_f32_16x16x32_bf16 v[20:23], v[212:215], v[144:147], v[20:23]
s_waitcnt lgkmcnt(5)
v_mfma_f32_16x16x32_bf16 v[24:27], v[216:219], v[144:147], v[24:27]
s_waitcnt lgkmcnt(3)
v_mfma_f32_16x16x32_bf16 v[28:31], v[220:223], v[144:147], v[28:31]
s_waitcnt lgkmcnt(2)
v_mfma_f32_16x16x32_bf16 v[32:35], v[192:195], v[148:151], v[32:35]
s_waitcnt lgkmcnt(0)
s_barrier
ds_read_b64_tr_b16 v[160:161], v226 offset:0
v_mfma_f32_16x16x32_bf16 v[36:39], v[196:199], v[148:151], v[36:39]
ds_read_b64_tr_b16 v[162:163], v226 offset:2048
v_mfma_f32_16x16x32_bf16 v[40:43], v[200:203], v[148:151], v[40:43]
ds_read_b128 v[128:131], v224 offset:0
v_mfma_f32_16x16x32_bf16 v[44:47], v[204:207], v[148:151], v[44:47]
ds_read_b64_tr_b16 v[164:165], v227 offset:0
v_mfma_f32_16x16x32_bf16 v[48:51], v[208:211], v[148:151], v[48:51]
ds_read_b64_tr_b16 v[166:167], v227 offset:2048
v_mfma_f32_16x16x32_bf16 v[52:55], v[212:215], v[148:151], v[52:55]
ds_read_b64_tr_b16 v[168:169], v228 offset:0
v_mfma_f32_16x16x32_bf16 v[56:59], v[216:219], v[148:151], v[56:59]
ds_read_b64_tr_b16 v[170:171], v228 offset:2048
v_mfma_f32_16x16x32_bf16 v[60:63], v[220:223], v[148:151], v[60:63]
ds_read_b64_tr_b16 v[172:173], v229 offset:0
v_mfma_f32_16x16x32_bf16 v[64:67], v[192:195], v[152:155], v[64:67]
ds_read_b64_tr_b16 v[174:175], v229 offset:2048
v_mfma_f32_16x16x32_bf16 v[68:71], v[196:199], v[152:155], v[68:71]
ds_read_b64_tr_b16 v[176:177], v230 offset:0
v_mfma_f32_16x16x32_bf16 v[72:75], v[200:203], v[152:155], v[72:75]
ds_read_b64_tr_b16 v[178:179], v230 offset:2048
v_mfma_f32_16x16x32_bf16 v[76:79], v[204:207], v[152:155], v[76:79]
ds_read_b64_tr_b16 v[180:181], v231 offset:0
v_mfma_f32_16x16x32_bf16 v[80:83], v[208:211], v[152:155], v[80:83]
ds_read_b64_tr_b16 v[182:183], v231 offset:2048
v_mfma_f32_16x16x32_bf16 v[84:87], v[212:215], v[152:155], v[84:87]
ds_read_b64_tr_b16 v[184:185], v232 offset:0
v_mfma_f32_16x16x32_bf16 v[88:91], v[216:219], v[152:155], v[88:91]
ds_read_b64_tr_b16 v[186:187], v232 offset:2048
v_mfma_f32_16x16x32_bf16 v[92:95], v[220:223], v[152:155], v[92:95]
ds_read_b64_tr_b16 v[188:189], v233 offset:0
v_mfma_f32_16x16x32_bf16 v[96:99], v[192:195], v[156:159], v[96:99]
ds_read_b64_tr_b16 v[190:191], v233 offset:2048
v_mfma_f32_16x16x32_bf16 v[100:103], v[196:199], v[156:159], v[100:103]
ds_read_b128 v[132:135], v224 offset:2048
v_mfma_f32_16x16x32_bf16 v[104:107], v[200:203], v[156:159], v[104:107]
ds_read_b128 v[136:139], v224 offset:4096
v_mfma_f32_16x16x32_bf16 v[108:111], v[204:207], v[156:159], v[108:111]
ds_read_b128 v[140:143], v224 offset:6144
v_mfma_f32_16x16x32_bf16 v[112:115], v[208:211], v[156:159], v[112:115]
v_mfma_f32_16x16x32_bf16 v[116:119], v[212:215], v[156:159], v[116:119]
v_mfma_f32_16x16x32_bf16 v[120:123], v[216:219], v[156:159], v[120:123]
v_mfma_f32_16x16x32_bf16 v[124:127], v[220:223], v[156:159], v[124:127]
s_waitcnt lgkmcnt(15)
v_mfma_f32_16x16x32_bf16 v[0:3], v[160:163], v[128:131], v[0:3]
ds_read_b64_tr_b16 v[192:193], v226 offset:16384
ds_read_b64_tr_b16 v[194:195], v226 offset:18432
v_mfma_f32_16x16x32_bf16 v[4:7], v[164:167], v[128:131], v[4:7]
ds_read_b128 v[144:147], v225 offset:0
ds_read_b64_tr_b16 v[196:197], v227 offset:16384
s_waitcnt lgkmcnt(15)
v_mfma_f32_16x16x32_bf16 v[8:11], v[168:171], v[128:131], v[8:11]
ds_read_b64_tr_b16 v[198:199], v227 offset:18432
ds_read_b64_tr_b16 v[200:201], v228 offset:16384
v_mfma_f32_16x16x32_bf16 v[12:15], v[172:175], v[128:131], v[12:15]
ds_read_b64_tr_b16 v[202:203], v228 offset:18432
ds_read_b64_tr_b16 v[204:205], v229 offset:16384
s_waitcnt lgkmcnt(15)
v_mfma_f32_16x16x32_bf16 v[16:19], v[176:179], v[128:131], v[16:19]
ds_read_b64_tr_b16 v[206:207], v229 offset:18432
ds_read_b64_tr_b16 v[208:209], v230 offset:16384
v_mfma_f32_16x16x32_bf16 v[20:23], v[180:183], v[128:131], v[20:23]
ds_read_b64_tr_b16 v[210:211], v230 offset:18432
ds_read_b64_tr_b16 v[212:213], v231 offset:16384
s_waitcnt lgkmcnt(15)
v_mfma_f32_16x16x32_bf16 v[24:27], v[184:187], v[128:131], v[24:27]
ds_read_b64_tr_b16 v[214:215], v231 offset:18432
ds_read_b64_tr_b16 v[216:217], v232 offset:16384
v_mfma_f32_16x16x32_bf16 v[28:31], v[188:191], v[128:131], v[28:31]
ds_read_b64_tr_b16 v[218:219], v232 offset:18432
ds_read_b64_tr_b16 v[220:221], v233 offset:16384
s_waitcnt lgkmcnt(15)
v_mfma_f32_16x16x32_bf16 v[32:35], v[160:163], v[132:135], v[32:35]
ds_read_b64_tr_b16 v[222:223], v233 offset:18432
ds_read_b128 v[148:151], v225 offset:2048
v_mfma_f32_16x16x32_bf16 v[36:39], v[164:167], v[132:135], v[36:39]
ds_read_b128 v[152:155], v225 offset:4096
ds_read_b128 v[156:159], v225 offset:6144
v_mfma_f32_16x16x32_bf16 v[40:43], v[168:171], v[132:135], v[40:43]
s_add_u32 s30, s30, 1
s_cmp_eq_u32 s30, 3
v_mfma_f32_16x16x32_bf16 v[44:47], v[172:175], v[132:135], v[44:47]
s_cselect_b32 s30, 0, s30
s_mov_b32 s38, 49152
v_mfma_f32_16x16x32_bf16 v[48:51], v[176:179], v[132:135], v[48:51]
s_cmov_b32 s38, 4294868992
s_add_u32 s29, s29, 1
v_mfma_f32_16x16x32_bf16 v[52:55], v[180:183], v[132:135], v[52:55]
v_add_u32 v224, s38, v224
v_add_u32 v225, s38, v225
v_mfma_f32_16x16x32_bf16 v[56:59], v[184:187], v[132:135], v[56:59]
v_add_u32 v226, s38, v226
v_add_u32 v227, s38, v227
v_mfma_f32_16x16x32_bf16 v[60:63], v[188:191], v[132:135], v[60:63]
v_add_u32 v228, s38, v228
v_add_u32 v229, s38, v229
v_mfma_f32_16x16x32_bf16 v[64:67], v[160:163], v[136:139], v[64:67]
v_add_u32 v230, s38, v230
v_add_u32 v231, s38, v231
v_mfma_f32_16x16x32_bf16 v[68:71], v[164:167], v[136:139], v[68:71]
v_add_u32 v232, s38, v232
v_add_u32 v233, s38, v233
v_mfma_f32_16x16x32_bf16 v[72:75], v[168:171], v[136:139], v[72:75]
v_mfma_f32_16x16x32_bf16 v[76:79], v[172:175], v[136:139], v[76:79]
v_mfma_f32_16x16x32_bf16 v[80:83], v[176:179], v[136:139], v[80:83]
v_mfma_f32_16x16x32_bf16 v[84:87], v[180:183], v[136:139], v[84:87]
v_mfma_f32_16x16x32_bf16 v[88:91], v[184:187], v[136:139], v[88:91]
v_mfma_f32_16x16x32_bf16 v[92:95], v[188:191], v[136:139], v[92:95]
v_mfma_f32_16x16x32_bf16 v[96:99], v[160:163], v[140:143], v[96:99]
v_mfma_f32_16x16x32_bf16 v[100:103], v[164:167], v[140:143], v[100:103]
v_mfma_f32_16x16x32_bf16 v[104:107], v[168:171], v[140:143], v[104:107]
v_mfma_f32_16x16x32_bf16 v[108:111], v[172:175], v[140:143], v[108:111]
v_mfma_f32_16x16x32_bf16 v[112:115], v[176:179], v[140:143], v[112:115]
v_mfma_f32_16x16x32_bf16 v[116:119], v[180:183], v[140:143], v[116:119]
v_mfma_f32_16x16x32_bf16 v[120:123], v[184:187], v[140:143], v[120:123]
v_mfma_f32_16x16x32_bf16 v[124:127], v[188:191], v[140:143], v[124:127]
s_waitcnt lgkmcnt(15)
v_mfma_f32_16x16x32_bf16 v[0:3], v[192:195], v[144:147], v[0:3]
v_mfma_f32_16x16x32_bf16 v[4:7], v[196:199], v[144:147], v[4:7]
s_waitcnt lgkmcnt(13)
v_mfma_f32_16x16x32_bf16 v[8:11], v[200:203], v[144:147], v[8:11]
s_waitcnt lgkmcnt(11)
v_mfma_f32_16x16x32_bf16 v[12:15], v[204:207], v[144:147], v[12:15]
s_waitcnt lgkmcnt(9)
v_mfma_f32_16x16x32_bf16 v[16:19], v[208:211], v[144:147], v[16:19]
s_waitcnt lgkmcnt(7)
v_mfma_f32_16x16x32_bf16 v[20:23], v[212:215], v[144:147], v[20:23]
s_waitcnt lgkmcnt(5)
v_mfma_f32_16x16x32_bf16 v[24:27], v[216:219], v[144:147], v[24:27]
s_waitcnt lgkmcnt(3)
v_mfma_f32_16x16x32_bf16 v[28:31], v[220:223], v[144:147], v[28:31]
s_waitcnt lgkmcnt(2)
v_mfma_f32_16x16x32_bf16 v[32:35], v[192:195], v[148:151], v[32:35]
s_waitcnt lgkmcnt(0)
s_barrier
ds_read_b64_tr_b16 v[160:161], v226 offset:0
v_mfma_f32_16x16x32_bf16 v[36:39], v[196:199], v[148:151], v[36:39]
ds_read_b64_tr_b16 v[162:163], v226 offset:2048
v_mfma_f32_16x16x32_bf16 v[40:43], v[200:203], v[148:151], v[40:43]
ds_read_b128 v[128:131], v224 offset:0
v_mfma_f32_16x16x32_bf16 v[44:47], v[204:207], v[148:151], v[44:47]
ds_read_b64_tr_b16 v[164:165], v227 offset:0
v_mfma_f32_16x16x32_bf16 v[48:51], v[208:211], v[148:151], v[48:51]
ds_read_b64_tr_b16 v[166:167], v227 offset:2048
v_mfma_f32_16x16x32_bf16 v[52:55], v[212:215], v[148:151], v[52:55]
ds_read_b64_tr_b16 v[168:169], v228 offset:0
v_mfma_f32_16x16x32_bf16 v[56:59], v[216:219], v[148:151], v[56:59]
ds_read_b64_tr_b16 v[170:171], v228 offset:2048
v_mfma_f32_16x16x32_bf16 v[60:63], v[220:223], v[148:151], v[60:63]
ds_read_b64_tr_b16 v[172:173], v229 offset:0
v_mfma_f32_16x16x32_bf16 v[64:67], v[192:195], v[152:155], v[64:67]
ds_read_b64_tr_b16 v[174:175], v229 offset:2048
v_mfma_f32_16x16x32_bf16 v[68:71], v[196:199], v[152:155], v[68:71]
ds_read_b64_tr_b16 v[176:177], v230 offset:0
v_mfma_f32_16x16x32_bf16 v[72:75], v[200:203], v[152:155], v[72:75]
ds_read_b64_tr_b16 v[178:179], v230 offset:2048
v_mfma_f32_16x16x32_bf16 v[76:79], v[204:207], v[152:155], v[76:79]
ds_read_b64_tr_b16 v[180:181], v231 offset:0
v_mfma_f32_16x16x32_bf16 v[80:83], v[208:211], v[152:155], v[80:83]
ds_read_b64_tr_b16 v[182:183], v231 offset:2048
v_mfma_f32_16x16x32_bf16 v[84:87], v[212:215], v[152:155], v[84:87]
ds_read_b64_tr_b16 v[184:185], v232 offset:0
v_mfma_f32_16x16x32_bf16 v[88:91], v[216:219], v[152:155], v[88:91]
ds_read_b64_tr_b16 v[186:187], v232 offset:2048
v_mfma_f32_16x16x32_bf16 v[92:95], v[220:223], v[152:155], v[92:95]
ds_read_b64_tr_b16 v[188:189], v233 offset:0
v_mfma_f32_16x16x32_bf16 v[96:99], v[192:195], v[156:159], v[96:99]
ds_read_b64_tr_b16 v[190:191], v233 offset:2048
v_mfma_f32_16x16x32_bf16 v[100:103], v[196:199], v[156:159], v[100:103]
ds_read_b128 v[132:135], v224 offset:2048
v_mfma_f32_16x16x32_bf16 v[104:107], v[200:203], v[156:159], v[104:107]
ds_read_b128 v[136:139], v224 offset:4096
v_mfma_f32_16x16x32_bf16 v[108:111], v[204:207], v[156:159], v[108:111]
ds_read_b128 v[140:143], v224 offset:6144
v_mfma_f32_16x16x32_bf16 v[112:115], v[208:211], v[156:159], v[112:115]
v_mfma_f32_16x16x32_bf16 v[116:119], v[212:215], v[156:159], v[116:119]
v_mfma_f32_16x16x32_bf16 v[120:123], v[216:219], v[156:159], v[120:123]
s_cmp_lt_u32 s29, 15
v_mfma_f32_16x16x32_bf16 v[124:127], v[220:223], v[156:159], v[124:127]
s_cbranch_scc1 L_s5_mm_29
s_waitcnt lgkmcnt(15)
v_mfma_f32_16x16x32_bf16 v[0:3], v[160:163], v[128:131], v[0:3]
ds_read_b64_tr_b16 v[192:193], v226 offset:16384
ds_read_b64_tr_b16 v[194:195], v226 offset:18432
v_mfma_f32_16x16x32_bf16 v[4:7], v[164:167], v[128:131], v[4:7]
ds_read_b128 v[144:147], v225 offset:0
ds_read_b64_tr_b16 v[196:197], v227 offset:16384
s_waitcnt lgkmcnt(15)
v_mfma_f32_16x16x32_bf16 v[8:11], v[168:171], v[128:131], v[8:11]
ds_read_b64_tr_b16 v[198:199], v227 offset:18432
ds_read_b64_tr_b16 v[200:201], v228 offset:16384
v_mfma_f32_16x16x32_bf16 v[12:15], v[172:175], v[128:131], v[12:15]
ds_read_b64_tr_b16 v[202:203], v228 offset:18432
ds_read_b64_tr_b16 v[204:205], v229 offset:16384
s_waitcnt lgkmcnt(15)
v_mfma_f32_16x16x32_bf16 v[16:19], v[176:179], v[128:131], v[16:19]
ds_read_b64_tr_b16 v[206:207], v229 offset:18432
ds_read_b64_tr_b16 v[208:209], v230 offset:16384
v_mfma_f32_16x16x32_bf16 v[20:23], v[180:183], v[128:131], v[20:23]
ds_read_b64_tr_b16 v[210:211], v230 offset:18432
ds_read_b64_tr_b16 v[212:213], v231 offset:16384
s_waitcnt lgkmcnt(15)
v_mfma_f32_16x16x32_bf16 v[24:27], v[184:187], v[128:131], v[24:27]
ds_read_b64_tr_b16 v[214:215], v231 offset:18432
ds_read_b64_tr_b16 v[216:217], v232 offset:16384
v_mfma_f32_16x16x32_bf16 v[28:31], v[188:191], v[128:131], v[28:31]
ds_read_b64_tr_b16 v[218:219], v232 offset:18432
ds_read_b64_tr_b16 v[220:221], v233 offset:16384
s_waitcnt lgkmcnt(15)
v_mfma_f32_16x16x32_bf16 v[32:35], v[160:163], v[132:135], v[32:35]
ds_read_b64_tr_b16 v[222:223], v233 offset:18432
ds_read_b128 v[148:151], v225 offset:2048
v_mfma_f32_16x16x32_bf16 v[36:39], v[164:167], v[132:135], v[36:39]
ds_read_b128 v[152:155], v225 offset:4096
ds_read_b128 v[156:159], v225 offset:6144
v_mfma_f32_16x16x32_bf16 v[40:43], v[168:171], v[132:135], v[40:43]
s_add_u32 s30, s30, 1
s_cmp_eq_u32 s30, 3
v_mfma_f32_16x16x32_bf16 v[44:47], v[172:175], v[132:135], v[44:47]
s_cselect_b32 s30, 0, s30
s_mov_b32 s38, 49152
v_mfma_f32_16x16x32_bf16 v[48:51], v[176:179], v[132:135], v[48:51]
s_cmov_b32 s38, 4294868992
s_add_u32 s29, s29, 1
v_mfma_f32_16x16x32_bf16 v[52:55], v[180:183], v[132:135], v[52:55]
v_add_u32 v224, s38, v224
v_add_u32 v225, s38, v225
v_mfma_f32_16x16x32_bf16 v[56:59], v[184:187], v[132:135], v[56:59]
v_add_u32 v226, s38, v226
v_add_u32 v227, s38, v227
v_mfma_f32_16x16x32_bf16 v[60:63], v[188:191], v[132:135], v[60:63]
v_add_u32 v228, s38, v228
v_add_u32 v229, s38, v229
v_mfma_f32_16x16x32_bf16 v[64:67], v[160:163], v[136:139], v[64:67]
v_add_u32 v230, s38, v230
v_add_u32 v231, s38, v231
v_mfma_f32_16x16x32_bf16 v[68:71], v[164:167], v[136:139], v[68:71]
v_add_u32 v232, s38, v232
v_add_u32 v233, s38, v233
v_mfma_f32_16x16x32_bf16 v[72:75], v[168:171], v[136:139], v[72:75]
v_mfma_f32_16x16x32_bf16 v[76:79], v[172:175], v[136:139], v[76:79]
v_mfma_f32_16x16x32_bf16 v[80:83], v[176:179], v[136:139], v[80:83]
v_mfma_f32_16x16x32_bf16 v[84:87], v[180:183], v[136:139], v[84:87]
v_mfma_f32_16x16x32_bf16 v[88:91], v[184:187], v[136:139], v[88:91]
v_mfma_f32_16x16x32_bf16 v[92:95], v[188:191], v[136:139], v[92:95]
v_mfma_f32_16x16x32_bf16 v[96:99], v[160:163], v[140:143], v[96:99]
v_mfma_f32_16x16x32_bf16 v[100:103], v[164:167], v[140:143], v[100:103]
v_mfma_f32_16x16x32_bf16 v[104:107], v[168:171], v[140:143], v[104:107]
v_mfma_f32_16x16x32_bf16 v[108:111], v[172:175], v[140:143], v[108:111]
v_mfma_f32_16x16x32_bf16 v[112:115], v[176:179], v[140:143], v[112:115]
v_mfma_f32_16x16x32_bf16 v[116:119], v[180:183], v[140:143], v[116:119]
v_mfma_f32_16x16x32_bf16 v[120:123], v[184:187], v[140:143], v[120:123]
v_mfma_f32_16x16x32_bf16 v[124:127], v[188:191], v[140:143], v[124:127]
s_waitcnt lgkmcnt(15)
v_mfma_f32_16x16x32_bf16 v[0:3], v[192:195], v[144:147], v[0:3]
v_mfma_f32_16x16x32_bf16 v[4:7], v[196:199], v[144:147], v[4:7]
s_waitcnt lgkmcnt(13)
v_mfma_f32_16x16x32_bf16 v[8:11], v[200:203], v[144:147], v[8:11]
s_waitcnt lgkmcnt(11)
v_mfma_f32_16x16x32_bf16 v[12:15], v[204:207], v[144:147], v[12:15]
s_waitcnt lgkmcnt(9)
v_mfma_f32_16x16x32_bf16 v[16:19], v[208:211], v[144:147], v[16:19]
s_waitcnt lgkmcnt(7)
v_mfma_f32_16x16x32_bf16 v[20:23], v[212:215], v[144:147], v[20:23]
s_waitcnt lgkmcnt(5)
v_mfma_f32_16x16x32_bf16 v[24:27], v[216:219], v[144:147], v[24:27]
s_waitcnt lgkmcnt(3)
v_mfma_f32_16x16x32_bf16 v[28:31], v[220:223], v[144:147], v[28:31]
s_waitcnt lgkmcnt(2)
v_mfma_f32_16x16x32_bf16 v[32:35], v[192:195], v[148:151], v[32:35]
s_waitcnt lgkmcnt(0)
s_barrier
ds_read_b64_tr_b16 v[160:161], v226 offset:0
v_mfma_f32_16x16x32_bf16 v[36:39], v[196:199], v[148:151], v[36:39]
ds_read_b64_tr_b16 v[162:163], v226 offset:2048
v_mfma_f32_16x16x32_bf16 v[40:43], v[200:203], v[148:151], v[40:43]
ds_read_b128 v[128:131], v224 offset:0
v_mfma_f32_16x16x32_bf16 v[44:47], v[204:207], v[148:151], v[44:47]
ds_read_b64_tr_b16 v[164:165], v227 offset:0
v_mfma_f32_16x16x32_bf16 v[48:51], v[208:211], v[148:151], v[48:51]
ds_read_b64_tr_b16 v[166:167], v227 offset:2048
v_mfma_f32_16x16x32_bf16 v[52:55], v[212:215], v[148:151], v[52:55]
ds_read_b64_tr_b16 v[168:169], v228 offset:0
v_mfma_f32_16x16x32_bf16 v[56:59], v[216:219], v[148:151], v[56:59]
ds_read_b64_tr_b16 v[170:171], v228 offset:2048
v_mfma_f32_16x16x32_bf16 v[60:63], v[220:223], v[148:151], v[60:63]
ds_read_b64_tr_b16 v[172:173], v229 offset:0
v_mfma_f32_16x16x32_bf16 v[64:67], v[192:195], v[152:155], v[64:67]
ds_read_b64_tr_b16 v[174:175], v229 offset:2048
v_mfma_f32_16x16x32_bf16 v[68:71], v[196:199], v[152:155], v[68:71]
ds_read_b64_tr_b16 v[176:177], v230 offset:0
v_mfma_f32_16x16x32_bf16 v[72:75], v[200:203], v[152:155], v[72:75]
ds_read_b64_tr_b16 v[178:179], v230 offset:2048
v_mfma_f32_16x16x32_bf16 v[76:79], v[204:207], v[152:155], v[76:79]
ds_read_b64_tr_b16 v[180:181], v231 offset:0
v_mfma_f32_16x16x32_bf16 v[80:83], v[208:211], v[152:155], v[80:83]
ds_read_b64_tr_b16 v[182:183], v231 offset:2048
v_mfma_f32_16x16x32_bf16 v[84:87], v[212:215], v[152:155], v[84:87]
ds_read_b64_tr_b16 v[184:185], v232 offset:0
v_mfma_f32_16x16x32_bf16 v[88:91], v[216:219], v[152:155], v[88:91]
ds_read_b64_tr_b16 v[186:187], v232 offset:2048
v_mfma_f32_16x16x32_bf16 v[92:95], v[220:223], v[152:155], v[92:95]
ds_read_b64_tr_b16 v[188:189], v233 offset:0
v_mfma_f32_16x16x32_bf16 v[96:99], v[192:195], v[156:159], v[96:99]
ds_read_b64_tr_b16 v[190:191], v233 offset:2048
v_mfma_f32_16x16x32_bf16 v[100:103], v[196:199], v[156:159], v[100:103]
ds_read_b128 v[132:135], v224 offset:2048
v_mfma_f32_16x16x32_bf16 v[104:107], v[200:203], v[156:159], v[104:107]
ds_read_b128 v[136:139], v224 offset:4096
v_mfma_f32_16x16x32_bf16 v[108:111], v[204:207], v[156:159], v[108:111]
ds_read_b128 v[140:143], v224 offset:6144
v_mfma_f32_16x16x32_bf16 v[112:115], v[208:211], v[156:159], v[112:115]
v_mfma_f32_16x16x32_bf16 v[116:119], v[212:215], v[156:159], v[116:119]
v_mfma_f32_16x16x32_bf16 v[120:123], v[216:219], v[156:159], v[120:123]
v_mfma_f32_16x16x32_bf16 v[124:127], v[220:223], v[156:159], v[124:127]
s_waitcnt lgkmcnt(15)
v_mfma_f32_16x16x32_bf16 v[0:3], v[160:163], v[128:131], v[0:3]
ds_read_b64_tr_b16 v[192:193], v226 offset:16384
v_mfma_f32_16x16x32_bf16 v[4:7], v[164:167], v[128:131], v[4:7]
ds_read_b64_tr_b16 v[194:195], v226 offset:18432
s_waitcnt lgkmcnt(15)
v_mfma_f32_16x16x32_bf16 v[8:11], v[168:171], v[128:131], v[8:11]
ds_read_b128 v[144:147], v225 offset:0
s_waitcnt lgkmcnt(14)
v_mfma_f32_16x16x32_bf16 v[12:15], v[172:175], v[128:131], v[12:15]
ds_read_b64_tr_b16 v[196:197], v227 offset:16384
s_waitcnt lgkmcnt(13)
v_mfma_f32_16x16x32_bf16 v[16:19], v[176:179], v[128:131], v[16:19]
ds_read_b64_tr_b16 v[198:199], v227 offset:18432
s_waitcnt lgkmcnt(12)
v_mfma_f32_16x16x32_bf16 v[20:23], v[180:183], v[128:131], v[20:23]
ds_read_b64_tr_b16 v[200:201], v228 offset:16384
s_waitcnt lgkmcnt(11)
v_mfma_f32_16x16x32_bf16 v[24:27], v[184:187], v[128:131], v[24:27]
ds_read_b64_tr_b16 v[202:203], v228 offset:18432
s_waitcnt lgkmcnt(10)
v_mfma_f32_16x16x32_bf16 v[28:31], v[188:191], v[128:131], v[28:31]
ds_read_b64_tr_b16 v[204:205], v229 offset:16384
s_waitcnt lgkmcnt(10)
v_mfma_f32_16x16x32_bf16 v[32:35], v[160:163], v[132:135], v[32:35]
ds_read_b64_tr_b16 v[206:207], v229 offset:18432
v_mfma_f32_16x16x32_bf16 v[36:39], v[164:167], v[132:135], v[36:39]
ds_read_b64_tr_b16 v[208:209], v230 offset:16384
v_mfma_f32_16x16x32_bf16 v[40:43], v[168:171], v[132:135], v[40:43]
ds_read_b64_tr_b16 v[210:211], v230 offset:18432
v_mfma_f32_16x16x32_bf16 v[44:47], v[172:175], v[132:135], v[44:47]
ds_read_b64_tr_b16 v[212:213], v231 offset:16384
v_mfma_f32_16x16x32_bf16 v[48:51], v[176:179], v[132:135], v[48:51]
ds_read_b64_tr_b16 v[214:215], v231 offset:18432
v_mfma_f32_16x16x32_bf16 v[52:55], v[180:183], v[132:135], v[52:55]
ds_read_b64_tr_b16 v[216:217], v232 offset:16384
v_mfma_f32_16x16x32_bf16 v[56:59], v[184:187], v[132:135], v[56:59]
ds_read_b64_tr_b16 v[218:219], v232 offset:18432
v_mfma_f32_16x16x32_bf16 v[60:63], v[188:191], v[132:135], v[60:63]
ds_read_b64_tr_b16 v[220:221], v233 offset:16384
s_waitcnt lgkmcnt(15)
v_mfma_f32_16x16x32_bf16 v[64:67], v[160:163], v[136:139], v[64:67]
ds_read_b64_tr_b16 v[222:223], v233 offset:18432
v_mfma_f32_16x16x32_bf16 v[68:71], v[164:167], v[136:139], v[68:71]
ds_read_b128 v[148:151], v225 offset:2048
v_mfma_f32_16x16x32_bf16 v[72:75], v[168:171], v[136:139], v[72:75]
ds_read_b128 v[152:155], v225 offset:4096
v_mfma_f32_16x16x32_bf16 v[76:79], v[172:175], v[136:139], v[76:79]
ds_read_b128 v[156:159], v225 offset:6144
v_mfma_f32_16x16x32_bf16 v[80:83], v[176:179], v[136:139], v[80:83]
v_mfma_f32_16x16x32_bf16 v[84:87], v[180:183], v[136:139], v[84:87]
v_mfma_f32_16x16x32_bf16 v[88:91], v[184:187], v[136:139], v[88:91]
v_mfma_f32_16x16x32_bf16 v[92:95], v[188:191], v[136:139], v[92:95]
v_mfma_f32_16x16x32_bf16 v[96:99], v[160:163], v[140:143], v[96:99]
v_mfma_f32_16x16x32_bf16 v[100:103], v[164:167], v[140:143], v[100:103]
v_mfma_f32_16x16x32_bf16 v[104:107], v[168:171], v[140:143], v[104:107]
v_mfma_f32_16x16x32_bf16 v[108:111], v[172:175], v[140:143], v[108:111]
v_mfma_f32_16x16x32_bf16 v[112:115], v[176:179], v[140:143], v[112:115]
v_mfma_f32_16x16x32_bf16 v[116:119], v[180:183], v[140:143], v[116:119]
v_mfma_f32_16x16x32_bf16 v[120:123], v[184:187], v[140:143], v[120:123]
v_mfma_f32_16x16x32_bf16 v[124:127], v[188:191], v[140:143], v[124:127]
s_waitcnt lgkmcnt(15)
v_mfma_f32_16x16x32_bf16 v[0:3], v[192:195], v[144:147], v[0:3]
v_mfma_f32_16x16x32_bf16 v[4:7], v[196:199], v[144:147], v[4:7]
s_waitcnt lgkmcnt(13)
v_mfma_f32_16x16x32_bf16 v[8:11], v[200:203], v[144:147], v[8:11]
s_waitcnt lgkmcnt(11)
v_mfma_f32_16x16x32_bf16 v[12:15], v[204:207], v[144:147], v[12:15]
s_waitcnt lgkmcnt(9)
v_mfma_f32_16x16x32_bf16 v[16:19], v[208:211], v[144:147], v[16:19]
s_waitcnt lgkmcnt(7)
v_mfma_f32_16x16x32_bf16 v[20:23], v[212:215], v[144:147], v[20:23]
s_waitcnt lgkmcnt(5)
v_mfma_f32_16x16x32_bf16 v[24:27], v[216:219], v[144:147], v[24:27]
s_waitcnt lgkmcnt(3)
v_mfma_f32_16x16x32_bf16 v[28:31], v[220:223], v[144:147], v[28:31]
s_waitcnt lgkmcnt(2)
v_mfma_f32_16x16x32_bf16 v[32:35], v[192:195], v[148:151], v[32:35]
s_waitcnt lgkmcnt(0)
s_barrier
v_mfma_f32_16x16x32_bf16 v[36:39], v[196:199], v[148:151], v[36:39]
v_mfma_f32_16x16x32_bf16 v[40:43], v[200:203], v[148:151], v[40:43]
v_mfma_f32_16x16x32_bf16 v[44:47], v[204:207], v[148:151], v[44:47]
v_mfma_f32_16x16x32_bf16 v[48:51], v[208:211], v[148:151], v[48:51]
v_mfma_f32_16x16x32_bf16 v[52:55], v[212:215], v[148:151], v[52:55]
v_mfma_f32_16x16x32_bf16 v[56:59], v[216:219], v[148:151], v[56:59]
v_mfma_f32_16x16x32_bf16 v[60:63], v[220:223], v[148:151], v[60:63]
v_mfma_f32_16x16x32_bf16 v[64:67], v[192:195], v[152:155], v[64:67]
v_mfma_f32_16x16x32_bf16 v[68:71], v[196:199], v[152:155], v[68:71]
v_mfma_f32_16x16x32_bf16 v[72:75], v[200:203], v[152:155], v[72:75]
v_mfma_f32_16x16x32_bf16 v[76:79], v[204:207], v[152:155], v[76:79]
v_mfma_f32_16x16x32_bf16 v[80:83], v[208:211], v[152:155], v[80:83]
v_mfma_f32_16x16x32_bf16 v[84:87], v[212:215], v[152:155], v[84:87]
v_mfma_f32_16x16x32_bf16 v[88:91], v[216:219], v[152:155], v[88:91]
v_mfma_f32_16x16x32_bf16 v[92:95], v[220:223], v[152:155], v[92:95]
v_mfma_f32_16x16x32_bf16 v[96:99], v[192:195], v[156:159], v[96:99]
v_mfma_f32_16x16x32_bf16 v[100:103], v[196:199], v[156:159], v[100:103]
v_mfma_f32_16x16x32_bf16 v[104:107], v[200:203], v[156:159], v[104:107]
v_mfma_f32_16x16x32_bf16 v[108:111], v[204:207], v[156:159], v[108:111]
v_mfma_f32_16x16x32_bf16 v[112:115], v[208:211], v[156:159], v[112:115]
v_mfma_f32_16x16x32_bf16 v[116:119], v[212:215], v[156:159], v[116:119]
v_mfma_f32_16x16x32_bf16 v[120:123], v[216:219], v[156:159], v[120:123]
v_mfma_f32_16x16x32_bf16 v[124:127], v[220:223], v[156:159], v[124:127]
s_lshr_b32 s31, s20, 1
s_and_b32 s32, s20, 1
s_mul_i32 s31, s31, 64
s_add_u32 s31, s31, s21
s_mul_i32 s32, s32, 256
s_add_u32 s32, s32, s22
v_and_b32 v234, 15, v254
v_add_u32 v234, s31, v234
v_mul_u32_u24 v234, 7168, v234
v_add_u32 v234, s32, v234
v_bfe_u32 v236, v254, 5, 1
v_lshl_add_u32 v234, v236, 4, v234
v_bfe_u32 v236, v254, 4, 1
v_lshl_add_u32 v234, v236, 5, v234
s_lshr_b32 s31, s20, 1
s_and_b32 s32, s20, 1
s_lshl_b32 s31, s31, 9
s_add_u32 s31, s31, 154176
v_and_b32 v237, 15, v254
v_lshl_add_u32 v237, v237, 3, s31
s_mul_i32 s32, s32, 512
s_add_u32 s32, s32, 155200
v_and_b32 v238, 48, v254
v_add_u32 v238, s32, v238
ds_read_b64 v[128:129], v237 offset:0
ds_read_b64 v[130:131], v237 offset:128
ds_read_b64 v[132:133], v237 offset:256
ds_read_b64 v[134:135], v237 offset:384
ds_read_b128 v[176:179], v238 offset:0
ds_read_b128 v[180:183], v238 offset:64
ds_read_b128 v[184:187], v238 offset:128
ds_read_b128 v[188:191], v238 offset:192
ds_read_b128 v[192:195], v238 offset:256
ds_read_b128 v[196:199], v238 offset:320
ds_read_b128 v[200:203], v238 offset:384
ds_read_b128 v[204:207], v238 offset:448
s_lshr_b32 s31, s20, 1
s_lshl_b32 s31, s31, 10
s_add_u32 s31, s31, 147456
v_and_b32 v239, 15, v254
v_lshl_add_u32 v239, v239, 4, s31
ds_read_b32 v136, v239 offset:8
ds_read_b32 v137, v239 offset:264
ds_read_b32 v138, v239 offset:520
ds_read_b32 v139, v239 offset:776
s_waitcnt lgkmcnt(0)
v_sub_f32 v136, 1.0, v136
v_max_f32 v136, 228737632, v136
v_mul_f32 v136, v136, v128
v_max_f32 v136, 61482021, v136
v_sub_f32 v160, 0, v129
v_rcp_f32 v161, v136
v_mul_f32 v162, v128, v128
v_mul_f32 v163, 3222493025, v128
v_sub_f32 v137, 1.0, v137
v_max_f32 v137, 228737632, v137
v_mul_f32 v137, v137, v130
v_max_f32 v137, 61482021, v137
v_sub_f32 v164, 0, v131
v_rcp_f32 v165, v137
v_mul_f32 v166, v130, v130
v_mul_f32 v167, 3222493025, v130
v_sub_f32 v138, 1.0, v138
v_max_f32 v138, 228737632, v138
v_mul_f32 v138, v138, v132
v_max_f32 v138, 61482021, v138
v_sub_f32 v168, 0, v133
v_rcp_f32 v169, v138
v_mul_f32 v170, v132, v132
v_mul_f32 v171, 3222493025, v132
v_sub_f32 v139, 1.0, v139
v_max_f32 v139, 228737632, v139
v_mul_f32 v139, v139, v134
v_max_f32 v139, 61482021, v139
v_sub_f32 v172, 0, v135
v_rcp_f32 v173, v139
v_mul_f32 v174, v134, v134
v_mul_f32 v175, 3222493025, v134
v_mul_f32 v162, v162, v128
v_mul_f32 v162, 3184710632, v162
v_mul_f32 v166, v166, v130
v_mul_f32 v166, 3184710632, v166
v_mul_f32 v170, v170, v132
v_mul_f32 v170, 3184710632, v170
v_mul_f32 v174, v174, v134
v_mul_f32 v174, 3184710632, v174
v_pk_fma_f32 v[0:1], v[176:177], v[160:161], v[0:1] op_sel_hi:[1,0,1]
v_pk_fma_f32 v[2:3], v[178:179], v[160:161], v[2:3] op_sel_hi:[1,0,1]
v_pk_fma_f32 v[4:5], v[180:181], v[160:161], v[4:5] op_sel_hi:[1,0,1]
v_pk_fma_f32 v[6:7], v[182:183], v[160:161], v[6:7] op_sel_hi:[1,0,1]
v_pk_mul_f32 v[136:137], v[0:1], v[0:1]
v_pk_mul_f32 v[138:139], v[2:3], v[2:3]
v_pk_mul_f32 v[140:141], v[4:5], v[4:5]
v_pk_mul_f32 v[142:143], v[6:7], v[6:7]
v_pk_fma_f32 v[136:137], v[136:137], v[162:163], v[162:163] op_sel:[0,0,1] op_sel_hi:[1,0,1]
v_pk_fma_f32 v[138:139], v[138:139], v[162:163], v[162:163] op_sel:[0,0,1] op_sel_hi:[1,0,1]
v_pk_fma_f32 v[140:141], v[140:141], v[162:163], v[162:163] op_sel:[0,0,1] op_sel_hi:[1,0,1]
v_pk_fma_f32 v[142:143], v[142:143], v[162:163], v[162:163] op_sel:[0,0,1] op_sel_hi:[1,0,1]
v_pk_mul_f32 v[136:137], v[136:137], v[0:1]
v_pk_mul_f32 v[138:139], v[138:139], v[2:3]
v_pk_mul_f32 v[140:141], v[140:141], v[4:5]
v_pk_mul_f32 v[142:143], v[142:143], v[6:7]
v_exp_f32 v136, v136
v_exp_f32 v137, v137
v_exp_f32 v138, v138
v_exp_f32 v139, v139
v_exp_f32 v140, v140
v_exp_f32 v141, v141
v_exp_f32 v142, v142
v_exp_f32 v143, v143
v_pk_fma_f32 v[136:137], v[136:137], v[160:161], v[160:161] op_sel:[0,1,1] op_sel_hi:[1,1,1]
v_pk_fma_f32 v[138:139], v[138:139], v[160:161], v[160:161] op_sel:[0,1,1] op_sel_hi:[1,1,1]
v_pk_fma_f32 v[140:141], v[140:141], v[160:161], v[160:161] op_sel:[0,1,1] op_sel_hi:[1,1,1]
v_pk_fma_f32 v[142:143], v[142:143], v[160:161], v[160:161] op_sel:[0,1,1] op_sel_hi:[1,1,1]
v_rcp_f32 v136, v136
v_rcp_f32 v137, v137
v_rcp_f32 v138, v138
v_rcp_f32 v139, v139
v_rcp_f32 v140, v140
v_rcp_f32 v141, v141
v_rcp_f32 v142, v142
v_rcp_f32 v143, v143
v_pk_mul_f32 v[0:1], v[0:1], v[136:137]
v_pk_mul_f32 v[2:3], v[2:3], v[138:139]
v_pk_mul_f32 v[4:5], v[4:5], v[140:141]
v_pk_mul_f32 v[6:7], v[6:7], v[142:143]
v_pk_fma_f32 v[8:9], v[184:185], v[160:161], v[8:9] op_sel_hi:[1,0,1]
v_pk_fma_f32 v[10:11], v[186:187], v[160:161], v[10:11] op_sel_hi:[1,0,1]
v_pk_fma_f32 v[12:13], v[188:189], v[160:161], v[12:13] op_sel_hi:[1,0,1]
v_cvt_pk_bf16_f32 v144, v0, v1
v_pk_fma_f32 v[14:15], v[190:191], v[160:161], v[14:15] op_sel_hi:[1,0,1]
v_pk_mul_f32 v[136:137], v[8:9], v[8:9]
v_pk_mul_f32 v[138:139], v[10:11], v[10:11]
v_cvt_pk_bf16_f32 v145, v2, v3
v_pk_mul_f32 v[140:141], v[12:13], v[12:13]
v_pk_mul_f32 v[142:143], v[14:15], v[14:15]
v_pk_fma_f32 v[136:137], v[136:137], v[162:163], v[162:163] op_sel:[0,0,1] op_sel_hi:[1,0,1]
v_cvt_pk_bf16_f32 v146, v4, v5
v_pk_fma_f32 v[138:139], v[138:139], v[162:163], v[162:163] op_sel:[0,0,1] op_sel_hi:[1,0,1]
v_pk_fma_f32 v[140:141], v[140:141], v[162:163], v[162:163] op_sel:[0,0,1] op_sel_hi:[1,0,1]
v_pk_fma_f32 v[142:143], v[142:143], v[162:163], v[162:163] op_sel:[0,0,1] op_sel_hi:[1,0,1]
v_cvt_pk_bf16_f32 v147, v6, v7
v_pk_mul_f32 v[136:137], v[136:137], v[8:9]
v_pk_mul_f32 v[138:139], v[138:139], v[10:11]
v_pk_mul_f32 v[140:141], v[140:141], v[12:13]
s_mov_b32 s34, 16777216
v_pk_mul_f32 v[142:143], v[142:143], v[14:15]
v_exp_f32 v136, v136
v_exp_f32 v137, v137
v_permlane16_swap_b32 v144, v146
v_exp_f32 v138, v138
v_exp_f32 v139, v139
v_exp_f32 v140, v140
v_permlane16_swap_b32 v145, v147
v_exp_f32 v141, v141
v_exp_f32 v142, v142
v_exp_f32 v143, v143
buffer_store_dwordx4 v[144:147], v234, s[16:19], s34 offen offset:0 sc0 sc1
v_pk_fma_f32 v[136:137], v[136:137], v[160:161], v[160:161] op_sel:[0,1,1] op_sel_hi:[1,1,1]
v_pk_fma_f32 v[138:139], v[138:139], v[160:161], v[160:161] op_sel:[0,1,1] op_sel_hi:[1,1,1]
v_pk_fma_f32 v[140:141], v[140:141], v[160:161], v[160:161] op_sel:[0,1,1] op_sel_hi:[1,1,1]
v_pk_fma_f32 v[142:143], v[142:143], v[160:161], v[160:161] op_sel:[0,1,1] op_sel_hi:[1,1,1]
v_rcp_f32 v136, v136
v_rcp_f32 v137, v137
v_rcp_f32 v138, v138
v_rcp_f32 v139, v139
v_rcp_f32 v140, v140
v_rcp_f32 v141, v141
v_rcp_f32 v142, v142
v_rcp_f32 v143, v143
v_pk_mul_f32 v[8:9], v[8:9], v[136:137]
v_pk_mul_f32 v[10:11], v[10:11], v[138:139]
v_pk_mul_f32 v[12:13], v[12:13], v[140:141]
v_pk_mul_f32 v[14:15], v[14:15], v[142:143]
v_pk_fma_f32 v[16:17], v[192:193], v[160:161], v[16:17] op_sel_hi:[1,0,1]
v_pk_fma_f32 v[18:19], v[194:195], v[160:161], v[18:19] op_sel_hi:[1,0,1]
v_pk_fma_f32 v[20:21], v[196:197], v[160:161], v[20:21] op_sel_hi:[1,0,1]
v_cvt_pk_bf16_f32 v148, v8, v9
v_pk_fma_f32 v[22:23], v[198:199], v[160:161], v[22:23] op_sel_hi:[1,0,1]
v_pk_mul_f32 v[136:137], v[16:17], v[16:17]
v_pk_mul_f32 v[138:139], v[18:19], v[18:19]
v_cvt_pk_bf16_f32 v149, v10, v11
v_pk_mul_f32 v[140:141], v[20:21], v[20:21]
v_pk_mul_f32 v[142:143], v[22:23], v[22:23]
v_pk_fma_f32 v[136:137], v[136:137], v[162:163], v[162:163] op_sel:[0,0,1] op_sel_hi:[1,0,1]
v_cvt_pk_bf16_f32 v150, v12, v13
v_pk_fma_f32 v[138:139], v[138:139], v[162:163], v[162:163] op_sel:[0,0,1] op_sel_hi:[1,0,1]
v_pk_fma_f32 v[140:141], v[140:141], v[162:163], v[162:163] op_sel:[0,0,1] op_sel_hi:[1,0,1]
v_pk_fma_f32 v[142:143], v[142:143], v[162:163], v[162:163] op_sel:[0,0,1] op_sel_hi:[1,0,1]
v_cvt_pk_bf16_f32 v151, v14, v15
v_pk_mul_f32 v[136:137], v[136:137], v[16:17]
v_pk_mul_f32 v[138:139], v[138:139], v[18:19]
v_pk_mul_f32 v[140:141], v[140:141], v[20:21]
s_mov_b32 s34, 16777216
v_pk_mul_f32 v[142:143], v[142:143], v[22:23]
v_exp_f32 v136, v136
v_exp_f32 v137, v137
v_permlane16_swap_b32 v148, v150
v_exp_f32 v138, v138
v_exp_f32 v139, v139
v_exp_f32 v140, v140
v_permlane16_swap_b32 v149, v151
v_exp_f32 v141, v141
v_exp_f32 v142, v142
v_exp_f32 v143, v143
buffer_store_dwordx4 v[148:151], v234, s[16:19], s34 offen offset:64 sc0 sc1
v_pk_fma_f32 v[136:137], v[136:137], v[160:161], v[160:161] op_sel:[0,1,1] op_sel_hi:[1,1,1]
v_pk_fma_f32 v[138:139], v[138:139], v[160:161], v[160:161] op_sel:[0,1,1] op_sel_hi:[1,1,1]
v_pk_fma_f32 v[140:141], v[140:141], v[160:161], v[160:161] op_sel:[0,1,1] op_sel_hi:[1,1,1]
v_pk_fma_f32 v[142:143], v[142:143], v[160:161], v[160:161] op_sel:[0,1,1] op_sel_hi:[1,1,1]
v_rcp_f32 v136, v136
v_rcp_f32 v137, v137
v_rcp_f32 v138, v138
v_rcp_f32 v139, v139
v_rcp_f32 v140, v140
v_rcp_f32 v141, v141
v_rcp_f32 v142, v142
v_rcp_f32 v143, v143
v_pk_mul_f32 v[16:17], v[16:17], v[136:137]
v_pk_mul_f32 v[18:19], v[18:19], v[138:139]
v_pk_mul_f32 v[20:21], v[20:21], v[140:141]
v_pk_mul_f32 v[22:23], v[22:23], v[142:143]
v_pk_fma_f32 v[24:25], v[200:201], v[160:161], v[24:25] op_sel_hi:[1,0,1]
v_pk_fma_f32 v[26:27], v[202:203], v[160:161], v[26:27] op_sel_hi:[1,0,1]
v_pk_fma_f32 v[28:29], v[204:205], v[160:161], v[28:29] op_sel_hi:[1,0,1]
v_cvt_pk_bf16_f32 v152, v16, v17
v_pk_fma_f32 v[30:31], v[206:207], v[160:161], v[30:31] op_sel_hi:[1,0,1]
v_pk_mul_f32 v[136:137], v[24:25], v[24:25]
v_pk_mul_f32 v[138:139], v[26:27], v[26:27]
v_cvt_pk_bf16_f32 v153, v18, v19
v_pk_mul_f32 v[140:141], v[28:29], v[28:29]
v_pk_mul_f32 v[142:143], v[30:31], v[30:31]
v_pk_fma_f32 v[136:137], v[136:137], v[162:163], v[162:163] op_sel:[0,0,1] op_sel_hi:[1,0,1]
v_cvt_pk_bf16_f32 v154, v20, v21
v_pk_fma_f32 v[138:139], v[138:139], v[162:163], v[162:163] op_sel:[0,0,1] op_sel_hi:[1,0,1]
v_pk_fma_f32 v[140:141], v[140:141], v[162:163], v[162:163] op_sel:[0,0,1] op_sel_hi:[1,0,1]
v_pk_fma_f32 v[142:143], v[142:143], v[162:163], v[162:163] op_sel:[0,0,1] op_sel_hi:[1,0,1]
v_cvt_pk_bf16_f32 v155, v22, v23
v_pk_mul_f32 v[136:137], v[136:137], v[24:25]
v_pk_mul_f32 v[138:139], v[138:139], v[26:27]
v_pk_mul_f32 v[140:141], v[140:141], v[28:29]
s_mov_b32 s34, 16777216
v_pk_mul_f32 v[142:143], v[142:143], v[30:31]
v_exp_f32 v136, v136
v_exp_f32 v137, v137
v_permlane16_swap_b32 v152, v154
v_exp_f32 v138, v138
v_exp_f32 v139, v139
v_exp_f32 v140, v140
v_permlane16_swap_b32 v153, v155
v_exp_f32 v141, v141
v_exp_f32 v142, v142
v_exp_f32 v143, v143
buffer_store_dwordx4 v[152:155], v234, s[16:19], s34 offen offset:128 sc0 sc1
v_pk_fma_f32 v[136:137], v[136:137], v[160:161], v[160:161] op_sel:[0,1,1] op_sel_hi:[1,1,1]
v_pk_fma_f32 v[138:139], v[138:139], v[160:161], v[160:161] op_sel:[0,1,1] op_sel_hi:[1,1,1]
v_pk_fma_f32 v[140:141], v[140:141], v[160:161], v[160:161] op_sel:[0,1,1] op_sel_hi:[1,1,1]
v_pk_fma_f32 v[142:143], v[142:143], v[160:161], v[160:161] op_sel:[0,1,1] op_sel_hi:[1,1,1]
v_rcp_f32 v136, v136
v_rcp_f32 v137, v137
v_rcp_f32 v138, v138
v_rcp_f32 v139, v139
v_rcp_f32 v140, v140
v_rcp_f32 v141, v141
v_rcp_f32 v142, v142
v_rcp_f32 v143, v143
v_pk_mul_f32 v[24:25], v[24:25], v[136:137]
v_pk_mul_f32 v[26:27], v[26:27], v[138:139]
v_pk_mul_f32 v[28:29], v[28:29], v[140:141]
v_pk_mul_f32 v[30:31], v[30:31], v[142:143]
v_pk_fma_f32 v[32:33], v[176:177], v[164:165], v[32:33] op_sel_hi:[1,0,1]
v_pk_fma_f32 v[34:35], v[178:179], v[164:165], v[34:35] op_sel_hi:[1,0,1]
v_pk_fma_f32 v[36:37], v[180:181], v[164:165], v[36:37] op_sel_hi:[1,0,1]
v_cvt_pk_bf16_f32 v156, v24, v25
v_pk_fma_f32 v[38:39], v[182:183], v[164:165], v[38:39] op_sel_hi:[1,0,1]
v_pk_mul_f32 v[136:137], v[32:33], v[32:33]
v_pk_mul_f32 v[138:139], v[34:35], v[34:35]
v_cvt_pk_bf16_f32 v157, v26, v27
v_pk_mul_f32 v[140:141], v[36:37], v[36:37]
v_pk_mul_f32 v[142:143], v[38:39], v[38:39]
v_pk_fma_f32 v[136:137], v[136:137], v[166:167], v[166:167] op_sel:[0,0,1] op_sel_hi:[1,0,1]
v_cvt_pk_bf16_f32 v158, v28, v29
v_pk_fma_f32 v[138:139], v[138:139], v[166:167], v[166:167] op_sel:[0,0,1] op_sel_hi:[1,0,1]
v_pk_fma_f32 v[140:141], v[140:141], v[166:167], v[166:167] op_sel:[0,0,1] op_sel_hi:[1,0,1]
v_pk_fma_f32 v[142:143], v[142:143], v[166:167], v[166:167] op_sel:[0,0,1] op_sel_hi:[1,0,1]
v_cvt_pk_bf16_f32 v159, v30, v31
v_pk_mul_f32 v[136:137], v[136:137], v[32:33]
v_pk_mul_f32 v[138:139], v[138:139], v[34:35]
v_pk_mul_f32 v[140:141], v[140:141], v[36:37]
s_mov_b32 s34, 16777216
v_pk_mul_f32 v[142:143], v[142:143], v[38:39]
v_exp_f32 v136, v136
v_exp_f32 v137, v137
v_permlane16_swap_b32 v156, v158
v_exp_f32 v138, v138
v_exp_f32 v139, v139
v_exp_f32 v140, v140
v_permlane16_swap_b32 v157, v159
v_exp_f32 v141, v141
v_exp_f32 v142, v142
v_exp_f32 v143, v143
buffer_store_dwordx4 v[156:159], v234, s[16:19], s34 offen offset:192 sc0 sc1
v_pk_fma_f32 v[136:137], v[136:137], v[164:165], v[164:165] op_sel:[0,1,1] op_sel_hi:[1,1,1]
v_pk_fma_f32 v[138:139], v[138:139], v[164:165], v[164:165] op_sel:[0,1,1] op_sel_hi:[1,1,1]
v_pk_fma_f32 v[140:141], v[140:141], v[164:165], v[164:165] op_sel:[0,1,1] op_sel_hi:[1,1,1]
v_pk_fma_f32 v[142:143], v[142:143], v[164:165], v[164:165] op_sel:[0,1,1] op_sel_hi:[1,1,1]
v_rcp_f32 v136, v136
v_rcp_f32 v137, v137
v_rcp_f32 v138, v138
v_rcp_f32 v139, v139
v_rcp_f32 v140, v140
v_rcp_f32 v141, v141
v_rcp_f32 v142, v142
v_rcp_f32 v143, v143
v_pk_mul_f32 v[32:33], v[32:33], v[136:137]
v_pk_mul_f32 v[34:35], v[34:35], v[138:139]
v_pk_mul_f32 v[36:37], v[36:37], v[140:141]
v_pk_mul_f32 v[38:39], v[38:39], v[142:143]
v_pk_fma_f32 v[40:41], v[184:185], v[164:165], v[40:41] op_sel_hi:[1,0,1]
v_pk_fma_f32 v[42:43], v[186:187], v[164:165], v[42:43] op_sel_hi:[1,0,1]
v_pk_fma_f32 v[44:45], v[188:189], v[164:165], v[44:45] op_sel_hi:[1,0,1]
v_cvt_pk_bf16_f32 v144, v32, v33
v_pk_fma_f32 v[46:47], v[190:191], v[164:165], v[46:47] op_sel_hi:[1,0,1]
v_pk_mul_f32 v[136:137], v[40:41], v[40:41]
v_pk_mul_f32 v[138:139], v[42:43], v[42:43]
v_cvt_pk_bf16_f32 v145, v34, v35
v_pk_mul_f32 v[140:141], v[44:45], v[44:45]
v_pk_mul_f32 v[142:143], v[46:47], v[46:47]
v_pk_fma_f32 v[136:137], v[136:137], v[166:167], v[166:167] op_sel:[0,0,1] op_sel_hi:[1,0,1]
v_cvt_pk_bf16_f32 v146, v36, v37
v_pk_fma_f32 v[138:139], v[138:139], v[166:167], v[166:167] op_sel:[0,0,1] op_sel_hi:[1,0,1]
v_pk_fma_f32 v[140:141], v[140:141], v[166:167], v[166:167] op_sel:[0,0,1] op_sel_hi:[1,0,1]
v_pk_fma_f32 v[142:143], v[142:143], v[166:167], v[166:167] op_sel:[0,0,1] op_sel_hi:[1,0,1]
v_cvt_pk_bf16_f32 v147, v38, v39
v_pk_mul_f32 v[136:137], v[136:137], v[40:41]
v_pk_mul_f32 v[138:139], v[138:139], v[42:43]
v_pk_mul_f32 v[140:141], v[140:141], v[44:45]
s_mov_b32 s34, 16891904
v_pk_mul_f32 v[142:143], v[142:143], v[46:47]
v_exp_f32 v136, v136
v_exp_f32 v137, v137
v_permlane16_swap_b32 v144, v146
v_exp_f32 v138, v138
v_exp_f32 v139, v139
v_exp_f32 v140, v140
v_permlane16_swap_b32 v145, v147
v_exp_f32 v141, v141
v_exp_f32 v142, v142
v_exp_f32 v143, v143
buffer_store_dwordx4 v[144:147], v234, s[16:19], s34 offen offset:0 sc0 sc1
v_pk_fma_f32 v[136:137], v[136:137], v[164:165], v[164:165] op_sel:[0,1,1] op_sel_hi:[1,1,1]
v_pk_fma_f32 v[138:139], v[138:139], v[164:165], v[164:165] op_sel:[0,1,1] op_sel_hi:[1,1,1]
v_pk_fma_f32 v[140:141], v[140:141], v[164:165], v[164:165] op_sel:[0,1,1] op_sel_hi:[1,1,1]
v_pk_fma_f32 v[142:143], v[142:143], v[164:165], v[164:165] op_sel:[0,1,1] op_sel_hi:[1,1,1]
v_rcp_f32 v136, v136
v_rcp_f32 v137, v137
v_rcp_f32 v138, v138
v_rcp_f32 v139, v139
v_rcp_f32 v140, v140
v_rcp_f32 v141, v141
v_rcp_f32 v142, v142
v_rcp_f32 v143, v143
v_pk_mul_f32 v[40:41], v[40:41], v[136:137]
v_pk_mul_f32 v[42:43], v[42:43], v[138:139]
v_pk_mul_f32 v[44:45], v[44:45], v[140:141]
v_pk_mul_f32 v[46:47], v[46:47], v[142:143]
v_pk_fma_f32 v[48:49], v[192:193], v[164:165], v[48:49] op_sel_hi:[1,0,1]
v_pk_fma_f32 v[50:51], v[194:195], v[164:165], v[50:51] op_sel_hi:[1,0,1]
v_pk_fma_f32 v[52:53], v[196:197], v[164:165], v[52:53] op_sel_hi:[1,0,1]
v_cvt_pk_bf16_f32 v148, v40, v41
v_pk_fma_f32 v[54:55], v[198:199], v[164:165], v[54:55] op_sel_hi:[1,0,1]
v_pk_mul_f32 v[136:137], v[48:49], v[48:49]
v_pk_mul_f32 v[138:139], v[50:51], v[50:51]
v_cvt_pk_bf16_f32 v149, v42, v43
v_pk_mul_f32 v[140:141], v[52:53], v[52:53]
v_pk_mul_f32 v[142:143], v[54:55], v[54:55]
v_pk_fma_f32 v[136:137], v[136:137], v[166:167], v[166:167] op_sel:[0,0,1] op_sel_hi:[1,0,1]
v_cvt_pk_bf16_f32 v150, v44, v45
v_pk_fma_f32 v[138:139], v[138:139], v[166:167], v[166:167] op_sel:[0,0,1] op_sel_hi:[1,0,1]
v_pk_fma_f32 v[140:141], v[140:141], v[166:167], v[166:167] op_sel:[0,0,1] op_sel_hi:[1,0,1]
v_pk_fma_f32 v[142:143], v[142:143], v[166:167], v[166:167] op_sel:[0,0,1] op_sel_hi:[1,0,1]
v_cvt_pk_bf16_f32 v151, v46, v47
v_pk_mul_f32 v[136:137], v[136:137], v[48:49]
v_pk_mul_f32 v[138:139], v[138:139], v[50:51]
v_pk_mul_f32 v[140:141], v[140:141], v[52:53]
s_mov_b32 s34, 16891904
v_pk_mul_f32 v[142:143], v[142:143], v[54:55]
v_exp_f32 v136, v136
v_exp_f32 v137, v137
v_permlane16_swap_b32 v148, v150
v_exp_f32 v138, v138
v_exp_f32 v139, v139
v_exp_f32 v140, v140
v_permlane16_swap_b32 v149, v151
v_exp_f32 v141, v141
v_exp_f32 v142, v142
v_exp_f32 v143, v143
buffer_store_dwordx4 v[148:151], v234, s[16:19], s34 offen offset:64 sc0 sc1
v_pk_fma_f32 v[136:137], v[136:137], v[164:165], v[164:165] op_sel:[0,1,1] op_sel_hi:[1,1,1]
v_pk_fma_f32 v[138:139], v[138:139], v[164:165], v[164:165] op_sel:[0,1,1] op_sel_hi:[1,1,1]
v_pk_fma_f32 v[140:141], v[140:141], v[164:165], v[164:165] op_sel:[0,1,1] op_sel_hi:[1,1,1]
v_pk_fma_f32 v[142:143], v[142:143], v[164:165], v[164:165] op_sel:[0,1,1] op_sel_hi:[1,1,1]
v_rcp_f32 v136, v136
v_rcp_f32 v137, v137
v_rcp_f32 v138, v138
v_rcp_f32 v139, v139
v_rcp_f32 v140, v140
v_rcp_f32 v141, v141
v_rcp_f32 v142, v142
v_rcp_f32 v143, v143
v_pk_mul_f32 v[48:49], v[48:49], v[136:137]
v_pk_mul_f32 v[50:51], v[50:51], v[138:139]
v_pk_mul_f32 v[52:53], v[52:53], v[140:141]
v_pk_mul_f32 v[54:55], v[54:55], v[142:143]
v_pk_fma_f32 v[56:57], v[200:201], v[164:165], v[56:57] op_sel_hi:[1,0,1]
v_pk_fma_f32 v[58:59], v[202:203], v[164:165], v[58:59] op_sel_hi:[1,0,1]
v_pk_fma_f32 v[60:61], v[204:205], v[164:165], v[60:61] op_sel_hi:[1,0,1]
v_cvt_pk_bf16_f32 v152, v48, v49
v_pk_fma_f32 v[62:63], v[206:207], v[164:165], v[62:63] op_sel_hi:[1,0,1]
v_pk_mul_f32 v[136:137], v[56:57], v[56:57]
v_pk_mul_f32 v[138:139], v[58:59], v[58:59]
v_cvt_pk_bf16_f32 v153, v50, v51
v_pk_mul_f32 v[140:141], v[60:61], v[60:61]
v_pk_mul_f32 v[142:143], v[62:63], v[62:63]
v_pk_fma_f32 v[136:137], v[136:137], v[166:167], v[166:167] op_sel:[0,0,1] op_sel_hi:[1,0,1]
v_cvt_pk_bf16_f32 v154, v52, v53
v_pk_fma_f32 v[138:139], v[138:139], v[166:167], v[166:167] op_sel:[0,0,1] op_sel_hi:[1,0,1]
v_pk_fma_f32 v[140:141], v[140:141], v[166:167], v[166:167] op_sel:[0,0,1] op_sel_hi:[1,0,1]
v_pk_fma_f32 v[142:143], v[142:143], v[166:167], v[166:167] op_sel:[0,0,1] op_sel_hi:[1,0,1]
v_cvt_pk_bf16_f32 v155, v54, v55
v_pk_mul_f32 v[136:137], v[136:137], v[56:57]
v_pk_mul_f32 v[138:139], v[138:139], v[58:59]
v_pk_mul_f32 v[140:141], v[140:141], v[60:61]
s_mov_b32 s34, 16891904
v_pk_mul_f32 v[142:143], v[142:143], v[62:63]
v_exp_f32 v136, v136
v_exp_f32 v137, v137
v_permlane16_swap_b32 v152, v154
v_exp_f32 v138, v138
v_exp_f32 v139, v139
v_exp_f32 v140, v140
v_permlane16_swap_b32 v153, v155
v_exp_f32 v141, v141
v_exp_f32 v142, v142
v_exp_f32 v143, v143
buffer_store_dwordx4 v[152:155], v234, s[16:19], s34 offen offset:128 sc0 sc1
v_pk_fma_f32 v[136:137], v[136:137], v[164:165], v[164:165] op_sel:[0,1,1] op_sel_hi:[1,1,1]
v_pk_fma_f32 v[138:139], v[138:139], v[164:165], v[164:165] op_sel:[0,1,1] op_sel_hi:[1,1,1]
v_pk_fma_f32 v[140:141], v[140:141], v[164:165], v[164:165] op_sel:[0,1,1] op_sel_hi:[1,1,1]
v_pk_fma_f32 v[142:143], v[142:143], v[164:165], v[164:165] op_sel:[0,1,1] op_sel_hi:[1,1,1]
v_rcp_f32 v136, v136
v_rcp_f32 v137, v137
v_rcp_f32 v138, v138
v_rcp_f32 v139, v139
v_rcp_f32 v140, v140
v_rcp_f32 v141, v141
v_rcp_f32 v142, v142
v_rcp_f32 v143, v143
v_pk_mul_f32 v[56:57], v[56:57], v[136:137]
v_pk_mul_f32 v[58:59], v[58:59], v[138:139]
v_pk_mul_f32 v[60:61], v[60:61], v[140:141]
v_pk_mul_f32 v[62:63], v[62:63], v[142:143]
v_pk_fma_f32 v[64:65], v[176:177], v[168:169], v[64:65] op_sel_hi:[1,0,1]
v_pk_fma_f32 v[66:67], v[178:179], v[168:169], v[66:67] op_sel_hi:[1,0,1]
v_pk_fma_f32 v[68:69], v[180:181], v[168:169], v[68:69] op_sel_hi:[1,0,1]
v_cvt_pk_bf16_f32 v156, v56, v57
v_pk_fma_f32 v[70:71], v[182:183], v[168:169], v[70:71] op_sel_hi:[1,0,1]
v_pk_mul_f32 v[136:137], v[64:65], v[64:65]
v_pk_mul_f32 v[138:139], v[66:67], v[66:67]
v_cvt_pk_bf16_f32 v157, v58, v59
v_pk_mul_f32 v[140:141], v[68:69], v[68:69]
v_pk_mul_f32 v[142:143], v[70:71], v[70:71]
v_pk_fma_f32 v[136:137], v[136:137], v[170:171], v[170:171] op_sel:[0,0,1] op_sel_hi:[1,0,1]
v_cvt_pk_bf16_f32 v158, v60, v61
v_pk_fma_f32 v[138:139], v[138:139], v[170:171], v[170:171] op_sel:[0,0,1] op_sel_hi:[1,0,1]
v_pk_fma_f32 v[140:141], v[140:141], v[170:171], v[170:171] op_sel:[0,0,1] op_sel_hi:[1,0,1]
v_pk_fma_f32 v[142:143], v[142:143], v[170:171], v[170:171] op_sel:[0,0,1] op_sel_hi:[1,0,1]
v_cvt_pk_bf16_f32 v159, v62, v63
v_pk_mul_f32 v[136:137], v[136:137], v[64:65]
v_pk_mul_f32 v[138:139], v[138:139], v[66:67]
v_pk_mul_f32 v[140:141], v[140:141], v[68:69]
s_mov_b32 s34, 16891904
v_pk_mul_f32 v[142:143], v[142:143], v[70:71]
v_exp_f32 v136, v136
v_exp_f32 v137, v137
v_permlane16_swap_b32 v156, v158
v_exp_f32 v138, v138
v_exp_f32 v139, v139
v_exp_f32 v140, v140
v_permlane16_swap_b32 v157, v159
v_exp_f32 v141, v141
v_exp_f32 v142, v142
v_exp_f32 v143, v143
buffer_store_dwordx4 v[156:159], v234, s[16:19], s34 offen offset:192 sc0 sc1
v_pk_fma_f32 v[136:137], v[136:137], v[168:169], v[168:169] op_sel:[0,1,1] op_sel_hi:[1,1,1]
v_pk_fma_f32 v[138:139], v[138:139], v[168:169], v[168:169] op_sel:[0,1,1] op_sel_hi:[1,1,1]
v_pk_fma_f32 v[140:141], v[140:141], v[168:169], v[168:169] op_sel:[0,1,1] op_sel_hi:[1,1,1]
v_pk_fma_f32 v[142:143], v[142:143], v[168:169], v[168:169] op_sel:[0,1,1] op_sel_hi:[1,1,1]
v_rcp_f32 v136, v136
v_rcp_f32 v137, v137
v_rcp_f32 v138, v138
v_rcp_f32 v139, v139
v_rcp_f32 v140, v140
v_rcp_f32 v141, v141
v_rcp_f32 v142, v142
v_rcp_f32 v143, v143
v_pk_mul_f32 v[64:65], v[64:65], v[136:137]
v_pk_mul_f32 v[66:67], v[66:67], v[138:139]
v_pk_mul_f32 v[68:69], v[68:69], v[140:141]
v_pk_mul_f32 v[70:71], v[70:71], v[142:143]
v_pk_fma_f32 v[72:73], v[184:185], v[168:169], v[72:73] op_sel_hi:[1,0,1]
v_pk_fma_f32 v[74:75], v[186:187], v[168:169], v[74:75] op_sel_hi:[1,0,1]
v_pk_fma_f32 v[76:77], v[188:189], v[168:169], v[76:77] op_sel_hi:[1,0,1]
v_cvt_pk_bf16_f32 v144, v64, v65
v_pk_fma_f32 v[78:79], v[190:191], v[168:169], v[78:79] op_sel_hi:[1,0,1]
v_pk_mul_f32 v[136:137], v[72:73], v[72:73]
v_pk_mul_f32 v[138:139], v[74:75], v[74:75]
v_cvt_pk_bf16_f32 v145, v66, v67
v_pk_mul_f32 v[140:141], v[76:77], v[76:77]
v_pk_mul_f32 v[142:143], v[78:79], v[78:79]
v_pk_fma_f32 v[136:137], v[136:137], v[170:171], v[170:171] op_sel:[0,0,1] op_sel_hi:[1,0,1]
v_cvt_pk_bf16_f32 v146, v68, v69
v_pk_fma_f32 v[138:139], v[138:139], v[170:171], v[170:171] op_sel:[0,0,1] op_sel_hi:[1,0,1]
v_pk_fma_f32 v[140:141], v[140:141], v[170:171], v[170:171] op_sel:[0,0,1] op_sel_hi:[1,0,1]
v_pk_fma_f32 v[142:143], v[142:143], v[170:171], v[170:171] op_sel:[0,0,1] op_sel_hi:[1,0,1]
v_cvt_pk_bf16_f32 v147, v70, v71
v_pk_mul_f32 v[136:137], v[136:137], v[72:73]
v_pk_mul_f32 v[138:139], v[138:139], v[74:75]
v_pk_mul_f32 v[140:141], v[140:141], v[76:77]
s_mov_b32 s34, 17006592
v_pk_mul_f32 v[142:143], v[142:143], v[78:79]
v_exp_f32 v136, v136
v_exp_f32 v137, v137
v_permlane16_swap_b32 v144, v146
v_exp_f32 v138, v138
v_exp_f32 v139, v139
v_exp_f32 v140, v140
v_permlane16_swap_b32 v145, v147
v_exp_f32 v141, v141
v_exp_f32 v142, v142
v_exp_f32 v143, v143
buffer_store_dwordx4 v[144:147], v234, s[16:19], s34 offen offset:0 sc0 sc1
v_pk_fma_f32 v[136:137], v[136:137], v[168:169], v[168:169] op_sel:[0,1,1] op_sel_hi:[1,1,1]
v_pk_fma_f32 v[138:139], v[138:139], v[168:169], v[168:169] op_sel:[0,1,1] op_sel_hi:[1,1,1]
v_pk_fma_f32 v[140:141], v[140:141], v[168:169], v[168:169] op_sel:[0,1,1] op_sel_hi:[1,1,1]
v_pk_fma_f32 v[142:143], v[142:143], v[168:169], v[168:169] op_sel:[0,1,1] op_sel_hi:[1,1,1]
v_rcp_f32 v136, v136
v_rcp_f32 v137, v137
v_rcp_f32 v138, v138
v_rcp_f32 v139, v139
v_rcp_f32 v140, v140
v_rcp_f32 v141, v141
v_rcp_f32 v142, v142
v_rcp_f32 v143, v143
v_pk_mul_f32 v[72:73], v[72:73], v[136:137]
v_pk_mul_f32 v[74:75], v[74:75], v[138:139]
v_pk_mul_f32 v[76:77], v[76:77], v[140:141]
v_pk_mul_f32 v[78:79], v[78:79], v[142:143]
v_pk_fma_f32 v[80:81], v[192:193], v[168:169], v[80:81] op_sel_hi:[1,0,1]
v_pk_fma_f32 v[82:83], v[194:195], v[168:169], v[82:83] op_sel_hi:[1,0,1]
v_pk_fma_f32 v[84:85], v[196:197], v[168:169], v[84:85] op_sel_hi:[1,0,1]
v_cvt_pk_bf16_f32 v148, v72, v73
v_pk_fma_f32 v[86:87], v[198:199], v[168:169], v[86:87] op_sel_hi:[1,0,1]
v_pk_mul_f32 v[136:137], v[80:81], v[80:81]
v_pk_mul_f32 v[138:139], v[82:83], v[82:83]
v_cvt_pk_bf16_f32 v149, v74, v75
v_pk_mul_f32 v[140:141], v[84:85], v[84:85]
v_pk_mul_f32 v[142:143], v[86:87], v[86:87]
v_pk_fma_f32 v[136:137], v[136:137], v[170:171], v[170:171] op_sel:[0,0,1] op_sel_hi:[1,0,1]
v_cvt_pk_bf16_f32 v150, v76, v77
v_pk_fma_f32 v[138:139], v[138:139], v[170:171], v[170:171] op_sel:[0,0,1] op_sel_hi:[1,0,1]
v_pk_fma_f32 v[140:141], v[140:141], v[170:171], v[170:171] op_sel:[0,0,1] op_sel_hi:[1,0,1]
v_pk_fma_f32 v[142:143], v[142:143], v[170:171], v[170:171] op_sel:[0,0,1] op_sel_hi:[1,0,1]
v_cvt_pk_bf16_f32 v151, v78, v79
v_pk_mul_f32 v[136:137], v[136:137], v[80:81]
v_pk_mul_f32 v[138:139], v[138:139], v[82:83]
v_pk_mul_f32 v[140:141], v[140:141], v[84:85]
s_mov_b32 s34, 17006592
v_pk_mul_f32 v[142:143], v[142:143], v[86:87]
v_exp_f32 v136, v136
v_exp_f32 v137, v137
v_permlane16_swap_b32 v148, v150
v_exp_f32 v138, v138
v_exp_f32 v139, v139
v_exp_f32 v140, v140
v_permlane16_swap_b32 v149, v151
v_exp_f32 v141, v141
v_exp_f32 v142, v142
v_exp_f32 v143, v143
buffer_store_dwordx4 v[148:151], v234, s[16:19], s34 offen offset:64 sc0 sc1
v_pk_fma_f32 v[136:137], v[136:137], v[168:169], v[168:169] op_sel:[0,1,1] op_sel_hi:[1,1,1]
v_pk_fma_f32 v[138:139], v[138:139], v[168:169], v[168:169] op_sel:[0,1,1] op_sel_hi:[1,1,1]
v_pk_fma_f32 v[140:141], v[140:141], v[168:169], v[168:169] op_sel:[0,1,1] op_sel_hi:[1,1,1]
v_pk_fma_f32 v[142:143], v[142:143], v[168:169], v[168:169] op_sel:[0,1,1] op_sel_hi:[1,1,1]
v_rcp_f32 v136, v136
v_rcp_f32 v137, v137
v_rcp_f32 v138, v138
v_rcp_f32 v139, v139
v_rcp_f32 v140, v140
v_rcp_f32 v141, v141
v_rcp_f32 v142, v142
v_rcp_f32 v143, v143
v_pk_mul_f32 v[80:81], v[80:81], v[136:137]
v_pk_mul_f32 v[82:83], v[82:83], v[138:139]
v_pk_mul_f32 v[84:85], v[84:85], v[140:141]
v_pk_mul_f32 v[86:87], v[86:87], v[142:143]
v_pk_fma_f32 v[88:89], v[200:201], v[168:169], v[88:89] op_sel_hi:[1,0,1]
v_pk_fma_f32 v[90:91], v[202:203], v[168:169], v[90:91] op_sel_hi:[1,0,1]
v_pk_fma_f32 v[92:93], v[204:205], v[168:169], v[92:93] op_sel_hi:[1,0,1]
v_cvt_pk_bf16_f32 v152, v80, v81
v_pk_fma_f32 v[94:95], v[206:207], v[168:169], v[94:95] op_sel_hi:[1,0,1]
v_pk_mul_f32 v[136:137], v[88:89], v[88:89]
v_pk_mul_f32 v[138:139], v[90:91], v[90:91]
v_cvt_pk_bf16_f32 v153, v82, v83
v_pk_mul_f32 v[140:141], v[92:93], v[92:93]
v_pk_mul_f32 v[142:143], v[94:95], v[94:95]
v_pk_fma_f32 v[136:137], v[136:137], v[170:171], v[170:171] op_sel:[0,0,1] op_sel_hi:[1,0,1]
v_cvt_pk_bf16_f32 v154, v84, v85
v_pk_fma_f32 v[138:139], v[138:139], v[170:171], v[170:171] op_sel:[0,0,1] op_sel_hi:[1,0,1]
v_pk_fma_f32 v[140:141], v[140:141], v[170:171], v[170:171] op_sel:[0,0,1] op_sel_hi:[1,0,1]
v_pk_fma_f32 v[142:143], v[142:143], v[170:171], v[170:171] op_sel:[0,0,1] op_sel_hi:[1,0,1]
v_cvt_pk_bf16_f32 v155, v86, v87
v_pk_mul_f32 v[136:137], v[136:137], v[88:89]
v_pk_mul_f32 v[138:139], v[138:139], v[90:91]
v_pk_mul_f32 v[140:141], v[140:141], v[92:93]
s_mov_b32 s34, 17006592
v_pk_mul_f32 v[142:143], v[142:143], v[94:95]
v_exp_f32 v136, v136
v_exp_f32 v137, v137
v_permlane16_swap_b32 v152, v154
v_exp_f32 v138, v138
v_exp_f32 v139, v139
v_exp_f32 v140, v140
v_permlane16_swap_b32 v153, v155
v_exp_f32 v141, v141
v_exp_f32 v142, v142
v_exp_f32 v143, v143
buffer_store_dwordx4 v[152:155], v234, s[16:19], s34 offen offset:128 sc0 sc1
v_pk_fma_f32 v[136:137], v[136:137], v[168:169], v[168:169] op_sel:[0,1,1] op_sel_hi:[1,1,1]
v_pk_fma_f32 v[138:139], v[138:139], v[168:169], v[168:169] op_sel:[0,1,1] op_sel_hi:[1,1,1]
v_pk_fma_f32 v[140:141], v[140:141], v[168:169], v[168:169] op_sel:[0,1,1] op_sel_hi:[1,1,1]
v_pk_fma_f32 v[142:143], v[142:143], v[168:169], v[168:169] op_sel:[0,1,1] op_sel_hi:[1,1,1]
v_rcp_f32 v136, v136
v_rcp_f32 v137, v137
v_rcp_f32 v138, v138
v_rcp_f32 v139, v139
v_rcp_f32 v140, v140
v_rcp_f32 v141, v141
v_rcp_f32 v142, v142
v_rcp_f32 v143, v143
v_pk_mul_f32 v[88:89], v[88:89], v[136:137]
v_pk_mul_f32 v[90:91], v[90:91], v[138:139]
v_pk_mul_f32 v[92:93], v[92:93], v[140:141]
v_pk_mul_f32 v[94:95], v[94:95], v[142:143]
v_pk_fma_f32 v[96:97], v[176:177], v[172:173], v[96:97] op_sel_hi:[1,0,1]
v_pk_fma_f32 v[98:99], v[178:179], v[172:173], v[98:99] op_sel_hi:[1,0,1]
v_pk_fma_f32 v[100:101], v[180:181], v[172:173], v[100:101] op_sel_hi:[1,0,1]
v_cvt_pk_bf16_f32 v156, v88, v89
v_pk_fma_f32 v[102:103], v[182:183], v[172:173], v[102:103] op_sel_hi:[1,0,1]
v_pk_mul_f32 v[136:137], v[96:97], v[96:97]
v_pk_mul_f32 v[138:139], v[98:99], v[98:99]
v_cvt_pk_bf16_f32 v157, v90, v91
v_pk_mul_f32 v[140:141], v[100:101], v[100:101]
v_pk_mul_f32 v[142:143], v[102:103], v[102:103]
v_pk_fma_f32 v[136:137], v[136:137], v[174:175], v[174:175] op_sel:[0,0,1] op_sel_hi:[1,0,1]
v_cvt_pk_bf16_f32 v158, v92, v93
v_pk_fma_f32 v[138:139], v[138:139], v[174:175], v[174:175] op_sel:[0,0,1] op_sel_hi:[1,0,1]
v_pk_fma_f32 v[140:141], v[140:141], v[174:175], v[174:175] op_sel:[0,0,1] op_sel_hi:[1,0,1]
v_pk_fma_f32 v[142:143], v[142:143], v[174:175], v[174:175] op_sel:[0,0,1] op_sel_hi:[1,0,1]
v_cvt_pk_bf16_f32 v159, v94, v95
v_pk_mul_f32 v[136:137], v[136:137], v[96:97]
v_pk_mul_f32 v[138:139], v[138:139], v[98:99]
v_pk_mul_f32 v[140:141], v[140:141], v[100:101]
s_mov_b32 s34, 17006592
v_pk_mul_f32 v[142:143], v[142:143], v[102:103]
v_exp_f32 v136, v136
v_exp_f32 v137, v137
v_permlane16_swap_b32 v156, v158
v_exp_f32 v138, v138
v_exp_f32 v139, v139
v_exp_f32 v140, v140
v_permlane16_swap_b32 v157, v159
v_exp_f32 v141, v141
v_exp_f32 v142, v142
v_exp_f32 v143, v143
buffer_store_dwordx4 v[156:159], v234, s[16:19], s34 offen offset:192 sc0 sc1
v_pk_fma_f32 v[136:137], v[136:137], v[172:173], v[172:173] op_sel:[0,1,1] op_sel_hi:[1,1,1]
v_pk_fma_f32 v[138:139], v[138:139], v[172:173], v[172:173] op_sel:[0,1,1] op_sel_hi:[1,1,1]
v_pk_fma_f32 v[140:141], v[140:141], v[172:173], v[172:173] op_sel:[0,1,1] op_sel_hi:[1,1,1]
v_pk_fma_f32 v[142:143], v[142:143], v[172:173], v[172:173] op_sel:[0,1,1] op_sel_hi:[1,1,1]
v_rcp_f32 v136, v136
v_rcp_f32 v137, v137
v_rcp_f32 v138, v138
v_rcp_f32 v139, v139
v_rcp_f32 v140, v140
v_rcp_f32 v141, v141
v_rcp_f32 v142, v142
v_rcp_f32 v143, v143
v_pk_mul_f32 v[96:97], v[96:97], v[136:137]
v_pk_mul_f32 v[98:99], v[98:99], v[138:139]
v_pk_mul_f32 v[100:101], v[100:101], v[140:141]
v_pk_mul_f32 v[102:103], v[102:103], v[142:143]
v_pk_fma_f32 v[104:105], v[184:185], v[172:173], v[104:105] op_sel_hi:[1,0,1]
v_pk_fma_f32 v[106:107], v[186:187], v[172:173], v[106:107] op_sel_hi:[1,0,1]
v_pk_fma_f32 v[108:109], v[188:189], v[172:173], v[108:109] op_sel_hi:[1,0,1]
v_cvt_pk_bf16_f32 v144, v96, v97
v_pk_fma_f32 v[110:111], v[190:191], v[172:173], v[110:111] op_sel_hi:[1,0,1]
v_pk_mul_f32 v[136:137], v[104:105], v[104:105]
v_pk_mul_f32 v[138:139], v[106:107], v[106:107]
v_cvt_pk_bf16_f32 v145, v98, v99
v_pk_mul_f32 v[140:141], v[108:109], v[108:109]
v_pk_mul_f32 v[142:143], v[110:111], v[110:111]
v_pk_fma_f32 v[136:137], v[136:137], v[174:175], v[174:175] op_sel:[0,0,1] op_sel_hi:[1,0,1]
v_cvt_pk_bf16_f32 v146, v100, v101
v_pk_fma_f32 v[138:139], v[138:139], v[174:175], v[174:175] op_sel:[0,0,1] op_sel_hi:[1,0,1]
v_pk_fma_f32 v[140:141], v[140:141], v[174:175], v[174:175] op_sel:[0,0,1] op_sel_hi:[1,0,1]
v_pk_fma_f32 v[142:143], v[142:143], v[174:175], v[174:175] op_sel:[0,0,1] op_sel_hi:[1,0,1]
v_cvt_pk_bf16_f32 v147, v102, v103
v_pk_mul_f32 v[136:137], v[136:137], v[104:105]
v_pk_mul_f32 v[138:139], v[138:139], v[106:107]
v_pk_mul_f32 v[140:141], v[140:141], v[108:109]
s_mov_b32 s34, 17121280
v_pk_mul_f32 v[142:143], v[142:143], v[110:111]
v_exp_f32 v136, v136
v_exp_f32 v137, v137
v_permlane16_swap_b32 v144, v146
v_exp_f32 v138, v138
v_exp_f32 v139, v139
v_exp_f32 v140, v140
v_permlane16_swap_b32 v145, v147
v_exp_f32 v141, v141
v_exp_f32 v142, v142
v_exp_f32 v143, v143
buffer_store_dwordx4 v[144:147], v234, s[16:19], s34 offen offset:0 sc0 sc1
v_pk_fma_f32 v[136:137], v[136:137], v[172:173], v[172:173] op_sel:[0,1,1] op_sel_hi:[1,1,1]
v_pk_fma_f32 v[138:139], v[138:139], v[172:173], v[172:173] op_sel:[0,1,1] op_sel_hi:[1,1,1]
v_pk_fma_f32 v[140:141], v[140:141], v[172:173], v[172:173] op_sel:[0,1,1] op_sel_hi:[1,1,1]
v_pk_fma_f32 v[142:143], v[142:143], v[172:173], v[172:173] op_sel:[0,1,1] op_sel_hi:[1,1,1]
v_rcp_f32 v136, v136
v_rcp_f32 v137, v137
v_rcp_f32 v138, v138
v_rcp_f32 v139, v139
v_rcp_f32 v140, v140
v_rcp_f32 v141, v141
v_rcp_f32 v142, v142
v_rcp_f32 v143, v143
v_pk_mul_f32 v[104:105], v[104:105], v[136:137]
v_pk_mul_f32 v[106:107], v[106:107], v[138:139]
v_pk_mul_f32 v[108:109], v[108:109], v[140:141]
v_pk_mul_f32 v[110:111], v[110:111], v[142:143]
v_pk_fma_f32 v[112:113], v[192:193], v[172:173], v[112:113] op_sel_hi:[1,0,1]
v_pk_fma_f32 v[114:115], v[194:195], v[172:173], v[114:115] op_sel_hi:[1,0,1]
v_pk_fma_f32 v[116:117], v[196:197], v[172:173], v[116:117] op_sel_hi:[1,0,1]
v_cvt_pk_bf16_f32 v148, v104, v105
v_pk_fma_f32 v[118:119], v[198:199], v[172:173], v[118:119] op_sel_hi:[1,0,1]
v_pk_mul_f32 v[136:137], v[112:113], v[112:113]
v_pk_mul_f32 v[138:139], v[114:115], v[114:115]
v_cvt_pk_bf16_f32 v149, v106, v107
v_pk_mul_f32 v[140:141], v[116:117], v[116:117]
v_pk_mul_f32 v[142:143], v[118:119], v[118:119]
v_pk_fma_f32 v[136:137], v[136:137], v[174:175], v[174:175] op_sel:[0,0,1] op_sel_hi:[1,0,1]
v_cvt_pk_bf16_f32 v150, v108, v109
v_pk_fma_f32 v[138:139], v[138:139], v[174:175], v[174:175] op_sel:[0,0,1] op_sel_hi:[1,0,1]
v_pk_fma_f32 v[140:141], v[140:141], v[174:175], v[174:175] op_sel:[0,0,1] op_sel_hi:[1,0,1]
v_pk_fma_f32 v[142:143], v[142:143], v[174:175], v[174:175] op_sel:[0,0,1] op_sel_hi:[1,0,1]
v_cvt_pk_bf16_f32 v151, v110, v111
v_pk_mul_f32 v[136:137], v[136:137], v[112:113]
v_pk_mul_f32 v[138:139], v[138:139], v[114:115]
v_pk_mul_f32 v[140:141], v[140:141], v[116:117]
s_mov_b32 s34, 17121280
v_pk_mul_f32 v[142:143], v[142:143], v[118:119]
v_exp_f32 v136, v136
v_exp_f32 v137, v137
v_permlane16_swap_b32 v148, v150
v_exp_f32 v138, v138
v_exp_f32 v139, v139
v_exp_f32 v140, v140
v_permlane16_swap_b32 v149, v151
v_exp_f32 v141, v141
v_exp_f32 v142, v142
v_exp_f32 v143, v143
buffer_store_dwordx4 v[148:151], v234, s[16:19], s34 offen offset:64 sc0 sc1
v_pk_fma_f32 v[136:137], v[136:137], v[172:173], v[172:173] op_sel:[0,1,1] op_sel_hi:[1,1,1]
v_pk_fma_f32 v[138:139], v[138:139], v[172:173], v[172:173] op_sel:[0,1,1] op_sel_hi:[1,1,1]
v_pk_fma_f32 v[140:141], v[140:141], v[172:173], v[172:173] op_sel:[0,1,1] op_sel_hi:[1,1,1]
v_pk_fma_f32 v[142:143], v[142:143], v[172:173], v[172:173] op_sel:[0,1,1] op_sel_hi:[1,1,1]
v_rcp_f32 v136, v136
v_rcp_f32 v137, v137
v_rcp_f32 v138, v138
v_rcp_f32 v139, v139
v_rcp_f32 v140, v140
v_rcp_f32 v141, v141
v_rcp_f32 v142, v142
v_rcp_f32 v143, v143
v_pk_mul_f32 v[112:113], v[112:113], v[136:137]
v_pk_mul_f32 v[114:115], v[114:115], v[138:139]
v_pk_mul_f32 v[116:117], v[116:117], v[140:141]
v_pk_mul_f32 v[118:119], v[118:119], v[142:143]
v_pk_fma_f32 v[120:121], v[200:201], v[172:173], v[120:121] op_sel_hi:[1,0,1]
v_pk_fma_f32 v[122:123], v[202:203], v[172:173], v[122:123] op_sel_hi:[1,0,1]
v_pk_fma_f32 v[124:125], v[204:205], v[172:173], v[124:125] op_sel_hi:[1,0,1]
v_cvt_pk_bf16_f32 v152, v112, v113
v_pk_fma_f32 v[126:127], v[206:207], v[172:173], v[126:127] op_sel_hi:[1,0,1]
v_pk_mul_f32 v[136:137], v[120:121], v[120:121]
v_pk_mul_f32 v[138:139], v[122:123], v[122:123]
v_cvt_pk_bf16_f32 v153, v114, v115
v_pk_mul_f32 v[140:141], v[124:125], v[124:125]
v_pk_mul_f32 v[142:143], v[126:127], v[126:127]
v_pk_fma_f32 v[136:137], v[136:137], v[174:175], v[174:175] op_sel:[0,0,1] op_sel_hi:[1,0,1]
v_cvt_pk_bf16_f32 v154, v116, v117
v_pk_fma_f32 v[138:139], v[138:139], v[174:175], v[174:175] op_sel:[0,0,1] op_sel_hi:[1,0,1]
v_pk_fma_f32 v[140:141], v[140:141], v[174:175], v[174:175] op_sel:[0,0,1] op_sel_hi:[1,0,1]
v_pk_fma_f32 v[142:143], v[142:143], v[174:175], v[174:175] op_sel:[0,0,1] op_sel_hi:[1,0,1]
v_cvt_pk_bf16_f32 v155, v118, v119
v_pk_mul_f32 v[136:137], v[136:137], v[120:121]
v_pk_mul_f32 v[138:139], v[138:139], v[122:123]
v_pk_mul_f32 v[140:141], v[140:141], v[124:125]
s_mov_b32 s34, 17121280
v_pk_mul_f32 v[142:143], v[142:143], v[126:127]
v_exp_f32 v136, v136
v_exp_f32 v137, v137
v_permlane16_swap_b32 v152, v154
v_exp_f32 v138, v138
v_exp_f32 v139, v139
v_exp_f32 v140, v140
v_permlane16_swap_b32 v153, v155
v_exp_f32 v141, v141
v_exp_f32 v142, v142
v_exp_f32 v143, v143
buffer_store_dwordx4 v[152:155], v234, s[16:19], s34 offen offset:128 sc0 sc1
v_pk_fma_f32 v[136:137], v[136:137], v[172:173], v[172:173] op_sel:[0,1,1] op_sel_hi:[1,1,1]
v_pk_fma_f32 v[138:139], v[138:139], v[172:173], v[172:173] op_sel:[0,1,1] op_sel_hi:[1,1,1]
v_pk_fma_f32 v[140:141], v[140:141], v[172:173], v[172:173] op_sel:[0,1,1] op_sel_hi:[1,1,1]
v_pk_fma_f32 v[142:143], v[142:143], v[172:173], v[172:173] op_sel:[0,1,1] op_sel_hi:[1,1,1]
v_rcp_f32 v136, v136
v_rcp_f32 v137, v137
v_rcp_f32 v138, v138
v_rcp_f32 v139, v139
v_rcp_f32 v140, v140
v_rcp_f32 v141, v141
v_rcp_f32 v142, v142
v_rcp_f32 v143, v143
v_pk_mul_f32 v[120:121], v[120:121], v[136:137]
v_pk_mul_f32 v[122:123], v[122:123], v[138:139]
v_pk_mul_f32 v[124:125], v[124:125], v[140:141]
v_pk_mul_f32 v[126:127], v[126:127], v[142:143]
v_cvt_pk_bf16_f32 v156, v120, v121
v_cvt_pk_bf16_f32 v157, v122, v123
v_cvt_pk_bf16_f32 v158, v124, v125
v_cvt_pk_bf16_f32 v159, v126, v127
s_mov_b32 s34, 17121280
s_nop 0
v_permlane16_swap_b32 v156, v158
v_permlane16_swap_b32 v157, v159
buffer_store_dwordx4 v[156:159], v234, s[16:19], s34 offen offset:192 sc0 sc1
s_lshl_b32 s60, s58, 4
s_add_u32 s60, s60, s59
s_lshl_b32 s60, s60, 2
s_add_u32 s60, s60, s20
s_lshl_b32 s60, s60, 4
s_add_u32 s60, s60, 38846464
s_branch L_c_s5_8
L_c_att_7:
s_lshr_b32 s49, s2, 3
s_mul_i32 s49, s49, 5
s_lshr_b32 s49, s49, 5
s_add_u32 s49, s49, 3
s_lshr_b32 s96, s2, 3
s_mul_i32 s96, s96, 7
s_lshr_b32 s96, s96, 5
s_add_u32 s96, s96, 8
s_mov_b32 s92, 8
s_mov_b32 s93, 0
s_bitset1_b64 s[92:93], s49
s_bitset1_b64 s[92:93], s96
s_mov_b32 s30, 0
s_mov_b32 s29, 1
s_barrier
ds_read_b64_tr_b16 v[160:161], v226 offset:0
ds_read_b64_tr_b16 v[162:163], v226 offset:2048
ds_read_b128 v[128:131], v224 offset:0
ds_read_b64_tr_b16 v[164:165], v227 offset:0
ds_read_b64_tr_b16 v[166:167], v227 offset:2048
ds_read_b64_tr_b16 v[168:169], v228 offset:0
ds_read_b64_tr_b16 v[170:171], v228 offset:2048
ds_read_b64_tr_b16 v[172:173], v229 offset:0
ds_read_b64_tr_b16 v[174:175], v229 offset:2048
ds_read_b64_tr_b16 v[176:177], v230 offset:0
ds_read_b64_tr_b16 v[178:179], v230 offset:2048
ds_read_b64_tr_b16 v[180:181], v231 offset:0
ds_read_b64_tr_b16 v[182:183], v231 offset:2048
ds_read_b64_tr_b16 v[184:185], v232 offset:0
ds_read_b64_tr_b16 v[186:187], v232 offset:2048
ds_read_b64_tr_b16 v[188:189], v233 offset:0
ds_read_b64_tr_b16 v[190:191], v233 offset:2048
ds_read_b128 v[132:135], v224 offset:2048
ds_read_b128 v[136:139], v224 offset:4096
ds_read_b128 v[140:143], v224 offset:6144
.p2align 6
L_kv_mm_30:
s_bitcmp1_b64 s[92:93], s29
s_cbranch_scc1 L_kv_H_31
L_kv_B_32:
s_waitcnt lgkmcnt(15)
v_mfma_f32_16x16x32_bf16 v[0:3], v[128:131], v[160:163], v[0:3]
ds_read_b64_tr_b16 v[192:193], v226 offset:16384
ds_read_b64_tr_b16 v[194:195], v226 offset:18432
v_mfma_f32_16x16x32_bf16 v[4:7], v[128:131], v[164:167], v[4:7]
ds_read_b128 v[144:147], v225 offset:0
ds_read_b64_tr_b16 v[196:197], v227 offset:16384
s_waitcnt lgkmcnt(15)
v_mfma_f32_16x16x32_bf16 v[8:11], v[128:131], v[168:171], v[8:11]
ds_read_b64_tr_b16 v[198:199], v227 offset:18432
ds_read_b64_tr_b16 v[200:201], v228 offset:16384
v_mfma_f32_16x16x32_bf16 v[12:15], v[128:131], v[172:175], v[12:15]
ds_read_b64_tr_b16 v[202:203], v228 offset:18432
ds_read_b64_tr_b16 v[204:205], v229 offset:16384
s_waitcnt lgkmcnt(15)
v_mfma_f32_16x16x32_bf16 v[16:19], v[128:131], v[176:179], v[16:19]
ds_read_b64_tr_b16 v[206:207], v229 offset:18432
ds_read_b64_tr_b16 v[208:209], v230 offset:16384
v_mfma_f32_16x16x32_bf16 v[20:23], v[128:131], v[180:183], v[20:23]
ds_read_b64_tr_b16 v[210:211], v230 offset:18432
ds_read_b64_tr_b16 v[212:213], v231 offset:16384
s_waitcnt lgkmcnt(15)
v_mfma_f32_16x16x32_bf16 v[24:27], v[128:131], v[184:187], v[24:27]
ds_read_b64_tr_b16 v[214:215], v231 offset:18432
ds_read_b64_tr_b16 v[216:217], v232 offset:16384
v_mfma_f32_16x16x32_bf16 v[28:31], v[128:131], v[188:191], v[28:31]
ds_read_b64_tr_b16 v[218:219], v232 offset:18432
ds_read_b64_tr_b16 v[220:221], v233 offset:16384
s_waitcnt lgkmcnt(15)
v_mfma_f32_16x16x32_bf16 v[32:35], v[132:135], v[160:163], v[32:35]
ds_read_b64_tr_b16 v[222:223], v233 offset:18432
ds_read_b128 v[148:151], v225 offset:2048
v_mfma_f32_16x16x32_bf16 v[36:39], v[132:135], v[164:167], v[36:39]
ds_read_b128 v[152:155], v225 offset:4096
ds_read_b128 v[156:159], v225 offset:6144
v_mfma_f32_16x16x32_bf16 v[40:43], v[132:135], v[168:171], v[40:43]
s_add_u32 s30, s30, 1
s_cmp_eq_u32 s30, 3
v_mfma_f32_16x16x32_bf16 v[44:47], v[132:135], v[172:175], v[44:47]
s_cselect_b32 s30, 0, s30
s_mov_b32 s38, 49152
v_mfma_f32_16x16x32_bf16 v[48:51], v[132:135], v[176:179], v[48:51]
s_cmov_b32 s38, 4294868992
s_add_u32 s29, s29, 1
v_mfma_f32_16x16x32_bf16 v[52:55], v[132:135], v[180:183], v[52:55]
v_add_u32 v224, s38, v224
v_add_u32 v225, s38, v225
v_mfma_f32_16x16x32_bf16 v[56:59], v[132:135], v[184:187], v[56:59]
v_add_u32 v226, s38, v226
v_add_u32 v227, s38, v227
v_mfma_f32_16x16x32_bf16 v[60:63], v[132:135], v[188:191], v[60:63]
v_add_u32 v228, s38, v228
v_add_u32 v229, s38, v229
v_mfma_f32_16x16x32_bf16 v[64:67], v[136:139], v[160:163], v[64:67]
v_add_u32 v230, s38, v230
v_add_u32 v231, s38, v231
v_mfma_f32_16x16x32_bf16 v[68:71], v[136:139], v[164:167], v[68:71]
v_add_u32 v232, s38, v232
v_add_u32 v233, s38, v233
v_mfma_f32_16x16x32_bf16 v[72:75], v[136:139], v[168:171], v[72:75]
v_mfma_f32_16x16x32_bf16 v[76:79], v[136:139], v[172:175], v[76:79]
v_mfma_f32_16x16x32_bf16 v[80:83], v[136:139], v[176:179], v[80:83]
v_mfma_f32_16x16x32_bf16 v[84:87], v[136:139], v[180:183], v[84:87]
v_mfma_f32_16x16x32_bf16 v[88:91], v[136:139], v[184:187], v[88:91]
v_mfma_f32_16x16x32_bf16 v[92:95], v[136:139], v[188:191], v[92:95]
v_mfma_f32_16x16x32_bf16 v[96:99], v[140:143], v[160:163], v[96:99]
v_mfma_f32_16x16x32_bf16 v[100:103], v[140:143], v[164:167], v[100:103]
v_mfma_f32_16x16x32_bf16 v[104:107], v[140:143], v[168:171], v[104:107]
v_mfma_f32_16x16x32_bf16 v[108:111], v[140:143], v[172:175], v[108:111]
v_mfma_f32_16x16x32_bf16 v[112:115], v[140:143], v[176:179], v[112:115]
v_mfma_f32_16x16x32_bf16 v[116:119], v[140:143], v[180:183], v[116:119]
v_mfma_f32_16x16x32_bf16 v[120:123], v[140:143], v[184:187], v[120:123]
v_mfma_f32_16x16x32_bf16 v[124:127], v[140:143], v[188:191], v[124:127]
s_waitcnt lgkmcnt(15)
v_mfma_f32_16x16x32_bf16 v[0:3], v[144:147], v[192:195], v[0:3]
v_mfma_f32_16x16x32_bf16 v[4:7], v[144:147], v[196:199], v[4:7]
s_waitcnt lgkmcnt(13)
v_mfma_f32_16x16x32_bf16 v[8:11], v[144:147], v[200:203], v[8:11]
s_waitcnt lgkmcnt(11)
v_mfma_f32_16x16x32_bf16 v[12:15], v[144:147], v[204:207], v[12:15]
s_waitcnt lgkmcnt(9)
v_mfma_f32_16x16x32_bf16 v[16:19], v[144:147], v[208:211], v[16:19]
s_waitcnt lgkmcnt(7)
v_mfma_f32_16x16x32_bf16 v[20:23], v[144:147], v[212:215], v[20:23]
s_waitcnt lgkmcnt(5)
v_mfma_f32_16x16x32_bf16 v[24:27], v[144:147], v[216:219], v[24:27]
s_waitcnt lgkmcnt(3)
v_mfma_f32_16x16x32_bf16 v[28:31], v[144:147], v[220:223], v[28:31]
s_waitcnt lgkmcnt(2)
v_mfma_f32_16x16x32_bf16 v[32:35], v[148:151], v[192:195], v[32:35]
s_waitcnt lgkmcnt(0)
s_barrier
ds_read_b64_tr_b16 v[160:161], v226 offset:0
v_mfma_f32_16x16x32_bf16 v[36:39], v[148:151], v[196:199], v[36:39]
ds_read_b64_tr_b16 v[162:163], v226 offset:2048
v_mfma_f32_16x16x32_bf16 v[40:43], v[148:151], v[200:203], v[40:43]
ds_read_b128 v[128:131], v224 offset:0
v_mfma_f32_16x16x32_bf16 v[44:47], v[148:151], v[204:207], v[44:47]
ds_read_b64_tr_b16 v[164:165], v227 offset:0
v_mfma_f32_16x16x32_bf16 v[48:51], v[148:151], v[208:211], v[48:51]
ds_read_b64_tr_b16 v[166:167], v227 offset:2048
v_mfma_f32_16x16x32_bf16 v[52:55], v[148:151], v[212:215], v[52:55]
ds_read_b64_tr_b16 v[168:169], v228 offset:0
v_mfma_f32_16x16x32_bf16 v[56:59], v[148:151], v[216:219], v[56:59]
ds_read_b64_tr_b16 v[170:171], v228 offset:2048
v_mfma_f32_16x16x32_bf16 v[60:63], v[148:151], v[220:223], v[60:63]
ds_read_b64_tr_b16 v[172:173], v229 offset:0
v_mfma_f32_16x16x32_bf16 v[64:67], v[152:155], v[192:195], v[64:67]
ds_read_b64_tr_b16 v[174:175], v229 offset:2048
v_mfma_f32_16x16x32_bf16 v[68:71], v[152:155], v[196:199], v[68:71]
ds_read_b64_tr_b16 v[176:177], v230 offset:0
v_mfma_f32_16x16x32_bf16 v[72:75], v[152:155], v[200:203], v[72:75]
ds_read_b64_tr_b16 v[178:179], v230 offset:2048
v_mfma_f32_16x16x32_bf16 v[76:79], v[152:155], v[204:207], v[76:79]
ds_read_b64_tr_b16 v[180:181], v231 offset:0
v_mfma_f32_16x16x32_bf16 v[80:83], v[152:155], v[208:211], v[80:83]
ds_read_b64_tr_b16 v[182:183], v231 offset:2048
v_mfma_f32_16x16x32_bf16 v[84:87], v[152:155], v[212:215], v[84:87]
ds_read_b64_tr_b16 v[184:185], v232 offset:0
v_mfma_f32_16x16x32_bf16 v[88:91], v[152:155], v[216:219], v[88:91]
ds_read_b64_tr_b16 v[186:187], v232 offset:2048
v_mfma_f32_16x16x32_bf16 v[92:95], v[152:155], v[220:223], v[92:95]
ds_read_b64_tr_b16 v[188:189], v233 offset:0
v_mfma_f32_16x16x32_bf16 v[96:99], v[156:159], v[192:195], v[96:99]
ds_read_b64_tr_b16 v[190:191], v233 offset:2048
v_mfma_f32_16x16x32_bf16 v[100:103], v[156:159], v[196:199], v[100:103]
ds_read_b128 v[132:135], v224 offset:2048
v_mfma_f32_16x16x32_bf16 v[104:107], v[156:159], v[200:203], v[104:107]
ds_read_b128 v[136:139], v224 offset:4096
v_mfma_f32_16x16x32_bf16 v[108:111], v[156:159], v[204:207], v[108:111]
ds_read_b128 v[140:143], v224 offset:6144
v_mfma_f32_16x16x32_bf16 v[112:115], v[156:159], v[208:211], v[112:115]
v_mfma_f32_16x16x32_bf16 v[116:119], v[156:159], v[212:215], v[116:119]
v_mfma_f32_16x16x32_bf16 v[120:123], v[156:159], v[216:219], v[120:123]
v_mfma_f32_16x16x32_bf16 v[124:127], v[156:159], v[220:223], v[124:127]
s_bitcmp1_b64 s[92:93], s29
s_cbranch_scc1 L_kv_H_33
L_kv_B_34:
s_waitcnt lgkmcnt(15)
v_mfma_f32_16x16x32_bf16 v[0:3], v[128:131], v[160:163], v[0:3]
ds_read_b64_tr_b16 v[192:193], v226 offset:16384
ds_read_b64_tr_b16 v[194:195], v226 offset:18432
v_mfma_f32_16x16x32_bf16 v[4:7], v[128:131], v[164:167], v[4:7]
ds_read_b128 v[144:147], v225 offset:0
ds_read_b64_tr_b16 v[196:197], v227 offset:16384
s_waitcnt lgkmcnt(15)
v_mfma_f32_16x16x32_bf16 v[8:11], v[128:131], v[168:171], v[8:11]
ds_read_b64_tr_b16 v[198:199], v227 offset:18432
ds_read_b64_tr_b16 v[200:201], v228 offset:16384
v_mfma_f32_16x16x32_bf16 v[12:15], v[128:131], v[172:175], v[12:15]
ds_read_b64_tr_b16 v[202:203], v228 offset:18432
ds_read_b64_tr_b16 v[204:205], v229 offset:16384
s_waitcnt lgkmcnt(15)
v_mfma_f32_16x16x32_bf16 v[16:19], v[128:131], v[176:179], v[16:19]
ds_read_b64_tr_b16 v[206:207], v229 offset:18432
ds_read_b64_tr_b16 v[208:209], v230 offset:16384
v_mfma_f32_16x16x32_bf16 v[20:23], v[128:131], v[180:183], v[20:23]
ds_read_b64_tr_b16 v[210:211], v230 offset:18432
ds_read_b64_tr_b16 v[212:213], v231 offset:16384
s_waitcnt lgkmcnt(15)
v_mfma_f32_16x16x32_bf16 v[24:27], v[128:131], v[184:187], v[24:27]
ds_read_b64_tr_b16 v[214:215], v231 offset:18432
ds_read_b64_tr_b16 v[216:217], v232 offset:16384
v_mfma_f32_16x16x32_bf16 v[28:31], v[128:131], v[188:191], v[28:31]
ds_read_b64_tr_b16 v[218:219], v232 offset:18432
ds_read_b64_tr_b16 v[220:221], v233 offset:16384
s_waitcnt lgkmcnt(15)
v_mfma_f32_16x16x32_bf16 v[32:35], v[132:135], v[160:163], v[32:35]
ds_read_b64_tr_b16 v[222:223], v233 offset:18432
ds_read_b128 v[148:151], v225 offset:2048
v_mfma_f32_16x16x32_bf16 v[36:39], v[132:135], v[164:167], v[36:39]
ds_read_b128 v[152:155], v225 offset:4096
ds_read_b128 v[156:159], v225 offset:6144
v_mfma_f32_16x16x32_bf16 v[40:43], v[132:135], v[168:171], v[40:43]
s_add_u32 s30, s30, 1
s_cmp_eq_u32 s30, 3
v_mfma_f32_16x16x32_bf16 v[44:47], v[132:135], v[172:175], v[44:47]
s_cselect_b32 s30, 0, s30
s_mov_b32 s38, 49152
v_mfma_f32_16x16x32_bf16 v[48:51], v[132:135], v[176:179], v[48:51]
s_cmov_b32 s38, 4294868992
s_add_u32 s29, s29, 1
v_mfma_f32_16x16x32_bf16 v[52:55], v[132:135], v[180:183], v[52:55]
v_add_u32 v224, s38, v224
v_add_u32 v225, s38, v225
v_mfma_f32_16x16x32_bf16 v[56:59], v[132:135], v[184:187], v[56:59]
v_add_u32 v226, s38, v226
v_add_u32 v227, s38, v227
v_mfma_f32_16x16x32_bf16 v[60:63], v[132:135], v[188:191], v[60:63]
v_add_u32 v228, s38, v228
v_add_u32 v229, s38, v229
v_mfma_f32_16x16x32_bf16 v[64:67], v[136:139], v[160:163], v[64:67]
v_add_u32 v230, s38, v230
v_add_u32 v231, s38, v231
v_mfma_f32_16x16x32_bf16 v[68:71], v[136:139], v[164:167], v[68:71]
v_add_u32 v232, s38, v232
v_add_u32 v233, s38, v233
v_mfma_f32_16x16x32_bf16 v[72:75], v[136:139], v[168:171], v[72:75]
v_mfma_f32_16x16x32_bf16 v[76:79], v[136:139], v[172:175], v[76:79]
v_mfma_f32_16x16x32_bf16 v[80:83], v[136:139], v[176:179], v[80:83]
v_mfma_f32_16x16x32_bf16 v[84:87], v[136:139], v[180:183], v[84:87]
v_mfma_f32_16x16x32_bf16 v[88:91], v[136:139], v[184:187], v[88:91]
v_mfma_f32_16x16x32_bf16 v[92:95], v[136:139], v[188:191], v[92:95]
v_mfma_f32_16x16x32_bf16 v[96:99], v[140:143], v[160:163], v[96:99]
v_mfma_f32_16x16x32_bf16 v[100:103], v[140:143], v[164:167], v[100:103]
v_mfma_f32_16x16x32_bf16 v[104:107], v[140:143], v[168:171], v[104:107]
v_mfma_f32_16x16x32_bf16 v[108:111], v[140:143], v[172:175], v[108:111]
v_mfma_f32_16x16x32_bf16 v[112:115], v[140:143], v[176:179], v[112:115]
v_mfma_f32_16x16x32_bf16 v[116:119], v[140:143], v[180:183], v[116:119]
v_mfma_f32_16x16x32_bf16 v[120:123], v[140:143], v[184:187], v[120:123]
v_mfma_f32_16x16x32_bf16 v[124:127], v[140:143], v[188:191], v[124:127]
s_waitcnt lgkmcnt(15)
v_mfma_f32_16x16x32_bf16 v[0:3], v[144:147], v[192:195], v[0:3]
v_mfma_f32_16x16x32_bf16 v[4:7], v[144:147], v[196:199], v[4:7]
s_waitcnt lgkmcnt(13)
v_mfma_f32_16x16x32_bf16 v[8:11], v[144:147], v[200:203], v[8:11]
s_waitcnt lgkmcnt(11)
v_mfma_f32_16x16x32_bf16 v[12:15], v[144:147], v[204:207], v[12:15]
s_waitcnt lgkmcnt(9)
v_mfma_f32_16x16x32_bf16 v[16:19], v[144:147], v[208:211], v[16:19]
s_waitcnt lgkmcnt(7)
v_mfma_f32_16x16x32_bf16 v[20:23], v[144:147], v[212:215], v[20:23]
s_waitcnt lgkmcnt(5)
v_mfma_f32_16x16x32_bf16 v[24:27], v[144:147], v[216:219], v[24:27]
s_waitcnt lgkmcnt(3)
v_mfma_f32_16x16x32_bf16 v[28:31], v[144:147], v[220:223], v[28:31]
s_waitcnt lgkmcnt(2)
v_mfma_f32_16x16x32_bf16 v[32:35], v[148:151], v[192:195], v[32:35]
s_waitcnt lgkmcnt(0)
s_barrier
ds_read_b64_tr_b16 v[160:161], v226 offset:0
v_mfma_f32_16x16x32_bf16 v[36:39], v[148:151], v[196:199], v[36:39]
ds_read_b64_tr_b16 v[162:163], v226 offset:2048
v_mfma_f32_16x16x32_bf16 v[40:43], v[148:151], v[200:203], v[40:43]
ds_read_b128 v[128:131], v224 offset:0
v_mfma_f32_16x16x32_bf16 v[44:47], v[148:151], v[204:207], v[44:47]
ds_read_b64_tr_b16 v[164:165], v227 offset:0
v_mfma_f32_16x16x32_bf16 v[48:51], v[148:151], v[208:211], v[48:51]
ds_read_b64_tr_b16 v[166:167], v227 offset:2048
v_mfma_f32_16x16x32_bf16 v[52:55], v[148:151], v[212:215], v[52:55]
ds_read_b64_tr_b16 v[168:169], v228 offset:0
v_mfma_f32_16x16x32_bf16 v[56:59], v[148:151], v[216:219], v[56:59]
ds_read_b64_tr_b16 v[170:171], v228 offset:2048
v_mfma_f32_16x16x32_bf16 v[60:63], v[148:151], v[220:223], v[60:63]
ds_read_b64_tr_b16 v[172:173], v229 offset:0
v_mfma_f32_16x16x32_bf16 v[64:67], v[152:155], v[192:195], v[64:67]
ds_read_b64_tr_b16 v[174:175], v229 offset:2048
v_mfma_f32_16x16x32_bf16 v[68:71], v[152:155], v[196:199], v[68:71]
ds_read_b64_tr_b16 v[176:177], v230 offset:0
v_mfma_f32_16x16x32_bf16 v[72:75], v[152:155], v[200:203], v[72:75]
ds_read_b64_tr_b16 v[178:179], v230 offset:2048
v_mfma_f32_16x16x32_bf16 v[76:79], v[152:155], v[204:207], v[76:79]
ds_read_b64_tr_b16 v[180:181], v231 offset:0
v_mfma_f32_16x16x32_bf16 v[80:83], v[152:155], v[208:211], v[80:83]
ds_read_b64_tr_b16 v[182:183], v231 offset:2048
v_mfma_f32_16x16x32_bf16 v[84:87], v[152:155], v[212:215], v[84:87]
ds_read_b64_tr_b16 v[184:185], v232 offset:0
v_mfma_f32_16x16x32_bf16 v[88:91], v[152:155], v[216:219], v[88:91]
ds_read_b64_tr_b16 v[186:187], v232 offset:2048
v_mfma_f32_16x16x32_bf16 v[92:95], v[152:155], v[220:223], v[92:95]
ds_read_b64_tr_b16 v[188:189], v233 offset:0
v_mfma_f32_16x16x32_bf16 v[96:99], v[156:159], v[192:195], v[96:99]
ds_read_b64_tr_b16 v[190:191], v233 offset:2048
v_mfma_f32_16x16x32_bf16 v[100:103], v[156:159], v[196:199], v[100:103]
ds_read_b128 v[132:135], v224 offset:2048
v_mfma_f32_16x16x32_bf16 v[104:107], v[156:159], v[200:203], v[104:107]
ds_read_b128 v[136:139], v224 offset:4096
v_mfma_f32_16x16x32_bf16 v[108:111], v[156:159], v[204:207], v[108:111]
ds_read_b128 v[140:143], v224 offset:6144
v_mfma_f32_16x16x32_bf16 v[112:115], v[156:159], v[208:211], v[112:115]
v_mfma_f32_16x16x32_bf16 v[116:119], v[156:159], v[212:215], v[116:119]
v_mfma_f32_16x16x32_bf16 v[120:123], v[156:159], v[216:219], v[120:123]
s_cmp_lt_u32 s29, 15
v_mfma_f32_16x16x32_bf16 v[124:127], v[156:159], v[220:223], v[124:127]
s_cbranch_scc1 L_kv_mm_30
s_bitcmp1_b64 s[92:93], s29
s_cbranch_scc1 L_kv_H_35
L_kv_B_36:
s_waitcnt lgkmcnt(15)
v_mfma_f32_16x16x32_bf16 v[0:3], v[128:131], v[160:163], v[0:3]
ds_read_b64_tr_b16 v[192:193], v226 offset:16384
ds_read_b64_tr_b16 v[194:195], v226 offset:18432
v_mfma_f32_16x16x32_bf16 v[4:7], v[128:131], v[164:167], v[4:7]
ds_read_b128 v[144:147], v225 offset:0
ds_read_b64_tr_b16 v[196:197], v227 offset:16384
s_waitcnt lgkmcnt(15)
v_mfma_f32_16x16x32_bf16 v[8:11], v[128:131], v[168:171], v[8:11]
ds_read_b64_tr_b16 v[198:199], v227 offset:18432
ds_read_b64_tr_b16 v[200:201], v228 offset:16384
v_mfma_f32_16x16x32_bf16 v[12:15], v[128:131], v[172:175], v[12:15]
ds_read_b64_tr_b16 v[202:203], v228 offset:18432
ds_read_b64_tr_b16 v[204:205], v229 offset:16384
s_waitcnt lgkmcnt(15)
v_mfma_f32_16x16x32_bf16 v[16:19], v[128:131], v[176:179], v[16:19]
ds_read_b64_tr_b16 v[206:207], v229 offset:18432
ds_read_b64_tr_b16 v[208:209], v230 offset:16384
v_mfma_f32_16x16x32_bf16 v[20:23], v[128:131], v[180:183], v[20:23]
ds_read_b64_tr_b16 v[210:211], v230 offset:18432
ds_read_b64_tr_b16 v[212:213], v231 offset:16384
s_waitcnt lgkmcnt(15)
v_mfma_f32_16x16x32_bf16 v[24:27], v[128:131], v[184:187], v[24:27]
ds_read_b64_tr_b16 v[214:215], v231 offset:18432
ds_read_b64_tr_b16 v[216:217], v232 offset:16384
v_mfma_f32_16x16x32_bf16 v[28:31], v[128:131], v[188:191], v[28:31]
ds_read_b64_tr_b16 v[218:219], v232 offset:18432
ds_read_b64_tr_b16 v[220:221], v233 offset:16384
s_waitcnt lgkmcnt(15)
v_mfma_f32_16x16x32_bf16 v[32:35], v[132:135], v[160:163], v[32:35]
ds_read_b64_tr_b16 v[222:223], v233 offset:18432
ds_read_b128 v[148:151], v225 offset:2048
v_mfma_f32_16x16x32_bf16 v[36:39], v[132:135], v[164:167], v[36:39]
ds_read_b128 v[152:155], v225 offset:4096
ds_read_b128 v[156:159], v225 offset:6144
v_mfma_f32_16x16x32_bf16 v[40:43], v[132:135], v[168:171], v[40:43]
s_add_u32 s30, s30, 1
s_cmp_eq_u32 s30, 3
v_mfma_f32_16x16x32_bf16 v[44:47], v[132:135], v[172:175], v[44:47]
s_cselect_b32 s30, 0, s30
s_mov_b32 s38, 49152
v_mfma_f32_16x16x32_bf16 v[48:51], v[132:135], v[176:179], v[48:51]
s_cmov_b32 s38, 4294868992
s_add_u32 s29, s29, 1
v_mfma_f32_16x16x32_bf16 v[52:55], v[132:135], v[180:183], v[52:55]
v_add_u32 v224, s38, v224
v_add_u32 v225, s38, v225
v_mfma_f32_16x16x32_bf16 v[56:59], v[132:135], v[184:187], v[56:59]
v_add_u32 v226, s38, v226
v_add_u32 v227, s38, v227
v_mfma_f32_16x16x32_bf16 v[60:63], v[132:135], v[188:191], v[60:63]
v_add_u32 v228, s38, v228
v_add_u32 v229, s38, v229
v_mfma_f32_16x16x32_bf16 v[64:67], v[136:139], v[160:163], v[64:67]
v_add_u32 v230, s38, v230
v_add_u32 v231, s38, v231
v_mfma_f32_16x16x32_bf16 v[68:71], v[136:139], v[164:167], v[68:71]
v_add_u32 v232, s38, v232
v_add_u32 v233, s38, v233
v_mfma_f32_16x16x32_bf16 v[72:75], v[136:139], v[168:171], v[72:75]
v_mfma_f32_16x16x32_bf16 v[76:79], v[136:139], v[172:175], v[76:79]
v_mfma_f32_16x16x32_bf16 v[80:83], v[136:139], v[176:179], v[80:83]
v_mfma_f32_16x16x32_bf16 v[84:87], v[136:139], v[180:183], v[84:87]
v_mfma_f32_16x16x32_bf16 v[88:91], v[136:139], v[184:187], v[88:91]
v_mfma_f32_16x16x32_bf16 v[92:95], v[136:139], v[188:191], v[92:95]
v_mfma_f32_16x16x32_bf16 v[96:99], v[140:143], v[160:163], v[96:99]
v_mfma_f32_16x16x32_bf16 v[100:103], v[140:143], v[164:167], v[100:103]
v_mfma_f32_16x16x32_bf16 v[104:107], v[140:143], v[168:171], v[104:107]
v_mfma_f32_16x16x32_bf16 v[108:111], v[140:143], v[172:175], v[108:111]
v_mfma_f32_16x16x32_bf16 v[112:115], v[140:143], v[176:179], v[112:115]
v_mfma_f32_16x16x32_bf16 v[116:119], v[140:143], v[180:183], v[116:119]
v_mfma_f32_16x16x32_bf16 v[120:123], v[140:143], v[184:187], v[120:123]
v_mfma_f32_16x16x32_bf16 v[124:127], v[140:143], v[188:191], v[124:127]
s_waitcnt lgkmcnt(15)
v_mfma_f32_16x16x32_bf16 v[0:3], v[144:147], v[192:195], v[0:3]
v_mfma_f32_16x16x32_bf16 v[4:7], v[144:147], v[196:199], v[4:7]
s_waitcnt lgkmcnt(13)
v_mfma_f32_16x16x32_bf16 v[8:11], v[144:147], v[200:203], v[8:11]
s_waitcnt lgkmcnt(11)
v_mfma_f32_16x16x32_bf16 v[12:15], v[144:147], v[204:207], v[12:15]
s_waitcnt lgkmcnt(9)
v_mfma_f32_16x16x32_bf16 v[16:19], v[144:147], v[208:211], v[16:19]
s_waitcnt lgkmcnt(7)
v_mfma_f32_16x16x32_bf16 v[20:23], v[144:147], v[212:215], v[20:23]
s_waitcnt lgkmcnt(5)
v_mfma_f32_16x16x32_bf16 v[24:27], v[144:147], v[216:219], v[24:27]
s_waitcnt lgkmcnt(3)
v_mfma_f32_16x16x32_bf16 v[28:31], v[144:147], v[220:223], v[28:31]
s_waitcnt lgkmcnt(2)
v_mfma_f32_16x16x32_bf16 v[32:35], v[148:151], v[192:195], v[32:35]
s_waitcnt lgkmcnt(0)
s_barrier
ds_read_b64_tr_b16 v[160:161], v226 offset:0
v_mfma_f32_16x16x32_bf16 v[36:39], v[148:151], v[196:199], v[36:39]
ds_read_b64_tr_b16 v[162:163], v226 offset:2048
v_mfma_f32_16x16x32_bf16 v[40:43], v[148:151], v[200:203], v[40:43]
ds_read_b128 v[128:131], v224 offset:0
v_mfma_f32_16x16x32_bf16 v[44:47], v[148:151], v[204:207], v[44:47]
ds_read_b64_tr_b16 v[164:165], v227 offset:0
v_mfma_f32_16x16x32_bf16 v[48:51], v[148:151], v[208:211], v[48:51]
ds_read_b64_tr_b16 v[166:167], v227 offset:2048
v_mfma_f32_16x16x32_bf16 v[52:55], v[148:151], v[212:215], v[52:55]
ds_read_b64_tr_b16 v[168:169], v228 offset:0
v_mfma_f32_16x16x32_bf16 v[56:59], v[148:151], v[216:219], v[56:59]
ds_read_b64_tr_b16 v[170:171], v228 offset:2048
v_mfma_f32_16x16x32_bf16 v[60:63], v[148:151], v[220:223], v[60:63]
ds_read_b64_tr_b16 v[172:173], v229 offset:0
v_mfma_f32_16x16x32_bf16 v[64:67], v[152:155], v[192:195], v[64:67]
ds_read_b64_tr_b16 v[174:175], v229 offset:2048
v_mfma_f32_16x16x32_bf16 v[68:71], v[152:155], v[196:199], v[68:71]
ds_read_b64_tr_b16 v[176:177], v230 offset:0
v_mfma_f32_16x16x32_bf16 v[72:75], v[152:155], v[200:203], v[72:75]
ds_read_b64_tr_b16 v[178:179], v230 offset:2048
v_mfma_f32_16x16x32_bf16 v[76:79], v[152:155], v[204:207], v[76:79]
ds_read_b64_tr_b16 v[180:181], v231 offset:0
v_mfma_f32_16x16x32_bf16 v[80:83], v[152:155], v[208:211], v[80:83]
ds_read_b64_tr_b16 v[182:183], v231 offset:2048
v_mfma_f32_16x16x32_bf16 v[84:87], v[152:155], v[212:215], v[84:87]
ds_read_b64_tr_b16 v[184:185], v232 offset:0
v_mfma_f32_16x16x32_bf16 v[88:91], v[152:155], v[216:219], v[88:91]
ds_read_b64_tr_b16 v[186:187], v232 offset:2048
v_mfma_f32_16x16x32_bf16 v[92:95], v[152:155], v[220:223], v[92:95]
ds_read_b64_tr_b16 v[188:189], v233 offset:0
v_mfma_f32_16x16x32_bf16 v[96:99], v[156:159], v[192:195], v[96:99]
ds_read_b64_tr_b16 v[190:191], v233 offset:2048
v_mfma_f32_16x16x32_bf16 v[100:103], v[156:159], v[196:199], v[100:103]
ds_read_b128 v[132:135], v224 offset:2048
v_mfma_f32_16x16x32_bf16 v[104:107], v[156:159], v[200:203], v[104:107]
ds_read_b128 v[136:139], v224 offset:4096
v_mfma_f32_16x16x32_bf16 v[108:111], v[156:159], v[204:207], v[108:111]
ds_read_b128 v[140:143], v224 offset:6144
v_mfma_f32_16x16x32_bf16 v[112:115], v[156:159], v[208:211], v[112:115]
v_mfma_f32_16x16x32_bf16 v[116:119], v[156:159], v[212:215], v[116:119]
v_mfma_f32_16x16x32_bf16 v[120:123], v[156:159], v[216:219], v[120:123]
v_mfma_f32_16x16x32_bf16 v[124:127], v[156:159], v[220:223], v[124:127]
s_bitcmp1_b64 s[92:93], s29
s_cbranch_scc1 L_kv_H_37
L_kv_B_38:
s_waitcnt lgkmcnt(15)
v_mfma_f32_16x16x32_bf16 v[0:3], v[128:131], v[160:163], v[0:3]
ds_read_b64_tr_b16 v[192:193], v226 offset:16384
v_mfma_f32_16x16x32_bf16 v[4:7], v[128:131], v[164:167], v[4:7]
ds_read_b64_tr_b16 v[194:195], v226 offset:18432
s_waitcnt lgkmcnt(15)
v_mfma_f32_16x16x32_bf16 v[8:11], v[128:131], v[168:171], v[8:11]
ds_read_b128 v[144:147], v225 offset:0
s_waitcnt lgkmcnt(14)
v_mfma_f32_16x16x32_bf16 v[12:15], v[128:131], v[172:175], v[12:15]
ds_read_b64_tr_b16 v[196:197], v227 offset:16384
s_waitcnt lgkmcnt(13)
v_mfma_f32_16x16x32_bf16 v[16:19], v[128:131], v[176:179], v[16:19]
ds_read_b64_tr_b16 v[198:199], v227 offset:18432
s_waitcnt lgkmcnt(12)
v_mfma_f32_16x16x32_bf16 v[20:23], v[128:131], v[180:183], v[20:23]
ds_read_b64_tr_b16 v[200:201], v228 offset:16384
s_waitcnt lgkmcnt(11)
v_mfma_f32_16x16x32_bf16 v[24:27], v[128:131], v[184:187], v[24:27]
ds_read_b64_tr_b16 v[202:203], v228 offset:18432
s_waitcnt lgkmcnt(10)
v_mfma_f32_16x16x32_bf16 v[28:31], v[128:131], v[188:191], v[28:31]
ds_read_b64_tr_b16 v[204:205], v229 offset:16384
s_waitcnt lgkmcnt(10)
v_mfma_f32_16x16x32_bf16 v[32:35], v[132:135], v[160:163], v[32:35]
ds_read_b64_tr_b16 v[206:207], v229 offset:18432
v_mfma_f32_16x16x32_bf16 v[36:39], v[132:135], v[164:167], v[36:39]
ds_read_b64_tr_b16 v[208:209], v230 offset:16384
v_mfma_f32_16x16x32_bf16 v[40:43], v[132:135], v[168:171], v[40:43]
ds_read_b64_tr_b16 v[210:211], v230 offset:18432
v_mfma_f32_16x16x32_bf16 v[44:47], v[132:135], v[172:175], v[44:47]
ds_read_b64_tr_b16 v[212:213], v231 offset:16384
v_mfma_f32_16x16x32_bf16 v[48:51], v[132:135], v[176:179], v[48:51]
ds_read_b64_tr_b16 v[214:215], v231 offset:18432
v_mfma_f32_16x16x32_bf16 v[52:55], v[132:135], v[180:183], v[52:55]
ds_read_b64_tr_b16 v[216:217], v232 offset:16384
v_mfma_f32_16x16x32_bf16 v[56:59], v[132:135], v[184:187], v[56:59]
ds_read_b64_tr_b16 v[218:219], v232 offset:18432
v_mfma_f32_16x16x32_bf16 v[60:63], v[132:135], v[188:191], v[60:63]
ds_read_b64_tr_b16 v[220:221], v233 offset:16384
s_waitcnt lgkmcnt(15)
v_mfma_f32_16x16x32_bf16 v[64:67], v[136:139], v[160:163], v[64:67]
ds_read_b64_tr_b16 v[222:223], v233 offset:18432
v_mfma_f32_16x16x32_bf16 v[68:71], v[136:139], v[164:167], v[68:71]
ds_read_b128 v[148:151], v225 offset:2048
v_mfma_f32_16x16x32_bf16 v[72:75], v[136:139], v[168:171], v[72:75]
ds_read_b128 v[152:155], v225 offset:4096
v_mfma_f32_16x16x32_bf16 v[76:79], v[136:139], v[172:175], v[76:79]
ds_read_b128 v[156:159], v225 offset:6144
v_mfma_f32_16x16x32_bf16 v[80:83], v[136:139], v[176:179], v[80:83]
v_mfma_f32_16x16x32_bf16 v[84:87], v[136:139], v[180:183], v[84:87]
v_mfma_f32_16x16x32_bf16 v[88:91], v[136:139], v[184:187], v[88:91]
v_mfma_f32_16x16x32_bf16 v[92:95], v[136:139], v[188:191], v[92:95]
v_mfma_f32_16x16x32_bf16 v[96:99], v[140:143], v[160:163], v[96:99]
v_mfma_f32_16x16x32_bf16 v[100:103], v[140:143], v[164:167], v[100:103]
v_mfma_f32_16x16x32_bf16 v[104:107], v[140:143], v[168:171], v[104:107]
v_mfma_f32_16x16x32_bf16 v[108:111], v[140:143], v[172:175], v[108:111]
v_mfma_f32_16x16x32_bf16 v[112:115], v[140:143], v[176:179], v[112:115]
v_mfma_f32_16x16x32_bf16 v[116:119], v[140:143], v[180:183], v[116:119]
v_mfma_f32_16x16x32_bf16 v[120:123], v[140:143], v[184:187], v[120:123]
v_mfma_f32_16x16x32_bf16 v[124:127], v[140:143], v[188:191], v[124:127]
s_waitcnt lgkmcnt(15)
v_mfma_f32_16x16x32_bf16 v[0:3], v[144:147], v[192:195], v[0:3]
v_mfma_f32_16x16x32_bf16 v[4:7], v[144:147], v[196:199], v[4:7]
s_waitcnt lgkmcnt(13)
v_mfma_f32_16x16x32_bf16 v[8:11], v[144:147], v[200:203], v[8:11]
s_waitcnt lgkmcnt(11)
v_mfma_f32_16x16x32_bf16 v[12:15], v[144:147], v[204:207], v[12:15]
s_waitcnt lgkmcnt(9)
v_mfma_f32_16x16x32_bf16 v[16:19], v[144:147], v[208:211], v[16:19]
s_waitcnt lgkmcnt(7)
v_mfma_f32_16x16x32_bf16 v[20:23], v[144:147], v[212:215], v[20:23]
s_waitcnt lgkmcnt(5)
v_mfma_f32_16x16x32_bf16 v[24:27], v[144:147], v[216:219], v[24:27]
s_waitcnt lgkmcnt(3)
v_mfma_f32_16x16x32_bf16 v[28:31], v[144:147], v[220:223], v[28:31]
s_waitcnt lgkmcnt(2)
v_mfma_f32_16x16x32_bf16 v[32:35], v[148:151], v[192:195], v[32:35]
s_waitcnt lgkmcnt(0)
s_barrier
v_mfma_f32_16x16x32_bf16 v[36:39], v[148:151], v[196:199], v[36:39]
v_mfma_f32_16x16x32_bf16 v[40:43], v[148:151], v[200:203], v[40:43]
v_mfma_f32_16x16x32_bf16 v[44:47], v[148:151], v[204:207], v[44:47]
v_mfma_f32_16x16x32_bf16 v[48:51], v[148:151], v[208:211], v[48:51]
v_mfma_f32_16x16x32_bf16 v[52:55], v[148:151], v[212:215], v[52:55]
v_mfma_f32_16x16x32_bf16 v[56:59], v[148:151], v[216:219], v[56:59]
v_mfma_f32_16x16x32_bf16 v[60:63], v[148:151], v[220:223], v[60:63]
v_mfma_f32_16x16x32_bf16 v[64:67], v[152:155], v[192:195], v[64:67]
v_mfma_f32_16x16x32_bf16 v[68:71], v[152:155], v[196:199], v[68:71]
v_mfma_f32_16x16x32_bf16 v[72:75], v[152:155], v[200:203], v[72:75]
v_mfma_f32_16x16x32_bf16 v[76:79], v[152:155], v[204:207], v[76:79]
v_mfma_f32_16x16x32_bf16 v[80:83], v[152:155], v[208:211], v[80:83]
v_mfma_f32_16x16x32_bf16 v[84:87], v[152:155], v[212:215], v[84:87]
v_mfma_f32_16x16x32_bf16 v[88:91], v[152:155], v[216:219], v[88:91]
v_mfma_f32_16x16x32_bf16 v[92:95], v[152:155], v[220:223], v[92:95]
v_mfma_f32_16x16x32_bf16 v[96:99], v[156:159], v[192:195], v[96:99]
v_mfma_f32_16x16x32_bf16 v[100:103], v[156:159], v[196:199], v[100:103]
v_mfma_f32_16x16x32_bf16 v[104:107], v[156:159], v[200:203], v[104:107]
v_mfma_f32_16x16x32_bf16 v[108:111], v[156:159], v[204:207], v[108:111]
v_mfma_f32_16x16x32_bf16 v[112:115], v[156:159], v[208:211], v[112:115]
v_mfma_f32_16x16x32_bf16 v[116:119], v[156:159], v[212:215], v[116:119]
v_mfma_f32_16x16x32_bf16 v[120:123], v[156:159], v[216:219], v[120:123]
v_mfma_f32_16x16x32_bf16 v[124:127], v[156:159], v[220:223], v[124:127]
v_mov_b32 v128, 1069066811
v_mov_b32 v129, 1069066811
v_mov_b32 v130, 897988541
v_mov_b32 v131, 897988541
v_mov_b32 v132, 0x3f803f80
v_mov_b32 v133, 0x3f803f80
v_mov_b32 v134, 0x3f803f80
v_mov_b32 v135, 0x3f803f80
v_pk_mul_f32 v[136:137], v[0:1], v[128:129]
v_pk_mul_f32 v[138:139], v[2:3], v[128:129]
v_pk_mul_f32 v[140:141], v[32:33], v[128:129]
v_pk_mul_f32 v[142:143], v[34:35], v[128:129]
v_exp_f32_e64 v136, v136 clamp
v_exp_f32_e64 v137, v137 clamp
v_exp_f32_e64 v138, v138 clamp
v_exp_f32_e64 v139, v139 clamp
v_exp_f32_e64 v140, v140 clamp
v_exp_f32_e64 v141, v141 clamp
v_exp_f32_e64 v142, v142 clamp
v_exp_f32_e64 v143, v143 clamp
v_max_f32 v0, 0, v0
v_max_f32 v1, 0, v1
v_max_f32 v2, 0, v2
v_max_f32 v3, 0, v3
v_max_f32 v32, 0, v32
v_max_f32 v33, 0, v33
v_max_f32 v34, 0, v34
v_max_f32 v35, 0, v35
v_pk_add_f32 v[0:1], v[0:1], v[130:131]
v_pk_add_f32 v[2:3], v[2:3], v[130:131]
v_pk_add_f32 v[32:33], v[32:33], v[130:131]
v_pk_add_f32 v[34:35], v[34:35], v[130:131]
v_pk_add_f32 v[0:1], v[0:1], v[136:137]
v_pk_add_f32 v[2:3], v[2:3], v[138:139]
v_pk_add_f32 v[32:33], v[32:33], v[140:141]
v_pk_add_f32 v[34:35], v[34:35], v[142:143]
v_pk_mul_f32 v[136:137], v[4:5], v[128:129]
v_pk_mul_f32 v[138:139], v[6:7], v[128:129]
v_pk_mul_f32 v[140:141], v[36:37], v[128:129]
v_pk_mul_f32 v[142:143], v[38:39], v[128:129]
v_exp_f32_e64 v136, v136 clamp
v_exp_f32_e64 v137, v137 clamp
v_exp_f32_e64 v138, v138 clamp
v_exp_f32_e64 v139, v139 clamp
v_exp_f32_e64 v140, v140 clamp
v_exp_f32_e64 v141, v141 clamp
v_exp_f32_e64 v142, v142 clamp
v_exp_f32_e64 v143, v143 clamp
v_max_f32 v4, 0, v4
v_max_f32 v5, 0, v5
v_max_f32 v6, 0, v6
v_max_f32 v7, 0, v7
v_max_f32 v36, 0, v36
v_max_f32 v37, 0, v37
v_max_f32 v38, 0, v38
v_max_f32 v39, 0, v39
v_pk_add_f32 v[4:5], v[4:5], v[130:131]
v_pk_add_f32 v[6:7], v[6:7], v[130:131]
v_pk_add_f32 v[36:37], v[36:37], v[130:131]
v_pk_add_f32 v[38:39], v[38:39], v[130:131]
v_pk_add_f32 v[4:5], v[4:5], v[136:137]
v_pk_add_f32 v[6:7], v[6:7], v[138:139]
v_pk_add_f32 v[36:37], v[36:37], v[140:141]
v_pk_add_f32 v[38:39], v[38:39], v[142:143]
v_cvt_pk_bf16_f32 v192, v0, v1
v_cvt_pk_bf16_f32 v193, v2, v3
v_cvt_pk_bf16_f32 v194, v32, v33
v_cvt_pk_bf16_f32 v195, v34, v35
v_cvt_pk_bf16_f32 v196, v4, v5
v_cvt_pk_bf16_f32 v197, v6, v7
v_cvt_pk_bf16_f32 v198, v36, v37
v_cvt_pk_bf16_f32 v199, v38, v39
v_cvt_pk_bf16_f32 v200, v8, v9
v_cvt_pk_bf16_f32 v201, v10, v11
v_cvt_pk_bf16_f32 v202, v40, v41
v_cvt_pk_bf16_f32 v203, v42, v43
v_cvt_pk_bf16_f32 v204, v12, v13
v_cvt_pk_bf16_f32 v205, v14, v15
v_cvt_pk_bf16_f32 v206, v44, v45
v_cvt_pk_bf16_f32 v207, v46, v47
s_nop 1
v_mfma_f32_16x16x32_bf16 v[144:147], v[192:195], v[200:203], 0
v_mfma_f32_16x16x32_bf16 v[148:151], v[192:195], v[204:207], 0
v_mfma_f32_16x16x32_bf16 v[160:163], v[192:195], v[132:135], 0
v_mfma_f32_16x16x32_bf16 v[152:155], v[196:199], v[200:203], 0
v_mfma_f32_16x16x32_bf16 v[156:159], v[196:199], v[204:207], 0
v_mfma_f32_16x16x32_bf16 v[164:167], v[196:199], v[132:135], 0
v_pk_mul_f32 v[136:137], v[64:65], v[128:129]
v_pk_mul_f32 v[138:139], v[66:67], v[128:129]
v_pk_mul_f32 v[140:141], v[96:97], v[128:129]
v_pk_mul_f32 v[142:143], v[98:99], v[128:129]
v_exp_f32_e64 v136, v136 clamp
v_exp_f32_e64 v137, v137 clamp
v_exp_f32_e64 v138, v138 clamp
v_exp_f32_e64 v139, v139 clamp
v_exp_f32_e64 v140, v140 clamp
v_exp_f32_e64 v141, v141 clamp
v_exp_f32_e64 v142, v142 clamp
v_exp_f32_e64 v143, v143 clamp
v_max_f32 v64, 0, v64
v_max_f32 v65, 0, v65
v_max_f32 v66, 0, v66
v_max_f32 v67, 0, v67
v_max_f32 v96, 0, v96
v_max_f32 v97, 0, v97
v_max_f32 v98, 0, v98
v_max_f32 v99, 0, v99
v_pk_add_f32 v[64:65], v[64:65], v[130:131]
v_pk_add_f32 v[66:67], v[66:67], v[130:131]
v_pk_add_f32 v[96:97], v[96:97], v[130:131]
v_pk_add_f32 v[98:99], v[98:99], v[130:131]
v_pk_add_f32 v[64:65], v[64:65], v[136:137]
v_pk_add_f32 v[66:67], v[66:67], v[138:139]
v_pk_add_f32 v[96:97], v[96:97], v[140:141]
v_pk_add_f32 v[98:99], v[98:99], v[142:143]
v_pk_mul_f32 v[136:137], v[68:69], v[128:129]
v_pk_mul_f32 v[138:139], v[70:71], v[128:129]
v_pk_mul_f32 v[140:141], v[100:101], v[128:129]
v_pk_mul_f32 v[142:143], v[102:103], v[128:129]
v_exp_f32_e64 v136, v136 clamp
v_exp_f32_e64 v137, v137 clamp
v_exp_f32_e64 v138, v138 clamp
v_exp_f32_e64 v139, v139 clamp
v_exp_f32_e64 v140, v140 clamp
v_exp_f32_e64 v141, v141 clamp
v_exp_f32_e64 v142, v142 clamp
v_exp_f32_e64 v143, v143 clamp
v_max_f32 v68, 0, v68
v_max_f32 v69, 0, v69
v_max_f32 v70, 0, v70
v_max_f32 v71, 0, v71
v_max_f32 v100, 0, v100
v_max_f32 v101, 0, v101
v_max_f32 v102, 0, v102
v_max_f32 v103, 0, v103
v_pk_add_f32 v[68:69], v[68:69], v[130:131]
v_pk_add_f32 v[70:71], v[70:71], v[130:131]
v_pk_add_f32 v[100:101], v[100:101], v[130:131]
v_pk_add_f32 v[102:103], v[102:103], v[130:131]
v_pk_add_f32 v[68:69], v[68:69], v[136:137]
v_pk_add_f32 v[70:71], v[70:71], v[138:139]
v_pk_add_f32 v[100:101], v[100:101], v[140:141]
v_pk_add_f32 v[102:103], v[102:103], v[142:143]
v_cvt_pk_bf16_f32 v208, v64, v65
v_cvt_pk_bf16_f32 v209, v66, v67
v_cvt_pk_bf16_f32 v210, v96, v97
v_cvt_pk_bf16_f32 v211, v98, v99
v_cvt_pk_bf16_f32 v212, v68, v69
v_cvt_pk_bf16_f32 v213, v70, v71
v_cvt_pk_bf16_f32 v214, v100, v101
v_cvt_pk_bf16_f32 v215, v102, v103
v_cvt_pk_bf16_f32 v216, v72, v73
v_cvt_pk_bf16_f32 v217, v74, v75
v_cvt_pk_bf16_f32 v218, v104, v105
v_cvt_pk_bf16_f32 v219, v106, v107
v_cvt_pk_bf16_f32 v220, v76, v77
v_cvt_pk_bf16_f32 v221, v78, v79
v_cvt_pk_bf16_f32 v222, v108, v109
v_cvt_pk_bf16_f32 v223, v110, v111
s_nop 1
v_mfma_f32_16x16x32_bf16 v[144:147], v[208:211], v[216:219], v[144:147]
v_mfma_f32_16x16x32_bf16 v[148:151], v[208:211], v[220:223], v[148:151]
v_mfma_f32_16x16x32_bf16 v[160:163], v[208:211], v[132:135], v[160:163]
v_mfma_f32_16x16x32_bf16 v[152:155], v[212:215], v[216:219], v[152:155]
v_mfma_f32_16x16x32_bf16 v[156:159], v[212:215], v[220:223], v[156:159]
v_mfma_f32_16x16x32_bf16 v[164:167], v[212:215], v[132:135], v[164:167]
v_pk_mul_f32 v[136:137], v[16:17], v[128:129]
v_pk_mul_f32 v[138:139], v[18:19], v[128:129]
v_pk_mul_f32 v[140:141], v[48:49], v[128:129]
v_pk_mul_f32 v[142:143], v[50:51], v[128:129]
v_exp_f32_e64 v136, v136 clamp
v_exp_f32_e64 v137, v137 clamp
v_exp_f32_e64 v138, v138 clamp
v_exp_f32_e64 v139, v139 clamp
v_exp_f32_e64 v140, v140 clamp
v_exp_f32_e64 v141, v141 clamp
v_exp_f32_e64 v142, v142 clamp
v_exp_f32_e64 v143, v143 clamp
v_max_f32 v16, 0, v16
v_max_f32 v17, 0, v17
v_max_f32 v18, 0, v18
v_max_f32 v19, 0, v19
v_max_f32 v48, 0, v48
v_max_f32 v49, 0, v49
v_max_f32 v50, 0, v50
v_max_f32 v51, 0, v51
v_pk_add_f32 v[16:17], v[16:17], v[130:131]
v_pk_add_f32 v[18:19], v[18:19], v[130:131]
v_pk_add_f32 v[48:49], v[48:49], v[130:131]
v_pk_add_f32 v[50:51], v[50:51], v[130:131]
v_pk_add_f32 v[16:17], v[16:17], v[136:137]
v_pk_add_f32 v[18:19], v[18:19], v[138:139]
v_pk_add_f32 v[48:49], v[48:49], v[140:141]
v_pk_add_f32 v[50:51], v[50:51], v[142:143]
v_pk_mul_f32 v[136:137], v[20:21], v[128:129]
v_pk_mul_f32 v[138:139], v[22:23], v[128:129]
v_pk_mul_f32 v[140:141], v[52:53], v[128:129]
v_pk_mul_f32 v[142:143], v[54:55], v[128:129]
v_exp_f32_e64 v136, v136 clamp
v_exp_f32_e64 v137, v137 clamp
v_exp_f32_e64 v138, v138 clamp
v_exp_f32_e64 v139, v139 clamp
v_exp_f32_e64 v140, v140 clamp
v_exp_f32_e64 v141, v141 clamp
v_exp_f32_e64 v142, v142 clamp
v_exp_f32_e64 v143, v143 clamp
v_max_f32 v20, 0, v20
v_max_f32 v21, 0, v21
v_max_f32 v22, 0, v22
v_max_f32 v23, 0, v23
v_max_f32 v52, 0, v52
v_max_f32 v53, 0, v53
v_max_f32 v54, 0, v54
v_max_f32 v55, 0, v55
v_pk_add_f32 v[20:21], v[20:21], v[130:131]
v_pk_add_f32 v[22:23], v[22:23], v[130:131]
v_pk_add_f32 v[52:53], v[52:53], v[130:131]
v_pk_add_f32 v[54:55], v[54:55], v[130:131]
v_pk_add_f32 v[20:21], v[20:21], v[136:137]
v_pk_add_f32 v[22:23], v[22:23], v[138:139]
v_pk_add_f32 v[52:53], v[52:53], v[140:141]
v_pk_add_f32 v[54:55], v[54:55], v[142:143]
v_cvt_pk_bf16_f32 v192, v16, v17
v_cvt_pk_bf16_f32 v193, v18, v19
v_cvt_pk_bf16_f32 v194, v48, v49
v_cvt_pk_bf16_f32 v195, v50, v51
v_cvt_pk_bf16_f32 v196, v20, v21
v_cvt_pk_bf16_f32 v197, v22, v23
v_cvt_pk_bf16_f32 v198, v52, v53
v_cvt_pk_bf16_f32 v199, v54, v55
v_cvt_pk_bf16_f32 v200, v24, v25
v_cvt_pk_bf16_f32 v201, v26, v27
v_cvt_pk_bf16_f32 v202, v56, v57
v_cvt_pk_bf16_f32 v203, v58, v59
v_cvt_pk_bf16_f32 v204, v28, v29
v_cvt_pk_bf16_f32 v205, v30, v31
v_cvt_pk_bf16_f32 v206, v60, v61
v_cvt_pk_bf16_f32 v207, v62, v63
s_nop 1
v_mfma_f32_16x16x32_bf16 v[168:171], v[192:195], v[200:203], 0
v_mfma_f32_16x16x32_bf16 v[172:175], v[192:195], v[204:207], 0
v_mfma_f32_16x16x32_bf16 v[184:187], v[192:195], v[132:135], 0
v_mfma_f32_16x16x32_bf16 v[176:179], v[196:199], v[200:203], 0
v_mfma_f32_16x16x32_bf16 v[180:183], v[196:199], v[204:207], 0
v_mfma_f32_16x16x32_bf16 v[188:191], v[196:199], v[132:135], 0
v_pk_mul_f32 v[136:137], v[80:81], v[128:129]
v_pk_mul_f32 v[138:139], v[82:83], v[128:129]
v_pk_mul_f32 v[140:141], v[112:113], v[128:129]
v_pk_mul_f32 v[142:143], v[114:115], v[128:129]
v_exp_f32_e64 v136, v136 clamp
v_exp_f32_e64 v137, v137 clamp
v_exp_f32_e64 v138, v138 clamp
v_exp_f32_e64 v139, v139 clamp
v_exp_f32_e64 v140, v140 clamp
v_exp_f32_e64 v141, v141 clamp
v_exp_f32_e64 v142, v142 clamp
v_exp_f32_e64 v143, v143 clamp
v_max_f32 v80, 0, v80
v_max_f32 v81, 0, v81
v_max_f32 v82, 0, v82
v_max_f32 v83, 0, v83
v_max_f32 v112, 0, v112
v_max_f32 v113, 0, v113
v_max_f32 v114, 0, v114
v_max_f32 v115, 0, v115
v_pk_add_f32 v[80:81], v[80:81], v[130:131]
v_pk_add_f32 v[82:83], v[82:83], v[130:131]
v_pk_add_f32 v[112:113], v[112:113], v[130:131]
v_pk_add_f32 v[114:115], v[114:115], v[130:131]
v_pk_add_f32 v[80:81], v[80:81], v[136:137]
v_pk_add_f32 v[82:83], v[82:83], v[138:139]
v_pk_add_f32 v[112:113], v[112:113], v[140:141]
v_pk_add_f32 v[114:115], v[114:115], v[142:143]
v_pk_mul_f32 v[136:137], v[84:85], v[128:129]
v_pk_mul_f32 v[138:139], v[86:87], v[128:129]
v_pk_mul_f32 v[140:141], v[116:117], v[128:129]
v_pk_mul_f32 v[142:143], v[118:119], v[128:129]
v_exp_f32_e64 v136, v136 clamp
v_exp_f32_e64 v137, v137 clamp
v_exp_f32_e64 v138, v138 clamp
v_exp_f32_e64 v139, v139 clamp
v_exp_f32_e64 v140, v140 clamp
v_exp_f32_e64 v141, v141 clamp
v_exp_f32_e64 v142, v142 clamp
v_exp_f32_e64 v143, v143 clamp
v_max_f32 v84, 0, v84
v_max_f32 v85, 0, v85
v_max_f32 v86, 0, v86
v_max_f32 v87, 0, v87
v_max_f32 v116, 0, v116
v_max_f32 v117, 0, v117
v_max_f32 v118, 0, v118
v_max_f32 v119, 0, v119
v_pk_add_f32 v[84:85], v[84:85], v[130:131]
v_pk_add_f32 v[86:87], v[86:87], v[130:131]
v_pk_add_f32 v[116:117], v[116:117], v[130:131]
v_pk_add_f32 v[118:119], v[118:119], v[130:131]
v_pk_add_f32 v[84:85], v[84:85], v[136:137]
v_pk_add_f32 v[86:87], v[86:87], v[138:139]
v_pk_add_f32 v[116:117], v[116:117], v[140:141]
v_pk_add_f32 v[118:119], v[118:119], v[142:143]
v_cvt_pk_bf16_f32 v208, v80, v81
v_cvt_pk_bf16_f32 v209, v82, v83
v_cvt_pk_bf16_f32 v210, v112, v113
v_cvt_pk_bf16_f32 v211, v114, v115
v_cvt_pk_bf16_f32 v212, v84, v85
v_cvt_pk_bf16_f32 v213, v86, v87
v_cvt_pk_bf16_f32 v214, v116, v117
v_cvt_pk_bf16_f32 v215, v118, v119
v_cvt_pk_bf16_f32 v216, v88, v89
v_cvt_pk_bf16_f32 v217, v90, v91
v_cvt_pk_bf16_f32 v218, v120, v121
v_cvt_pk_bf16_f32 v219, v122, v123
v_cvt_pk_bf16_f32 v220, v92, v93
v_cvt_pk_bf16_f32 v221, v94, v95
v_cvt_pk_bf16_f32 v222, v124, v125
v_cvt_pk_bf16_f32 v223, v126, v127
s_nop 1
v_mfma_f32_16x16x32_bf16 v[168:171], v[208:211], v[216:219], v[168:171]
v_mfma_f32_16x16x32_bf16 v[172:175], v[208:211], v[220:223], v[172:175]
v_mfma_f32_16x16x32_bf16 v[184:187], v[208:211], v[132:135], v[184:187]
v_mfma_f32_16x16x32_bf16 v[176:179], v[212:215], v[216:219], v[176:179]
v_mfma_f32_16x16x32_bf16 v[180:183], v[212:215], v[220:223], v[180:183]
v_mfma_f32_16x16x32_bf16 v[188:191], v[212:215], v[132:135], v[188:191]
s_and_b32 s32, s20, 1
s_mul_i32 s31, s32, 6144
s_add_u32 s33, s31, 150080
s_add_u32 s31, s31, 131072
s_cmp_lt_u32 s20, 2
s_cselect_b32 s32, s31, s33
s_cselect_b32 s33, s33, s31
v_lshl_add_u32 v234, v254, 4, s32
v_lshl_add_u32 v235, v254, 4, s33
s_lshl_b32 s31, s20, 2
s_add_u32 s31, s31, 150048
v_mov_b32 v236, s31
v_xor_b32 v237, 8, v236
v_mov_b32 v238, 1
s_nop 7
s_cmp_lt_u32 s20, 2
s_cbranch_scc1 L_kv_g1_48
ds_write_b128 v234, v[144:147] offset:0
ds_write_b128 v234, v[148:151] offset:1024
ds_write_b128 v234, v[152:155] offset:2048
ds_write_b128 v234, v[156:159] offset:3072
ds_write_b128 v234, v[160:163] offset:4096
ds_write_b128 v234, v[164:167] offset:5120
v_mov_b32 v24, v168
v_mov_b32 v25, v169
v_mov_b32 v26, v170
v_mov_b32 v27, v171
v_mov_b32 v28, v172
v_mov_b32 v29, v173
v_mov_b32 v30, v174
v_mov_b32 v31, v175
v_mov_b32 v32, v176
v_mov_b32 v33, v177
v_mov_b32 v34, v178
v_mov_b32 v35, v179
v_mov_b32 v36, v180
v_mov_b32 v37, v181
v_mov_b32 v38, v182
v_mov_b32 v39, v183
v_mov_b32 v40, v184
v_mov_b32 v41, v185
v_mov_b32 v42, v186
v_mov_b32 v43, v187
v_mov_b32 v44, v188
v_mov_b32 v45, v189
v_mov_b32 v46, v190
v_mov_b32 v47, v191
s_branch L_kv_g2_49
L_kv_g1_48:
ds_write_b128 v234, v[168:171] offset:0
ds_write_b128 v234, v[172:175] offset:1024
ds_write_b128 v234, v[176:179] offset:2048
ds_write_b128 v234, v[180:183] offset:3072
ds_write_b128 v234, v[184:187] offset:4096
ds_write_b128 v234, v[188:191] offset:5120
v_mov_b32 v24, v144
v_mov_b32 v25, v145
v_mov_b32 v26, v146
v_mov_b32 v27, v147
v_mov_b32 v28, v148
v_mov_b32 v29, v149
v_mov_b32 v30, v150
v_mov_b32 v31, v151
v_mov_b32 v32, v152
v_mov_b32 v33, v153
v_mov_b32 v34, v154
v_mov_b32 v35, v155
v_mov_b32 v36, v156
v_mov_b32 v37, v157
v_mov_b32 v38, v158
v_mov_b32 v39, v159
v_mov_b32 v40, v160
v_mov_b32 v41, v161
v_mov_b32 v42, v162
v_mov_b32 v43, v163
v_mov_b32 v44, v164
v_mov_b32 v45, v165
v_mov_b32 v46, v166
v_mov_b32 v47, v167
L_kv_g2_49:
s_waitcnt lgkmcnt(0)
ds_write_b32 v236, v238
s_lshl_b32 s60, s59, 2
s_and_b32 s31, s20, 1
s_lshl_b32 s31, s31, 1
s_add_u32 s60, s60, s31
s_lshr_b32 s31, s20, 1
s_add_u32 s60, s60, s31
s_lshl_b32 s60, s60, 4
s_add_u32 s60, s60, s58
v_and_b32 v234, 15, v254
v_lshlrev_b32 v234, 7, v234
v_lshrrev_b32 v236, 4, v254
v_lshl_add_u32 v234, v236, 4, v234
v_lshlrev_b32 v236, 4, v236
L_kv_pollw_50:
ds_read_b32 v238, v237
s_waitcnt lgkmcnt(0)
v_readfirstlane_b32 s31, v238
s_cmp_eq_u32 s31, 0
s_cbranch_scc1 L_kv_pollw_50
ds_read_b128 v[0:3], v235 offset:0
ds_read_b128 v[4:7], v235 offset:1024
ds_read_b128 v[8:11], v235 offset:2048
ds_read_b128 v[12:15], v235 offset:3072
ds_read_b128 v[16:19], v235 offset:4096
ds_read_b128 v[20:23], v235 offset:5120
s_mul_i32 s31, s60, 4352
s_add_u32 s31, s31, 50331648
s_add_u32 s32, s31, 4096
s_waitcnt lgkmcnt(0)
v_pk_add_f32 v[200:201], v[24:25], v[0:1]
v_pk_add_f32 v[202:203], v[26:27], v[2:3]
v_pk_add_f32 v[204:205], v[28:29], v[4:5]
v_pk_add_f32 v[206:207], v[30:31], v[6:7]
v_pk_add_f32 v[208:209], v[32:33], v[8:9]
v_pk_add_f32 v[210:211], v[34:35], v[10:11]
v_pk_add_f32 v[212:213], v[36:37], v[12:13]
v_pk_add_f32 v[214:215], v[38:39], v[14:15]
v_pk_add_f32 v[216:217], v[40:41], v[16:17]
v_pk_add_f32 v[218:219], v[42:43], v[18:19]
v_pk_add_f32 v[220:221], v[44:45], v[20:21]
v_pk_add_f32 v[222:223], v[46:47], v[22:23]
buffer_store_dwordx4 v[200:203], v234, s[16:19], s31 offen offset:0 sc0 sc1
buffer_store_dwordx4 v[204:207], v234, s[16:19], s31 offen offset:2048 sc0 sc1
buffer_store_dwordx4 v[208:211], v234, s[16:19], s31 offen offset:64 sc0 sc1
buffer_store_dwordx4 v[212:215], v234, s[16:19], s31 offen offset:2112 sc0 sc1
s_mov_b32 exec_lo, 0x00010001
s_mov_b32 exec_hi, 0x00010001
buffer_store_dwordx4 v[216:219], v236, s[16:19], s32 offen offset:0 sc0 sc1
buffer_store_dwordx4 v[220:223], v236, s[16:19], s32 offen offset:64 sc0 sc1
s_mov_b64 exec, -1
s_lshl_b32 s63, s60, 4
s_add_u32 s63, s63, 38879232
v_and_b32 v139, 63, v254
s_lshr_b32 s31, s20, 1
s_and_b32 s32, s20, 1
v_and_b32 v140, 15, v139
s_mul_i32 s33, s31, 64
v_add_u32 v140, s33, v140
v_bfe_u32 v141, v140, 1, 3
v_lshrrev_b32 v142, 4, v139
v_xor_b32 v141, v141, v142
v_lshlrev_b32 v141, 4, v141
v_lshl_add_u32 v128, v140, 7, v141
v_xor_b32 v129, 64, v128
v_lshrrev_b32 v140, 4, v139
v_bfe_u32 v141, v139, 2, 2
v_and_b32 v142, 3, v139
v_lshl_add_u32 v143, v140, 3, v141
v_lshlrev_b32 v142, 3, v142
v_and_b32 v140, 3, v143
v_bfe_u32 v141, v143, 3, 1
v_lshl_or_b32 v140, v141, 2, v140
v_lshlrev_b32 v140, 1, v140
v_lshlrev_b32 v140, 4, v140
v_mul_u32_u24 v143, 256, v143
v_add_u32 v143, 16384, v143
s_mul_i32 s33, s32, 128
s_add_u32 s33, s33, 0
v_add_u32 v141, s33, v142
v_xor_b32 v141, v141, v140
v_add_u32 v130, v141, v143
s_mul_i32 s33, s32, 128
s_add_u32 s33, s33, 32
v_add_u32 v141, s33, v142
v_xor_b32 v141, v141, v140
v_add_u32 v131, v141, v143
s_mul_i32 s33, s32, 128
s_add_u32 s33, s33, 64
v_add_u32 v141, s33, v142
v_xor_b32 v141, v141, v140
v_add_u32 v132, v141, v143
s_mul_i32 s33, s32, 128
s_add_u32 s33, s33, 96
v_add_u32 v141, s33, v142
v_xor_b32 v141, v141, v140
v_add_u32 v133, v141, v143
v_mov_b32 v0, 0
v_mov_b32 v1, 0
v_mov_b32 v2, 0
v_mov_b32 v3, 0
v_mov_b32 v4, 0
v_mov_b32 v5, 0
v_mov_b32 v6, 0
v_mov_b32 v7, 0
v_mov_b32 v8, 0
v_mov_b32 v9, 0
v_mov_b32 v10, 0
v_mov_b32 v11, 0
v_mov_b32 v12, 0
v_mov_b32 v13, 0
v_mov_b32 v14, 0
v_mov_b32 v15, 0
v_mov_b32 v16, 0
v_mov_b32 v17, 0
v_mov_b32 v18, 0
v_mov_b32 v19, 0
v_mov_b32 v20, 0
v_mov_b32 v21, 0
v_mov_b32 v22, 0
v_mov_b32 v23, 0
v_mov_b32 v24, 0
v_mov_b32 v25, 0
v_mov_b32 v26, 0
v_mov_b32 v27, 0
v_mov_b32 v28, 0
v_mov_b32 v29, 0
v_mov_b32 v30, 0
v_mov_b32 v31, 0
v_mov_b32 v32, 0
v_mov_b32 v33, 0
v_mov_b32 v34, 0
v_mov_b32 v35, 0
v_mov_b32 v36, 0
v_mov_b32 v37, 0
v_mov_b32 v38, 0
v_mov_b32 v39, 0
v_mov_b32 v40, 0
v_mov_b32 v41, 0
v_mov_b32 v42, 0
v_mov_b32 v43, 0
v_mov_b32 v44, 0
v_mov_b32 v45, 0
v_mov_b32 v46, 0
v_mov_b32 v47, 0
v_mov_b32 v48, 0
v_mov_b32 v49, 0
v_mov_b32 v50, 0
v_mov_b32 v51, 0
v_mov_b32 v52, 0
v_mov_b32 v53, 0
v_mov_b32 v54, 0
v_mov_b32 v55, 0
v_mov_b32 v56, 0
v_mov_b32 v57, 0
v_mov_b32 v58, 0
v_mov_b32 v59, 0
v_mov_b32 v60, 0
v_mov_b32 v61, 0
v_mov_b32 v62, 0
v_mov_b32 v63, 0
s_lshr_b32 s31, s20, 1
s_and_b32 s32, s20, 1
s_mul_i32 s31, s31, 64
s_add_u32 s31, s31, s21
s_mul_i32 s32, s32, 128
s_add_u32 s32, s32, s22
v_and_b32 v134, 15, v254
v_add_u32 v134, s31, v134
v_mul_u32_u24 v134, 2048, v134
v_add_u32 v134, s32, v134
v_bfe_u32 v139, v254, 5, 1
v_lshl_add_u32 v134, v139, 4, v134
v_bfe_u32 v139, v254, 4, 1
v_lshl_add_u32 v134, v139, 5, v134
v_mov_b32 v137, 0
v_mov_b32 v138, 0
s_mov_b32 s92, 86664
s_mov_b32 s93, 0
s_mov_b32 s30, 0
s_mov_b32 s29, 1
s_barrier
ds_read_b64_tr_b16 v[96:97], v130 offset:0
ds_read_b64_tr_b16 v[98:99], v130 offset:1024
ds_read_b128 v[64:67], v128 offset:0
ds_read_b64_tr_b16 v[100:101], v131 offset:0
ds_read_b64_tr_b16 v[102:103], v131 offset:1024
ds_read_b64_tr_b16 v[104:105], v132 offset:0
ds_read_b64_tr_b16 v[106:107], v132 offset:1024
ds_read_b64_tr_b16 v[108:109], v133 offset:0
ds_read_b64_tr_b16 v[110:111], v133 offset:1024
ds_read_b128 v[68:71], v128 offset:2048
ds_read_b128 v[72:75], v128 offset:4096
ds_read_b128 v[76:79], v128 offset:6144
.p2align 6
L_q_mm_51:
s_bitcmp1_b64 s[92:93], s29
s_cbranch_scc1 L_q_H_52
L_q_B_53:
s_waitcnt lgkmcnt(9)
v_mfma_f32_16x16x32_bf16 v[0:3], v[96:99], v[64:67], v[0:3]
ds_read_b64_tr_b16 v[112:113], v130 offset:8192
ds_read_b64_tr_b16 v[114:115], v130 offset:9216
s_waitcnt lgkmcnt(9)
v_mfma_f32_16x16x32_bf16 v[4:7], v[100:103], v[64:67], v[4:7]
ds_read_b128 v[80:83], v129 offset:0
ds_read_b64_tr_b16 v[116:117], v131 offset:8192
s_waitcnt lgkmcnt(9)
v_mfma_f32_16x16x32_bf16 v[8:11], v[104:107], v[64:67], v[8:11]
ds_read_b64_tr_b16 v[118:119], v131 offset:9216
ds_read_b64_tr_b16 v[120:121], v132 offset:8192
s_waitcnt lgkmcnt(9)
v_mfma_f32_16x16x32_bf16 v[12:15], v[108:111], v[64:67], v[12:15]
ds_read_b64_tr_b16 v[122:123], v132 offset:9216
ds_read_b64_tr_b16 v[124:125], v133 offset:8192
s_waitcnt lgkmcnt(10)
v_mfma_f32_16x16x32_bf16 v[16:19], v[96:99], v[68:71], v[16:19]
ds_read_b64_tr_b16 v[126:127], v133 offset:9216
ds_read_b128 v[84:87], v129 offset:2048
v_mfma_f32_16x16x32_bf16 v[20:23], v[100:103], v[68:71], v[20:23]
ds_read_b128 v[88:91], v129 offset:4096
ds_read_b128 v[92:95], v129 offset:6144
v_mfma_f32_16x16x32_bf16 v[24:27], v[104:107], v[68:71], v[24:27]
s_add_u32 s30, s30, 1
s_cmp_eq_u32 s30, 4
v_mfma_f32_16x16x32_bf16 v[28:31], v[108:111], v[68:71], v[28:31]
s_cselect_b32 s30, 0, s30
s_mov_b32 s38, 32768
s_waitcnt lgkmcnt(13)
v_mfma_f32_16x16x32_bf16 v[32:35], v[96:99], v[72:75], v[32:35]
s_cmov_b32 s38, 4294868992
s_add_u32 s29, s29, 1
v_mfma_f32_16x16x32_bf16 v[36:39], v[100:103], v[72:75], v[36:39]
v_add_u32 v128, s38, v128
v_add_u32 v129, s38, v129
v_mfma_f32_16x16x32_bf16 v[40:43], v[104:107], v[72:75], v[40:43]
v_add_u32 v130, s38, v130
v_add_u32 v131, s38, v131
v_mfma_f32_16x16x32_bf16 v[44:47], v[108:111], v[72:75], v[44:47]
v_add_u32 v132, s38, v132
v_add_u32 v133, s38, v133
s_waitcnt lgkmcnt(12)
v_mfma_f32_16x16x32_bf16 v[48:51], v[96:99], v[76:79], v[48:51]
v_mfma_f32_16x16x32_bf16 v[52:55], v[100:103], v[76:79], v[52:55]
v_mfma_f32_16x16x32_bf16 v[56:59], v[104:107], v[76:79], v[56:59]
v_mfma_f32_16x16x32_bf16 v[60:63], v[108:111], v[76:79], v[60:63]
s_waitcnt lgkmcnt(9)
v_mfma_f32_16x16x32_bf16 v[0:3], v[112:115], v[80:83], v[0:3]
s_waitcnt lgkmcnt(7)
v_mfma_f32_16x16x32_bf16 v[4:7], v[116:119], v[80:83], v[4:7]
s_waitcnt lgkmcnt(5)
v_mfma_f32_16x16x32_bf16 v[8:11], v[120:123], v[80:83], v[8:11]
s_waitcnt lgkmcnt(3)
v_mfma_f32_16x16x32_bf16 v[12:15], v[124:127], v[80:83], v[12:15]
s_waitcnt lgkmcnt(2)
v_mfma_f32_16x16x32_bf16 v[16:19], v[112:115], v[84:87], v[16:19]
s_waitcnt lgkmcnt(0)
s_barrier
ds_read_b64_tr_b16 v[96:97], v130 offset:0
ds_read_b64_tr_b16 v[98:99], v130 offset:1024
v_mfma_f32_16x16x32_bf16 v[20:23], v[116:119], v[84:87], v[20:23]
ds_read_b128 v[64:67], v128 offset:0
ds_read_b64_tr_b16 v[100:101], v131 offset:0
v_mfma_f32_16x16x32_bf16 v[24:27], v[120:123], v[84:87], v[24:27]
ds_read_b64_tr_b16 v[102:103], v131 offset:1024
ds_read_b64_tr_b16 v[104:105], v132 offset:0
v_mfma_f32_16x16x32_bf16 v[28:31], v[124:127], v[84:87], v[28:31]
ds_read_b64_tr_b16 v[106:107], v132 offset:1024
ds_read_b64_tr_b16 v[108:109], v133 offset:0
v_mfma_f32_16x16x32_bf16 v[32:35], v[112:115], v[88:91], v[32:35]
ds_read_b64_tr_b16 v[110:111], v133 offset:1024
ds_read_b128 v[68:71], v128 offset:2048
v_mfma_f32_16x16x32_bf16 v[36:39], v[116:119], v[88:91], v[36:39]
ds_read_b128 v[72:75], v128 offset:4096
ds_read_b128 v[76:79], v128 offset:6144
v_mfma_f32_16x16x32_bf16 v[40:43], v[120:123], v[88:91], v[40:43]
v_mfma_f32_16x16x32_bf16 v[44:47], v[124:127], v[88:91], v[44:47]
v_mfma_f32_16x16x32_bf16 v[48:51], v[112:115], v[92:95], v[48:51]
v_mfma_f32_16x16x32_bf16 v[52:55], v[116:119], v[92:95], v[52:55]
v_mfma_f32_16x16x32_bf16 v[56:59], v[120:123], v[92:95], v[56:59]
v_mfma_f32_16x16x32_bf16 v[60:63], v[124:127], v[92:95], v[60:63]
s_bitcmp1_b64 s[92:93], s29
s_cbranch_scc1 L_q_H_54
L_q_B_55:
s_waitcnt lgkmcnt(9)
v_mfma_f32_16x16x32_bf16 v[0:3], v[96:99], v[64:67], v[0:3]
ds_read_b64_tr_b16 v[112:113], v130 offset:8192
ds_read_b64_tr_b16 v[114:115], v130 offset:9216
s_waitcnt lgkmcnt(9)
v_mfma_f32_16x16x32_bf16 v[4:7], v[100:103], v[64:67], v[4:7]
ds_read_b128 v[80:83], v129 offset:0
ds_read_b64_tr_b16 v[116:117], v131 offset:8192
s_waitcnt lgkmcnt(9)
v_mfma_f32_16x16x32_bf16 v[8:11], v[104:107], v[64:67], v[8:11]
ds_read_b64_tr_b16 v[118:119], v131 offset:9216
ds_read_b64_tr_b16 v[120:121], v132 offset:8192
s_waitcnt lgkmcnt(9)
v_mfma_f32_16x16x32_bf16 v[12:15], v[108:111], v[64:67], v[12:15]
ds_read_b64_tr_b16 v[122:123], v132 offset:9216
ds_read_b64_tr_b16 v[124:125], v133 offset:8192
s_waitcnt lgkmcnt(10)
v_mfma_f32_16x16x32_bf16 v[16:19], v[96:99], v[68:71], v[16:19]
ds_read_b64_tr_b16 v[126:127], v133 offset:9216
ds_read_b128 v[84:87], v129 offset:2048
v_mfma_f32_16x16x32_bf16 v[20:23], v[100:103], v[68:71], v[20:23]
ds_read_b128 v[88:91], v129 offset:4096
ds_read_b128 v[92:95], v129 offset:6144
v_mfma_f32_16x16x32_bf16 v[24:27], v[104:107], v[68:71], v[24:27]
s_add_u32 s30, s30, 1
s_cmp_eq_u32 s30, 4
v_mfma_f32_16x16x32_bf16 v[28:31], v[108:111], v[68:71], v[28:31]
s_cselect_b32 s30, 0, s30
s_mov_b32 s38, 32768
s_waitcnt lgkmcnt(13)
v_mfma_f32_16x16x32_bf16 v[32:35], v[96:99], v[72:75], v[32:35]
s_cmov_b32 s38, 4294868992
s_add_u32 s29, s29, 1
v_mfma_f32_16x16x32_bf16 v[36:39], v[100:103], v[72:75], v[36:39]
v_add_u32 v128, s38, v128
v_add_u32 v129, s38, v129
v_mfma_f32_16x16x32_bf16 v[40:43], v[104:107], v[72:75], v[40:43]
v_add_u32 v130, s38, v130
v_add_u32 v131, s38, v131
v_mfma_f32_16x16x32_bf16 v[44:47], v[108:111], v[72:75], v[44:47]
v_add_u32 v132, s38, v132
v_add_u32 v133, s38, v133
s_waitcnt lgkmcnt(12)
v_mfma_f32_16x16x32_bf16 v[48:51], v[96:99], v[76:79], v[48:51]
v_mfma_f32_16x16x32_bf16 v[52:55], v[100:103], v[76:79], v[52:55]
v_mfma_f32_16x16x32_bf16 v[56:59], v[104:107], v[76:79], v[56:59]
v_mfma_f32_16x16x32_bf16 v[60:63], v[108:111], v[76:79], v[60:63]
s_waitcnt lgkmcnt(9)
v_mfma_f32_16x16x32_bf16 v[0:3], v[112:115], v[80:83], v[0:3]
s_waitcnt lgkmcnt(7)
v_mfma_f32_16x16x32_bf16 v[4:7], v[116:119], v[80:83], v[4:7]
s_waitcnt lgkmcnt(5)
v_mfma_f32_16x16x32_bf16 v[8:11], v[120:123], v[80:83], v[8:11]
s_waitcnt lgkmcnt(3)
v_mfma_f32_16x16x32_bf16 v[12:15], v[124:127], v[80:83], v[12:15]
s_waitcnt lgkmcnt(2)
v_mfma_f32_16x16x32_bf16 v[16:19], v[112:115], v[84:87], v[16:19]
s_waitcnt lgkmcnt(0)
s_barrier
ds_read_b64_tr_b16 v[96:97], v130 offset:0
ds_read_b64_tr_b16 v[98:99], v130 offset:1024
v_mfma_f32_16x16x32_bf16 v[20:23], v[116:119], v[84:87], v[20:23]
ds_read_b128 v[64:67], v128 offset:0
ds_read_b64_tr_b16 v[100:101], v131 offset:0
v_mfma_f32_16x16x32_bf16 v[24:27], v[120:123], v[84:87], v[24:27]
ds_read_b64_tr_b16 v[102:103], v131 offset:1024
ds_read_b64_tr_b16 v[104:105], v132 offset:0
v_mfma_f32_16x16x32_bf16 v[28:31], v[124:127], v[84:87], v[28:31]
ds_read_b64_tr_b16 v[106:107], v132 offset:1024
ds_read_b64_tr_b16 v[108:109], v133 offset:0
v_mfma_f32_16x16x32_bf16 v[32:35], v[112:115], v[88:91], v[32:35]
ds_read_b64_tr_b16 v[110:111], v133 offset:1024
ds_read_b128 v[68:71], v128 offset:2048
v_mfma_f32_16x16x32_bf16 v[36:39], v[116:119], v[88:91], v[36:39]
ds_read_b128 v[72:75], v128 offset:4096
ds_read_b128 v[76:79], v128 offset:6144
v_mfma_f32_16x16x32_bf16 v[40:43], v[120:123], v[88:91], v[40:43]
v_mfma_f32_16x16x32_bf16 v[44:47], v[124:127], v[88:91], v[44:47]
v_mfma_f32_16x16x32_bf16 v[48:51], v[112:115], v[92:95], v[48:51]
v_mfma_f32_16x16x32_bf16 v[52:55], v[116:119], v[92:95], v[52:55]
v_mfma_f32_16x16x32_bf16 v[56:59], v[120:123], v[92:95], v[56:59]
s_cmp_lt_u32 s29, 15
v_mfma_f32_16x16x32_bf16 v[60:63], v[124:127], v[92:95], v[60:63]
s_cbranch_scc1 L_q_mm_51
s_waitcnt lgkmcnt(9)
v_mfma_f32_16x16x32_bf16 v[0:3], v[96:99], v[64:67], v[0:3]
ds_read_b64_tr_b16 v[112:113], v130 offset:8192
ds_read_b64_tr_b16 v[114:115], v130 offset:9216
s_waitcnt lgkmcnt(9)
v_mfma_f32_16x16x32_bf16 v[4:7], v[100:103], v[64:67], v[4:7]
ds_read_b128 v[80:83], v129 offset:0
ds_read_b64_tr_b16 v[116:117], v131 offset:8192
s_waitcnt lgkmcnt(9)
v_mfma_f32_16x16x32_bf16 v[8:11], v[104:107], v[64:67], v[8:11]
ds_read_b64_tr_b16 v[118:119], v131 offset:9216
ds_read_b64_tr_b16 v[120:121], v132 offset:8192
s_waitcnt lgkmcnt(9)
v_mfma_f32_16x16x32_bf16 v[12:15], v[108:111], v[64:67], v[12:15]
ds_read_b64_tr_b16 v[122:123], v132 offset:9216
ds_read_b64_tr_b16 v[124:125], v133 offset:8192
s_waitcnt lgkmcnt(10)
v_mfma_f32_16x16x32_bf16 v[16:19], v[96:99], v[68:71], v[16:19]
ds_read_b64_tr_b16 v[126:127], v133 offset:9216
ds_read_b128 v[84:87], v129 offset:2048
v_mfma_f32_16x16x32_bf16 v[20:23], v[100:103], v[68:71], v[20:23]
ds_read_b128 v[88:91], v129 offset:4096
ds_read_b128 v[92:95], v129 offset:6144
v_mfma_f32_16x16x32_bf16 v[24:27], v[104:107], v[68:71], v[24:27]
s_add_u32 s30, s30, 1
s_cmp_eq_u32 s30, 4
v_mfma_f32_16x16x32_bf16 v[28:31], v[108:111], v[68:71], v[28:31]
s_cselect_b32 s30, 0, s30
s_mov_b32 s38, 32768
s_waitcnt lgkmcnt(13)
v_mfma_f32_16x16x32_bf16 v[32:35], v[96:99], v[72:75], v[32:35]
s_cmov_b32 s38, 4294868992
s_add_u32 s29, s29, 1
v_mfma_f32_16x16x32_bf16 v[36:39], v[100:103], v[72:75], v[36:39]
v_add_u32 v128, s38, v128
v_add_u32 v129, s38, v129
v_mfma_f32_16x16x32_bf16 v[40:43], v[104:107], v[72:75], v[40:43]
v_add_u32 v130, s38, v130
v_add_u32 v131, s38, v131
v_mfma_f32_16x16x32_bf16 v[44:47], v[108:111], v[72:75], v[44:47]
v_add_u32 v132, s38, v132
v_add_u32 v133, s38, v133
s_waitcnt lgkmcnt(12)
v_mfma_f32_16x16x32_bf16 v[48:51], v[96:99], v[76:79], v[48:51]
v_mfma_f32_16x16x32_bf16 v[52:55], v[100:103], v[76:79], v[52:55]
v_mfma_f32_16x16x32_bf16 v[56:59], v[104:107], v[76:79], v[56:59]
v_mfma_f32_16x16x32_bf16 v[60:63], v[108:111], v[76:79], v[60:63]
s_waitcnt lgkmcnt(9)
v_mfma_f32_16x16x32_bf16 v[0:3], v[112:115], v[80:83], v[0:3]
s_waitcnt lgkmcnt(7)
v_mfma_f32_16x16x32_bf16 v[4:7], v[116:119], v[80:83], v[4:7]
s_waitcnt lgkmcnt(5)
v_mfma_f32_16x16x32_bf16 v[8:11], v[120:123], v[80:83], v[8:11]
s_waitcnt lgkmcnt(3)
v_mfma_f32_16x16x32_bf16 v[12:15], v[124:127], v[80:83], v[12:15]
s_waitcnt lgkmcnt(2)
v_mfma_f32_16x16x32_bf16 v[16:19], v[112:115], v[84:87], v[16:19]
s_waitcnt lgkmcnt(0)
s_barrier
ds_read_b64_tr_b16 v[96:97], v130 offset:0
ds_read_b64_tr_b16 v[98:99], v130 offset:1024
v_mfma_f32_16x16x32_bf16 v[20:23], v[116:119], v[84:87], v[20:23]
ds_read_b128 v[64:67], v128 offset:0
ds_read_b64_tr_b16 v[100:101], v131 offset:0
v_mfma_f32_16x16x32_bf16 v[24:27], v[120:123], v[84:87], v[24:27]
ds_read_b64_tr_b16 v[102:103], v131 offset:1024
ds_read_b64_tr_b16 v[104:105], v132 offset:0
v_mfma_f32_16x16x32_bf16 v[28:31], v[124:127], v[84:87], v[28:31]
ds_read_b64_tr_b16 v[106:107], v132 offset:1024
ds_read_b64_tr_b16 v[108:109], v133 offset:0
v_mfma_f32_16x16x32_bf16 v[32:35], v[112:115], v[88:91], v[32:35]
ds_read_b64_tr_b16 v[110:111], v133 offset:1024
ds_read_b128 v[68:71], v128 offset:2048
v_mfma_f32_16x16x32_bf16 v[36:39], v[116:119], v[88:91], v[36:39]
ds_read_b128 v[72:75], v128 offset:4096
ds_read_b128 v[76:79], v128 offset:6144
v_mfma_f32_16x16x32_bf16 v[40:43], v[120:123], v[88:91], v[40:43]
v_mfma_f32_16x16x32_bf16 v[44:47], v[124:127], v[88:91], v[44:47]
v_mfma_f32_16x16x32_bf16 v[48:51], v[112:115], v[92:95], v[48:51]
v_mfma_f32_16x16x32_bf16 v[52:55], v[116:119], v[92:95], v[52:55]
v_mfma_f32_16x16x32_bf16 v[56:59], v[120:123], v[92:95], v[56:59]
v_mfma_f32_16x16x32_bf16 v[60:63], v[124:127], v[92:95], v[60:63]
s_bitcmp1_b64 s[92:93], s29
s_cbranch_scc1 L_q_H_56
L_q_B_57:
s_waitcnt lgkmcnt(9)
v_mfma_f32_16x16x32_bf16 v[0:3], v[96:99], v[64:67], v[0:3]
ds_read_b64_tr_b16 v[112:113], v130 offset:8192
s_waitcnt lgkmcnt(8)
v_mfma_f32_16x16x32_bf16 v[4:7], v[100:103], v[64:67], v[4:7]
ds_read_b64_tr_b16 v[114:115], v130 offset:9216
s_waitcnt lgkmcnt(7)
v_mfma_f32_16x16x32_bf16 v[8:11], v[104:107], v[64:67], v[8:11]
ds_read_b128 v[80:83], v129 offset:0
s_waitcnt lgkmcnt(6)
v_mfma_f32_16x16x32_bf16 v[12:15], v[108:111], v[64:67], v[12:15]
ds_read_b64_tr_b16 v[116:117], v131 offset:8192
s_waitcnt lgkmcnt(6)
v_mfma_f32_16x16x32_bf16 v[16:19], v[96:99], v[68:71], v[16:19]
ds_read_b64_tr_b16 v[118:119], v131 offset:9216
v_mfma_f32_16x16x32_bf16 v[20:23], v[100:103], v[68:71], v[20:23]
ds_read_b64_tr_b16 v[120:121], v132 offset:8192
v_mfma_f32_16x16x32_bf16 v[24:27], v[104:107], v[68:71], v[24:27]
ds_read_b64_tr_b16 v[122:123], v132 offset:9216
v_mfma_f32_16x16x32_bf16 v[28:31], v[108:111], v[68:71], v[28:31]
ds_read_b64_tr_b16 v[124:125], v133 offset:8192
s_waitcnt lgkmcnt(9)
v_mfma_f32_16x16x32_bf16 v[32:35], v[96:99], v[72:75], v[32:35]
ds_read_b64_tr_b16 v[126:127], v133 offset:9216
v_mfma_f32_16x16x32_bf16 v[36:39], v[100:103], v[72:75], v[36:39]
ds_read_b128 v[84:87], v129 offset:2048
v_mfma_f32_16x16x32_bf16 v[40:43], v[104:107], v[72:75], v[40:43]
ds_read_b128 v[88:91], v129 offset:4096
v_mfma_f32_16x16x32_bf16 v[44:47], v[108:111], v[72:75], v[44:47]
ds_read_b128 v[92:95], v129 offset:6144
s_waitcnt lgkmcnt(12)
v_mfma_f32_16x16x32_bf16 v[48:51], v[96:99], v[76:79], v[48:51]
v_mfma_f32_16x16x32_bf16 v[52:55], v[100:103], v[76:79], v[52:55]
v_mfma_f32_16x16x32_bf16 v[56:59], v[104:107], v[76:79], v[56:59]
v_mfma_f32_16x16x32_bf16 v[60:63], v[108:111], v[76:79], v[60:63]
s_waitcnt lgkmcnt(9)
v_mfma_f32_16x16x32_bf16 v[0:3], v[112:115], v[80:83], v[0:3]
s_waitcnt lgkmcnt(7)
v_mfma_f32_16x16x32_bf16 v[4:7], v[116:119], v[80:83], v[4:7]
s_waitcnt lgkmcnt(5)
v_mfma_f32_16x16x32_bf16 v[8:11], v[120:123], v[80:83], v[8:11]
s_waitcnt lgkmcnt(3)
v_mfma_f32_16x16x32_bf16 v[12:15], v[124:127], v[80:83], v[12:15]
s_waitcnt lgkmcnt(2)
v_mfma_f32_16x16x32_bf16 v[16:19], v[112:115], v[84:87], v[16:19]
s_waitcnt lgkmcnt(0)
s_barrier
v_mfma_f32_16x16x32_bf16 v[20:23], v[116:119], v[84:87], v[20:23]
v_mfma_f32_16x16x32_bf16 v[24:27], v[120:123], v[84:87], v[24:27]
v_mfma_f32_16x16x32_bf16 v[28:31], v[124:127], v[84:87], v[28:31]
v_mfma_f32_16x16x32_bf16 v[32:35], v[112:115], v[88:91], v[32:35]
v_mfma_f32_16x16x32_bf16 v[36:39], v[116:119], v[88:91], v[36:39]
v_mfma_f32_16x16x32_bf16 v[40:43], v[120:123], v[88:91], v[40:43]
v_mfma_f32_16x16x32_bf16 v[44:47], v[124:127], v[88:91], v[44:47]
v_mfma_f32_16x16x32_bf16 v[48:51], v[112:115], v[92:95], v[48:51]
v_mfma_f32_16x16x32_bf16 v[52:55], v[116:119], v[92:95], v[52:55]
v_mfma_f32_16x16x32_bf16 v[56:59], v[120:123], v[92:95], v[56:59]
v_mfma_f32_16x16x32_bf16 v[60:63], v[124:127], v[92:95], v[60:63]
v_mov_b32 v64, 1069066811
v_mov_b32 v65, 1069066811
v_mov_b32 v66, 897988541
v_mov_b32 v67, 897988541
s_lshr_b32 s31, s20, 1
s_lshl_b32 s31, s31, 10
s_add_u32 s31, s31, 147456
v_and_b32 v139, 15, v254
v_lshl_add_u32 v139, v139, 4, s31
ds_read_b32 v68, v139 offset:8
ds_read_b32 v69, v139 offset:264
ds_read_b32 v70, v139 offset:520
ds_read_b32 v71, v139 offset:776
v_pk_mul_f32 v[72:73], v[0:1], v[64:65]
v_pk_mul_f32 v[74:75], v[2:3], v[64:65]
v_pk_mul_f32 v[76:77], v[4:5], v[64:65]
v_pk_mul_f32 v[78:79], v[6:7], v[64:65]
v_exp_f32_e64 v72, v72 clamp
v_exp_f32_e64 v73, v73 clamp
v_exp_f32_e64 v74, v74 clamp
v_exp_f32_e64 v75, v75 clamp
v_exp_f32_e64 v76, v76 clamp
v_exp_f32_e64 v77, v77 clamp
v_exp_f32_e64 v78, v78 clamp
v_exp_f32_e64 v79, v79 clamp
v_max_f32 v0, 0, v0
v_max_f32 v1, 0, v1
v_max_f32 v2, 0, v2
v_max_f32 v3, 0, v3
v_max_f32 v4, 0, v4
v_max_f32 v5, 0, v5
v_max_f32 v6, 0, v6
v_max_f32 v7, 0, v7
v_pk_add_f32 v[0:1], v[0:1], v[66:67]
v_pk_add_f32 v[2:3], v[2:3], v[66:67]
v_pk_add_f32 v[4:5], v[4:5], v[66:67]
v_pk_add_f32 v[6:7], v[6:7], v[66:67]
v_pk_add_f32 v[0:1], v[0:1], v[72:73]
v_pk_add_f32 v[2:3], v[2:3], v[74:75]
v_pk_add_f32 v[4:5], v[4:5], v[76:77]
v_pk_add_f32 v[6:7], v[6:7], v[78:79]
v_cvt_pk_bf16_f32 v80, v0, v1
v_cvt_pk_bf16_f32 v81, v2, v3
v_cvt_pk_bf16_f32 v82, v4, v5
v_cvt_pk_bf16_f32 v83, v6, v7
v_pk_mul_f32 v[72:73], v[8:9], v[64:65]
v_pk_mul_f32 v[74:75], v[10:11], v[64:65]
v_pk_mul_f32 v[76:77], v[12:13], v[64:65]
v_pk_mul_f32 v[78:79], v[14:15], v[64:65]
v_exp_f32_e64 v72, v72 clamp
v_exp_f32_e64 v73, v73 clamp
v_exp_f32_e64 v74, v74 clamp
v_exp_f32_e64 v75, v75 clamp
v_exp_f32_e64 v76, v76 clamp
v_exp_f32_e64 v77, v77 clamp
v_exp_f32_e64 v78, v78 clamp
v_exp_f32_e64 v79, v79 clamp
v_max_f32 v8, 0, v8
v_max_f32 v9, 0, v9
v_max_f32 v10, 0, v10
v_max_f32 v11, 0, v11
v_max_f32 v12, 0, v12
v_max_f32 v13, 0, v13
v_max_f32 v14, 0, v14
v_max_f32 v15, 0, v15
v_pk_add_f32 v[8:9], v[8:9], v[66:67]
v_pk_add_f32 v[10:11], v[10:11], v[66:67]
v_pk_add_f32 v[12:13], v[12:13], v[66:67]
v_pk_add_f32 v[14:15], v[14:15], v[66:67]
v_pk_add_f32 v[8:9], v[8:9], v[72:73]
v_pk_add_f32 v[10:11], v[10:11], v[74:75]
v_pk_add_f32 v[12:13], v[12:13], v[76:77]
v_pk_add_f32 v[14:15], v[14:15], v[78:79]
v_cvt_pk_bf16_f32 v84, v8, v9
v_cvt_pk_bf16_f32 v85, v10, v11
v_cvt_pk_bf16_f32 v86, v12, v13
v_cvt_pk_bf16_f32 v87, v14, v15
v_pk_mul_f32 v[72:73], v[16:17], v[64:65]
v_pk_mul_f32 v[74:75], v[18:19], v[64:65]
v_pk_mul_f32 v[76:77], v[20:21], v[64:65]
v_pk_mul_f32 v[78:79], v[22:23], v[64:65]
v_exp_f32_e64 v72, v72 clamp
v_exp_f32_e64 v73, v73 clamp
v_exp_f32_e64 v74, v74 clamp
v_exp_f32_e64 v75, v75 clamp
v_exp_f32_e64 v76, v76 clamp
v_exp_f32_e64 v77, v77 clamp
v_exp_f32_e64 v78, v78 clamp
v_exp_f32_e64 v79, v79 clamp
v_max_f32 v16, 0, v16
v_max_f32 v17, 0, v17
v_max_f32 v18, 0, v18
v_max_f32 v19, 0, v19
v_max_f32 v20, 0, v20
v_max_f32 v21, 0, v21
v_max_f32 v22, 0, v22
v_max_f32 v23, 0, v23
v_pk_add_f32 v[16:17], v[16:17], v[66:67]
v_pk_add_f32 v[18:19], v[18:19], v[66:67]
v_pk_add_f32 v[20:21], v[20:21], v[66:67]
v_pk_add_f32 v[22:23], v[22:23], v[66:67]
v_pk_add_f32 v[16:17], v[16:17], v[72:73]
v_pk_add_f32 v[18:19], v[18:19], v[74:75]
v_pk_add_f32 v[20:21], v[20:21], v[76:77]
v_pk_add_f32 v[22:23], v[22:23], v[78:79]
v_cvt_pk_bf16_f32 v88, v16, v17
v_cvt_pk_bf16_f32 v89, v18, v19
v_cvt_pk_bf16_f32 v90, v20, v21
v_cvt_pk_bf16_f32 v91, v22, v23
v_pk_mul_f32 v[72:73], v[24:25], v[64:65]
v_pk_mul_f32 v[74:75], v[26:27], v[64:65]
v_pk_mul_f32 v[76:77], v[28:29], v[64:65]
v_pk_mul_f32 v[78:79], v[30:31], v[64:65]
v_exp_f32_e64 v72, v72 clamp
v_exp_f32_e64 v73, v73 clamp
v_exp_f32_e64 v74, v74 clamp
v_exp_f32_e64 v75, v75 clamp
v_exp_f32_e64 v76, v76 clamp
v_exp_f32_e64 v77, v77 clamp
v_exp_f32_e64 v78, v78 clamp
v_exp_f32_e64 v79, v79 clamp
v_max_f32 v24, 0, v24
v_max_f32 v25, 0, v25
v_max_f32 v26, 0, v26
v_max_f32 v27, 0, v27
v_max_f32 v28, 0, v28
v_max_f32 v29, 0, v29
v_max_f32 v30, 0, v30
v_max_f32 v31, 0, v31
v_pk_add_f32 v[24:25], v[24:25], v[66:67]
v_pk_add_f32 v[26:27], v[26:27], v[66:67]
v_pk_add_f32 v[28:29], v[28:29], v[66:67]
v_pk_add_f32 v[30:31], v[30:31], v[66:67]
v_pk_add_f32 v[24:25], v[24:25], v[72:73]
v_pk_add_f32 v[26:27], v[26:27], v[74:75]
v_pk_add_f32 v[28:29], v[28:29], v[76:77]
v_pk_add_f32 v[30:31], v[30:31], v[78:79]
v_cvt_pk_bf16_f32 v92, v24, v25
v_cvt_pk_bf16_f32 v93, v26, v27
v_cvt_pk_bf16_f32 v94, v28, v29
v_cvt_pk_bf16_f32 v95, v30, v31
s_and_b32 s32, s20, 1
s_lshl_b32 s61, s59, 1
s_add_u32 s61, s61, s32
s_lshl_b32 s31, s61, 9
s_add_u32 s31, s31, 38887424
s_waitcnt vmcnt(0)
v_cmp_eq_u32 vcc, 0, v138
s_and_b32 vcc_lo, vcc_lo, 33489407
s_and_b32 vcc_hi, vcc_hi, 0
s_cmp_eq_u64 vcc, 0
s_cbranch_scc1 L_nbok_77
s_mov_b32 s50, 0
L_poll_78:
buffer_load_dword v138, v137, s[16:19], s31 offen sc0 sc1
s_waitcnt vmcnt(0)
v_cmp_eq_u32 vcc, 0, v138
s_and_b32 vcc_lo, vcc_lo, 33489407
s_and_b32 vcc_hi, vcc_hi, 0
s_cmp_eq_u64 vcc, 0
s_cbranch_scc1 L_pollx_79
s_sleep 4
s_add_u32 s50, s50, 1
s_cmp_lt_u32 s50, 100000
s_cbranch_scc1 L_poll_78
L_pollx_79:
L_nbok_77:
v_lshlrev_b32 v137, 4, v254
v_and_b32 v138, 48, v254
s_lshl_b32 s31, s61, 12
s_add_u32 s31, s31, 35651584
s_lshl_b32 s32, s61, 7
s_add_u32 s32, s32, 35717120
buffer_load_dwordx4 v[224:227], v137, s[16:19], s31 offen offset:0
buffer_load_dwordx4 v[228:231], v137, s[16:19], s31 offen offset:1024
buffer_load_dwordx4 v[232:235], v138, s[16:19], s32 offen offset:0
buffer_load_dwordx4 v[236:239], v137, s[16:19], s31 offen offset:2048
buffer_load_dwordx4 v[240:243], v137, s[16:19], s31 offen offset:3072
buffer_load_dwordx4 v[244:247], v138, s[16:19], s32 offen offset:64
v_pk_mul_f32 v[72:73], v[32:33], v[64:65]
v_pk_mul_f32 v[74:75], v[34:35], v[64:65]
v_pk_mul_f32 v[76:77], v[36:37], v[64:65]
v_pk_mul_f32 v[78:79], v[38:39], v[64:65]
v_exp_f32_e64 v72, v72 clamp
v_exp_f32_e64 v73, v73 clamp
v_exp_f32_e64 v74, v74 clamp
v_exp_f32_e64 v75, v75 clamp
v_exp_f32_e64 v76, v76 clamp
v_exp_f32_e64 v77, v77 clamp
v_exp_f32_e64 v78, v78 clamp
v_exp_f32_e64 v79, v79 clamp
v_max_f32 v32, 0, v32
v_max_f32 v33, 0, v33
v_max_f32 v34, 0, v34
v_max_f32 v35, 0, v35
v_max_f32 v36, 0, v36
v_max_f32 v37, 0, v37
v_max_f32 v38, 0, v38
v_max_f32 v39, 0, v39
v_pk_add_f32 v[32:33], v[32:33], v[66:67]
v_pk_add_f32 v[34:35], v[34:35], v[66:67]
v_pk_add_f32 v[36:37], v[36:37], v[66:67]
v_pk_add_f32 v[38:39], v[38:39], v[66:67]
v_pk_add_f32 v[32:33], v[32:33], v[72:73]
v_pk_add_f32 v[34:35], v[34:35], v[74:75]
v_pk_add_f32 v[36:37], v[36:37], v[76:77]
v_pk_add_f32 v[38:39], v[38:39], v[78:79]
v_cvt_pk_bf16_f32 v96, v32, v33
v_cvt_pk_bf16_f32 v97, v34, v35
v_cvt_pk_bf16_f32 v98, v36, v37
v_cvt_pk_bf16_f32 v99, v38, v39
v_pk_mul_f32 v[72:73], v[40:41], v[64:65]
v_pk_mul_f32 v[74:75], v[42:43], v[64:65]
v_pk_mul_f32 v[76:77], v[44:45], v[64:65]
v_pk_mul_f32 v[78:79], v[46:47], v[64:65]
v_exp_f32_e64 v72, v72 clamp
v_exp_f32_e64 v73, v73 clamp
v_exp_f32_e64 v74, v74 clamp
v_exp_f32_e64 v75, v75 clamp
v_exp_f32_e64 v76, v76 clamp
v_exp_f32_e64 v77, v77 clamp
v_exp_f32_e64 v78, v78 clamp
v_exp_f32_e64 v79, v79 clamp
v_max_f32 v40, 0, v40
v_max_f32 v41, 0, v41
v_max_f32 v42, 0, v42
v_max_f32 v43, 0, v43
v_max_f32 v44, 0, v44
v_max_f32 v45, 0, v45
v_max_f32 v46, 0, v46
v_max_f32 v47, 0, v47
v_pk_add_f32 v[40:41], v[40:41], v[66:67]
v_pk_add_f32 v[42:43], v[42:43], v[66:67]
v_pk_add_f32 v[44:45], v[44:45], v[66:67]
v_pk_add_f32 v[46:47], v[46:47], v[66:67]
v_pk_add_f32 v[40:41], v[40:41], v[72:73]
v_pk_add_f32 v[42:43], v[42:43], v[74:75]
v_pk_add_f32 v[44:45], v[44:45], v[76:77]
v_pk_add_f32 v[46:47], v[46:47], v[78:79]
v_cvt_pk_bf16_f32 v100, v40, v41
v_cvt_pk_bf16_f32 v101, v42, v43
v_cvt_pk_bf16_f32 v102, v44, v45
v_cvt_pk_bf16_f32 v103, v46, v47
v_pk_mul_f32 v[72:73], v[48:49], v[64:65]
v_pk_mul_f32 v[74:75], v[50:51], v[64:65]
v_pk_mul_f32 v[76:77], v[52:53], v[64:65]
v_pk_mul_f32 v[78:79], v[54:55], v[64:65]
v_exp_f32_e64 v72, v72 clamp
v_exp_f32_e64 v73, v73 clamp
v_exp_f32_e64 v74, v74 clamp
v_exp_f32_e64 v75, v75 clamp
v_exp_f32_e64 v76, v76 clamp
v_exp_f32_e64 v77, v77 clamp
v_exp_f32_e64 v78, v78 clamp
v_exp_f32_e64 v79, v79 clamp
v_max_f32 v48, 0, v48
v_max_f32 v49, 0, v49
v_max_f32 v50, 0, v50
v_max_f32 v51, 0, v51
v_max_f32 v52, 0, v52
v_max_f32 v53, 0, v53
v_max_f32 v54, 0, v54
v_max_f32 v55, 0, v55
v_pk_add_f32 v[48:49], v[48:49], v[66:67]
v_pk_add_f32 v[50:51], v[50:51], v[66:67]
v_pk_add_f32 v[52:53], v[52:53], v[66:67]
v_pk_add_f32 v[54:55], v[54:55], v[66:67]
v_pk_add_f32 v[48:49], v[48:49], v[72:73]
v_pk_add_f32 v[50:51], v[50:51], v[74:75]
v_pk_add_f32 v[52:53], v[52:53], v[76:77]
v_pk_add_f32 v[54:55], v[54:55], v[78:79]
v_cvt_pk_bf16_f32 v104, v48, v49
v_cvt_pk_bf16_f32 v105, v50, v51
v_cvt_pk_bf16_f32 v106, v52, v53
v_cvt_pk_bf16_f32 v107, v54, v55
v_pk_mul_f32 v[72:73], v[56:57], v[64:65]
v_pk_mul_f32 v[74:75], v[58:59], v[64:65]
v_pk_mul_f32 v[76:77], v[60:61], v[64:65]
v_pk_mul_f32 v[78:79], v[62:63], v[64:65]
v_exp_f32_e64 v72, v72 clamp
v_exp_f32_e64 v73, v73 clamp
v_exp_f32_e64 v74, v74 clamp
v_exp_f32_e64 v75, v75 clamp
v_exp_f32_e64 v76, v76 clamp
v_exp_f32_e64 v77, v77 clamp
v_exp_f32_e64 v78, v78 clamp
v_exp_f32_e64 v79, v79 clamp
v_max_f32 v56, 0, v56
v_max_f32 v57, 0, v57
v_max_f32 v58, 0, v58
v_max_f32 v59, 0, v59
v_max_f32 v60, 0, v60
v_max_f32 v61, 0, v61
v_max_f32 v62, 0, v62
v_max_f32 v63, 0, v63
v_pk_add_f32 v[56:57], v[56:57], v[66:67]
v_pk_add_f32 v[58:59], v[58:59], v[66:67]
v_pk_add_f32 v[60:61], v[60:61], v[66:67]
v_pk_add_f32 v[62:63], v[62:63], v[66:67]
v_pk_add_f32 v[56:57], v[56:57], v[72:73]
v_pk_add_f32 v[58:59], v[58:59], v[74:75]
v_pk_add_f32 v[60:61], v[60:61], v[76:77]
v_pk_add_f32 v[62:63], v[62:63], v[78:79]
v_cvt_pk_bf16_f32 v108, v56, v57
v_cvt_pk_bf16_f32 v109, v58, v59
v_cvt_pk_bf16_f32 v110, v60, v61
v_cvt_pk_bf16_f32 v111, v62, v63
s_waitcnt vmcnt(0)
v_mfma_f32_16x16x32_bf16 v[8:11], v[232:235], v[80:83], 0
v_mfma_f32_16x16x32_bf16 v[0:3], v[224:227], v[80:83], 0
v_mfma_f32_16x16x32_bf16 v[4:7], v[228:231], v[80:83], 0
v_mfma_f32_16x16x32_bf16 v[20:23], v[244:247], v[84:87], 0
v_mfma_f32_16x16x32_bf16 v[12:15], v[236:239], v[84:87], 0
v_mfma_f32_16x16x32_bf16 v[16:19], v[240:243], v[84:87], 0
v_mfma_f32_16x16x32_bf16 v[32:35], v[232:235], v[88:91], 0
v_mfma_f32_16x16x32_bf16 v[24:27], v[224:227], v[88:91], 0
v_mfma_f32_16x16x32_bf16 v[28:31], v[228:231], v[88:91], 0
v_mfma_f32_16x16x32_bf16 v[44:47], v[244:247], v[92:95], 0
v_mfma_f32_16x16x32_bf16 v[36:39], v[236:239], v[92:95], 0
v_mfma_f32_16x16x32_bf16 v[40:43], v[240:243], v[92:95], 0
v_mfma_f32_16x16x32_bf16 v[56:59], v[232:235], v[96:99], 0
v_mfma_f32_16x16x32_bf16 v[48:51], v[224:227], v[96:99], 0
v_mfma_f32_16x16x32_bf16 v[52:55], v[228:231], v[96:99], 0
v_mfma_f32_16x16x32_bf16 v[160:163], v[244:247], v[100:103], 0
v_mfma_f32_16x16x32_bf16 v[152:155], v[236:239], v[100:103], 0
v_mfma_f32_16x16x32_bf16 v[156:159], v[240:243], v[100:103], 0
v_mfma_f32_16x16x32_bf16 v[172:175], v[232:235], v[104:107], 0
v_mfma_f32_16x16x32_bf16 v[164:167], v[224:227], v[104:107], 0
v_mfma_f32_16x16x32_bf16 v[168:171], v[228:231], v[104:107], 0
v_mfma_f32_16x16x32_bf16 v[184:187], v[244:247], v[108:111], 0
v_mfma_f32_16x16x32_bf16 v[176:179], v[236:239], v[108:111], 0
v_mfma_f32_16x16x32_bf16 v[180:183], v[240:243], v[108:111], 0
s_nop 7
v_add_f32 v8, 897988541, v8
v_add_f32 v20, 897988541, v20
v_add_f32 v32, 897988541, v32
v_add_f32 v44, 897988541, v44
v_add_f32 v56, 897988541, v56
v_add_f32 v160, 897988541, v160
v_add_f32 v172, 897988541, v172
v_add_f32 v184, 897988541, v184
v_rcp_f32 v8, v8
v_rcp_f32 v20, v20
v_rcp_f32 v32, v32
v_rcp_f32 v44, v44
v_rcp_f32 v56, v56
v_rcp_f32 v160, v160
v_rcp_f32 v172, v172
v_rcp_f32 v184, v184
s_waitcnt lgkmcnt(0)
v_mul_f32 v8, v8, v68
v_mul_f32 v20, v20, v68
v_mul_f32 v32, v32, v69
v_mul_f32 v44, v44, v69
v_mul_f32 v56, v56, v70
v_mul_f32 v160, v160, v70
v_mul_f32 v172, v172, v71
v_mul_f32 v184, v184, v71
v_pk_mul_f32 v[0:1], v[0:1], v[8:9] op_sel_hi:[1,0]
v_pk_mul_f32 v[2:3], v[2:3], v[8:9] op_sel_hi:[1,0]
v_pk_mul_f32 v[4:5], v[4:5], v[8:9] op_sel_hi:[1,0]
v_pk_mul_f32 v[6:7], v[6:7], v[8:9] op_sel_hi:[1,0]
v_cvt_pk_bf16_f32 v112, v0, v1
v_cvt_pk_bf16_f32 v113, v2, v3
v_cvt_pk_bf16_f32 v114, v4, v5
v_cvt_pk_bf16_f32 v115, v6, v7
s_mov_b32 s34, 8388608
s_nop 0
v_permlane16_swap_b32 v112, v114
v_permlane16_swap_b32 v113, v115
buffer_store_dwordx4 v[112:115], v134, s[16:19], s34 offen offset:0 sc0 sc1
v_pk_mul_f32 v[12:13], v[12:13], v[20:21] op_sel_hi:[1,0]
v_pk_mul_f32 v[14:15], v[14:15], v[20:21] op_sel_hi:[1,0]
v_pk_mul_f32 v[16:17], v[16:17], v[20:21] op_sel_hi:[1,0]
v_pk_mul_f32 v[18:19], v[18:19], v[20:21] op_sel_hi:[1,0]
v_cvt_pk_bf16_f32 v116, v12, v13
v_cvt_pk_bf16_f32 v117, v14, v15
v_cvt_pk_bf16_f32 v118, v16, v17
v_cvt_pk_bf16_f32 v119, v18, v19
s_mov_b32 s34, 8388608
s_nop 0
v_permlane16_swap_b32 v116, v118
v_permlane16_swap_b32 v117, v119
buffer_store_dwordx4 v[116:119], v134, s[16:19], s34 offen offset:64 sc0 sc1
v_pk_mul_f32 v[24:25], v[24:25], v[32:33] op_sel_hi:[1,0]
v_pk_mul_f32 v[26:27], v[26:27], v[32:33] op_sel_hi:[1,0]
v_pk_mul_f32 v[28:29], v[28:29], v[32:33] op_sel_hi:[1,0]
v_pk_mul_f32 v[30:31], v[30:31], v[32:33] op_sel_hi:[1,0]
v_cvt_pk_bf16_f32 v120, v24, v25
v_cvt_pk_bf16_f32 v121, v26, v27
v_cvt_pk_bf16_f32 v122, v28, v29
v_cvt_pk_bf16_f32 v123, v30, v31
s_mov_b32 s34, 8421376
s_nop 0
v_permlane16_swap_b32 v120, v122
v_permlane16_swap_b32 v121, v123
buffer_store_dwordx4 v[120:123], v134, s[16:19], s34 offen offset:0 sc0 sc1
v_pk_mul_f32 v[36:37], v[36:37], v[44:45] op_sel_hi:[1,0]
v_pk_mul_f32 v[38:39], v[38:39], v[44:45] op_sel_hi:[1,0]
v_pk_mul_f32 v[40:41], v[40:41], v[44:45] op_sel_hi:[1,0]
v_pk_mul_f32 v[42:43], v[42:43], v[44:45] op_sel_hi:[1,0]
v_cvt_pk_bf16_f32 v124, v36, v37
v_cvt_pk_bf16_f32 v125, v38, v39
v_cvt_pk_bf16_f32 v126, v40, v41
v_cvt_pk_bf16_f32 v127, v42, v43
s_mov_b32 s34, 8421376
s_nop 0
v_permlane16_swap_b32 v124, v126
v_permlane16_swap_b32 v125, v127
buffer_store_dwordx4 v[124:127], v134, s[16:19], s34 offen offset:64 sc0 sc1
v_pk_mul_f32 v[48:49], v[48:49], v[56:57] op_sel_hi:[1,0]
v_pk_mul_f32 v[50:51], v[50:51], v[56:57] op_sel_hi:[1,0]
v_pk_mul_f32 v[52:53], v[52:53], v[56:57] op_sel_hi:[1,0]
v_pk_mul_f32 v[54:55], v[54:55], v[56:57] op_sel_hi:[1,0]
v_cvt_pk_bf16_f32 v112, v48, v49
v_cvt_pk_bf16_f32 v113, v50, v51
v_cvt_pk_bf16_f32 v114, v52, v53
v_cvt_pk_bf16_f32 v115, v54, v55
s_mov_b32 s34, 8454144
s_nop 0
v_permlane16_swap_b32 v112, v114
v_permlane16_swap_b32 v113, v115
buffer_store_dwordx4 v[112:115], v134, s[16:19], s34 offen offset:0 sc0 sc1
v_pk_mul_f32 v[152:153], v[152:153], v[160:161] op_sel_hi:[1,0]
v_pk_mul_f32 v[154:155], v[154:155], v[160:161] op_sel_hi:[1,0]
v_pk_mul_f32 v[156:157], v[156:157], v[160:161] op_sel_hi:[1,0]
v_pk_mul_f32 v[158:159], v[158:159], v[160:161] op_sel_hi:[1,0]
v_cvt_pk_bf16_f32 v116, v152, v153
v_cvt_pk_bf16_f32 v117, v154, v155
v_cvt_pk_bf16_f32 v118, v156, v157
v_cvt_pk_bf16_f32 v119, v158, v159
s_mov_b32 s34, 8454144
s_nop 0
v_permlane16_swap_b32 v116, v118
v_permlane16_swap_b32 v117, v119
buffer_store_dwordx4 v[116:119], v134, s[16:19], s34 offen offset:64 sc0 sc1
v_pk_mul_f32 v[164:165], v[164:165], v[172:173] op_sel_hi:[1,0]
v_pk_mul_f32 v[166:167], v[166:167], v[172:173] op_sel_hi:[1,0]
v_pk_mul_f32 v[168:169], v[168:169], v[172:173] op_sel_hi:[1,0]
v_pk_mul_f32 v[170:171], v[170:171], v[172:173] op_sel_hi:[1,0]
v_cvt_pk_bf16_f32 v120, v164, v165
v_cvt_pk_bf16_f32 v121, v166, v167
v_cvt_pk_bf16_f32 v122, v168, v169
v_cvt_pk_bf16_f32 v123, v170, v171
s_mov_b32 s34, 8486912
s_nop 0
v_permlane16_swap_b32 v120, v122
v_permlane16_swap_b32 v121, v123
buffer_store_dwordx4 v[120:123], v134, s[16:19], s34 offen offset:0 sc0 sc1
v_pk_mul_f32 v[176:177], v[176:177], v[184:185] op_sel_hi:[1,0]
v_pk_mul_f32 v[178:179], v[178:179], v[184:185] op_sel_hi:[1,0]
v_pk_mul_f32 v[180:181], v[180:181], v[184:185] op_sel_hi:[1,0]
v_pk_mul_f32 v[182:183], v[182:183], v[184:185] op_sel_hi:[1,0]
v_cvt_pk_bf16_f32 v124, v176, v177
v_cvt_pk_bf16_f32 v125, v178, v179
v_cvt_pk_bf16_f32 v126, v180, v181
v_cvt_pk_bf16_f32 v127, v182, v183
s_mov_b32 s34, 8486912
s_nop 0
v_permlane16_swap_b32 v124, v126
v_permlane16_swap_b32 v125, v127
buffer_store_dwordx4 v[124:127], v134, s[16:19], s34 offen offset:64 sc0 sc1
s_lshl_b32 s63, s58, 4
s_add_u32 s63, s63, s59
s_lshl_b32 s63, s63, 2
s_add_u32 s63, s63, s20
s_lshl_b32 s63, s63, 4
s_add_u32 s63, s63, 38830080
s_bfe_u32 s5, s2, 0x10002
s_bfe_u32 s6, s2, 0x10001
s_lshr_b32 s4, s2, 3
s_lshr_b32 s7, s4, 2
s_and_b32 s4, s4, 3
s_lshl_b32 s5, s5, 3
s_add_u32 s58, s5, s7
s_lshl_b32 s6, s6, 2
s_add_u32 s59, s6, s4
s_mul_i32 s3, s7, 1
s_mul_i32 s31, s4, 0
s_add_u32 s3, s3, s31
s_lshl_b32 s21, s58, 7
s_lshl_b32 s22, s59, 8
s_mul_i32 s22, s59, 384
s_add_u32 s22, s22, 4096
s_nop 1
v_and_b32 v186, 63, v254
s_lshr_b32 s31, s20, 1
s_and_b32 s32, s20, 1
v_and_b32 v187, 15, v186
s_mul_i32 s33, s31, 64
v_add_u32 v187, s33, v187
v_bfe_u32 v188, v187, 1, 3
v_lshrrev_b32 v189, 4, v186
v_xor_b32 v188, v188, v189
v_lshlrev_b32 v188, 4, v188
v_lshl_add_u32 v176, v187, 7, v188
v_xor_b32 v177, 64, v176
v_lshrrev_b32 v187, 4, v186
v_bfe_u32 v188, v186, 2, 2
v_and_b32 v189, 3, v186
v_lshl_add_u32 v190, v187, 3, v188
v_lshlrev_b32 v189, 3, v189
v_bfe_u32 v187, v190, 1, 1
v_bfe_u32 v188, v190, 3, 1
v_lshl_or_b32 v187, v188, 1, v187
v_lshlrev_b32 v187, 1, v187
v_lshlrev_b32 v187, 4, v187
v_mul_u32_u24 v190, 384, v190
v_add_u32 v190, 16384, v190
s_mul_i32 s33, s32, 192
s_add_u32 s33, s33, 0
v_add_u32 v188, s33, v189
v_xor_b32 v188, v188, v187
v_add_u32 v178, v188, v190
s_mul_i32 s33, s32, 192
s_add_u32 s33, s33, 32
v_add_u32 v188, s33, v189
v_xor_b32 v188, v188, v187
v_add_u32 v179, v188, v190
s_mul_i32 s33, s32, 192
s_add_u32 s33, s33, 64
v_add_u32 v188, s33, v189
v_xor_b32 v188, v188, v187
v_add_u32 v180, v188, v190
s_mul_i32 s33, s32, 192
s_add_u32 s33, s33, 96
v_add_u32 v188, s33, v189
v_xor_b32 v188, v188, v187
v_add_u32 v181, v188, v190
s_mul_i32 s33, s32, 192
s_add_u32 s33, s33, 128
v_add_u32 v188, s33, v189
v_xor_b32 v188, v188, v187
v_add_u32 v182, v188, v190
s_mul_i32 s33, s32, 192
s_add_u32 s33, s33, 160
v_add_u32 v188, s33, v189
v_xor_b32 v188, v188, v187
v_add_u32 v183, v188, v190
v_mov_b32 v0, 0
v_mov_b32 v1, 0
v_mov_b32 v2, 0
v_mov_b32 v3, 0
v_mov_b32 v4, 0
v_mov_b32 v5, 0
v_mov_b32 v6, 0
v_mov_b32 v7, 0
v_mov_b32 v8, 0
v_mov_b32 v9, 0
v_mov_b32 v10, 0
v_mov_b32 v11, 0
v_mov_b32 v12, 0
v_mov_b32 v13, 0
v_mov_b32 v14, 0
v_mov_b32 v15, 0
v_mov_b32 v16, 0
v_mov_b32 v17, 0
v_mov_b32 v18, 0
v_mov_b32 v19, 0
v_mov_b32 v20, 0
v_mov_b32 v21, 0
v_mov_b32 v22, 0
v_mov_b32 v23, 0
v_mov_b32 v24, 0
v_mov_b32 v25, 0
v_mov_b32 v26, 0
v_mov_b32 v27, 0
v_mov_b32 v28, 0
v_mov_b32 v29, 0
v_mov_b32 v30, 0
v_mov_b32 v31, 0
v_mov_b32 v32, 0
v_mov_b32 v33, 0
v_mov_b32 v34, 0
v_mov_b32 v35, 0
v_mov_b32 v36, 0
v_mov_b32 v37, 0
v_mov_b32 v38, 0
v_mov_b32 v39, 0
v_mov_b32 v40, 0
v_mov_b32 v41, 0
v_mov_b32 v42, 0
v_mov_b32 v43, 0
v_mov_b32 v44, 0
v_mov_b32 v45, 0
v_mov_b32 v46, 0
v_mov_b32 v47, 0
v_mov_b32 v48, 0
v_mov_b32 v49, 0
v_mov_b32 v50, 0
v_mov_b32 v51, 0
v_mov_b32 v52, 0
v_mov_b32 v53, 0
v_mov_b32 v54, 0
v_mov_b32 v55, 0
v_mov_b32 v56, 0
v_mov_b32 v57, 0
v_mov_b32 v58, 0
v_mov_b32 v59, 0
v_mov_b32 v60, 0
v_mov_b32 v61, 0
v_mov_b32 v62, 0
v_mov_b32 v63, 0
v_mov_b32 v64, 0
v_mov_b32 v65, 0
v_mov_b32 v66, 0
v_mov_b32 v67, 0
v_mov_b32 v68, 0
v_mov_b32 v69, 0
v_mov_b32 v70, 0
v_mov_b32 v71, 0
v_mov_b32 v72, 0
v_mov_b32 v73, 0
v_mov_b32 v74, 0
v_mov_b32 v75, 0
v_mov_b32 v76, 0
v_mov_b32 v77, 0
v_mov_b32 v78, 0
v_mov_b32 v79, 0
v_mov_b32 v80, 0
v_mov_b32 v81, 0
v_mov_b32 v82, 0
v_mov_b32 v83, 0
v_mov_b32 v84, 0
v_mov_b32 v85, 0
v_mov_b32 v86, 0
v_mov_b32 v87, 0
v_mov_b32 v88, 0
v_mov_b32 v89, 0
v_mov_b32 v90, 0
v_mov_b32 v91, 0
v_mov_b32 v92, 0
v_mov_b32 v93, 0
v_mov_b32 v94, 0
v_mov_b32 v95, 0
s_mov_b32 s92, 16
s_mov_b32 s93, 0
s_mov_b32 s30, 0
s_mov_b32 s29, 1
s_barrier
ds_read_b64_tr_b16 v[128:129], v178 offset:0
ds_read_b64_tr_b16 v[130:131], v178 offset:1536
ds_read_b128 v[96:99], v176 offset:0
ds_read_b64_tr_b16 v[132:133], v179 offset:0
ds_read_b64_tr_b16 v[134:135], v179 offset:1536
ds_read_b64_tr_b16 v[136:137], v180 offset:0
ds_read_b64_tr_b16 v[138:139], v180 offset:1536
ds_read_b64_tr_b16 v[140:141], v181 offset:0
ds_read_b64_tr_b16 v[142:143], v181 offset:1536
ds_read_b64_tr_b16 v[144:145], v182 offset:0
ds_read_b64_tr_b16 v[146:147], v182 offset:1536
ds_read_b64_tr_b16 v[148:149], v183 offset:0
ds_read_b64_tr_b16 v[150:151], v183 offset:1536
ds_read_b128 v[100:103], v176 offset:2048
ds_read_b128 v[104:107], v176 offset:4096
ds_read_b128 v[108:111], v176 offset:6144
.p2align 6
L_s7_mm_80:
s_waitcnt lgkmcnt(13)
v_mfma_f32_16x16x32_bf16 v[0:3], v[128:131], v[96:99], v[0:3]
ds_read_b64_tr_b16 v[152:153], v178 offset:12288
ds_read_b64_tr_b16 v[154:155], v178 offset:13824
s_waitcnt lgkmcnt(13)
v_mfma_f32_16x16x32_bf16 v[4:7], v[132:135], v[96:99], v[4:7]
ds_read_b128 v[112:115], v177 offset:0
ds_read_b64_tr_b16 v[156:157], v179 offset:12288
s_waitcnt lgkmcnt(13)
v_mfma_f32_16x16x32_bf16 v[8:11], v[136:139], v[96:99], v[8:11]
ds_read_b64_tr_b16 v[158:159], v179 offset:13824
ds_read_b64_tr_b16 v[160:161], v180 offset:12288
s_waitcnt lgkmcnt(13)
v_mfma_f32_16x16x32_bf16 v[12:15], v[140:143], v[96:99], v[12:15]
ds_read_b64_tr_b16 v[162:163], v180 offset:13824
ds_read_b64_tr_b16 v[164:165], v181 offset:12288
s_waitcnt lgkmcnt(13)
v_mfma_f32_16x16x32_bf16 v[16:19], v[144:147], v[96:99], v[16:19]
ds_read_b64_tr_b16 v[166:167], v181 offset:13824
ds_read_b64_tr_b16 v[168:169], v182 offset:12288
s_waitcnt lgkmcnt(13)
v_mfma_f32_16x16x32_bf16 v[20:23], v[148:151], v[96:99], v[20:23]
ds_read_b64_tr_b16 v[170:171], v182 offset:13824
ds_read_b64_tr_b16 v[172:173], v183 offset:12288
s_waitcnt lgkmcnt(14)
v_mfma_f32_16x16x32_bf16 v[24:27], v[128:131], v[100:103], v[24:27]
ds_read_b64_tr_b16 v[174:175], v183 offset:13824
ds_read_b128 v[116:119], v177 offset:2048
v_mfma_f32_16x16x32_bf16 v[28:31], v[132:135], v[100:103], v[28:31]
ds_read_b128 v[120:123], v177 offset:4096
ds_read_b128 v[124:127], v177 offset:6144
v_mfma_f32_16x16x32_bf16 v[32:35], v[136:139], v[100:103], v[32:35]
s_add_u32 s30, s30, 1
s_cmp_eq_u32 s30, 3
v_mfma_f32_16x16x32_bf16 v[36:39], v[140:143], v[100:103], v[36:39]
s_cselect_b32 s30, 0, s30
s_mov_b32 s38, 40960
v_mfma_f32_16x16x32_bf16 v[40:43], v[144:147], v[100:103], v[40:43]
s_cmov_b32 s38, 4294885376
s_add_u32 s29, s29, 1
v_mfma_f32_16x16x32_bf16 v[44:47], v[148:151], v[100:103], v[44:47]
v_add_u32 v176, s38, v176
v_add_u32 v177, s38, v177
s_waitcnt lgkmcnt(15)
v_mfma_f32_16x16x32_bf16 v[48:51], v[128:131], v[104:107], v[48:51]
v_add_u32 v178, s38, v178
v_add_u32 v179, s38, v179
v_mfma_f32_16x16x32_bf16 v[52:55], v[132:135], v[104:107], v[52:55]
v_add_u32 v180, s38, v180
v_add_u32 v181, s38, v181
v_mfma_f32_16x16x32_bf16 v[56:59], v[136:139], v[104:107], v[56:59]
v_add_u32 v182, s38, v182
v_add_u32 v183, s38, v183
v_mfma_f32_16x16x32_bf16 v[60:63], v[140:143], v[104:107], v[60:63]
v_mfma_f32_16x16x32_bf16 v[64:67], v[144:147], v[104:107], v[64:67]
v_mfma_f32_16x16x32_bf16 v[68:71], v[148:151], v[104:107], v[68:71]
v_mfma_f32_16x16x32_bf16 v[72:75], v[128:131], v[108:111], v[72:75]
v_mfma_f32_16x16x32_bf16 v[76:79], v[132:135], v[108:111], v[76:79]
v_mfma_f32_16x16x32_bf16 v[80:83], v[136:139], v[108:111], v[80:83]
v_mfma_f32_16x16x32_bf16 v[84:87], v[140:143], v[108:111], v[84:87]
v_mfma_f32_16x16x32_bf16 v[88:91], v[144:147], v[108:111], v[88:91]
v_mfma_f32_16x16x32_bf16 v[92:95], v[148:151], v[108:111], v[92:95]
s_waitcnt lgkmcnt(13)
v_mfma_f32_16x16x32_bf16 v[0:3], v[152:155], v[112:115], v[0:3]
s_waitcnt lgkmcnt(11)
v_mfma_f32_16x16x32_bf16 v[4:7], v[156:159], v[112:115], v[4:7]
s_waitcnt lgkmcnt(9)
v_mfma_f32_16x16x32_bf16 v[8:11], v[160:163], v[112:115], v[8:11]
s_waitcnt lgkmcnt(7)
v_mfma_f32_16x16x32_bf16 v[12:15], v[164:167], v[112:115], v[12:15]
s_waitcnt lgkmcnt(5)
v_mfma_f32_16x16x32_bf16 v[16:19], v[168:171], v[112:115], v[16:19]
s_waitcnt lgkmcnt(3)
v_mfma_f32_16x16x32_bf16 v[20:23], v[172:175], v[112:115], v[20:23]
s_waitcnt lgkmcnt(2)
v_mfma_f32_16x16x32_bf16 v[24:27], v[152:155], v[116:119], v[24:27]
s_waitcnt lgkmcnt(0)
s_barrier
ds_read_b64_tr_b16 v[128:129], v178 offset:0
v_mfma_f32_16x16x32_bf16 v[28:31], v[156:159], v[116:119], v[28:31]
ds_read_b64_tr_b16 v[130:131], v178 offset:1536
v_mfma_f32_16x16x32_bf16 v[32:35], v[160:163], v[116:119], v[32:35]
ds_read_b128 v[96:99], v176 offset:0
v_mfma_f32_16x16x32_bf16 v[36:39], v[164:167], v[116:119], v[36:39]
ds_read_b64_tr_b16 v[132:133], v179 offset:0
v_mfma_f32_16x16x32_bf16 v[40:43], v[168:171], v[116:119], v[40:43]
ds_read_b64_tr_b16 v[134:135], v179 offset:1536
v_mfma_f32_16x16x32_bf16 v[44:47], v[172:175], v[116:119], v[44:47]
ds_read_b64_tr_b16 v[136:137], v180 offset:0
v_mfma_f32_16x16x32_bf16 v[48:51], v[152:155], v[120:123], v[48:51]
ds_read_b64_tr_b16 v[138:139], v180 offset:1536
v_mfma_f32_16x16x32_bf16 v[52:55], v[156:159], v[120:123], v[52:55]
ds_read_b64_tr_b16 v[140:141], v181 offset:0
v_mfma_f32_16x16x32_bf16 v[56:59], v[160:163], v[120:123], v[56:59]
ds_read_b64_tr_b16 v[142:143], v181 offset:1536
v_mfma_f32_16x16x32_bf16 v[60:63], v[164:167], v[120:123], v[60:63]
ds_read_b64_tr_b16 v[144:145], v182 offset:0
v_mfma_f32_16x16x32_bf16 v[64:67], v[168:171], v[120:123], v[64:67]
ds_read_b64_tr_b16 v[146:147], v182 offset:1536
v_mfma_f32_16x16x32_bf16 v[68:71], v[172:175], v[120:123], v[68:71]
ds_read_b64_tr_b16 v[148:149], v183 offset:0
v_mfma_f32_16x16x32_bf16 v[72:75], v[152:155], v[124:127], v[72:75]
ds_read_b64_tr_b16 v[150:151], v183 offset:1536
v_mfma_f32_16x16x32_bf16 v[76:79], v[156:159], v[124:127], v[76:79]
ds_read_b128 v[100:103], v176 offset:2048
v_mfma_f32_16x16x32_bf16 v[80:83], v[160:163], v[124:127], v[80:83]
ds_read_b128 v[104:107], v176 offset:4096
v_mfma_f32_16x16x32_bf16 v[84:87], v[164:167], v[124:127], v[84:87]
ds_read_b128 v[108:111], v176 offset:6144
v_mfma_f32_16x16x32_bf16 v[88:91], v[168:171], v[124:127], v[88:91]
v_mfma_f32_16x16x32_bf16 v[92:95], v[172:175], v[124:127], v[92:95]
s_bitcmp1_b64 s[92:93], s29
s_cbranch_scc1 L_s7_H_81
L_s7_B_82:
s_waitcnt lgkmcnt(13)
v_mfma_f32_16x16x32_bf16 v[0:3], v[128:131], v[96:99], v[0:3]
ds_read_b64_tr_b16 v[152:153], v178 offset:12288
ds_read_b64_tr_b16 v[154:155], v178 offset:13824
s_waitcnt lgkmcnt(13)
v_mfma_f32_16x16x32_bf16 v[4:7], v[132:135], v[96:99], v[4:7]
ds_read_b128 v[112:115], v177 offset:0
ds_read_b64_tr_b16 v[156:157], v179 offset:12288
s_waitcnt lgkmcnt(13)
v_mfma_f32_16x16x32_bf16 v[8:11], v[136:139], v[96:99], v[8:11]
ds_read_b64_tr_b16 v[158:159], v179 offset:13824
ds_read_b64_tr_b16 v[160:161], v180 offset:12288
s_waitcnt lgkmcnt(13)
v_mfma_f32_16x16x32_bf16 v[12:15], v[140:143], v[96:99], v[12:15]
ds_read_b64_tr_b16 v[162:163], v180 offset:13824
ds_read_b64_tr_b16 v[164:165], v181 offset:12288
s_waitcnt lgkmcnt(13)
v_mfma_f32_16x16x32_bf16 v[16:19], v[144:147], v[96:99], v[16:19]
ds_read_b64_tr_b16 v[166:167], v181 offset:13824
ds_read_b64_tr_b16 v[168:169], v182 offset:12288
s_waitcnt lgkmcnt(13)
v_mfma_f32_16x16x32_bf16 v[20:23], v[148:151], v[96:99], v[20:23]
ds_read_b64_tr_b16 v[170:171], v182 offset:13824
ds_read_b64_tr_b16 v[172:173], v183 offset:12288
s_waitcnt lgkmcnt(14)
v_mfma_f32_16x16x32_bf16 v[24:27], v[128:131], v[100:103], v[24:27]
ds_read_b64_tr_b16 v[174:175], v183 offset:13824
ds_read_b128 v[116:119], v177 offset:2048
v_mfma_f32_16x16x32_bf16 v[28:31], v[132:135], v[100:103], v[28:31]
ds_read_b128 v[120:123], v177 offset:4096
ds_read_b128 v[124:127], v177 offset:6144
v_mfma_f32_16x16x32_bf16 v[32:35], v[136:139], v[100:103], v[32:35]
s_add_u32 s30, s30, 1
s_cmp_eq_u32 s30, 3
v_mfma_f32_16x16x32_bf16 v[36:39], v[140:143], v[100:103], v[36:39]
s_cselect_b32 s30, 0, s30
s_mov_b32 s38, 40960
v_mfma_f32_16x16x32_bf16 v[40:43], v[144:147], v[100:103], v[40:43]
s_cmov_b32 s38, 4294885376
s_add_u32 s29, s29, 1
v_mfma_f32_16x16x32_bf16 v[44:47], v[148:151], v[100:103], v[44:47]
v_add_u32 v176, s38, v176
v_add_u32 v177, s38, v177
s_waitcnt lgkmcnt(15)
v_mfma_f32_16x16x32_bf16 v[48:51], v[128:131], v[104:107], v[48:51]
v_add_u32 v178, s38, v178
v_add_u32 v179, s38, v179
v_mfma_f32_16x16x32_bf16 v[52:55], v[132:135], v[104:107], v[52:55]
v_add_u32 v180, s38, v180
v_add_u32 v181, s38, v181
v_mfma_f32_16x16x32_bf16 v[56:59], v[136:139], v[104:107], v[56:59]
v_add_u32 v182, s38, v182
v_add_u32 v183, s38, v183
v_mfma_f32_16x16x32_bf16 v[60:63], v[140:143], v[104:107], v[60:63]
v_mfma_f32_16x16x32_bf16 v[64:67], v[144:147], v[104:107], v[64:67]
v_mfma_f32_16x16x32_bf16 v[68:71], v[148:151], v[104:107], v[68:71]
v_mfma_f32_16x16x32_bf16 v[72:75], v[128:131], v[108:111], v[72:75]
v_mfma_f32_16x16x32_bf16 v[76:79], v[132:135], v[108:111], v[76:79]
v_mfma_f32_16x16x32_bf16 v[80:83], v[136:139], v[108:111], v[80:83]
v_mfma_f32_16x16x32_bf16 v[84:87], v[140:143], v[108:111], v[84:87]
v_mfma_f32_16x16x32_bf16 v[88:91], v[144:147], v[108:111], v[88:91]
v_mfma_f32_16x16x32_bf16 v[92:95], v[148:151], v[108:111], v[92:95]
s_waitcnt lgkmcnt(13)
v_mfma_f32_16x16x32_bf16 v[0:3], v[152:155], v[112:115], v[0:3]
s_waitcnt lgkmcnt(11)
v_mfma_f32_16x16x32_bf16 v[4:7], v[156:159], v[112:115], v[4:7]
s_waitcnt lgkmcnt(9)
v_mfma_f32_16x16x32_bf16 v[8:11], v[160:163], v[112:115], v[8:11]
s_waitcnt lgkmcnt(7)
v_mfma_f32_16x16x32_bf16 v[12:15], v[164:167], v[112:115], v[12:15]
s_waitcnt lgkmcnt(5)
v_mfma_f32_16x16x32_bf16 v[16:19], v[168:171], v[112:115], v[16:19]
s_waitcnt lgkmcnt(3)
v_mfma_f32_16x16x32_bf16 v[20:23], v[172:175], v[112:115], v[20:23]
s_waitcnt lgkmcnt(2)
v_mfma_f32_16x16x32_bf16 v[24:27], v[152:155], v[116:119], v[24:27]
s_waitcnt lgkmcnt(0)
s_barrier
ds_read_b64_tr_b16 v[128:129], v178 offset:0
v_mfma_f32_16x16x32_bf16 v[28:31], v[156:159], v[116:119], v[28:31]
ds_read_b64_tr_b16 v[130:131], v178 offset:1536
v_mfma_f32_16x16x32_bf16 v[32:35], v[160:163], v[116:119], v[32:35]
ds_read_b128 v[96:99], v176 offset:0
v_mfma_f32_16x16x32_bf16 v[36:39], v[164:167], v[116:119], v[36:39]
ds_read_b64_tr_b16 v[132:133], v179 offset:0
v_mfma_f32_16x16x32_bf16 v[40:43], v[168:171], v[116:119], v[40:43]
ds_read_b64_tr_b16 v[134:135], v179 offset:1536
v_mfma_f32_16x16x32_bf16 v[44:47], v[172:175], v[116:119], v[44:47]
ds_read_b64_tr_b16 v[136:137], v180 offset:0
v_mfma_f32_16x16x32_bf16 v[48:51], v[152:155], v[120:123], v[48:51]
ds_read_b64_tr_b16 v[138:139], v180 offset:1536
v_mfma_f32_16x16x32_bf16 v[52:55], v[156:159], v[120:123], v[52:55]
ds_read_b64_tr_b16 v[140:141], v181 offset:0
v_mfma_f32_16x16x32_bf16 v[56:59], v[160:163], v[120:123], v[56:59]
ds_read_b64_tr_b16 v[142:143], v181 offset:1536
v_mfma_f32_16x16x32_bf16 v[60:63], v[164:167], v[120:123], v[60:63]
ds_read_b64_tr_b16 v[144:145], v182 offset:0
v_mfma_f32_16x16x32_bf16 v[64:67], v[168:171], v[120:123], v[64:67]
ds_read_b64_tr_b16 v[146:147], v182 offset:1536
v_mfma_f32_16x16x32_bf16 v[68:71], v[172:175], v[120:123], v[68:71]
ds_read_b64_tr_b16 v[148:149], v183 offset:0
v_mfma_f32_16x16x32_bf16 v[72:75], v[152:155], v[124:127], v[72:75]
ds_read_b64_tr_b16 v[150:151], v183 offset:1536
v_mfma_f32_16x16x32_bf16 v[76:79], v[156:159], v[124:127], v[76:79]
ds_read_b128 v[100:103], v176 offset:2048
v_mfma_f32_16x16x32_bf16 v[80:83], v[160:163], v[124:127], v[80:83]
ds_read_b128 v[104:107], v176 offset:4096
v_mfma_f32_16x16x32_bf16 v[84:87], v[164:167], v[124:127], v[84:87]
ds_read_b128 v[108:111], v176 offset:6144
v_mfma_f32_16x16x32_bf16 v[88:91], v[168:171], v[124:127], v[88:91]
s_cmp_lt_u32 s29, 15
v_mfma_f32_16x16x32_bf16 v[92:95], v[172:175], v[124:127], v[92:95]
s_cbranch_scc1 L_s7_mm_80
s_waitcnt lgkmcnt(13)
v_mfma_f32_16x16x32_bf16 v[0:3], v[128:131], v[96:99], v[0:3]
ds_read_b64_tr_b16 v[152:153], v178 offset:12288
ds_read_b64_tr_b16 v[154:155], v178 offset:13824
s_waitcnt lgkmcnt(13)
v_mfma_f32_16x16x32_bf16 v[4:7], v[132:135], v[96:99], v[4:7]
ds_read_b128 v[112:115], v177 offset:0
ds_read_b64_tr_b16 v[156:157], v179 offset:12288
s_waitcnt lgkmcnt(13)
v_mfma_f32_16x16x32_bf16 v[8:11], v[136:139], v[96:99], v[8:11]
ds_read_b64_tr_b16 v[158:159], v179 offset:13824
ds_read_b64_tr_b16 v[160:161], v180 offset:12288
s_waitcnt lgkmcnt(13)
v_mfma_f32_16x16x32_bf16 v[12:15], v[140:143], v[96:99], v[12:15]
ds_read_b64_tr_b16 v[162:163], v180 offset:13824
ds_read_b64_tr_b16 v[164:165], v181 offset:12288
s_waitcnt lgkmcnt(13)
v_mfma_f32_16x16x32_bf16 v[16:19], v[144:147], v[96:99], v[16:19]
ds_read_b64_tr_b16 v[166:167], v181 offset:13824
ds_read_b64_tr_b16 v[168:169], v182 offset:12288
s_waitcnt lgkmcnt(13)
v_mfma_f32_16x16x32_bf16 v[20:23], v[148:151], v[96:99], v[20:23]
ds_read_b64_tr_b16 v[170:171], v182 offset:13824
ds_read_b64_tr_b16 v[172:173], v183 offset:12288
s_waitcnt lgkmcnt(14)
v_mfma_f32_16x16x32_bf16 v[24:27], v[128:131], v[100:103], v[24:27]
ds_read_b64_tr_b16 v[174:175], v183 offset:13824
ds_read_b128 v[116:119], v177 offset:2048
v_mfma_f32_16x16x32_bf16 v[28:31], v[132:135], v[100:103], v[28:31]
ds_read_b128 v[120:123], v177 offset:4096
ds_read_b128 v[124:127], v177 offset:6144
v_mfma_f32_16x16x32_bf16 v[32:35], v[136:139], v[100:103], v[32:35]
s_add_u32 s30, s30, 1
s_cmp_eq_u32 s30, 3
v_mfma_f32_16x16x32_bf16 v[36:39], v[140:143], v[100:103], v[36:39]
s_cselect_b32 s30, 0, s30
s_mov_b32 s38, 40960
v_mfma_f32_16x16x32_bf16 v[40:43], v[144:147], v[100:103], v[40:43]
s_cmov_b32 s38, 4294885376
s_add_u32 s29, s29, 1
v_mfma_f32_16x16x32_bf16 v[44:47], v[148:151], v[100:103], v[44:47]
v_add_u32 v176, s38, v176
v_add_u32 v177, s38, v177
s_waitcnt lgkmcnt(15)
v_mfma_f32_16x16x32_bf16 v[48:51], v[128:131], v[104:107], v[48:51]
v_add_u32 v178, s38, v178
v_add_u32 v179, s38, v179
v_mfma_f32_16x16x32_bf16 v[52:55], v[132:135], v[104:107], v[52:55]
v_add_u32 v180, s38, v180
v_add_u32 v181, s38, v181
v_mfma_f32_16x16x32_bf16 v[56:59], v[136:139], v[104:107], v[56:59]
v_add_u32 v182, s38, v182
v_add_u32 v183, s38, v183
v_mfma_f32_16x16x32_bf16 v[60:63], v[140:143], v[104:107], v[60:63]
v_mfma_f32_16x16x32_bf16 v[64:67], v[144:147], v[104:107], v[64:67]
v_mfma_f32_16x16x32_bf16 v[68:71], v[148:151], v[104:107], v[68:71]
v_mfma_f32_16x16x32_bf16 v[72:75], v[128:131], v[108:111], v[72:75]
v_mfma_f32_16x16x32_bf16 v[76:79], v[132:135], v[108:111], v[76:79]
v_mfma_f32_16x16x32_bf16 v[80:83], v[136:139], v[108:111], v[80:83]
v_mfma_f32_16x16x32_bf16 v[84:87], v[140:143], v[108:111], v[84:87]
v_mfma_f32_16x16x32_bf16 v[88:91], v[144:147], v[108:111], v[88:91]
v_mfma_f32_16x16x32_bf16 v[92:95], v[148:151], v[108:111], v[92:95]
s_waitcnt lgkmcnt(13)
v_mfma_f32_16x16x32_bf16 v[0:3], v[152:155], v[112:115], v[0:3]
s_waitcnt lgkmcnt(11)
v_mfma_f32_16x16x32_bf16 v[4:7], v[156:159], v[112:115], v[4:7]
s_waitcnt lgkmcnt(9)
v_mfma_f32_16x16x32_bf16 v[8:11], v[160:163], v[112:115], v[8:11]
s_waitcnt lgkmcnt(7)
v_mfma_f32_16x16x32_bf16 v[12:15], v[164:167], v[112:115], v[12:15]
s_waitcnt lgkmcnt(5)
v_mfma_f32_16x16x32_bf16 v[16:19], v[168:171], v[112:115], v[16:19]
s_waitcnt lgkmcnt(3)
v_mfma_f32_16x16x32_bf16 v[20:23], v[172:175], v[112:115], v[20:23]
s_waitcnt lgkmcnt(2)
v_mfma_f32_16x16x32_bf16 v[24:27], v[152:155], v[116:119], v[24:27]
s_waitcnt lgkmcnt(0)
s_barrier
ds_read_b64_tr_b16 v[128:129], v178 offset:0
v_mfma_f32_16x16x32_bf16 v[28:31], v[156:159], v[116:119], v[28:31]
ds_read_b64_tr_b16 v[130:131], v178 offset:1536
v_mfma_f32_16x16x32_bf16 v[32:35], v[160:163], v[116:119], v[32:35]
ds_read_b128 v[96:99], v176 offset:0
v_mfma_f32_16x16x32_bf16 v[36:39], v[164:167], v[116:119], v[36:39]
ds_read_b64_tr_b16 v[132:133], v179 offset:0
v_mfma_f32_16x16x32_bf16 v[40:43], v[168:171], v[116:119], v[40:43]
ds_read_b64_tr_b16 v[134:135], v179 offset:1536
v_mfma_f32_16x16x32_bf16 v[44:47], v[172:175], v[116:119], v[44:47]
ds_read_b64_tr_b16 v[136:137], v180 offset:0
v_mfma_f32_16x16x32_bf16 v[48:51], v[152:155], v[120:123], v[48:51]
ds_read_b64_tr_b16 v[138:139], v180 offset:1536
v_mfma_f32_16x16x32_bf16 v[52:55], v[156:159], v[120:123], v[52:55]
ds_read_b64_tr_b16 v[140:141], v181 offset:0
v_mfma_f32_16x16x32_bf16 v[56:59], v[160:163], v[120:123], v[56:59]
ds_read_b64_tr_b16 v[142:143], v181 offset:1536
v_mfma_f32_16x16x32_bf16 v[60:63], v[164:167], v[120:123], v[60:63]
ds_read_b64_tr_b16 v[144:145], v182 offset:0
v_mfma_f32_16x16x32_bf16 v[64:67], v[168:171], v[120:123], v[64:67]
ds_read_b64_tr_b16 v[146:147], v182 offset:1536
v_mfma_f32_16x16x32_bf16 v[68:71], v[172:175], v[120:123], v[68:71]
ds_read_b64_tr_b16 v[148:149], v183 offset:0
v_mfma_f32_16x16x32_bf16 v[72:75], v[152:155], v[124:127], v[72:75]
ds_read_b64_tr_b16 v[150:151], v183 offset:1536
v_mfma_f32_16x16x32_bf16 v[76:79], v[156:159], v[124:127], v[76:79]
ds_read_b128 v[100:103], v176 offset:2048
v_mfma_f32_16x16x32_bf16 v[80:83], v[160:163], v[124:127], v[80:83]
ds_read_b128 v[104:107], v176 offset:4096
v_mfma_f32_16x16x32_bf16 v[84:87], v[164:167], v[124:127], v[84:87]
ds_read_b128 v[108:111], v176 offset:6144
v_mfma_f32_16x16x32_bf16 v[88:91], v[168:171], v[124:127], v[88:91]
v_mfma_f32_16x16x32_bf16 v[92:95], v[172:175], v[124:127], v[92:95]
s_waitcnt lgkmcnt(13)
v_mfma_f32_16x16x32_bf16 v[0:3], v[128:131], v[96:99], v[0:3]
ds_read_b64_tr_b16 v[152:153], v178 offset:12288
s_waitcnt lgkmcnt(12)
v_mfma_f32_16x16x32_bf16 v[4:7], v[132:135], v[96:99], v[4:7]
ds_read_b64_tr_b16 v[154:155], v178 offset:13824
s_waitcnt lgkmcnt(11)
v_mfma_f32_16x16x32_bf16 v[8:11], v[136:139], v[96:99], v[8:11]
ds_read_b128 v[112:115], v177 offset:0
s_waitcnt lgkmcnt(10)
v_mfma_f32_16x16x32_bf16 v[12:15], v[140:143], v[96:99], v[12:15]
ds_read_b64_tr_b16 v[156:157], v179 offset:12288
s_waitcnt lgkmcnt(9)
v_mfma_f32_16x16x32_bf16 v[16:19], v[144:147], v[96:99], v[16:19]
ds_read_b64_tr_b16 v[158:159], v179 offset:13824
s_waitcnt lgkmcnt(8)
v_mfma_f32_16x16x32_bf16 v[20:23], v[148:151], v[96:99], v[20:23]
ds_read_b64_tr_b16 v[160:161], v180 offset:12288
s_waitcnt lgkmcnt(8)
v_mfma_f32_16x16x32_bf16 v[24:27], v[128:131], v[100:103], v[24:27]
ds_read_b64_tr_b16 v[162:163], v180 offset:13824
v_mfma_f32_16x16x32_bf16 v[28:31], v[132:135], v[100:103], v[28:31]
ds_read_b64_tr_b16 v[164:165], v181 offset:12288
v_mfma_f32_16x16x32_bf16 v[32:35], v[136:139], v[100:103], v[32:35]
ds_read_b64_tr_b16 v[166:167], v181 offset:13824
v_mfma_f32_16x16x32_bf16 v[36:39], v[140:143], v[100:103], v[36:39]
ds_read_b64_tr_b16 v[168:169], v182 offset:12288
v_mfma_f32_16x16x32_bf16 v[40:43], v[144:147], v[100:103], v[40:43]
ds_read_b64_tr_b16 v[170:171], v182 offset:13824
v_mfma_f32_16x16x32_bf16 v[44:47], v[148:151], v[100:103], v[44:47]
ds_read_b64_tr_b16 v[172:173], v183 offset:12288
s_waitcnt lgkmcnt(13)
v_mfma_f32_16x16x32_bf16 v[48:51], v[128:131], v[104:107], v[48:51]
ds_read_b64_tr_b16 v[174:175], v183 offset:13824
v_mfma_f32_16x16x32_bf16 v[52:55], v[132:135], v[104:107], v[52:55]
ds_read_b128 v[116:119], v177 offset:2048
v_mfma_f32_16x16x32_bf16 v[56:59], v[136:139], v[104:107], v[56:59]
ds_read_b128 v[120:123], v177 offset:4096
v_mfma_f32_16x16x32_bf16 v[60:63], v[140:143], v[104:107], v[60:63]
ds_read_b128 v[124:127], v177 offset:6144
v_mfma_f32_16x16x32_bf16 v[64:67], v[144:147], v[104:107], v[64:67]
v_mfma_f32_16x16x32_bf16 v[68:71], v[148:151], v[104:107], v[68:71]
s_waitcnt lgkmcnt(15)
v_mfma_f32_16x16x32_bf16 v[72:75], v[128:131], v[108:111], v[72:75]
v_mfma_f32_16x16x32_bf16 v[76:79], v[132:135], v[108:111], v[76:79]
v_mfma_f32_16x16x32_bf16 v[80:83], v[136:139], v[108:111], v[80:83]
v_mfma_f32_16x16x32_bf16 v[84:87], v[140:143], v[108:111], v[84:87]
v_mfma_f32_16x16x32_bf16 v[88:91], v[144:147], v[108:111], v[88:91]
v_mfma_f32_16x16x32_bf16 v[92:95], v[148:151], v[108:111], v[92:95]
s_waitcnt lgkmcnt(13)
v_mfma_f32_16x16x32_bf16 v[0:3], v[152:155], v[112:115], v[0:3]
s_waitcnt lgkmcnt(11)
v_mfma_f32_16x16x32_bf16 v[4:7], v[156:159], v[112:115], v[4:7]
s_waitcnt lgkmcnt(9)
v_mfma_f32_16x16x32_bf16 v[8:11], v[160:163], v[112:115], v[8:11]
s_waitcnt lgkmcnt(7)
v_mfma_f32_16x16x32_bf16 v[12:15], v[164:167], v[112:115], v[12:15]
s_waitcnt lgkmcnt(5)
v_mfma_f32_16x16x32_bf16 v[16:19], v[168:171], v[112:115], v[16:19]
s_waitcnt lgkmcnt(3)
v_mfma_f32_16x16x32_bf16 v[20:23], v[172:175], v[112:115], v[20:23]
s_waitcnt lgkmcnt(2)
v_mfma_f32_16x16x32_bf16 v[24:27], v[152:155], v[116:119], v[24:27]
s_waitcnt lgkmcnt(0)
s_barrier
v_mfma_f32_16x16x32_bf16 v[28:31], v[156:159], v[116:119], v[28:31]
v_mfma_f32_16x16x32_bf16 v[32:35], v[160:163], v[116:119], v[32:35]
v_mfma_f32_16x16x32_bf16 v[36:39], v[164:167], v[116:119], v[36:39]
v_mfma_f32_16x16x32_bf16 v[40:43], v[168:171], v[116:119], v[40:43]
v_mfma_f32_16x16x32_bf16 v[44:47], v[172:175], v[116:119], v[44:47]
v_mfma_f32_16x16x32_bf16 v[48:51], v[152:155], v[120:123], v[48:51]
v_mfma_f32_16x16x32_bf16 v[52:55], v[156:159], v[120:123], v[52:55]
v_mfma_f32_16x16x32_bf16 v[56:59], v[160:163], v[120:123], v[56:59]
v_mfma_f32_16x16x32_bf16 v[60:63], v[164:167], v[120:123], v[60:63]
v_mfma_f32_16x16x32_bf16 v[64:67], v[168:171], v[120:123], v[64:67]
v_mfma_f32_16x16x32_bf16 v[68:71], v[172:175], v[120:123], v[68:71]
v_mfma_f32_16x16x32_bf16 v[72:75], v[152:155], v[124:127], v[72:75]
v_mfma_f32_16x16x32_bf16 v[76:79], v[156:159], v[124:127], v[76:79]
v_mfma_f32_16x16x32_bf16 v[80:83], v[160:163], v[124:127], v[80:83]
v_mfma_f32_16x16x32_bf16 v[84:87], v[164:167], v[124:127], v[84:87]
v_mfma_f32_16x16x32_bf16 v[88:91], v[168:171], v[124:127], v[88:91]
v_mfma_f32_16x16x32_bf16 v[92:95], v[172:175], v[124:127], v[92:95]
s_lshr_b32 s31, s20, 1
s_and_b32 s32, s20, 1
s_mul_i32 s31, s31, 64
s_add_u32 s31, s31, s21
s_mul_i32 s32, s32, 192
s_add_u32 s32, s32, s22
v_and_b32 v184, 15, v254
v_add_u32 v184, s31, v184
v_mul_u32_u24 v184, 7168, v184
v_add_u32 v184, s32, v184
v_bfe_u32 v186, v254, 5, 1
v_lshl_add_u32 v184, v186, 4, v184
v_bfe_u32 v186, v254, 4, 1
v_lshl_add_u32 v184, v186, 5, v184
s_lshr_b32 s31, s20, 1
s_and_b32 s32, s20, 1
s_lshl_b32 s31, s31, 9
s_add_u32 s31, s31, 154176
v_and_b32 v187, 15, v254
v_lshl_add_u32 v187, v187, 3, s31
s_mul_i32 s32, s32, 384
s_add_u32 s32, s32, 155200
v_and_b32 v188, 48, v254
v_add_u32 v188, s32, v188
ds_read_b64 v[96:97], v187 offset:0
ds_read_b64 v[98:99], v187 offset:128
ds_read_b64 v[100:101], v187 offset:256
ds_read_b64 v[102:103], v187 offset:384
ds_read_b128 v[144:147], v188 offset:0
ds_read_b128 v[148:151], v188 offset:64
ds_read_b128 v[152:155], v188 offset:128
ds_read_b128 v[156:159], v188 offset:192
ds_read_b128 v[160:163], v188 offset:256
ds_read_b128 v[164:167], v188 offset:320
s_lshr_b32 s31, s20, 1
s_lshl_b32 s31, s31, 10
s_add_u32 s31, s31, 147456
v_and_b32 v189, 15, v254
v_lshl_add_u32 v189, v189, 4, s31
ds_read_b32 v104, v189 offset:8
ds_read_b32 v105, v189 offset:264
ds_read_b32 v106, v189 offset:520
ds_read_b32 v107, v189 offset:776
s_waitcnt lgkmcnt(0)
v_sub_f32 v104, 1.0, v104
v_max_f32 v104, 228737632, v104
v_mul_f32 v104, v104, v96
v_max_f32 v104, 61482021, v104
v_sub_f32 v128, 0, v97
v_rcp_f32 v129, v104
v_mul_f32 v130, v96, v96
v_mul_f32 v131, 3222493025, v96
v_sub_f32 v105, 1.0, v105
v_max_f32 v105, 228737632, v105
v_mul_f32 v105, v105, v98
v_max_f32 v105, 61482021, v105
v_sub_f32 v132, 0, v99
v_rcp_f32 v133, v105
v_mul_f32 v134, v98, v98
v_mul_f32 v135, 3222493025, v98
v_sub_f32 v106, 1.0, v106
v_max_f32 v106, 228737632, v106
v_mul_f32 v106, v106, v100
v_max_f32 v106, 61482021, v106
v_sub_f32 v136, 0, v101
v_rcp_f32 v137, v106
v_mul_f32 v138, v100, v100
v_mul_f32 v139, 3222493025, v100
v_sub_f32 v107, 1.0, v107
v_max_f32 v107, 228737632, v107
v_mul_f32 v107, v107, v102
v_max_f32 v107, 61482021, v107
v_sub_f32 v140, 0, v103
v_rcp_f32 v141, v107
v_mul_f32 v142, v102, v102
v_mul_f32 v143, 3222493025, v102
v_mul_f32 v130, v130, v96
v_mul_f32 v130, 3184710632, v130
v_mul_f32 v134, v134, v98
v_mul_f32 v134, 3184710632, v134
v_mul_f32 v138, v138, v100
v_mul_f32 v138, 3184710632, v138
v_mul_f32 v142, v142, v102
v_mul_f32 v142, 3184710632, v142
v_pk_fma_f32 v[0:1], v[144:145], v[128:129], v[0:1] op_sel_hi:[1,0,1]
v_pk_fma_f32 v[2:3], v[146:147], v[128:129], v[2:3] op_sel_hi:[1,0,1]
v_pk_fma_f32 v[4:5], v[148:149], v[128:129], v[4:5] op_sel_hi:[1,0,1]
v_pk_fma_f32 v[6:7], v[150:151], v[128:129], v[6:7] op_sel_hi:[1,0,1]
v_pk_mul_f32 v[104:105], v[0:1], v[0:1]
v_pk_mul_f32 v[106:107], v[2:3], v[2:3]
v_pk_mul_f32 v[108:109], v[4:5], v[4:5]
v_pk_mul_f32 v[110:111], v[6:7], v[6:7]
v_pk_fma_f32 v[104:105], v[104:105], v[130:131], v[130:131] op_sel:[0,0,1] op_sel_hi:[1,0,1]
v_pk_fma_f32 v[106:107], v[106:107], v[130:131], v[130:131] op_sel:[0,0,1] op_sel_hi:[1,0,1]
v_pk_fma_f32 v[108:109], v[108:109], v[130:131], v[130:131] op_sel:[0,0,1] op_sel_hi:[1,0,1]
v_pk_fma_f32 v[110:111], v[110:111], v[130:131], v[130:131] op_sel:[0,0,1] op_sel_hi:[1,0,1]
v_pk_mul_f32 v[104:105], v[104:105], v[0:1]
v_pk_mul_f32 v[106:107], v[106:107], v[2:3]
v_pk_mul_f32 v[108:109], v[108:109], v[4:5]
v_pk_mul_f32 v[110:111], v[110:111], v[6:7]
v_exp_f32 v104, v104
v_exp_f32 v105, v105
v_exp_f32 v106, v106
v_exp_f32 v107, v107
v_exp_f32 v108, v108
v_exp_f32 v109, v109
v_exp_f32 v110, v110
v_exp_f32 v111, v111
v_pk_fma_f32 v[104:105], v[104:105], v[128:129], v[128:129] op_sel:[0,1,1] op_sel_hi:[1,1,1]
v_pk_fma_f32 v[106:107], v[106:107], v[128:129], v[128:129] op_sel:[0,1,1] op_sel_hi:[1,1,1]
v_pk_fma_f32 v[108:109], v[108:109], v[128:129], v[128:129] op_sel:[0,1,1] op_sel_hi:[1,1,1]
v_pk_fma_f32 v[110:111], v[110:111], v[128:129], v[128:129] op_sel:[0,1,1] op_sel_hi:[1,1,1]
v_rcp_f32 v104, v104
v_rcp_f32 v105, v105
v_rcp_f32 v106, v106
v_rcp_f32 v107, v107
v_rcp_f32 v108, v108
v_rcp_f32 v109, v109
v_rcp_f32 v110, v110
v_rcp_f32 v111, v111
v_pk_mul_f32 v[0:1], v[0:1], v[104:105]
v_pk_mul_f32 v[2:3], v[2:3], v[106:107]
v_pk_mul_f32 v[4:5], v[4:5], v[108:109]
v_pk_mul_f32 v[6:7], v[6:7], v[110:111]
v_pk_fma_f32 v[8:9], v[152:153], v[128:129], v[8:9] op_sel_hi:[1,0,1]
v_pk_fma_f32 v[10:11], v[154:155], v[128:129], v[10:11] op_sel_hi:[1,0,1]
v_pk_fma_f32 v[12:13], v[156:157], v[128:129], v[12:13] op_sel_hi:[1,0,1]
v_cvt_pk_bf16_f32 v112, v0, v1
v_pk_fma_f32 v[14:15], v[158:159], v[128:129], v[14:15] op_sel_hi:[1,0,1]
v_pk_mul_f32 v[104:105], v[8:9], v[8:9]
v_pk_mul_f32 v[106:107], v[10:11], v[10:11]
v_cvt_pk_bf16_f32 v113, v2, v3
v_pk_mul_f32 v[108:109], v[12:13], v[12:13]
v_pk_mul_f32 v[110:111], v[14:15], v[14:15]
v_pk_fma_f32 v[104:105], v[104:105], v[130:131], v[130:131] op_sel:[0,0,1] op_sel_hi:[1,0,1]
v_cvt_pk_bf16_f32 v114, v4, v5
v_pk_fma_f32 v[106:107], v[106:107], v[130:131], v[130:131] op_sel:[0,0,1] op_sel_hi:[1,0,1]
v_pk_fma_f32 v[108:109], v[108:109], v[130:131], v[130:131] op_sel:[0,0,1] op_sel_hi:[1,0,1]
v_pk_fma_f32 v[110:111], v[110:111], v[130:131], v[130:131] op_sel:[0,0,1] op_sel_hi:[1,0,1]
v_cvt_pk_bf16_f32 v115, v6, v7
v_pk_mul_f32 v[104:105], v[104:105], v[8:9]
v_pk_mul_f32 v[106:107], v[106:107], v[10:11]
v_pk_mul_f32 v[108:109], v[108:109], v[12:13]
s_mov_b32 s34, 16777216
v_pk_mul_f32 v[110:111], v[110:111], v[14:15]
v_exp_f32 v104, v104
v_exp_f32 v105, v105
v_permlane16_swap_b32 v112, v114
v_exp_f32 v106, v106
v_exp_f32 v107, v107
v_exp_f32 v108, v108
v_permlane16_swap_b32 v113, v115
v_exp_f32 v109, v109
v_exp_f32 v110, v110
v_exp_f32 v111, v111
buffer_store_dwordx4 v[112:115], v184, s[16:19], s34 offen offset:0 sc0 sc1
v_pk_fma_f32 v[104:105], v[104:105], v[128:129], v[128:129] op_sel:[0,1,1] op_sel_hi:[1,1,1]
v_pk_fma_f32 v[106:107], v[106:107], v[128:129], v[128:129] op_sel:[0,1,1] op_sel_hi:[1,1,1]
v_pk_fma_f32 v[108:109], v[108:109], v[128:129], v[128:129] op_sel:[0,1,1] op_sel_hi:[1,1,1]
v_pk_fma_f32 v[110:111], v[110:111], v[128:129], v[128:129] op_sel:[0,1,1] op_sel_hi:[1,1,1]
v_rcp_f32 v104, v104
v_rcp_f32 v105, v105
v_rcp_f32 v106, v106
v_rcp_f32 v107, v107
v_rcp_f32 v108, v108
v_rcp_f32 v109, v109
v_rcp_f32 v110, v110
v_rcp_f32 v111, v111
v_pk_mul_f32 v[8:9], v[8:9], v[104:105]
v_pk_mul_f32 v[10:11], v[10:11], v[106:107]
v_pk_mul_f32 v[12:13], v[12:13], v[108:109]
v_pk_mul_f32 v[14:15], v[14:15], v[110:111]
v_pk_fma_f32 v[16:17], v[160:161], v[128:129], v[16:17] op_sel_hi:[1,0,1]
v_pk_fma_f32 v[18:19], v[162:163], v[128:129], v[18:19] op_sel_hi:[1,0,1]
v_pk_fma_f32 v[20:21], v[164:165], v[128:129], v[20:21] op_sel_hi:[1,0,1]
v_cvt_pk_bf16_f32 v116, v8, v9
v_pk_fma_f32 v[22:23], v[166:167], v[128:129], v[22:23] op_sel_hi:[1,0,1]
v_pk_mul_f32 v[104:105], v[16:17], v[16:17]
v_pk_mul_f32 v[106:107], v[18:19], v[18:19]
v_cvt_pk_bf16_f32 v117, v10, v11
v_pk_mul_f32 v[108:109], v[20:21], v[20:21]
v_pk_mul_f32 v[110:111], v[22:23], v[22:23]
v_pk_fma_f32 v[104:105], v[104:105], v[130:131], v[130:131] op_sel:[0,0,1] op_sel_hi:[1,0,1]
v_cvt_pk_bf16_f32 v118, v12, v13
v_pk_fma_f32 v[106:107], v[106:107], v[130:131], v[130:131] op_sel:[0,0,1] op_sel_hi:[1,0,1]
v_pk_fma_f32 v[108:109], v[108:109], v[130:131], v[130:131] op_sel:[0,0,1] op_sel_hi:[1,0,1]
v_pk_fma_f32 v[110:111], v[110:111], v[130:131], v[130:131] op_sel:[0,0,1] op_sel_hi:[1,0,1]
v_cvt_pk_bf16_f32 v119, v14, v15
v_pk_mul_f32 v[104:105], v[104:105], v[16:17]
v_pk_mul_f32 v[106:107], v[106:107], v[18:19]
v_pk_mul_f32 v[108:109], v[108:109], v[20:21]
s_mov_b32 s34, 16777216
v_pk_mul_f32 v[110:111], v[110:111], v[22:23]
v_exp_f32 v104, v104
v_exp_f32 v105, v105
v_permlane16_swap_b32 v116, v118
v_exp_f32 v106, v106
v_exp_f32 v107, v107
v_exp_f32 v108, v108
v_permlane16_swap_b32 v117, v119
v_exp_f32 v109, v109
v_exp_f32 v110, v110
v_exp_f32 v111, v111
buffer_store_dwordx4 v[116:119], v184, s[16:19], s34 offen offset:64 sc0 sc1
v_pk_fma_f32 v[104:105], v[104:105], v[128:129], v[128:129] op_sel:[0,1,1] op_sel_hi:[1,1,1]
v_pk_fma_f32 v[106:107], v[106:107], v[128:129], v[128:129] op_sel:[0,1,1] op_sel_hi:[1,1,1]
v_pk_fma_f32 v[108:109], v[108:109], v[128:129], v[128:129] op_sel:[0,1,1] op_sel_hi:[1,1,1]
v_pk_fma_f32 v[110:111], v[110:111], v[128:129], v[128:129] op_sel:[0,1,1] op_sel_hi:[1,1,1]
v_rcp_f32 v104, v104
v_rcp_f32 v105, v105
v_rcp_f32 v106, v106
v_rcp_f32 v107, v107
v_rcp_f32 v108, v108
v_rcp_f32 v109, v109
v_rcp_f32 v110, v110
v_rcp_f32 v111, v111
v_pk_mul_f32 v[16:17], v[16:17], v[104:105]
v_pk_mul_f32 v[18:19], v[18:19], v[106:107]
v_pk_mul_f32 v[20:21], v[20:21], v[108:109]
v_pk_mul_f32 v[22:23], v[22:23], v[110:111]
v_pk_fma_f32 v[24:25], v[144:145], v[132:133], v[24:25] op_sel_hi:[1,0,1]
v_pk_fma_f32 v[26:27], v[146:147], v[132:133], v[26:27] op_sel_hi:[1,0,1]
v_pk_fma_f32 v[28:29], v[148:149], v[132:133], v[28:29] op_sel_hi:[1,0,1]
v_cvt_pk_bf16_f32 v120, v16, v17
v_pk_fma_f32 v[30:31], v[150:151], v[132:133], v[30:31] op_sel_hi:[1,0,1]
v_pk_mul_f32 v[104:105], v[24:25], v[24:25]
v_pk_mul_f32 v[106:107], v[26:27], v[26:27]
v_cvt_pk_bf16_f32 v121, v18, v19
v_pk_mul_f32 v[108:109], v[28:29], v[28:29]
v_pk_mul_f32 v[110:111], v[30:31], v[30:31]
v_pk_fma_f32 v[104:105], v[104:105], v[134:135], v[134:135] op_sel:[0,0,1] op_sel_hi:[1,0,1]
v_cvt_pk_bf16_f32 v122, v20, v21
v_pk_fma_f32 v[106:107], v[106:107], v[134:135], v[134:135] op_sel:[0,0,1] op_sel_hi:[1,0,1]
v_pk_fma_f32 v[108:109], v[108:109], v[134:135], v[134:135] op_sel:[0,0,1] op_sel_hi:[1,0,1]
v_pk_fma_f32 v[110:111], v[110:111], v[134:135], v[134:135] op_sel:[0,0,1] op_sel_hi:[1,0,1]
v_cvt_pk_bf16_f32 v123, v22, v23
v_pk_mul_f32 v[104:105], v[104:105], v[24:25]
v_pk_mul_f32 v[106:107], v[106:107], v[26:27]
v_pk_mul_f32 v[108:109], v[108:109], v[28:29]
s_mov_b32 s34, 16777216
v_pk_mul_f32 v[110:111], v[110:111], v[30:31]
v_exp_f32 v104, v104
v_exp_f32 v105, v105
v_permlane16_swap_b32 v120, v122
v_exp_f32 v106, v106
v_exp_f32 v107, v107
v_exp_f32 v108, v108
v_permlane16_swap_b32 v121, v123
v_exp_f32 v109, v109
v_exp_f32 v110, v110
v_exp_f32 v111, v111
buffer_store_dwordx4 v[120:123], v184, s[16:19], s34 offen offset:128 sc0 sc1
v_pk_fma_f32 v[104:105], v[104:105], v[132:133], v[132:133] op_sel:[0,1,1] op_sel_hi:[1,1,1]
v_pk_fma_f32 v[106:107], v[106:107], v[132:133], v[132:133] op_sel:[0,1,1] op_sel_hi:[1,1,1]
v_pk_fma_f32 v[108:109], v[108:109], v[132:133], v[132:133] op_sel:[0,1,1] op_sel_hi:[1,1,1]
v_pk_fma_f32 v[110:111], v[110:111], v[132:133], v[132:133] op_sel:[0,1,1] op_sel_hi:[1,1,1]
v_rcp_f32 v104, v104
v_rcp_f32 v105, v105
v_rcp_f32 v106, v106
v_rcp_f32 v107, v107
v_rcp_f32 v108, v108
v_rcp_f32 v109, v109
v_rcp_f32 v110, v110
v_rcp_f32 v111, v111
v_pk_mul_f32 v[24:25], v[24:25], v[104:105]
v_pk_mul_f32 v[26:27], v[26:27], v[106:107]
v_pk_mul_f32 v[28:29], v[28:29], v[108:109]
v_pk_mul_f32 v[30:31], v[30:31], v[110:111]
v_pk_fma_f32 v[32:33], v[152:153], v[132:133], v[32:33] op_sel_hi:[1,0,1]
v_pk_fma_f32 v[34:35], v[154:155], v[132:133], v[34:35] op_sel_hi:[1,0,1]
v_pk_fma_f32 v[36:37], v[156:157], v[132:133], v[36:37] op_sel_hi:[1,0,1]
v_cvt_pk_bf16_f32 v124, v24, v25
v_pk_fma_f32 v[38:39], v[158:159], v[132:133], v[38:39] op_sel_hi:[1,0,1]
v_pk_mul_f32 v[104:105], v[32:33], v[32:33]
v_pk_mul_f32 v[106:107], v[34:35], v[34:35]
v_cvt_pk_bf16_f32 v125, v26, v27
v_pk_mul_f32 v[108:109], v[36:37], v[36:37]
v_pk_mul_f32 v[110:111], v[38:39], v[38:39]
v_pk_fma_f32 v[104:105], v[104:105], v[134:135], v[134:135] op_sel:[0,0,1] op_sel_hi:[1,0,1]
v_cvt_pk_bf16_f32 v126, v28, v29
v_pk_fma_f32 v[106:107], v[106:107], v[134:135], v[134:135] op_sel:[0,0,1] op_sel_hi:[1,0,1]
v_pk_fma_f32 v[108:109], v[108:109], v[134:135], v[134:135] op_sel:[0,0,1] op_sel_hi:[1,0,1]
v_pk_fma_f32 v[110:111], v[110:111], v[134:135], v[134:135] op_sel:[0,0,1] op_sel_hi:[1,0,1]
v_cvt_pk_bf16_f32 v127, v30, v31
v_pk_mul_f32 v[104:105], v[104:105], v[32:33]
v_pk_mul_f32 v[106:107], v[106:107], v[34:35]
v_pk_mul_f32 v[108:109], v[108:109], v[36:37]
s_mov_b32 s34, 16891904
v_pk_mul_f32 v[110:111], v[110:111], v[38:39]
v_exp_f32 v104, v104
v_exp_f32 v105, v105
v_permlane16_swap_b32 v124, v126
v_exp_f32 v106, v106
v_exp_f32 v107, v107
v_exp_f32 v108, v108
v_permlane16_swap_b32 v125, v127
v_exp_f32 v109, v109
v_exp_f32 v110, v110
v_exp_f32 v111, v111
buffer_store_dwordx4 v[124:127], v184, s[16:19], s34 offen offset:0 sc0 sc1
v_pk_fma_f32 v[104:105], v[104:105], v[132:133], v[132:133] op_sel:[0,1,1] op_sel_hi:[1,1,1]
v_pk_fma_f32 v[106:107], v[106:107], v[132:133], v[132:133] op_sel:[0,1,1] op_sel_hi:[1,1,1]
v_pk_fma_f32 v[108:109], v[108:109], v[132:133], v[132:133] op_sel:[0,1,1] op_sel_hi:[1,1,1]
v_pk_fma_f32 v[110:111], v[110:111], v[132:133], v[132:133] op_sel:[0,1,1] op_sel_hi:[1,1,1]
v_rcp_f32 v104, v104
v_rcp_f32 v105, v105
v_rcp_f32 v106, v106
v_rcp_f32 v107, v107
v_rcp_f32 v108, v108
v_rcp_f32 v109, v109
v_rcp_f32 v110, v110
v_rcp_f32 v111, v111
v_pk_mul_f32 v[32:33], v[32:33], v[104:105]
v_pk_mul_f32 v[34:35], v[34:35], v[106:107]
v_pk_mul_f32 v[36:37], v[36:37], v[108:109]
v_pk_mul_f32 v[38:39], v[38:39], v[110:111]
v_pk_fma_f32 v[40:41], v[160:161], v[132:133], v[40:41] op_sel_hi:[1,0,1]
v_pk_fma_f32 v[42:43], v[162:163], v[132:133], v[42:43] op_sel_hi:[1,0,1]
v_pk_fma_f32 v[44:45], v[164:165], v[132:133], v[44:45] op_sel_hi:[1,0,1]
v_cvt_pk_bf16_f32 v112, v32, v33
v_pk_fma_f32 v[46:47], v[166:167], v[132:133], v[46:47] op_sel_hi:[1,0,1]
v_pk_mul_f32 v[104:105], v[40:41], v[40:41]
v_pk_mul_f32 v[106:107], v[42:43], v[42:43]
v_cvt_pk_bf16_f32 v113, v34, v35
v_pk_mul_f32 v[108:109], v[44:45], v[44:45]
v_pk_mul_f32 v[110:111], v[46:47], v[46:47]
v_pk_fma_f32 v[104:105], v[104:105], v[134:135], v[134:135] op_sel:[0,0,1] op_sel_hi:[1,0,1]
v_cvt_pk_bf16_f32 v114, v36, v37
v_pk_fma_f32 v[106:107], v[106:107], v[134:135], v[134:135] op_sel:[0,0,1] op_sel_hi:[1,0,1]
v_pk_fma_f32 v[108:109], v[108:109], v[134:135], v[134:135] op_sel:[0,0,1] op_sel_hi:[1,0,1]
v_pk_fma_f32 v[110:111], v[110:111], v[134:135], v[134:135] op_sel:[0,0,1] op_sel_hi:[1,0,1]
v_cvt_pk_bf16_f32 v115, v38, v39
v_pk_mul_f32 v[104:105], v[104:105], v[40:41]
v_pk_mul_f32 v[106:107], v[106:107], v[42:43]
v_pk_mul_f32 v[108:109], v[108:109], v[44:45]
s_mov_b32 s34, 16891904
v_pk_mul_f32 v[110:111], v[110:111], v[46:47]
v_exp_f32 v104, v104
v_exp_f32 v105, v105
v_permlane16_swap_b32 v112, v114
v_exp_f32 v106, v106
v_exp_f32 v107, v107
v_exp_f32 v108, v108
v_permlane16_swap_b32 v113, v115
v_exp_f32 v109, v109
v_exp_f32 v110, v110
v_exp_f32 v111, v111
buffer_store_dwordx4 v[112:115], v184, s[16:19], s34 offen offset:64 sc0 sc1
v_pk_fma_f32 v[104:105], v[104:105], v[132:133], v[132:133] op_sel:[0,1,1] op_sel_hi:[1,1,1]
v_pk_fma_f32 v[106:107], v[106:107], v[132:133], v[132:133] op_sel:[0,1,1] op_sel_hi:[1,1,1]
v_pk_fma_f32 v[108:109], v[108:109], v[132:133], v[132:133] op_sel:[0,1,1] op_sel_hi:[1,1,1]
v_pk_fma_f32 v[110:111], v[110:111], v[132:133], v[132:133] op_sel:[0,1,1] op_sel_hi:[1,1,1]
v_rcp_f32 v104, v104
v_rcp_f32 v105, v105
v_rcp_f32 v106, v106
v_rcp_f32 v107, v107
v_rcp_f32 v108, v108
v_rcp_f32 v109, v109
v_rcp_f32 v110, v110
v_rcp_f32 v111, v111
v_pk_mul_f32 v[40:41], v[40:41], v[104:105]
v_pk_mul_f32 v[42:43], v[42:43], v[106:107]
v_pk_mul_f32 v[44:45], v[44:45], v[108:109]
v_pk_mul_f32 v[46:47], v[46:47], v[110:111]
v_pk_fma_f32 v[48:49], v[144:145], v[136:137], v[48:49] op_sel_hi:[1,0,1]
v_pk_fma_f32 v[50:51], v[146:147], v[136:137], v[50:51] op_sel_hi:[1,0,1]
v_pk_fma_f32 v[52:53], v[148:149], v[136:137], v[52:53] op_sel_hi:[1,0,1]
v_cvt_pk_bf16_f32 v116, v40, v41
v_pk_fma_f32 v[54:55], v[150:151], v[136:137], v[54:55] op_sel_hi:[1,0,1]
v_pk_mul_f32 v[104:105], v[48:49], v[48:49]
v_pk_mul_f32 v[106:107], v[50:51], v[50:51]
v_cvt_pk_bf16_f32 v117, v42, v43
v_pk_mul_f32 v[108:109], v[52:53], v[52:53]
v_pk_mul_f32 v[110:111], v[54:55], v[54:55]
v_pk_fma_f32 v[104:105], v[104:105], v[138:139], v[138:139] op_sel:[0,0,1] op_sel_hi:[1,0,1]
v_cvt_pk_bf16_f32 v118, v44, v45
v_pk_fma_f32 v[106:107], v[106:107], v[138:139], v[138:139] op_sel:[0,0,1] op_sel_hi:[1,0,1]
v_pk_fma_f32 v[108:109], v[108:109], v[138:139], v[138:139] op_sel:[0,0,1] op_sel_hi:[1,0,1]
v_pk_fma_f32 v[110:111], v[110:111], v[138:139], v[138:139] op_sel:[0,0,1] op_sel_hi:[1,0,1]
v_cvt_pk_bf16_f32 v119, v46, v47
v_pk_mul_f32 v[104:105], v[104:105], v[48:49]
v_pk_mul_f32 v[106:107], v[106:107], v[50:51]
v_pk_mul_f32 v[108:109], v[108:109], v[52:53]
s_mov_b32 s34, 16891904
v_pk_mul_f32 v[110:111], v[110:111], v[54:55]
v_exp_f32 v104, v104
v_exp_f32 v105, v105
v_permlane16_swap_b32 v116, v118
v_exp_f32 v106, v106
v_exp_f32 v107, v107
v_exp_f32 v108, v108
v_permlane16_swap_b32 v117, v119
v_exp_f32 v109, v109
v_exp_f32 v110, v110
v_exp_f32 v111, v111
buffer_store_dwordx4 v[116:119], v184, s[16:19], s34 offen offset:128 sc0 sc1
v_pk_fma_f32 v[104:105], v[104:105], v[136:137], v[136:137] op_sel:[0,1,1] op_sel_hi:[1,1,1]
v_pk_fma_f32 v[106:107], v[106:107], v[136:137], v[136:137] op_sel:[0,1,1] op_sel_hi:[1,1,1]
v_pk_fma_f32 v[108:109], v[108:109], v[136:137], v[136:137] op_sel:[0,1,1] op_sel_hi:[1,1,1]
v_pk_fma_f32 v[110:111], v[110:111], v[136:137], v[136:137] op_sel:[0,1,1] op_sel_hi:[1,1,1]
v_rcp_f32 v104, v104
v_rcp_f32 v105, v105
v_rcp_f32 v106, v106
v_rcp_f32 v107, v107
v_rcp_f32 v108, v108
v_rcp_f32 v109, v109
v_rcp_f32 v110, v110
v_rcp_f32 v111, v111
v_pk_mul_f32 v[48:49], v[48:49], v[104:105]
v_pk_mul_f32 v[50:51], v[50:51], v[106:107]
v_pk_mul_f32 v[52:53], v[52:53], v[108:109]
v_pk_mul_f32 v[54:55], v[54:55], v[110:111]
v_pk_fma_f32 v[56:57], v[152:153], v[136:137], v[56:57] op_sel_hi:[1,0,1]
v_pk_fma_f32 v[58:59], v[154:155], v[136:137], v[58:59] op_sel_hi:[1,0,1]
v_pk_fma_f32 v[60:61], v[156:157], v[136:137], v[60:61] op_sel_hi:[1,0,1]
v_cvt_pk_bf16_f32 v120, v48, v49
v_pk_fma_f32 v[62:63], v[158:159], v[136:137], v[62:63] op_sel_hi:[1,0,1]
v_pk_mul_f32 v[104:105], v[56:57], v[56:57]
v_pk_mul_f32 v[106:107], v[58:59], v[58:59]
v_cvt_pk_bf16_f32 v121, v50, v51
v_pk_mul_f32 v[108:109], v[60:61], v[60:61]
v_pk_mul_f32 v[110:111], v[62:63], v[62:63]
v_pk_fma_f32 v[104:105], v[104:105], v[138:139], v[138:139] op_sel:[0,0,1] op_sel_hi:[1,0,1]
v_cvt_pk_bf16_f32 v122, v52, v53
v_pk_fma_f32 v[106:107], v[106:107], v[138:139], v[138:139] op_sel:[0,0,1] op_sel_hi:[1,0,1]
v_pk_fma_f32 v[108:109], v[108:109], v[138:139], v[138:139] op_sel:[0,0,1] op_sel_hi:[1,0,1]
v_pk_fma_f32 v[110:111], v[110:111], v[138:139], v[138:139] op_sel:[0,0,1] op_sel_hi:[1,0,1]
v_cvt_pk_bf16_f32 v123, v54, v55
v_pk_mul_f32 v[104:105], v[104:105], v[56:57]
v_pk_mul_f32 v[106:107], v[106:107], v[58:59]
v_pk_mul_f32 v[108:109], v[108:109], v[60:61]
s_mov_b32 s34, 17006592
v_pk_mul_f32 v[110:111], v[110:111], v[62:63]
v_exp_f32 v104, v104
v_exp_f32 v105, v105
v_permlane16_swap_b32 v120, v122
v_exp_f32 v106, v106
v_exp_f32 v107, v107
v_exp_f32 v108, v108
v_permlane16_swap_b32 v121, v123
v_exp_f32 v109, v109
v_exp_f32 v110, v110
v_exp_f32 v111, v111
buffer_store_dwordx4 v[120:123], v184, s[16:19], s34 offen offset:0 sc0 sc1
v_pk_fma_f32 v[104:105], v[104:105], v[136:137], v[136:137] op_sel:[0,1,1] op_sel_hi:[1,1,1]
v_pk_fma_f32 v[106:107], v[106:107], v[136:137], v[136:137] op_sel:[0,1,1] op_sel_hi:[1,1,1]
v_pk_fma_f32 v[108:109], v[108:109], v[136:137], v[136:137] op_sel:[0,1,1] op_sel_hi:[1,1,1]
v_pk_fma_f32 v[110:111], v[110:111], v[136:137], v[136:137] op_sel:[0,1,1] op_sel_hi:[1,1,1]
v_rcp_f32 v104, v104
v_rcp_f32 v105, v105
v_rcp_f32 v106, v106
v_rcp_f32 v107, v107
v_rcp_f32 v108, v108
v_rcp_f32 v109, v109
v_rcp_f32 v110, v110
v_rcp_f32 v111, v111
v_pk_mul_f32 v[56:57], v[56:57], v[104:105]
v_pk_mul_f32 v[58:59], v[58:59], v[106:107]
v_pk_mul_f32 v[60:61], v[60:61], v[108:109]
v_pk_mul_f32 v[62:63], v[62:63], v[110:111]
v_pk_fma_f32 v[64:65], v[160:161], v[136:137], v[64:65] op_sel_hi:[1,0,1]
v_pk_fma_f32 v[66:67], v[162:163], v[136:137], v[66:67] op_sel_hi:[1,0,1]
v_pk_fma_f32 v[68:69], v[164:165], v[136:137], v[68:69] op_sel_hi:[1,0,1]
v_cvt_pk_bf16_f32 v124, v56, v57
v_pk_fma_f32 v[70:71], v[166:167], v[136:137], v[70:71] op_sel_hi:[1,0,1]
v_pk_mul_f32 v[104:105], v[64:65], v[64:65]
v_pk_mul_f32 v[106:107], v[66:67], v[66:67]
v_cvt_pk_bf16_f32 v125, v58, v59
v_pk_mul_f32 v[108:109], v[68:69], v[68:69]
v_pk_mul_f32 v[110:111], v[70:71], v[70:71]
v_pk_fma_f32 v[104:105], v[104:105], v[138:139], v[138:139] op_sel:[0,0,1] op_sel_hi:[1,0,1]
v_cvt_pk_bf16_f32 v126, v60, v61
v_pk_fma_f32 v[106:107], v[106:107], v[138:139], v[138:139] op_sel:[0,0,1] op_sel_hi:[1,0,1]
v_pk_fma_f32 v[108:109], v[108:109], v[138:139], v[138:139] op_sel:[0,0,1] op_sel_hi:[1,0,1]
v_pk_fma_f32 v[110:111], v[110:111], v[138:139], v[138:139] op_sel:[0,0,1] op_sel_hi:[1,0,1]
v_cvt_pk_bf16_f32 v127, v62, v63
v_pk_mul_f32 v[104:105], v[104:105], v[64:65]
v_pk_mul_f32 v[106:107], v[106:107], v[66:67]
v_pk_mul_f32 v[108:109], v[108:109], v[68:69]
s_mov_b32 s34, 17006592
v_pk_mul_f32 v[110:111], v[110:111], v[70:71]
v_exp_f32 v104, v104
v_exp_f32 v105, v105
v_permlane16_swap_b32 v124, v126
v_exp_f32 v106, v106
v_exp_f32 v107, v107
v_exp_f32 v108, v108
v_permlane16_swap_b32 v125, v127
v_exp_f32 v109, v109
v_exp_f32 v110, v110
v_exp_f32 v111, v111
buffer_store_dwordx4 v[124:127], v184, s[16:19], s34 offen offset:64 sc0 sc1
v_pk_fma_f32 v[104:105], v[104:105], v[136:137], v[136:137] op_sel:[0,1,1] op_sel_hi:[1,1,1]
v_pk_fma_f32 v[106:107], v[106:107], v[136:137], v[136:137] op_sel:[0,1,1] op_sel_hi:[1,1,1]
v_pk_fma_f32 v[108:109], v[108:109], v[136:137], v[136:137] op_sel:[0,1,1] op_sel_hi:[1,1,1]
v_pk_fma_f32 v[110:111], v[110:111], v[136:137], v[136:137] op_sel:[0,1,1] op_sel_hi:[1,1,1]
v_rcp_f32 v104, v104
v_rcp_f32 v105, v105
v_rcp_f32 v106, v106
v_rcp_f32 v107, v107
v_rcp_f32 v108, v108
v_rcp_f32 v109, v109
v_rcp_f32 v110, v110
v_rcp_f32 v111, v111
v_pk_mul_f32 v[64:65], v[64:65], v[104:105]
v_pk_mul_f32 v[66:67], v[66:67], v[106:107]
v_pk_mul_f32 v[68:69], v[68:69], v[108:109]
v_pk_mul_f32 v[70:71], v[70:71], v[110:111]
v_pk_fma_f32 v[72:73], v[144:145], v[140:141], v[72:73] op_sel_hi:[1,0,1]
v_pk_fma_f32 v[74:75], v[146:147], v[140:141], v[74:75] op_sel_hi:[1,0,1]
v_pk_fma_f32 v[76:77], v[148:149], v[140:141], v[76:77] op_sel_hi:[1,0,1]
v_cvt_pk_bf16_f32 v112, v64, v65
v_pk_fma_f32 v[78:79], v[150:151], v[140:141], v[78:79] op_sel_hi:[1,0,1]
v_pk_mul_f32 v[104:105], v[72:73], v[72:73]
v_pk_mul_f32 v[106:107], v[74:75], v[74:75]
v_cvt_pk_bf16_f32 v113, v66, v67
v_pk_mul_f32 v[108:109], v[76:77], v[76:77]
v_pk_mul_f32 v[110:111], v[78:79], v[78:79]
v_pk_fma_f32 v[104:105], v[104:105], v[142:143], v[142:143] op_sel:[0,0,1] op_sel_hi:[1,0,1]
v_cvt_pk_bf16_f32 v114, v68, v69
v_pk_fma_f32 v[106:107], v[106:107], v[142:143], v[142:143] op_sel:[0,0,1] op_sel_hi:[1,0,1]
v_pk_fma_f32 v[108:109], v[108:109], v[142:143], v[142:143] op_sel:[0,0,1] op_sel_hi:[1,0,1]
v_pk_fma_f32 v[110:111], v[110:111], v[142:143], v[142:143] op_sel:[0,0,1] op_sel_hi:[1,0,1]
v_cvt_pk_bf16_f32 v115, v70, v71
v_pk_mul_f32 v[104:105], v[104:105], v[72:73]
v_pk_mul_f32 v[106:107], v[106:107], v[74:75]
v_pk_mul_f32 v[108:109], v[108:109], v[76:77]
s_mov_b32 s34, 17006592
v_pk_mul_f32 v[110:111], v[110:111], v[78:79]
v_exp_f32 v104, v104
v_exp_f32 v105, v105
v_permlane16_swap_b32 v112, v114
v_exp_f32 v106, v106
v_exp_f32 v107, v107
v_exp_f32 v108, v108
v_permlane16_swap_b32 v113, v115
v_exp_f32 v109, v109
v_exp_f32 v110, v110
v_exp_f32 v111, v111
buffer_store_dwordx4 v[112:115], v184, s[16:19], s34 offen offset:128 sc0 sc1
v_pk_fma_f32 v[104:105], v[104:105], v[140:141], v[140:141] op_sel:[0,1,1] op_sel_hi:[1,1,1]
v_pk_fma_f32 v[106:107], v[106:107], v[140:141], v[140:141] op_sel:[0,1,1] op_sel_hi:[1,1,1]
v_pk_fma_f32 v[108:109], v[108:109], v[140:141], v[140:141] op_sel:[0,1,1] op_sel_hi:[1,1,1]
v_pk_fma_f32 v[110:111], v[110:111], v[140:141], v[140:141] op_sel:[0,1,1] op_sel_hi:[1,1,1]
v_rcp_f32 v104, v104
v_rcp_f32 v105, v105
v_rcp_f32 v106, v106
v_rcp_f32 v107, v107
v_rcp_f32 v108, v108
v_rcp_f32 v109, v109
v_rcp_f32 v110, v110
v_rcp_f32 v111, v111
v_pk_mul_f32 v[72:73], v[72:73], v[104:105]
v_pk_mul_f32 v[74:75], v[74:75], v[106:107]
v_pk_mul_f32 v[76:77], v[76:77], v[108:109]
v_pk_mul_f32 v[78:79], v[78:79], v[110:111]
v_pk_fma_f32 v[80:81], v[152:153], v[140:141], v[80:81] op_sel_hi:[1,0,1]
v_pk_fma_f32 v[82:83], v[154:155], v[140:141], v[82:83] op_sel_hi:[1,0,1]
v_pk_fma_f32 v[84:85], v[156:157], v[140:141], v[84:85] op_sel_hi:[1,0,1]
v_cvt_pk_bf16_f32 v116, v72, v73
v_pk_fma_f32 v[86:87], v[158:159], v[140:141], v[86:87] op_sel_hi:[1,0,1]
v_pk_mul_f32 v[104:105], v[80:81], v[80:81]
v_pk_mul_f32 v[106:107], v[82:83], v[82:83]
v_cvt_pk_bf16_f32 v117, v74, v75
v_pk_mul_f32 v[108:109], v[84:85], v[84:85]
v_pk_mul_f32 v[110:111], v[86:87], v[86:87]
v_pk_fma_f32 v[104:105], v[104:105], v[142:143], v[142:143] op_sel:[0,0,1] op_sel_hi:[1,0,1]
v_cvt_pk_bf16_f32 v118, v76, v77
v_pk_fma_f32 v[106:107], v[106:107], v[142:143], v[142:143] op_sel:[0,0,1] op_sel_hi:[1,0,1]
v_pk_fma_f32 v[108:109], v[108:109], v[142:143], v[142:143] op_sel:[0,0,1] op_sel_hi:[1,0,1]
v_pk_fma_f32 v[110:111], v[110:111], v[142:143], v[142:143] op_sel:[0,0,1] op_sel_hi:[1,0,1]
v_cvt_pk_bf16_f32 v119, v78, v79
v_pk_mul_f32 v[104:105], v[104:105], v[80:81]
v_pk_mul_f32 v[106:107], v[106:107], v[82:83]
v_pk_mul_f32 v[108:109], v[108:109], v[84:85]
s_mov_b32 s34, 17121280
v_pk_mul_f32 v[110:111], v[110:111], v[86:87]
v_exp_f32 v104, v104
v_exp_f32 v105, v105
v_permlane16_swap_b32 v116, v118
v_exp_f32 v106, v106
v_exp_f32 v107, v107
v_exp_f32 v108, v108
v_permlane16_swap_b32 v117, v119
v_exp_f32 v109, v109
v_exp_f32 v110, v110
v_exp_f32 v111, v111
buffer_store_dwordx4 v[116:119], v184, s[16:19], s34 offen offset:0 sc0 sc1
v_pk_fma_f32 v[104:105], v[104:105], v[140:141], v[140:141] op_sel:[0,1,1] op_sel_hi:[1,1,1]
v_pk_fma_f32 v[106:107], v[106:107], v[140:141], v[140:141] op_sel:[0,1,1] op_sel_hi:[1,1,1]
v_pk_fma_f32 v[108:109], v[108:109], v[140:141], v[140:141] op_sel:[0,1,1] op_sel_hi:[1,1,1]
v_pk_fma_f32 v[110:111], v[110:111], v[140:141], v[140:141] op_sel:[0,1,1] op_sel_hi:[1,1,1]
v_rcp_f32 v104, v104
v_rcp_f32 v105, v105
v_rcp_f32 v106, v106
v_rcp_f32 v107, v107
v_rcp_f32 v108, v108
v_rcp_f32 v109, v109
v_rcp_f32 v110, v110
v_rcp_f32 v111, v111
v_pk_mul_f32 v[80:81], v[80:81], v[104:105]
v_pk_mul_f32 v[82:83], v[82:83], v[106:107]
v_pk_mul_f32 v[84:85], v[84:85], v[108:109]
v_pk_mul_f32 v[86:87], v[86:87], v[110:111]
v_pk_fma_f32 v[88:89], v[160:161], v[140:141], v[88:89] op_sel_hi:[1,0,1]
v_pk_fma_f32 v[90:91], v[162:163], v[140:141], v[90:91] op_sel_hi:[1,0,1]
v_pk_fma_f32 v[92:93], v[164:165], v[140:141], v[92:93] op_sel_hi:[1,0,1]
v_cvt_pk_bf16_f32 v120, v80, v81
v_pk_fma_f32 v[94:95], v[166:167], v[140:141], v[94:95] op_sel_hi:[1,0,1]
v_pk_mul_f32 v[104:105], v[88:89], v[88:89]
v_pk_mul_f32 v[106:107], v[90:91], v[90:91]
v_cvt_pk_bf16_f32 v121, v82, v83
v_pk_mul_f32 v[108:109], v[92:93], v[92:93]
v_pk_mul_f32 v[110:111], v[94:95], v[94:95]
v_pk_fma_f32 v[104:105], v[104:105], v[142:143], v[142:143] op_sel:[0,0,1] op_sel_hi:[1,0,1]
v_cvt_pk_bf16_f32 v122, v84, v85
v_pk_fma_f32 v[106:107], v[106:107], v[142:143], v[142:143] op_sel:[0,0,1] op_sel_hi:[1,0,1]
v_pk_fma_f32 v[108:109], v[108:109], v[142:143], v[142:143] op_sel:[0,0,1] op_sel_hi:[1,0,1]
v_pk_fma_f32 v[110:111], v[110:111], v[142:143], v[142:143] op_sel:[0,0,1] op_sel_hi:[1,0,1]
v_cvt_pk_bf16_f32 v123, v86, v87
v_pk_mul_f32 v[104:105], v[104:105], v[88:89]
v_pk_mul_f32 v[106:107], v[106:107], v[90:91]
v_pk_mul_f32 v[108:109], v[108:109], v[92:93]
s_mov_b32 s34, 17121280
v_pk_mul_f32 v[110:111], v[110:111], v[94:95]
v_exp_f32 v104, v104
v_exp_f32 v105, v105
v_permlane16_swap_b32 v120, v122
v_exp_f32 v106, v106
v_exp_f32 v107, v107
v_exp_f32 v108, v108
v_permlane16_swap_b32 v121, v123
v_exp_f32 v109, v109
v_exp_f32 v110, v110
v_exp_f32 v111, v111
buffer_store_dwordx4 v[120:123], v184, s[16:19], s34 offen offset:64 sc0 sc1
v_pk_fma_f32 v[104:105], v[104:105], v[140:141], v[140:141] op_sel:[0,1,1] op_sel_hi:[1,1,1]
v_pk_fma_f32 v[106:107], v[106:107], v[140:141], v[140:141] op_sel:[0,1,1] op_sel_hi:[1,1,1]
v_pk_fma_f32 v[108:109], v[108:109], v[140:141], v[140:141] op_sel:[0,1,1] op_sel_hi:[1,1,1]
v_pk_fma_f32 v[110:111], v[110:111], v[140:141], v[140:141] op_sel:[0,1,1] op_sel_hi:[1,1,1]
v_rcp_f32 v104, v104
v_rcp_f32 v105, v105
v_rcp_f32 v106, v106
v_rcp_f32 v107, v107
v_rcp_f32 v108, v108
v_rcp_f32 v109, v109
v_rcp_f32 v110, v110
v_rcp_f32 v111, v111
v_pk_mul_f32 v[88:89], v[88:89], v[104:105]
v_pk_mul_f32 v[90:91], v[90:91], v[106:107]
v_pk_mul_f32 v[92:93], v[92:93], v[108:109]
v_pk_mul_f32 v[94:95], v[94:95], v[110:111]
v_cvt_pk_bf16_f32 v124, v88, v89
v_cvt_pk_bf16_f32 v125, v90, v91
v_cvt_pk_bf16_f32 v126, v92, v93
v_cvt_pk_bf16_f32 v127, v94, v95
s_mov_b32 s34, 17121280
s_nop 0
v_permlane16_swap_b32 v124, v126
v_permlane16_swap_b32 v125, v127
buffer_store_dwordx4 v[124:127], v184, s[16:19], s34 offen offset:128 sc0 sc1
s_lshl_b32 s60, s58, 4
s_add_u32 s60, s60, s59
s_lshl_b32 s60, s60, 2
s_add_u32 s60, s60, s20
s_lshl_b32 s60, s60, 4
s_add_u32 s60, s60, 38846976
L_c_s5_8:
s_and_b32 s56, s2, 1
s_bfe_u32 s5, s2, 0x10002
s_bfe_u32 s6, s2, 0x10001
s_lshr_b32 s4, s2, 3
s_lshr_b32 s7, s4, 2
s_and_b32 s4, s4, 3
s_lshl_b32 s5, s5, 3
s_add_u32 s58, s5, s7
s_lshl_b32 s6, s6, 2
s_add_u32 s59, s6, s4
s_mul_i32 s3, s7, 1
s_mul_i32 s31, s4, 0
s_add_u32 s3, s3, s31
s_lshl_b32 s21, s58, 7
s_lshl_b32 s22, s59, 8
s_mov_b32 s51, 32
s_mov_b32 s57, 8
s_cmp_eq_u32 s56, 1
s_cmov_b32 s51, 28
s_cmov_b32 s57, 8
s_sub_u32 s98, s51, 1
s_mov_b32 s99, 3
s_lshl_b32 s101, s56, 5
s_mov_b32 s52, s82
s_mov_b32 s53, s83
s_mov_b32 s54, 4194304
s_mov_b32 s55, 0x20000
s_lshr_b32 s31, s20, 1
s_and_b32 s32, s20, 1
s_mul_i32 s31, s31, 64
s_add_u32 s31, s31, s21
s_mul_i32 s32, s32, 128
s_add_u32 s32, s32, s22
v_and_b32 v134, 15, v254
v_add_u32 v134, s31, v134
v_mul_u32_u24 v134, 2048, v134
v_add_u32 v134, s32, v134
v_bfe_u32 v137, v254, 5, 1
v_lshl_add_u32 v134, v137, 4, v134
v_bfe_u32 v137, v254, 4, 1
v_lshl_add_u32 v134, v137, 5, v134
v_and_b32 v137, 63, v254
s_lshr_b32 s31, s20, 1
s_and_b32 s32, s20, 1
v_and_b32 v138, 15, v137
s_mul_i32 s33, s31, 64
v_add_u32 v138, s33, v138
v_bfe_u32 v139, v138, 1, 3
v_lshrrev_b32 v140, 4, v137
v_xor_b32 v139, v139, v140
v_lshlrev_b32 v139, 4, v139
v_lshl_add_u32 v128, v138, 7, v139
v_xor_b32 v129, 64, v128
v_lshrrev_b32 v138, 4, v137
v_bfe_u32 v139, v137, 2, 2
v_and_b32 v140, 3, v137
v_lshl_add_u32 v141, v138, 3, v139
v_lshlrev_b32 v140, 3, v140
v_and_b32 v138, 3, v141
v_bfe_u32 v139, v141, 3, 1
v_lshl_or_b32 v138, v139, 2, v138
v_lshlrev_b32 v138, 1, v138
v_lshlrev_b32 v138, 4, v138
v_mul_u32_u24 v141, 256, v141
v_add_u32 v141, 16384, v141
s_mul_i32 s33, s32, 128
s_add_u32 s33, s33, 0
v_add_u32 v139, s33, v140
v_xor_b32 v139, v139, v138
v_add_u32 v130, v139, v141
s_mul_i32 s33, s32, 128
s_add_u32 s33, s33, 32
v_add_u32 v139, s33, v140
v_xor_b32 v139, v139, v138
v_add_u32 v131, v139, v141
s_mul_i32 s33, s32, 128
s_add_u32 s33, s33, 64
v_add_u32 v139, s33, v140
v_xor_b32 v139, v139, v138
v_add_u32 v132, v139, v141
s_mul_i32 s33, s32, 128
s_add_u32 s33, s33, 96
v_add_u32 v139, s33, v140
v_xor_b32 v139, v139, v138
v_add_u32 v133, v139, v141
v_mov_b32 v0, 0
v_mov_b32 v1, 0
v_mov_b32 v2, 0
v_mov_b32 v3, 0
v_mov_b32 v4, 0
v_mov_b32 v5, 0
v_mov_b32 v6, 0
v_mov_b32 v7, 0
v_mov_b32 v8, 0
v_mov_b32 v9, 0
v_mov_b32 v10, 0
v_mov_b32 v11, 0
v_mov_b32 v12, 0
v_mov_b32 v13, 0
v_mov_b32 v14, 0
v_mov_b32 v15, 0
v_mov_b32 v16, 0
v_mov_b32 v17, 0
v_mov_b32 v18, 0
v_mov_b32 v19, 0
v_mov_b32 v20, 0
v_mov_b32 v21, 0
v_mov_b32 v22, 0
v_mov_b32 v23, 0
v_mov_b32 v24, 0
v_mov_b32 v25, 0
v_mov_b32 v26, 0
v_mov_b32 v27, 0
v_mov_b32 v28, 0
v_mov_b32 v29, 0
v_mov_b32 v30, 0
v_mov_b32 v31, 0
v_mov_b32 v32, 0
v_mov_b32 v33, 0
v_mov_b32 v34, 0
v_mov_b32 v35, 0
v_mov_b32 v36, 0
v_mov_b32 v37, 0
v_mov_b32 v38, 0
v_mov_b32 v39, 0
v_mov_b32 v40, 0
v_mov_b32 v41, 0
v_mov_b32 v42, 0
v_mov_b32 v43, 0
v_mov_b32 v44, 0
v_mov_b32 v45, 0
v_mov_b32 v46, 0
v_mov_b32 v47, 0
v_mov_b32 v48, 0
v_mov_b32 v49, 0
v_mov_b32 v50, 0
v_mov_b32 v51, 0
v_mov_b32 v52, 0
v_mov_b32 v53, 0
v_mov_b32 v54, 0
v_mov_b32 v55, 0
v_mov_b32 v56, 0
v_mov_b32 v57, 0
v_mov_b32 v58, 0
v_mov_b32 v59, 0
v_mov_b32 v60, 0
v_mov_b32 v61, 0
v_mov_b32 v62, 0
v_mov_b32 v63, 0
s_lshl_b32 s31, s56, 16
v_add_u32 v134, s31, v134
s_mov_b32 s92, 4
s_mov_b32 s93, 0
s_mov_b32 s30, 0
s_mov_b32 s29, 1
s_lshr_b32 s31, s20, 1
s_lshl_b32 s31, s31, 10
s_lshl_b32 s32, s56, 9
s_add_u32 s31, s31, s32
s_add_u32 s31, s31, 147456
v_and_b32 v136, 15, v254
v_lshl_add_u32 v136, v136, 4, s31
ds_read_b32 v164, v136 offset:8
ds_read_b32 v166, v136 offset:264
s_waitcnt lgkmcnt(0)
v_sub_f32 v164, 1.0, v164
v_sub_f32 v166, 1.0, v166
v_lshlrev_b32 v135, 4, v254
s_lshl_b32 s31, s2, 2
s_add_u32 s31, s31, s20
s_lshl_b32 s62, s31, 13
s_add_u32 s62, s62, 41943040
s_lshl_b32 s63, s31, 4
s_add_u32 s63, s63, 38862848
s_lshr_b32 s31, s20, 1
s_lshl_b32 s31, s31, 13
s_and_b32 s32, s20, 1
s_lshl_b32 s32, s32, 14
s_add_u32 s31, s31, s32
s_and_b32 s32, s51, 3
s_lshl_b32 s32, s32, 15
s_add_u32 s31, s31, s32
v_bfe_u32 v139, v254, 4, 1
v_bfe_u32 v140, v254, 5, 1
v_lshl_or_b32 v139, v139, 1, v140
v_bfe_u32 v140, v254, 1, 3
v_xor_b32 v139, v139, v140
v_and_b32 v140, 15, v254
v_lshlrev_b32 v140, 7, v140
v_lshl_add_u32 v139, v139, 4, v140
v_add_u32 v139, s31, v139
v_xor_b32 v140, 64, v139
s_add_u32 s32, s51, 1
s_and_b32 s32, s32, 3
s_lshl_b32 s32, s32, 15
s_lshl_b32 s31, s20, 13
s_add_u32 s31, s31, s32
v_add_u32 v136, s31, v135
s_barrier
ds_read_b64_tr_b16 v[96:97], v130 offset:0
ds_read_b64_tr_b16 v[98:99], v130 offset:1024
ds_read_b128 v[64:67], v128 offset:0
ds_read_b64_tr_b16 v[100:101], v131 offset:0
ds_read_b64_tr_b16 v[102:103], v131 offset:1024
ds_read_b64_tr_b16 v[104:105], v132 offset:0
ds_read_b64_tr_b16 v[106:107], v132 offset:1024
ds_read_b64_tr_b16 v[108:109], v133 offset:0
ds_read_b64_tr_b16 v[110:111], v133 offset:1024
ds_read_b128 v[68:71], v128 offset:2048
ds_read_b128 v[72:75], v128 offset:4096
ds_read_b128 v[76:79], v128 offset:6144
.p2align 6
L_s6_mm_84:
s_waitcnt lgkmcnt(9)
v_mfma_f32_16x16x32_bf16 v[0:3], v[96:99], v[64:67], v[0:3]
ds_read_b64_tr_b16 v[112:113], v130 offset:8192
ds_read_b64_tr_b16 v[114:115], v130 offset:9216
s_waitcnt lgkmcnt(9)
v_mfma_f32_16x16x32_bf16 v[4:7], v[100:103], v[64:67], v[4:7]
ds_read_b128 v[80:83], v129 offset:0
ds_read_b64_tr_b16 v[116:117], v131 offset:8192
s_waitcnt lgkmcnt(9)
v_mfma_f32_16x16x32_bf16 v[8:11], v[104:107], v[64:67], v[8:11]
ds_read_b64_tr_b16 v[118:119], v131 offset:9216
ds_read_b64_tr_b16 v[120:121], v132 offset:8192
s_waitcnt lgkmcnt(9)
v_mfma_f32_16x16x32_bf16 v[12:15], v[108:111], v[64:67], v[12:15]
ds_read_b64_tr_b16 v[122:123], v132 offset:9216
ds_read_b64_tr_b16 v[124:125], v133 offset:8192
s_waitcnt lgkmcnt(10)
v_mfma_f32_16x16x32_bf16 v[16:19], v[96:99], v[68:71], v[16:19]
ds_read_b64_tr_b16 v[126:127], v133 offset:9216
ds_read_b128 v[84:87], v129 offset:2048
v_mfma_f32_16x16x32_bf16 v[20:23], v[100:103], v[68:71], v[20:23]
ds_read_b128 v[88:91], v129 offset:4096
ds_read_b128 v[92:95], v129 offset:6144
v_mfma_f32_16x16x32_bf16 v[24:27], v[104:107], v[68:71], v[24:27]
s_add_u32 s30, s30, 1
s_cmp_eq_u32 s30, 4
v_mfma_f32_16x16x32_bf16 v[28:31], v[108:111], v[68:71], v[28:31]
s_cselect_b32 s30, 0, s30
s_mov_b32 s38, 32768
s_waitcnt lgkmcnt(13)
v_mfma_f32_16x16x32_bf16 v[32:35], v[96:99], v[72:75], v[32:35]
s_cmov_b32 s38, 4294868992
s_add_u32 s29, s29, 1
v_mfma_f32_16x16x32_bf16 v[36:39], v[100:103], v[72:75], v[36:39]
v_add_u32 v128, s38, v128
v_add_u32 v129, s38, v129
v_mfma_f32_16x16x32_bf16 v[40:43], v[104:107], v[72:75], v[40:43]
v_add_u32 v130, s38, v130
v_add_u32 v131, s38, v131
v_mfma_f32_16x16x32_bf16 v[44:47], v[108:111], v[72:75], v[44:47]
v_add_u32 v132, s38, v132
v_add_u32 v133, s38, v133
s_waitcnt lgkmcnt(12)
v_mfma_f32_16x16x32_bf16 v[48:51], v[96:99], v[76:79], v[48:51]
v_mfma_f32_16x16x32_bf16 v[52:55], v[100:103], v[76:79], v[52:55]
v_mfma_f32_16x16x32_bf16 v[56:59], v[104:107], v[76:79], v[56:59]
v_mfma_f32_16x16x32_bf16 v[60:63], v[108:111], v[76:79], v[60:63]
s_waitcnt lgkmcnt(9)
v_mfma_f32_16x16x32_bf16 v[0:3], v[112:115], v[80:83], v[0:3]
s_waitcnt lgkmcnt(7)
v_mfma_f32_16x16x32_bf16 v[4:7], v[116:119], v[80:83], v[4:7]
s_waitcnt lgkmcnt(5)
v_mfma_f32_16x16x32_bf16 v[8:11], v[120:123], v[80:83], v[8:11]
s_waitcnt lgkmcnt(3)
v_mfma_f32_16x16x32_bf16 v[12:15], v[124:127], v[80:83], v[12:15]
s_waitcnt lgkmcnt(2)
v_mfma_f32_16x16x32_bf16 v[16:19], v[112:115], v[84:87], v[16:19]
s_waitcnt lgkmcnt(0)
s_barrier
ds_read_b64_tr_b16 v[96:97], v130 offset:0
ds_read_b64_tr_b16 v[98:99], v130 offset:1024
v_mfma_f32_16x16x32_bf16 v[20:23], v[116:119], v[84:87], v[20:23]
ds_read_b128 v[64:67], v128 offset:0
ds_read_b64_tr_b16 v[100:101], v131 offset:0
v_mfma_f32_16x16x32_bf16 v[24:27], v[120:123], v[84:87], v[24:27]
ds_read_b64_tr_b16 v[102:103], v131 offset:1024
ds_read_b64_tr_b16 v[104:105], v132 offset:0
v_mfma_f32_16x16x32_bf16 v[28:31], v[124:127], v[84:87], v[28:31]
ds_read_b64_tr_b16 v[106:107], v132 offset:1024
ds_read_b64_tr_b16 v[108:109], v133 offset:0
v_mfma_f32_16x16x32_bf16 v[32:35], v[112:115], v[88:91], v[32:35]
ds_read_b64_tr_b16 v[110:111], v133 offset:1024
ds_read_b128 v[68:71], v128 offset:2048
v_mfma_f32_16x16x32_bf16 v[36:39], v[116:119], v[88:91], v[36:39]
ds_read_b128 v[72:75], v128 offset:4096
ds_read_b128 v[76:79], v128 offset:6144
v_mfma_f32_16x16x32_bf16 v[40:43], v[120:123], v[88:91], v[40:43]
v_mfma_f32_16x16x32_bf16 v[44:47], v[124:127], v[88:91], v[44:47]
v_mfma_f32_16x16x32_bf16 v[48:51], v[112:115], v[92:95], v[48:51]
v_mfma_f32_16x16x32_bf16 v[52:55], v[116:119], v[92:95], v[52:55]
v_mfma_f32_16x16x32_bf16 v[56:59], v[120:123], v[92:95], v[56:59]
v_mfma_f32_16x16x32_bf16 v[60:63], v[124:127], v[92:95], v[60:63]
s_bitcmp1_b64 s[92:93], s29
s_cbranch_scc1 L_s6_H_85
L_s6_B_86:
s_waitcnt lgkmcnt(9)
v_mfma_f32_16x16x32_bf16 v[0:3], v[96:99], v[64:67], v[0:3]
ds_read_b64_tr_b16 v[112:113], v130 offset:8192
ds_read_b64_tr_b16 v[114:115], v130 offset:9216
s_waitcnt lgkmcnt(9)
v_mfma_f32_16x16x32_bf16 v[4:7], v[100:103], v[64:67], v[4:7]
ds_read_b128 v[80:83], v129 offset:0
ds_read_b64_tr_b16 v[116:117], v131 offset:8192
s_waitcnt lgkmcnt(9)
v_mfma_f32_16x16x32_bf16 v[8:11], v[104:107], v[64:67], v[8:11]
ds_read_b64_tr_b16 v[118:119], v131 offset:9216
ds_read_b64_tr_b16 v[120:121], v132 offset:8192
s_waitcnt lgkmcnt(9)
v_mfma_f32_16x16x32_bf16 v[12:15], v[108:111], v[64:67], v[12:15]
ds_read_b64_tr_b16 v[122:123], v132 offset:9216
ds_read_b64_tr_b16 v[124:125], v133 offset:8192
s_waitcnt lgkmcnt(10)
v_mfma_f32_16x16x32_bf16 v[16:19], v[96:99], v[68:71], v[16:19]
ds_read_b64_tr_b16 v[126:127], v133 offset:9216
ds_read_b128 v[84:87], v129 offset:2048
v_mfma_f32_16x16x32_bf16 v[20:23], v[100:103], v[68:71], v[20:23]
ds_read_b128 v[88:91], v129 offset:4096
ds_read_b128 v[92:95], v129 offset:6144
v_mfma_f32_16x16x32_bf16 v[24:27], v[104:107], v[68:71], v[24:27]
s_add_u32 s30, s30, 1
s_cmp_eq_u32 s30, 4
v_mfma_f32_16x16x32_bf16 v[28:31], v[108:111], v[68:71], v[28:31]
s_cselect_b32 s30, 0, s30
s_mov_b32 s38, 32768
s_waitcnt lgkmcnt(13)
v_mfma_f32_16x16x32_bf16 v[32:35], v[96:99], v[72:75], v[32:35]
s_cmov_b32 s38, 4294868992
s_add_u32 s29, s29, 1
v_mfma_f32_16x16x32_bf16 v[36:39], v[100:103], v[72:75], v[36:39]
v_add_u32 v128, s38, v128
v_add_u32 v129, s38, v129
v_mfma_f32_16x16x32_bf16 v[40:43], v[104:107], v[72:75], v[40:43]
v_add_u32 v130, s38, v130
v_add_u32 v131, s38, v131
v_mfma_f32_16x16x32_bf16 v[44:47], v[108:111], v[72:75], v[44:47]
v_add_u32 v132, s38, v132
v_add_u32 v133, s38, v133
s_waitcnt lgkmcnt(12)
v_mfma_f32_16x16x32_bf16 v[48:51], v[96:99], v[76:79], v[48:51]
v_mfma_f32_16x16x32_bf16 v[52:55], v[100:103], v[76:79], v[52:55]
v_mfma_f32_16x16x32_bf16 v[56:59], v[104:107], v[76:79], v[56:59]
v_mfma_f32_16x16x32_bf16 v[60:63], v[108:111], v[76:79], v[60:63]
s_waitcnt lgkmcnt(9)
v_mfma_f32_16x16x32_bf16 v[0:3], v[112:115], v[80:83], v[0:3]
s_waitcnt lgkmcnt(7)
v_mfma_f32_16x16x32_bf16 v[4:7], v[116:119], v[80:83], v[4:7]
s_waitcnt lgkmcnt(5)
v_mfma_f32_16x16x32_bf16 v[8:11], v[120:123], v[80:83], v[8:11]
s_waitcnt lgkmcnt(3)
v_mfma_f32_16x16x32_bf16 v[12:15], v[124:127], v[80:83], v[12:15]
s_waitcnt lgkmcnt(2)
v_mfma_f32_16x16x32_bf16 v[16:19], v[112:115], v[84:87], v[16:19]
s_waitcnt lgkmcnt(0)
s_barrier
ds_read_b64_tr_b16 v[96:97], v130 offset:0
ds_read_b64_tr_b16 v[98:99], v130 offset:1024
v_mfma_f32_16x16x32_bf16 v[20:23], v[116:119], v[84:87], v[20:23]
ds_read_b128 v[64:67], v128 offset:0
ds_read_b64_tr_b16 v[100:101], v131 offset:0
v_mfma_f32_16x16x32_bf16 v[24:27], v[120:123], v[84:87], v[24:27]
ds_read_b64_tr_b16 v[102:103], v131 offset:1024
ds_read_b64_tr_b16 v[104:105], v132 offset:0
v_mfma_f32_16x16x32_bf16 v[28:31], v[124:127], v[84:87], v[28:31]
ds_read_b64_tr_b16 v[106:107], v132 offset:1024
ds_read_b64_tr_b16 v[108:109], v133 offset:0
v_mfma_f32_16x16x32_bf16 v[32:35], v[112:115], v[88:91], v[32:35]
ds_read_b64_tr_b16 v[110:111], v133 offset:1024
ds_read_b128 v[68:71], v128 offset:2048
v_mfma_f32_16x16x32_bf16 v[36:39], v[116:119], v[88:91], v[36:39]
ds_read_b128 v[72:75], v128 offset:4096
ds_read_b128 v[76:79], v128 offset:6144
v_mfma_f32_16x16x32_bf16 v[40:43], v[120:123], v[88:91], v[40:43]
v_mfma_f32_16x16x32_bf16 v[44:47], v[124:127], v[88:91], v[44:47]
v_mfma_f32_16x16x32_bf16 v[48:51], v[112:115], v[92:95], v[48:51]
v_mfma_f32_16x16x32_bf16 v[52:55], v[116:119], v[92:95], v[52:55]
v_mfma_f32_16x16x32_bf16 v[56:59], v[120:123], v[92:95], v[56:59]
s_cmp_lt_u32 s29, s98
v_mfma_f32_16x16x32_bf16 v[60:63], v[124:127], v[92:95], v[60:63]
s_cbranch_scc1 L_s6_mm_84
s_waitcnt lgkmcnt(9)
v_mfma_f32_16x16x32_bf16 v[0:3], v[96:99], v[64:67], v[0:3]
ds_read_b64_tr_b16 v[112:113], v130 offset:8192
ds_read_b64_tr_b16 v[114:115], v130 offset:9216
s_waitcnt lgkmcnt(9)
v_mfma_f32_16x16x32_bf16 v[4:7], v[100:103], v[64:67], v[4:7]
ds_read_b128 v[80:83], v129 offset:0
ds_read_b64_tr_b16 v[116:117], v131 offset:8192
s_waitcnt lgkmcnt(9)
v_mfma_f32_16x16x32_bf16 v[8:11], v[104:107], v[64:67], v[8:11]
ds_read_b64_tr_b16 v[118:119], v131 offset:9216
ds_read_b64_tr_b16 v[120:121], v132 offset:8192
s_waitcnt lgkmcnt(9)
v_mfma_f32_16x16x32_bf16 v[12:15], v[108:111], v[64:67], v[12:15]
ds_read_b64_tr_b16 v[122:123], v132 offset:9216
ds_read_b64_tr_b16 v[124:125], v133 offset:8192
s_waitcnt lgkmcnt(10)
v_mfma_f32_16x16x32_bf16 v[16:19], v[96:99], v[68:71], v[16:19]
ds_read_b64_tr_b16 v[126:127], v133 offset:9216
ds_read_b128 v[84:87], v129 offset:2048
v_mfma_f32_16x16x32_bf16 v[20:23], v[100:103], v[68:71], v[20:23]
ds_read_b128 v[88:91], v129 offset:4096
ds_read_b128 v[92:95], v129 offset:6144
v_mfma_f32_16x16x32_bf16 v[24:27], v[104:107], v[68:71], v[24:27]
s_add_u32 s30, s30, 1
s_cmp_eq_u32 s30, 4
v_mfma_f32_16x16x32_bf16 v[28:31], v[108:111], v[68:71], v[28:31]
s_cselect_b32 s30, 0, s30
s_mov_b32 s38, 32768
s_waitcnt lgkmcnt(13)
v_mfma_f32_16x16x32_bf16 v[32:35], v[96:99], v[72:75], v[32:35]
s_cmov_b32 s38, 4294868992
s_add_u32 s29, s29, 1
v_mfma_f32_16x16x32_bf16 v[36:39], v[100:103], v[72:75], v[36:39]
v_add_u32 v128, s38, v128
v_add_u32 v129, s38, v129
v_mfma_f32_16x16x32_bf16 v[40:43], v[104:107], v[72:75], v[40:43]
v_add_u32 v130, s38, v130
v_add_u32 v131, s38, v131
v_mfma_f32_16x16x32_bf16 v[44:47], v[108:111], v[72:75], v[44:47]
v_add_u32 v132, s38, v132
v_add_u32 v133, s38, v133
s_waitcnt lgkmcnt(12)
v_mfma_f32_16x16x32_bf16 v[48:51], v[96:99], v[76:79], v[48:51]
v_mfma_f32_16x16x32_bf16 v[52:55], v[100:103], v[76:79], v[52:55]
v_mfma_f32_16x16x32_bf16 v[56:59], v[104:107], v[76:79], v[56:59]
v_mfma_f32_16x16x32_bf16 v[60:63], v[108:111], v[76:79], v[60:63]
s_waitcnt lgkmcnt(9)
v_mfma_f32_16x16x32_bf16 v[0:3], v[112:115], v[80:83], v[0:3]
s_waitcnt lgkmcnt(7)
v_mfma_f32_16x16x32_bf16 v[4:7], v[116:119], v[80:83], v[4:7]
s_waitcnt lgkmcnt(5)
v_mfma_f32_16x16x32_bf16 v[8:11], v[120:123], v[80:83], v[8:11]
s_waitcnt lgkmcnt(3)
v_mfma_f32_16x16x32_bf16 v[12:15], v[124:127], v[80:83], v[12:15]
s_waitcnt lgkmcnt(2)
v_mfma_f32_16x16x32_bf16 v[16:19], v[112:115], v[84:87], v[16:19]
s_waitcnt lgkmcnt(0)
s_barrier
ds_read_b64_tr_b16 v[96:97], v130 offset:0
ds_read_b64_tr_b16 v[98:99], v130 offset:1024
v_mfma_f32_16x16x32_bf16 v[20:23], v[116:119], v[84:87], v[20:23]
ds_read_b128 v[64:67], v128 offset:0
ds_read_b64_tr_b16 v[100:101], v131 offset:0
v_mfma_f32_16x16x32_bf16 v[24:27], v[120:123], v[84:87], v[24:27]
ds_read_b64_tr_b16 v[102:103], v131 offset:1024
ds_read_b64_tr_b16 v[104:105], v132 offset:0
v_mfma_f32_16x16x32_bf16 v[28:31], v[124:127], v[84:87], v[28:31]
ds_read_b64_tr_b16 v[106:107], v132 offset:1024
ds_read_b64_tr_b16 v[108:109], v133 offset:0
v_mfma_f32_16x16x32_bf16 v[32:35], v[112:115], v[88:91], v[32:35]
ds_read_b64_tr_b16 v[110:111], v133 offset:1024
ds_read_b128 v[68:71], v128 offset:2048
v_mfma_f32_16x16x32_bf16 v[36:39], v[116:119], v[88:91], v[36:39]
ds_read_b128 v[72:75], v128 offset:4096
ds_read_b128 v[76:79], v128 offset:6144
v_mfma_f32_16x16x32_bf16 v[40:43], v[120:123], v[88:91], v[40:43]
v_mfma_f32_16x16x32_bf16 v[44:47], v[124:127], v[88:91], v[44:47]
v_mfma_f32_16x16x32_bf16 v[48:51], v[112:115], v[92:95], v[48:51]
v_mfma_f32_16x16x32_bf16 v[52:55], v[116:119], v[92:95], v[52:55]
v_mfma_f32_16x16x32_bf16 v[56:59], v[120:123], v[92:95], v[56:59]
v_mfma_f32_16x16x32_bf16 v[60:63], v[124:127], v[92:95], v[60:63]
s_waitcnt lgkmcnt(9)
v_mfma_f32_16x16x32_bf16 v[0:3], v[96:99], v[64:67], v[0:3]
ds_read_b64_tr_b16 v[112:113], v130 offset:8192
ds_read_b64_tr_b16 v[114:115], v130 offset:9216
s_waitcnt lgkmcnt(9)
v_mfma_f32_16x16x32_bf16 v[4:7], v[100:103], v[64:67], v[4:7]
ds_read_b128 v[80:83], v129 offset:0
ds_read_b64_tr_b16 v[116:117], v131 offset:8192
s_waitcnt lgkmcnt(9)
v_mfma_f32_16x16x32_bf16 v[8:11], v[104:107], v[64:67], v[8:11]
ds_read_b64_tr_b16 v[118:119], v131 offset:9216
ds_read_b64_tr_b16 v[120:121], v132 offset:8192
s_waitcnt lgkmcnt(9)
v_mfma_f32_16x16x32_bf16 v[12:15], v[108:111], v[64:67], v[12:15]
ds_read_b64_tr_b16 v[122:123], v132 offset:9216
ds_read_b64_tr_b16 v[124:125], v133 offset:8192
s_waitcnt lgkmcnt(10)
v_mfma_f32_16x16x32_bf16 v[16:19], v[96:99], v[68:71], v[16:19]
ds_read_b64_tr_b16 v[126:127], v133 offset:9216
ds_read_b128 v[84:87], v129 offset:2048
v_mfma_f32_16x16x32_bf16 v[20:23], v[100:103], v[68:71], v[20:23]
ds_read_b128 v[88:91], v129 offset:4096
ds_read_b128 v[92:95], v129 offset:6144
v_mfma_f32_16x16x32_bf16 v[24:27], v[104:107], v[68:71], v[24:27]
s_add_u32 s30, s30, 1
s_cmp_eq_u32 s30, 4
v_mfma_f32_16x16x32_bf16 v[28:31], v[108:111], v[68:71], v[28:31]
s_cselect_b32 s30, 0, s30
s_mov_b32 s38, 32768
s_waitcnt lgkmcnt(13)
v_mfma_f32_16x16x32_bf16 v[32:35], v[96:99], v[72:75], v[32:35]
s_cmov_b32 s38, 4294868992
s_add_u32 s29, s29, 1
v_mfma_f32_16x16x32_bf16 v[36:39], v[100:103], v[72:75], v[36:39]
v_add_u32 v128, s38, v128
v_add_u32 v129, s38, v129
v_mfma_f32_16x16x32_bf16 v[40:43], v[104:107], v[72:75], v[40:43]
v_add_u32 v130, s38, v130
v_add_u32 v131, s38, v131
v_mfma_f32_16x16x32_bf16 v[44:47], v[108:111], v[72:75], v[44:47]
v_add_u32 v132, s38, v132
v_add_u32 v133, s38, v133
s_waitcnt lgkmcnt(12)
v_mfma_f32_16x16x32_bf16 v[48:51], v[96:99], v[76:79], v[48:51]
v_mfma_f32_16x16x32_bf16 v[52:55], v[100:103], v[76:79], v[52:55]
v_mfma_f32_16x16x32_bf16 v[56:59], v[104:107], v[76:79], v[56:59]
v_mfma_f32_16x16x32_bf16 v[60:63], v[108:111], v[76:79], v[60:63]
s_waitcnt lgkmcnt(9)
v_mfma_f32_16x16x32_bf16 v[0:3], v[112:115], v[80:83], v[0:3]
s_waitcnt lgkmcnt(7)
v_mfma_f32_16x16x32_bf16 v[4:7], v[116:119], v[80:83], v[4:7]
s_waitcnt lgkmcnt(5)
v_mfma_f32_16x16x32_bf16 v[8:11], v[120:123], v[80:83], v[8:11]
s_waitcnt lgkmcnt(3)
v_mfma_f32_16x16x32_bf16 v[12:15], v[124:127], v[80:83], v[12:15]
s_waitcnt lgkmcnt(2)
v_mfma_f32_16x16x32_bf16 v[16:19], v[112:115], v[84:87], v[16:19]
s_waitcnt lgkmcnt(0)
s_barrier
v_mfma_f32_16x16x32_bf16 v[20:23], v[116:119], v[84:87], v[20:23]
v_mfma_f32_16x16x32_bf16 v[24:27], v[120:123], v[84:87], v[24:27]
v_mfma_f32_16x16x32_bf16 v[28:31], v[124:127], v[84:87], v[28:31]
v_mfma_f32_16x16x32_bf16 v[32:35], v[112:115], v[88:91], v[32:35]
v_mfma_f32_16x16x32_bf16 v[36:39], v[116:119], v[88:91], v[36:39]
v_mfma_f32_16x16x32_bf16 v[40:43], v[120:123], v[88:91], v[40:43]
v_mfma_f32_16x16x32_bf16 v[44:47], v[124:127], v[88:91], v[44:47]
v_mfma_f32_16x16x32_bf16 v[48:51], v[112:115], v[92:95], v[48:51]
v_mfma_f32_16x16x32_bf16 v[52:55], v[116:119], v[92:95], v[52:55]
v_mfma_f32_16x16x32_bf16 v[56:59], v[120:123], v[92:95], v[56:59]
v_mfma_f32_16x16x32_bf16 v[60:63], v[124:127], v[92:95], v[60:63]
s_mov_b32 s92, 36
s_mov_b32 s93, 0
s_mov_b32 s29, 1
ds_read_b64_tr_b16 v[96:97], v130 offset:0
ds_read_b64_tr_b16 v[98:99], v130 offset:1024
ds_read_b128 v[64:67], v128 offset:0
ds_read_b64_tr_b16 v[100:101], v131 offset:0
ds_read_b64_tr_b16 v[102:103], v131 offset:1024
ds_read_b64_tr_b16 v[104:105], v132 offset:0
ds_read_b64_tr_b16 v[106:107], v132 offset:1024
ds_read_b64_tr_b16 v[108:109], v133 offset:0
ds_read_b64_tr_b16 v[110:111], v133 offset:1024
ds_read_b128 v[68:71], v128 offset:2048
.p2align 6
L_s6z_mm_88:
s_bitcmp1_b64 s[92:93], s29
s_cbranch_scc1 L_s6z_H_89
L_s6z_B_90:
s_waitcnt lgkmcnt(7)
v_mfma_f32_16x16x32_bf16 v[0:3], v[96:99], v[64:67], v[0:3]
ds_read_b64_tr_b16 v[112:113], v130 offset:8192
ds_read_b64_tr_b16 v[114:115], v130 offset:9216
ds_read_b128 v[80:83], v129 offset:0
s_waitcnt lgkmcnt(8)
v_mfma_f32_16x16x32_bf16 v[4:7], v[100:103], v[64:67], v[4:7]
ds_read_b64_tr_b16 v[116:117], v131 offset:8192
ds_read_b64_tr_b16 v[118:119], v131 offset:9216
ds_read_b64_tr_b16 v[120:121], v132 offset:8192
s_waitcnt lgkmcnt(9)
v_mfma_f32_16x16x32_bf16 v[8:11], v[104:107], v[64:67], v[8:11]
ds_read_b64_tr_b16 v[122:123], v132 offset:9216
ds_read_b64_tr_b16 v[124:125], v133 offset:8192
ds_read_b64_tr_b16 v[126:127], v133 offset:9216
s_waitcnt lgkmcnt(10)
v_mfma_f32_16x16x32_bf16 v[12:15], v[108:111], v[64:67], v[12:15]
ds_read_b128 v[84:87], v129 offset:2048
s_add_u32 s30, s30, 1
s_cmp_eq_u32 s30, 4
s_cselect_b32 s30, 0, s30
s_waitcnt lgkmcnt(10)
v_mfma_f32_16x16x32_bf16 v[16:19], v[96:99], v[68:71], v[16:19]
s_mov_b32 s38, 32768
s_cmov_b32 s38, 4294868992
s_add_u32 s29, s29, 1
v_mfma_f32_16x16x32_bf16 v[20:23], v[100:103], v[68:71], v[20:23]
v_add_u32 v128, s38, v128
v_add_u32 v129, s38, v129
v_add_u32 v130, s38, v130
v_mfma_f32_16x16x32_bf16 v[24:27], v[104:107], v[68:71], v[24:27]
v_add_u32 v131, s38, v131
v_add_u32 v132, s38, v132
v_add_u32 v133, s38, v133
v_mfma_f32_16x16x32_bf16 v[28:31], v[108:111], v[68:71], v[28:31]
s_waitcnt lgkmcnt(7)
v_mfma_f32_16x16x32_bf16 v[0:3], v[112:115], v[80:83], v[0:3]
s_waitcnt lgkmcnt(5)
v_mfma_f32_16x16x32_bf16 v[4:7], v[116:119], v[80:83], v[4:7]
s_waitcnt lgkmcnt(3)
v_mfma_f32_16x16x32_bf16 v[8:11], v[120:123], v[80:83], v[8:11]
s_waitcnt lgkmcnt(0)
s_barrier
ds_read_b64_tr_b16 v[96:97], v130 offset:0
ds_read_b64_tr_b16 v[98:99], v130 offset:1024
v_mfma_f32_16x16x32_bf16 v[12:15], v[124:127], v[80:83], v[12:15]
ds_read_b128 v[64:67], v128 offset:0
ds_read_b64_tr_b16 v[100:101], v131 offset:0
v_mfma_f32_16x16x32_bf16 v[16:19], v[112:115], v[84:87], v[16:19]
ds_read_b64_tr_b16 v[102:103], v131 offset:1024
ds_read_b64_tr_b16 v[104:105], v132 offset:0
v_mfma_f32_16x16x32_bf16 v[20:23], v[116:119], v[84:87], v[20:23]
ds_read_b64_tr_b16 v[106:107], v132 offset:1024
ds_read_b64_tr_b16 v[108:109], v133 offset:0
v_mfma_f32_16x16x32_bf16 v[24:27], v[120:123], v[84:87], v[24:27]
ds_read_b64_tr_b16 v[110:111], v133 offset:1024
ds_read_b128 v[68:71], v128 offset:2048
v_mfma_f32_16x16x32_bf16 v[28:31], v[124:127], v[84:87], v[28:31]
s_bitcmp1_b64 s[92:93], s29
s_cbranch_scc1 L_s6z_H_91
L_s6z_B_92:
s_waitcnt lgkmcnt(7)
v_mfma_f32_16x16x32_bf16 v[0:3], v[96:99], v[64:67], v[0:3]
ds_read_b64_tr_b16 v[112:113], v130 offset:8192
ds_read_b64_tr_b16 v[114:115], v130 offset:9216
ds_read_b128 v[80:83], v129 offset:0
s_waitcnt lgkmcnt(8)
v_mfma_f32_16x16x32_bf16 v[4:7], v[100:103], v[64:67], v[4:7]
ds_read_b64_tr_b16 v[116:117], v131 offset:8192
ds_read_b64_tr_b16 v[118:119], v131 offset:9216
ds_read_b64_tr_b16 v[120:121], v132 offset:8192
s_waitcnt lgkmcnt(9)
v_mfma_f32_16x16x32_bf16 v[8:11], v[104:107], v[64:67], v[8:11]
ds_read_b64_tr_b16 v[122:123], v132 offset:9216
ds_read_b64_tr_b16 v[124:125], v133 offset:8192
ds_read_b64_tr_b16 v[126:127], v133 offset:9216
s_waitcnt lgkmcnt(10)
v_mfma_f32_16x16x32_bf16 v[12:15], v[108:111], v[64:67], v[12:15]
ds_read_b128 v[84:87], v129 offset:2048
s_add_u32 s30, s30, 1
s_cmp_eq_u32 s30, 4
s_cselect_b32 s30, 0, s30
s_waitcnt lgkmcnt(10)
v_mfma_f32_16x16x32_bf16 v[16:19], v[96:99], v[68:71], v[16:19]
s_mov_b32 s38, 32768
s_cmov_b32 s38, 4294868992
s_add_u32 s29, s29, 1
v_mfma_f32_16x16x32_bf16 v[20:23], v[100:103], v[68:71], v[20:23]
v_add_u32 v128, s38, v128
v_add_u32 v129, s38, v129
v_add_u32 v130, s38, v130
v_mfma_f32_16x16x32_bf16 v[24:27], v[104:107], v[68:71], v[24:27]
v_add_u32 v131, s38, v131
v_add_u32 v132, s38, v132
v_add_u32 v133, s38, v133
v_mfma_f32_16x16x32_bf16 v[28:31], v[108:111], v[68:71], v[28:31]
s_waitcnt lgkmcnt(7)
v_mfma_f32_16x16x32_bf16 v[0:3], v[112:115], v[80:83], v[0:3]
s_waitcnt lgkmcnt(5)
v_mfma_f32_16x16x32_bf16 v[4:7], v[116:119], v[80:83], v[4:7]
s_waitcnt lgkmcnt(3)
v_mfma_f32_16x16x32_bf16 v[8:11], v[120:123], v[80:83], v[8:11]
s_waitcnt lgkmcnt(0)
s_barrier
ds_read_b64_tr_b16 v[96:97], v130 offset:0
ds_read_b64_tr_b16 v[98:99], v130 offset:1024
v_mfma_f32_16x16x32_bf16 v[12:15], v[124:127], v[80:83], v[12:15]
ds_read_b128 v[64:67], v128 offset:0
ds_read_b64_tr_b16 v[100:101], v131 offset:0
v_mfma_f32_16x16x32_bf16 v[16:19], v[112:115], v[84:87], v[16:19]
ds_read_b64_tr_b16 v[102:103], v131 offset:1024
ds_read_b64_tr_b16 v[104:105], v132 offset:0
v_mfma_f32_16x16x32_bf16 v[20:23], v[116:119], v[84:87], v[20:23]
ds_read_b64_tr_b16 v[106:107], v132 offset:1024
ds_read_b64_tr_b16 v[108:109], v133 offset:0
v_mfma_f32_16x16x32_bf16 v[24:27], v[120:123], v[84:87], v[24:27]
ds_read_b64_tr_b16 v[110:111], v133 offset:1024
ds_read_b128 v[68:71], v128 offset:2048
s_cmp_lt_u32 s29, 11
v_mfma_f32_16x16x32_bf16 v[28:31], v[124:127], v[84:87], v[28:31]
s_cbranch_scc1 L_s6z_mm_88
s_waitcnt lgkmcnt(7)
v_mfma_f32_16x16x32_bf16 v[0:3], v[96:99], v[64:67], v[0:3]
ds_read_b64_tr_b16 v[112:113], v130 offset:8192
ds_read_b64_tr_b16 v[114:115], v130 offset:9216
ds_read_b128 v[80:83], v129 offset:0
s_waitcnt lgkmcnt(8)
v_mfma_f32_16x16x32_bf16 v[4:7], v[100:103], v[64:67], v[4:7]
ds_read_b64_tr_b16 v[116:117], v131 offset:8192
ds_read_b64_tr_b16 v[118:119], v131 offset:9216
ds_read_b64_tr_b16 v[120:121], v132 offset:8192
s_waitcnt lgkmcnt(9)
v_mfma_f32_16x16x32_bf16 v[8:11], v[104:107], v[64:67], v[8:11]
ds_read_b64_tr_b16 v[122:123], v132 offset:9216
ds_read_b64_tr_b16 v[124:125], v133 offset:8192
ds_read_b64_tr_b16 v[126:127], v133 offset:9216
s_waitcnt lgkmcnt(10)
v_mfma_f32_16x16x32_bf16 v[12:15], v[108:111], v[64:67], v[12:15]
ds_read_b128 v[84:87], v129 offset:2048
s_add_u32 s30, s30, 1
s_cmp_eq_u32 s30, 4
s_cselect_b32 s30, 0, s30
s_waitcnt lgkmcnt(10)
v_mfma_f32_16x16x32_bf16 v[16:19], v[96:99], v[68:71], v[16:19]
s_mov_b32 s38, 32768
s_cmov_b32 s38, 4294868992
s_add_u32 s29, s29, 1
v_mfma_f32_16x16x32_bf16 v[20:23], v[100:103], v[68:71], v[20:23]
v_add_u32 v128, s38, v128
v_add_u32 v129, s38, v129
v_add_u32 v130, s38, v130
v_mfma_f32_16x16x32_bf16 v[24:27], v[104:107], v[68:71], v[24:27]
v_add_u32 v131, s38, v131
v_add_u32 v132, s38, v132
v_add_u32 v133, s38, v133
v_mfma_f32_16x16x32_bf16 v[28:31], v[108:111], v[68:71], v[28:31]
s_waitcnt lgkmcnt(7)
v_mfma_f32_16x16x32_bf16 v[0:3], v[112:115], v[80:83], v[0:3]
s_waitcnt lgkmcnt(5)
v_mfma_f32_16x16x32_bf16 v[4:7], v[116:119], v[80:83], v[4:7]
s_waitcnt lgkmcnt(3)
v_mfma_f32_16x16x32_bf16 v[8:11], v[120:123], v[80:83], v[8:11]
s_waitcnt lgkmcnt(0)
s_barrier
ds_read_b64_tr_b16 v[96:97], v130 offset:0
ds_read_b64_tr_b16 v[98:99], v130 offset:1024
v_mfma_f32_16x16x32_bf16 v[12:15], v[124:127], v[80:83], v[12:15]
ds_read_b128 v[64:67], v128 offset:0
ds_read_b64_tr_b16 v[100:101], v131 offset:0
v_mfma_f32_16x16x32_bf16 v[16:19], v[112:115], v[84:87], v[16:19]
ds_read_b64_tr_b16 v[102:103], v131 offset:1024
ds_read_b64_tr_b16 v[104:105], v132 offset:0
v_mfma_f32_16x16x32_bf16 v[20:23], v[116:119], v[84:87], v[20:23]
ds_read_b64_tr_b16 v[106:107], v132 offset:1024
ds_read_b64_tr_b16 v[108:109], v133 offset:0
v_mfma_f32_16x16x32_bf16 v[24:27], v[120:123], v[84:87], v[24:27]
ds_read_b64_tr_b16 v[110:111], v133 offset:1024
ds_read_b128 v[68:71], v128 offset:2048
v_mfma_f32_16x16x32_bf16 v[28:31], v[124:127], v[84:87], v[28:31]
s_waitcnt lgkmcnt(7)
v_mfma_f32_16x16x32_bf16 v[0:3], v[96:99], v[64:67], v[0:3]
ds_read_b64_tr_b16 v[112:113], v130 offset:8192
ds_read_b64_tr_b16 v[114:115], v130 offset:9216
s_waitcnt lgkmcnt(7)
v_mfma_f32_16x16x32_bf16 v[4:7], v[100:103], v[64:67], v[4:7]
ds_read_b128 v[80:83], v129 offset:0
ds_read_b64_tr_b16 v[116:117], v131 offset:8192
s_waitcnt lgkmcnt(7)
v_mfma_f32_16x16x32_bf16 v[8:11], v[104:107], v[64:67], v[8:11]
ds_read_b64_tr_b16 v[118:119], v131 offset:9216
ds_read_b64_tr_b16 v[120:121], v132 offset:8192
s_waitcnt lgkmcnt(7)
v_mfma_f32_16x16x32_bf16 v[12:15], v[108:111], v[64:67], v[12:15]
ds_read_b64_tr_b16 v[122:123], v132 offset:9216
ds_read_b64_tr_b16 v[124:125], v133 offset:8192
s_waitcnt lgkmcnt(8)
v_mfma_f32_16x16x32_bf16 v[16:19], v[96:99], v[68:71], v[16:19]
ds_read_b64_tr_b16 v[126:127], v133 offset:9216
ds_read_b128 v[84:87], v129 offset:2048
v_mfma_f32_16x16x32_bf16 v[20:23], v[100:103], v[68:71], v[20:23]
v_mfma_f32_16x16x32_bf16 v[24:27], v[104:107], v[68:71], v[24:27]
v_mfma_f32_16x16x32_bf16 v[28:31], v[108:111], v[68:71], v[28:31]
s_waitcnt lgkmcnt(7)
v_mfma_f32_16x16x32_bf16 v[0:3], v[112:115], v[80:83], v[0:3]
s_waitcnt lgkmcnt(5)
v_mfma_f32_16x16x32_bf16 v[4:7], v[116:119], v[80:83], v[4:7]
s_waitcnt lgkmcnt(3)
v_mfma_f32_16x16x32_bf16 v[8:11], v[120:123], v[80:83], v[8:11]
s_waitcnt lgkmcnt(1)
v_mfma_f32_16x16x32_bf16 v[12:15], v[124:127], v[80:83], v[12:15]
s_waitcnt lgkmcnt(0)
v_mfma_f32_16x16x32_bf16 v[16:19], v[112:115], v[84:87], v[16:19]
v_mfma_f32_16x16x32_bf16 v[20:23], v[116:119], v[84:87], v[20:23]
v_mfma_f32_16x16x32_bf16 v[24:27], v[120:123], v[84:87], v[24:27]
v_mfma_f32_16x16x32_bf16 v[28:31], v[124:127], v[84:87], v[28:31]
s_barrier
ds_read_b128 v[148:151], v139 offset:0
ds_read_b128 v[152:155], v140 offset:0
ds_read_b128 v[156:159], v139 offset:2048
ds_read_b128 v[160:163], v140 offset:2048
s_waitcnt lgkmcnt(3)
v_permlane16_swap_b32 v148, v150
v_permlane16_swap_b32 v149, v151
s_nop 0
v_lshlrev_b32 v104, 16, v148
v_and_b32 v105, 0xffff0000, v148
v_lshlrev_b32 v106, 16, v149
v_and_b32 v107, 0xffff0000, v149
v_lshlrev_b32 v108, 16, v150
v_and_b32 v109, 0xffff0000, v150
v_lshlrev_b32 v110, 16, v151
v_and_b32 v111, 0xffff0000, v151
v_pk_fma_f32 v[0:1], v[104:105], v[164:165], v[0:1] op_sel_hi:[1,0,1]
v_pk_fma_f32 v[2:3], v[106:107], v[164:165], v[2:3] op_sel_hi:[1,0,1]
v_pk_fma_f32 v[4:5], v[108:109], v[164:165], v[4:5] op_sel_hi:[1,0,1]
v_pk_fma_f32 v[6:7], v[110:111], v[164:165], v[6:7] op_sel_hi:[1,0,1]
s_waitcnt lgkmcnt(2)
v_permlane16_swap_b32 v152, v154
v_permlane16_swap_b32 v153, v155
s_nop 0
v_lshlrev_b32 v104, 16, v152
v_and_b32 v105, 0xffff0000, v152
v_lshlrev_b32 v106, 16, v153
v_and_b32 v107, 0xffff0000, v153
v_lshlrev_b32 v108, 16, v154
v_and_b32 v109, 0xffff0000, v154
v_lshlrev_b32 v110, 16, v155
v_and_b32 v111, 0xffff0000, v155
v_pk_fma_f32 v[8:9], v[104:105], v[164:165], v[8:9] op_sel_hi:[1,0,1]
v_pk_fma_f32 v[10:11], v[106:107], v[164:165], v[10:11] op_sel_hi:[1,0,1]
v_pk_fma_f32 v[12:13], v[108:109], v[164:165], v[12:13] op_sel_hi:[1,0,1]
v_pk_fma_f32 v[14:15], v[110:111], v[164:165], v[14:15] op_sel_hi:[1,0,1]
s_waitcnt lgkmcnt(1)
v_permlane16_swap_b32 v156, v158
v_permlane16_swap_b32 v157, v159
s_nop 0
v_lshlrev_b32 v104, 16, v156
v_and_b32 v105, 0xffff0000, v156
v_lshlrev_b32 v106, 16, v157
v_and_b32 v107, 0xffff0000, v157
v_lshlrev_b32 v108, 16, v158
v_and_b32 v109, 0xffff0000, v158
v_lshlrev_b32 v110, 16, v159
v_and_b32 v111, 0xffff0000, v159
v_pk_fma_f32 v[16:17], v[104:105], v[166:167], v[16:17] op_sel_hi:[1,0,1]
v_pk_fma_f32 v[18:19], v[106:107], v[166:167], v[18:19] op_sel_hi:[1,0,1]
v_pk_fma_f32 v[20:21], v[108:109], v[166:167], v[20:21] op_sel_hi:[1,0,1]
v_pk_fma_f32 v[22:23], v[110:111], v[166:167], v[22:23] op_sel_hi:[1,0,1]
s_waitcnt lgkmcnt(0)
v_permlane16_swap_b32 v160, v162
v_permlane16_swap_b32 v161, v163
s_nop 0
v_lshlrev_b32 v104, 16, v160
v_and_b32 v105, 0xffff0000, v160
v_lshlrev_b32 v106, 16, v161
v_and_b32 v107, 0xffff0000, v161
v_lshlrev_b32 v108, 16, v162
v_and_b32 v109, 0xffff0000, v162
v_lshlrev_b32 v110, 16, v163
v_and_b32 v111, 0xffff0000, v163
v_pk_fma_f32 v[24:25], v[104:105], v[166:167], v[24:25] op_sel_hi:[1,0,1]
v_pk_fma_f32 v[26:27], v[106:107], v[166:167], v[26:27] op_sel_hi:[1,0,1]
v_pk_fma_f32 v[28:29], v[108:109], v[166:167], v[28:29] op_sel_hi:[1,0,1]
v_pk_fma_f32 v[30:31], v[110:111], v[166:167], v[30:31] op_sel_hi:[1,0,1]
s_barrier
ds_read_b128 v[64:67], v136 offset:0
ds_read_b128 v[68:71], v136 offset:1024
ds_read_b128 v[72:75], v136 offset:2048
ds_read_b128 v[76:79], v136 offset:3072
s_waitcnt lgkmcnt(3)
v_lshlrev_b32 v104, 16, v64
v_and_b32 v105, 0xffff0000, v64
v_lshlrev_b32 v106, 16, v65
v_and_b32 v107, 0xffff0000, v65
v_lshlrev_b32 v108, 16, v66
v_and_b32 v109, 0xffff0000, v66
v_lshlrev_b32 v110, 16, v67
v_and_b32 v111, 0xffff0000, v67
v_pk_add_f32 v[0:1], v[0:1], v[104:105]
v_pk_add_f32 v[2:3], v[2:3], v[106:107]
v_pk_add_f32 v[4:5], v[4:5], v[108:109]
v_pk_add_f32 v[6:7], v[6:7], v[110:111]
v_cvt_pk_bf16_f32 v96, v0, v1
v_cvt_pk_bf16_f32 v97, v2, v3
v_cvt_pk_bf16_f32 v98, v4, v5
v_cvt_pk_bf16_f32 v99, v6, v7
s_mov_b32 s34, 0
s_nop 0
v_permlane16_swap_b32 v96, v98
v_permlane16_swap_b32 v97, v99
buffer_store_dwordx4 v[96:99], v134, s[52:55], s34 offen offset:0 sc0 sc1
s_waitcnt lgkmcnt(2)
v_lshlrev_b32 v104, 16, v68
v_and_b32 v105, 0xffff0000, v68
v_lshlrev_b32 v106, 16, v69
v_and_b32 v107, 0xffff0000, v69
v_lshlrev_b32 v108, 16, v70
v_and_b32 v109, 0xffff0000, v70
v_lshlrev_b32 v110, 16, v71
v_and_b32 v111, 0xffff0000, v71
v_pk_add_f32 v[8:9], v[8:9], v[104:105]
v_pk_add_f32 v[10:11], v[10:11], v[106:107]
v_pk_add_f32 v[12:13], v[12:13], v[108:109]
v_pk_add_f32 v[14:15], v[14:15], v[110:111]
v_cvt_pk_bf16_f32 v100, v8, v9
v_cvt_pk_bf16_f32 v101, v10, v11
v_cvt_pk_bf16_f32 v102, v12, v13
v_cvt_pk_bf16_f32 v103, v14, v15
s_mov_b32 s34, 0
s_nop 0
v_permlane16_swap_b32 v100, v102
v_permlane16_swap_b32 v101, v103
buffer_store_dwordx4 v[100:103], v134, s[52:55], s34 offen offset:64 sc0 sc1
s_waitcnt lgkmcnt(1)
v_lshlrev_b32 v104, 16, v72
v_and_b32 v105, 0xffff0000, v72
v_lshlrev_b32 v106, 16, v73
v_and_b32 v107, 0xffff0000, v73
v_lshlrev_b32 v108, 16, v74
v_and_b32 v109, 0xffff0000, v74
v_lshlrev_b32 v110, 16, v75
v_and_b32 v111, 0xffff0000, v75
v_pk_add_f32 v[16:17], v[16:17], v[104:105]
v_pk_add_f32 v[18:19], v[18:19], v[106:107]
v_pk_add_f32 v[20:21], v[20:21], v[108:109]
v_pk_add_f32 v[22:23], v[22:23], v[110:111]
v_cvt_pk_bf16_f32 v96, v16, v17
v_cvt_pk_bf16_f32 v97, v18, v19
v_cvt_pk_bf16_f32 v98, v20, v21
v_cvt_pk_bf16_f32 v99, v22, v23
s_mov_b32 s34, 32768
s_nop 0
v_permlane16_swap_b32 v96, v98
v_permlane16_swap_b32 v97, v99
buffer_store_dwordx4 v[96:99], v134, s[52:55], s34 offen offset:0 sc0 sc1
s_waitcnt lgkmcnt(0)
v_lshlrev_b32 v104, 16, v76
v_and_b32 v105, 0xffff0000, v76
v_lshlrev_b32 v106, 16, v77
v_and_b32 v107, 0xffff0000, v77
v_lshlrev_b32 v108, 16, v78
v_and_b32 v109, 0xffff0000, v78
v_lshlrev_b32 v110, 16, v79
v_and_b32 v111, 0xffff0000, v79
v_pk_add_f32 v[24:25], v[24:25], v[104:105]
v_pk_add_f32 v[26:27], v[26:27], v[106:107]
v_pk_add_f32 v[28:29], v[28:29], v[108:109]
v_pk_add_f32 v[30:31], v[30:31], v[110:111]
v_cvt_pk_bf16_f32 v100, v24, v25
v_cvt_pk_bf16_f32 v101, v26, v27
v_cvt_pk_bf16_f32 v102, v28, v29
v_cvt_pk_bf16_f32 v103, v30, v31
s_mov_b32 s34, 32768
s_nop 0
v_permlane16_swap_b32 v100, v102
v_permlane16_swap_b32 v101, v103
buffer_store_dwordx4 v[100:103], v134, s[52:55], s34 offen offset:64 sc0 sc1
L_s6_ef_95:
s_endpgm
L_h_H_10:
s_cmp_lg_u32 s29, 3
s_cbranch_scc1 L_h_hs_18
s_waitcnt vmcnt(0)
L_h_hs_18:
s_cmp_lg_u32 s29, s97
s_cbranch_scc1 L_h_hs_19
s_lshr_b32 s31, s20, 1
s_lshl_b32 s31, s31, 13
s_lshl_b32 s32, s30, 15
s_add_u32 s31, s31, s32
v_add_u32 v138, s31, v138
v_xor_b32 v139, 64, v138
ds_read_b128 v[164:167], v138 offset:0
ds_read_b128 v[168:171], v139 offset:0
ds_read_b128 v[172:175], v138 offset:2048
ds_read_b128 v[176:179], v139 offset:2048
ds_read_b128 v[180:183], v138 offset:4096
ds_read_b128 v[184:187], v139 offset:4096
ds_read_b128 v[188:191], v138 offset:6144
ds_read_b128 v[192:195], v139 offset:6144
L_h_hs_19:
s_branch L_h_B_11
L_h_H_12:
s_cmp_lg_u32 s29, s97
s_cbranch_scc1 L_h_hs_20
s_lshr_b32 s31, s20, 1
s_lshl_b32 s31, s31, 13
s_lshl_b32 s32, s30, 15
s_add_u32 s31, s31, s32
v_add_u32 v138, s31, v138
v_xor_b32 v139, 64, v138
ds_read_b128 v[164:167], v138 offset:0
ds_read_b128 v[168:171], v139 offset:0
ds_read_b128 v[172:175], v138 offset:2048
ds_read_b128 v[176:179], v139 offset:2048
ds_read_b128 v[180:183], v138 offset:4096
ds_read_b128 v[184:187], v139 offset:4096
ds_read_b128 v[188:191], v138 offset:6144
ds_read_b128 v[192:195], v139 offset:6144
L_h_hs_20:
s_branch L_h_B_13
L_h_H_14:
s_cmp_lg_u32 s29, s97
s_cbranch_scc1 L_h_hs_21
s_lshr_b32 s31, s20, 1
s_lshl_b32 s31, s31, 13
s_lshl_b32 s32, s30, 15
s_add_u32 s31, s31, s32
v_add_u32 v138, s31, v138
v_xor_b32 v139, 64, v138
ds_read_b128 v[164:167], v138 offset:0
ds_read_b128 v[168:171], v139 offset:0
ds_read_b128 v[172:175], v138 offset:2048
ds_read_b128 v[176:179], v139 offset:2048
ds_read_b128 v[180:183], v138 offset:4096
ds_read_b128 v[184:187], v139 offset:4096
ds_read_b128 v[188:191], v138 offset:6144
ds_read_b128 v[192:195], v139 offset:6144
L_h_hs_21:
s_branch L_h_B_15
L_h_H_16:
s_cmp_lg_u32 s29, s97
s_cbranch_scc1 L_h_hs_22
s_lshr_b32 s31, s20, 1
s_lshl_b32 s31, s31, 13
s_lshl_b32 s32, s30, 15
s_add_u32 s31, s31, s32
v_add_u32 v138, s31, v138
v_xor_b32 v139, 64, v138
ds_read_b128 v[164:167], v138 offset:0
ds_read_b128 v[168:171], v139 offset:0
ds_read_b128 v[172:175], v138 offset:2048
ds_read_b128 v[176:179], v139 offset:2048
ds_read_b128 v[180:183], v138 offset:4096
ds_read_b128 v[184:187], v139 offset:4096
ds_read_b128 v[188:191], v138 offset:6144
ds_read_b128 v[192:195], v139 offset:6144
L_h_hs_22:
s_branch L_h_B_17
L_x1_H_25:
s_cmp_lg_u32 s29, 6
s_cbranch_scc1 L_x1_hs_27
s_lshr_b32 s60, s2, 1
s_lshl_b32 s60, s60, 2
s_add_u32 s60, s60, s20
s_lshl_b32 s60, s60, 1
s_add_u32 s60, s60, 0
s_mul_i32 s61, s60, 1171
s_lshr_b32 s61, s61, 16
s_mul_i32 s62, s61, 56
s_sub_u32 s62, s60, s62
s_mul_i32 s63, s61, 14336
s_lshl_b32 s32, s62, 8
s_add_u32 s63, s63, s32
s_add_u32 s63, s63, 36962304
s_lshl_b32 s61, s61, 6
s_lshl_b32 s62, s62, 7
s_cmp_ge_u32 s60, 896
s_cbranch_scc1 L_h_nocs2_28
s_lshl_b32 s60, s60, 4
s_add_u32 s60, s60, 38895616
s_waitcnt vmcnt(0)
v_mov_b32 v136, 1
v_lshlrev_b32 v137, 4, v254
s_mov_b64 exec, 3
buffer_store_dword v136, v137, s[16:19], s60 offen sc0 sc1
s_mov_b64 exec, -1
L_h_nocs2_28:
L_x1_hs_27:
s_branch L_x1_B_26
L_kv_H_31:
s_cmp_lg_u32 s29, 3
s_cbranch_scc1 L_kv_hs_39
s_waitcnt vmcnt(0)
L_kv_hs_39:
s_cmp_lg_u32 s29, s49
s_cbranch_scc1 L_kv_hs_40
v_lshlrev_b32 v238, 7, v254
s_mov_b32 s44, s74
s_mov_b32 s45, s75
s_mov_b32 s46, 2097152
s_mov_b32 s47, 0x20000
s_lshr_b32 s48, s2, 1
s_lshl_b32 s48, s48, 2
s_add_u32 s48, s48, s20
s_add_u32 s48, s48, 256
s_and_b32 s48, s48, 511
s_lshl_b32 s48, s48, 13
s_add_u32 s48, s48, 0
buffer_load_dword v255, v238, s[44:47], s48 offen
L_kv_hs_40:
s_cmp_lg_u32 s29, s96
s_cbranch_scc1 L_kv_hs_41
v_lshlrev_b32 v238, 7, v254
s_mov_b32 s44, s68
s_mov_b32 s45, s69
s_mov_b32 s46, 2097152
s_mov_b32 s47, 0x20000
s_lshr_b32 s48, s2, 1
s_lshl_b32 s48, s48, 2
s_add_u32 s48, s48, s20
s_add_u32 s48, s48, 128
s_and_b32 s48, s48, 511
s_lshl_b32 s48, s48, 13
s_add_u32 s48, s48, 0
buffer_load_dword v255, v238, s[44:47], s48 offen
s_mov_b32 s44, s78
s_mov_b32 s45, s79
s_mov_b32 s46, 7340032
s_mov_b32 s47, 0x20000
s_lshr_b32 s48, s2, 1
s_lshl_b32 s48, s48, 2
s_add_u32 s48, s48, s20
s_add_u32 s48, s48, 0
s_and_b32 s48, s48, 511
s_lshl_b32 s48, s48, 13
s_add_u32 s48, s48, 0
buffer_load_dword v255, v238, s[44:47], s48 offen
s_add_u32 s48, s48, 4194304
buffer_load_dword v255, v238, s[44:47], s48 offen
L_kv_hs_41:
s_branch L_kv_B_32
L_kv_H_33:
s_cmp_lg_u32 s29, s49
s_cbranch_scc1 L_kv_hs_42
v_lshlrev_b32 v238, 7, v254
s_mov_b32 s44, s74
s_mov_b32 s45, s75
s_mov_b32 s46, 2097152
s_mov_b32 s47, 0x20000
s_lshr_b32 s48, s2, 1
s_lshl_b32 s48, s48, 2
s_add_u32 s48, s48, s20
s_add_u32 s48, s48, 256
s_and_b32 s48, s48, 511
s_lshl_b32 s48, s48, 13
s_add_u32 s48, s48, 0
buffer_load_dword v255, v238, s[44:47], s48 offen
L_kv_hs_42:
s_cmp_lg_u32 s29, s96
s_cbranch_scc1 L_kv_hs_43
v_lshlrev_b32 v238, 7, v254
s_mov_b32 s44, s68
s_mov_b32 s45, s69
s_mov_b32 s46, 2097152
s_mov_b32 s47, 0x20000
s_lshr_b32 s48, s2, 1
s_lshl_b32 s48, s48, 2
s_add_u32 s48, s48, s20
s_add_u32 s48, s48, 128
s_and_b32 s48, s48, 511
s_lshl_b32 s48, s48, 13
s_add_u32 s48, s48, 0
buffer_load_dword v255, v238, s[44:47], s48 offen
s_mov_b32 s44, s78
s_mov_b32 s45, s79
s_mov_b32 s46, 7340032
s_mov_b32 s47, 0x20000
s_lshr_b32 s48, s2, 1
s_lshl_b32 s48, s48, 2
s_add_u32 s48, s48, s20
s_add_u32 s48, s48, 0
s_and_b32 s48, s48, 511
s_lshl_b32 s48, s48, 13
s_add_u32 s48, s48, 0
buffer_load_dword v255, v238, s[44:47], s48 offen
s_add_u32 s48, s48, 4194304
buffer_load_dword v255, v238, s[44:47], s48 offen
L_kv_hs_43:
s_branch L_kv_B_34
L_kv_H_35:
s_cmp_lg_u32 s29, s49
s_cbranch_scc1 L_kv_hs_44
v_lshlrev_b32 v238, 7, v254
s_mov_b32 s44, s74
s_mov_b32 s45, s75
s_mov_b32 s46, 2097152
s_mov_b32 s47, 0x20000
s_lshr_b32 s48, s2, 1
s_lshl_b32 s48, s48, 2
s_add_u32 s48, s48, s20
s_add_u32 s48, s48, 256
s_and_b32 s48, s48, 511
s_lshl_b32 s48, s48, 13
s_add_u32 s48, s48, 0
buffer_load_dword v255, v238, s[44:47], s48 offen
L_kv_hs_44:
s_cmp_lg_u32 s29, s96
s_cbranch_scc1 L_kv_hs_45
v_lshlrev_b32 v238, 7, v254
s_mov_b32 s44, s68
s_mov_b32 s45, s69
s_mov_b32 s46, 2097152
s_mov_b32 s47, 0x20000
s_lshr_b32 s48, s2, 1
s_lshl_b32 s48, s48, 2
s_add_u32 s48, s48, s20
s_add_u32 s48, s48, 128
s_and_b32 s48, s48, 511
s_lshl_b32 s48, s48, 13
s_add_u32 s48, s48, 0
buffer_load_dword v255, v238, s[44:47], s48 offen
s_mov_b32 s44, s78
s_mov_b32 s45, s79
s_mov_b32 s46, 7340032
s_mov_b32 s47, 0x20000
s_lshr_b32 s48, s2, 1
s_lshl_b32 s48, s48, 2
s_add_u32 s48, s48, s20
s_add_u32 s48, s48, 0
s_and_b32 s48, s48, 511
s_lshl_b32 s48, s48, 13
s_add_u32 s48, s48, 0
buffer_load_dword v255, v238, s[44:47], s48 offen
s_add_u32 s48, s48, 4194304
buffer_load_dword v255, v238, s[44:47], s48 offen
L_kv_hs_45:
s_branch L_kv_B_36
L_kv_H_37:
s_cmp_lg_u32 s29, s49
s_cbranch_scc1 L_kv_hs_46
v_lshlrev_b32 v238, 7, v254
s_mov_b32 s44, s74
s_mov_b32 s45, s75
s_mov_b32 s46, 2097152
s_mov_b32 s47, 0x20000
s_lshr_b32 s48, s2, 1
s_lshl_b32 s48, s48, 2
s_add_u32 s48, s48, s20
s_add_u32 s48, s48, 256
s_and_b32 s48, s48, 511
s_lshl_b32 s48, s48, 13
s_add_u32 s48, s48, 0
buffer_load_dword v255, v238, s[44:47], s48 offen
L_kv_hs_46:
s_cmp_lg_u32 s29, s96
s_cbranch_scc1 L_kv_hs_47
v_lshlrev_b32 v238, 7, v254
s_mov_b32 s44, s68
s_mov_b32 s45, s69
s_mov_b32 s46, 2097152
s_mov_b32 s47, 0x20000
s_lshr_b32 s48, s2, 1
s_lshl_b32 s48, s48, 2
s_add_u32 s48, s48, s20
s_add_u32 s48, s48, 128
s_and_b32 s48, s48, 511
s_lshl_b32 s48, s48, 13
s_add_u32 s48, s48, 0
buffer_load_dword v255, v238, s[44:47], s48 offen
s_mov_b32 s44, s78
s_mov_b32 s45, s79
s_mov_b32 s46, 7340032
s_mov_b32 s47, 0x20000
s_lshr_b32 s48, s2, 1
s_lshl_b32 s48, s48, 2
s_add_u32 s48, s48, s20
s_add_u32 s48, s48, 0
s_and_b32 s48, s48, 511
s_lshl_b32 s48, s48, 13
s_add_u32 s48, s48, 0
buffer_load_dword v255, v238, s[44:47], s48 offen
s_add_u32 s48, s48, 4194304
buffer_load_dword v255, v238, s[44:47], s48 offen
L_kv_hs_47:
s_branch L_kv_B_38
L_q_H_52:
s_cmp_lg_u32 s29, 3
s_cbranch_scc1 L_q_hs_58
s_waitcnt vmcnt(0)
v_mov_b32 v139, 1
v_mov_b32 v140, 0
s_mov_b64 exec, 1
buffer_store_dword v139, v140, s[16:19], s63 offen sc0 sc1
s_mov_b64 exec, -1
L_q_hs_58:
s_cmp_lg_u32 s29, 7
s_cbranch_scc1 L_q_hs_59
s_lshr_b32 s62, s2, 3
s_bfe_u32 s61, s2, 0x20001
s_lshl_b32 s61, s61, 1
s_cmp_lt_u32 s20, 2
s_cbranch_scc1 L_q_who_61
s_cmp_lg_u32 s20, 3
s_cbranch_scc1 L_q_ri_60
s_cmp_lg_u32 s61, 0
s_cbranch_scc1 L_q_ri_60
s_sub_u32 s61, s61, 3
L_q_who_61:
s_add_u32 s61, s61, s20
s_lshl_b32 s31, s62, 8
s_add_u32 s31, s31, 38879232
v_and_b32 v137, 15, v254
v_lshlrev_b32 v137, 4, v137
buffer_load_dword v138, v137, s[16:19], s31 offen sc0 sc1
L_q_ri_60:
L_q_hs_59:
s_cmp_lg_u32 s29, 9
s_cbranch_scc1 L_q_hs_62
s_lshr_b32 s62, s2, 3
s_bfe_u32 s61, s2, 0x20001
s_lshl_b32 s61, s61, 1
s_cmp_lt_u32 s20, 2
s_cbranch_scc1 L_q_who_64
s_cmp_lg_u32 s20, 3
s_cbranch_scc1 L_q_rl_63
s_cmp_lg_u32 s61, 0
s_cbranch_scc1 L_q_rl_63
s_sub_u32 s61, s61, 3
L_q_who_64:
s_add_u32 s61, s61, s20
s_lshl_b32 s31, s62, 8
s_add_u32 s31, s31, 38879232
s_waitcnt vmcnt(0)
v_cmp_eq_u32 vcc, 0, v138
s_cmp_eq_u64 vcc, 0
s_cbranch_scc1 L_nbok_65
s_mov_b32 s50, 0
L_poll_66:
buffer_load_dword v138, v137, s[16:19], s31 offen sc0 sc1
s_waitcnt vmcnt(0)
v_cmp_eq_u32 vcc, 0, v138
s_cmp_eq_u64 vcc, 0
s_cbranch_scc1 L_pollx_67
s_sleep 4
s_add_u32 s50, s50, 1
s_cmp_lt_u32 s50, 100000
s_cbranch_scc1 L_poll_66
L_pollx_67:
L_nbok_65:
v_bfe_u32 v135, v254, 2, 2
s_lshl_b32 s31, s61, 2
v_add_u32 v135, s31, v135
v_and_b32 v136, 3, v254
v_lshlrev_b32 v137, 7, v135
s_cmp_eq_u32 s20, 3
s_cbranch_scc0 L_q_rlz_68
v_mov_b32 v137, 4096
L_q_rlz_68:
v_lshl_add_u32 v137, v136, 4, v137
v_lshrrev_b32 v139, 4, v254
v_mul_u32_u24 v139, 17408, v139
v_add_u32 v137, v137, v139
s_mul_i32 s31, s62, 69632
s_add_u32 s31, s31, 50331648
buffer_load_dwordx4 v[152:155], v137, s[16:19], s31 offen offset:0
buffer_load_dwordx4 v[156:159], v137, s[16:19], s31 offen offset:64
s_add_u32 s31, s31, 4352
buffer_load_dwordx4 v[160:163], v137, s[16:19], s31 offen offset:0
buffer_load_dwordx4 v[164:167], v137, s[16:19], s31 offen offset:64
s_add_u32 s31, s31, 4352
buffer_load_dwordx4 v[168:171], v137, s[16:19], s31 offen offset:0
buffer_load_dwordx4 v[172:175], v137, s[16:19], s31 offen offset:64
s_add_u32 s31, s31, 4352
buffer_load_dwordx4 v[176:179], v137, s[16:19], s31 offen offset:0
buffer_load_dwordx4 v[180:183], v137, s[16:19], s31 offen offset:64
s_add_u32 s31, s31, 4352
L_q_rl_63:
L_q_hs_62:
s_branch L_q_B_53
L_q_H_54:
s_cmp_lg_u32 s29, 12
s_cbranch_scc1 L_q_hs_69
s_lshr_b32 s62, s2, 3
s_bfe_u32 s61, s2, 0x20001
s_lshl_b32 s61, s61, 1
s_cmp_lt_u32 s20, 2
s_cbranch_scc1 L_q_who_71
s_cmp_lg_u32 s20, 3
s_cbranch_scc1 L_q_rf_70
s_cmp_lg_u32 s61, 0
s_cbranch_scc1 L_q_rf_70
s_sub_u32 s61, s61, 3
L_q_who_71:
s_add_u32 s61, s61, s20
s_waitcnt vmcnt(0)
v_pk_add_f32 v[152:153], v[152:153], v[160:161]
v_pk_add_f32 v[154:155], v[154:155], v[162:163]
v_pk_add_f32 v[156:157], v[156:157], v[164:165]
v_pk_add_f32 v[158:159], v[158:159], v[166:167]
v_pk_add_f32 v[152:153], v[152:153], v[168:169]
v_pk_add_f32 v[154:155], v[154:155], v[170:171]
v_pk_add_f32 v[156:157], v[156:157], v[172:173]
v_pk_add_f32 v[158:159], v[158:159], v[174:175]
v_pk_add_f32 v[152:153], v[152:153], v[176:177]
v_pk_add_f32 v[154:155], v[154:155], v[178:179]
v_pk_add_f32 v[156:157], v[156:157], v[180:181]
v_pk_add_f32 v[158:159], v[158:159], v[182:183]
v_mov_b32 v160, v152
v_mov_b32 v161, v153
v_mov_b32 v162, v154
v_mov_b32 v163, v155
v_mov_b32 v164, v156
v_mov_b32 v165, v157
v_mov_b32 v166, v158
v_mov_b32 v167, v159
v_permlane16_swap_b32 v152, v160
v_permlane16_swap_b32 v153, v161
v_permlane16_swap_b32 v154, v162
v_permlane16_swap_b32 v155, v163
v_permlane16_swap_b32 v156, v164
v_permlane16_swap_b32 v157, v165
v_permlane16_swap_b32 v158, v166
v_permlane16_swap_b32 v159, v167
v_add_f32 v152, v152, v160
v_add_f32 v153, v153, v161
v_add_f32 v154, v154, v162
v_add_f32 v155, v155, v163
v_add_f32 v156, v156, v164
v_add_f32 v157, v157, v165
v_add_f32 v158, v158, v166
v_add_f32 v159, v159, v167
v_mov_b32 v160, v152
v_mov_b32 v161, v153
v_mov_b32 v162, v154
v_mov_b32 v163, v155
v_mov_b32 v164, v156
v_mov_b32 v165, v157
v_mov_b32 v166, v158
v_mov_b32 v167, v159
v_permlane32_swap_b32 v152, v160
v_permlane32_swap_b32 v153, v161
v_permlane32_swap_b32 v154, v162
v_permlane32_swap_b32 v155, v163
v_permlane32_swap_b32 v156, v164
v_permlane32_swap_b32 v157, v165
v_permlane32_swap_b32 v158, v166
v_permlane32_swap_b32 v159, v167
v_add_f32 v152, v152, v160
v_add_f32 v153, v153, v161
v_add_f32 v154, v154, v162
v_add_f32 v155, v155, v163
v_add_f32 v156, v156, v164
v_add_f32 v157, v157, v165
v_add_f32 v158, v158, v166
v_add_f32 v159, v159, v167
v_cvt_pk_bf16_f32 v184, v152, v153
v_cvt_pk_bf16_f32 v185, v154, v155
v_cvt_pk_bf16_f32 v186, v156, v157
v_cvt_pk_bf16_f32 v187, v158, v159
v_lshrrev_b32 v139, 4, v135
v_lshlrev_b32 v139, 10, v139
v_and_b32 v135, 15, v135
v_lshl_add_u32 v135, v136, 4, v135
v_lshl_add_u32 v139, v135, 4, v139
s_lshl_b32 s31, s62, 11
s_add_u32 s31, s31, 35651584
s_lshl_b32 s60, s62, 4
s_add_u32 s60, s60, s61
s_lshl_b32 s60, s60, 4
s_add_u32 s60, s60, 38887424
s_mov_b64 exec, 0xffff
s_cmp_lg_u32 s20, 3
s_cbranch_scc1 L_q_rfz_72
v_lshlrev_b32 v139, 4, v136
s_lshl_b32 s31, s62, 6
s_add_u32 s31, s31, 35717120
s_add_u32 s60, s60, 128
s_mov_b64 exec, 0xf
L_q_rfz_72:
buffer_store_dwordx4 v[184:187], v139, s[16:19], s31 offen sc0 sc1
s_mov_b64 exec, -1
L_q_rf_70:
L_q_hs_69:
s_cmp_lg_u32 s29, 14
s_cbranch_scc1 L_q_hs_73
s_lshr_b32 s62, s2, 3
s_bfe_u32 s61, s2, 0x20001
s_lshl_b32 s61, s61, 1
s_cmp_lt_u32 s20, 2
s_cbranch_scc1 L_q_who_75
s_cmp_lg_u32 s20, 3
s_cbranch_scc1 L_q_rs_74
s_cmp_lg_u32 s61, 0
s_cbranch_scc1 L_q_rs_74
s_sub_u32 s61, s61, 3
L_q_who_75:
s_add_u32 s61, s61, s20
s_waitcnt vmcnt(0)
v_mov_b32 v139, 1
v_mov_b32 v140, 0
s_mov_b64 exec, 1
buffer_store_dword v139, v140, s[16:19], s60 offen sc0 sc1
s_mov_b64 exec, -1
L_q_rs_74:
L_q_hs_73:
s_branch L_q_B_55
L_q_H_56:
s_cmp_lg_u32 s29, 16
s_cbranch_scc1 L_q_hs_76
s_and_b32 s32, s20, 1
s_lshl_b32 s61, s59, 1
s_add_u32 s61, s61, s32
s_lshl_b32 s31, s61, 9
s_add_u32 s31, s31, 38887424
v_and_b32 v137, 31, v254
v_lshlrev_b32 v137, 4, v137
buffer_load_dword v138, v137, s[16:19], s31 offen sc0 sc1
L_q_hs_76:
s_branch L_q_B_57
L_s7_H_81:
s_cmp_lg_u32 s29, 4
s_cbranch_scc1 L_s7_hs_83
s_waitcnt vmcnt(0)
v_mov_b32 v186, 1
v_mov_b32 v187, 0
s_mov_b64 exec, 1
buffer_store_dword v186, v187, s[16:19], s63 offen sc0 sc1
s_mov_b64 exec, -1
L_s7_hs_83:
s_branch L_s7_B_82
L_s6_H_85:
s_cmp_lg_u32 s29, 2
s_cbranch_scc1 L_s6_hs_87
s_waitcnt vmcnt(0)
v_mov_b32 v137, 1
v_mov_b32 v138, 0
s_mov_b64 exec, 1
buffer_store_dword v137, v138, s[16:19], s60 offen sc0 sc1
s_mov_b64 exec, -1
L_s6_hs_87:
s_branch L_s6_B_86
L_s6z_H_89:
s_cmp_lg_u32 s29, 5
s_cbranch_scc1 L_s6z_hs_93
s_waitcnt vmcnt(0)
v_mov_b32 v137, 1
v_mov_b32 v138, 0
s_mov_b64 exec, 1
buffer_store_dword v137, v138, s[16:19], s63 offen sc0 sc1
s_mov_b64 exec, -1
L_s6z_hs_93:
s_branch L_s6z_B_90
L_s6z_H_91:
s_cmp_lg_u32 s29, 2
s_cbranch_scc1 L_s6z_hs_94
v_cvt_pk_bf16_f32 v32, v32, v33
v_cvt_pk_bf16_f32 v33, v34, v35
v_cvt_pk_bf16_f32 v34, v36, v37
v_cvt_pk_bf16_f32 v35, v38, v39
v_cvt_pk_bf16_f32 v40, v40, v41
v_cvt_pk_bf16_f32 v41, v42, v43
v_cvt_pk_bf16_f32 v42, v44, v45
v_cvt_pk_bf16_f32 v43, v46, v47
v_cvt_pk_bf16_f32 v48, v48, v49
v_cvt_pk_bf16_f32 v49, v50, v51
v_cvt_pk_bf16_f32 v50, v52, v53
v_cvt_pk_bf16_f32 v51, v54, v55
v_cvt_pk_bf16_f32 v56, v56, v57
v_cvt_pk_bf16_f32 v57, v58, v59
v_cvt_pk_bf16_f32 v58, v60, v61
v_cvt_pk_bf16_f32 v59, v62, v63
buffer_store_dwordx4 v[32:35], v135, s[16:19], s62 offen offset:0 sc0 sc1
buffer_store_dwordx4 v[40:43], v135, s[16:19], s62 offen offset:1024 sc0 sc1
buffer_store_dwordx4 v[48:51], v135, s[16:19], s62 offen offset:2048 sc0 sc1
buffer_store_dwordx4 v[56:59], v135, s[16:19], s62 offen offset:3072 sc0 sc1
L_s6z_hs_94:
s_branch L_s6z_B_92
L_loader:
s_bitcmp1_b32 s2, 0
s_cbranch_scc1 L_l_att_96
s_sub_u32 s31, s20, 4
s_mul_i32 s32, s31, 256
s_add_u32 s32, s32, 0
v_add_u32 v2, s32, v254
v_lshrrev_b32 v3, 4, v2
v_and_b32 v4, 15, v2
v_and_b32 v5, 3, v3
v_bfe_u32 v2, v3, 3, 1
v_lshl_or_b32 v5, v2, 2, v5
v_lshlrev_b32 v5, 1, v5
v_xor_b32 v4, v4, v5
v_mul_lo_u32 v3, v3, s25
v_lshrrev_b32 v2, 3, v4
v_mul_lo_u32 v2, v2, s23
v_add_u32 v3, v3, v2
v_bfe_u32 v2, v4, 2, 1
v_mul_lo_u32 v2, v2, s24
v_add_u32 v3, v3, v2
v_and_b32 v2, 3, v4
v_lshl_add_u32 v3, v2, 4, v3
v_add_u32 v14, s22, v3
s_mul_i32 s32, s31, 256
s_add_u32 s32, s32, 64
v_add_u32 v2, s32, v254
v_lshrrev_b32 v3, 4, v2
v_and_b32 v4, 15, v2
v_and_b32 v5, 3, v3
v_bfe_u32 v2, v3, 3, 1
v_lshl_or_b32 v5, v2, 2, v5
v_lshlrev_b32 v5, 1, v5
v_xor_b32 v4, v4, v5
v_mul_lo_u32 v3, v3, s25
v_lshrrev_b32 v2, 3, v4
v_mul_lo_u32 v2, v2, s23
v_add_u32 v3, v3, v2
v_bfe_u32 v2, v4, 2, 1
v_mul_lo_u32 v2, v2, s24
v_add_u32 v3, v3, v2
v_and_b32 v2, 3, v4
v_lshl_add_u32 v3, v2, 4, v3
v_add_u32 v15, s22, v3
s_mul_i32 s32, s31, 256
s_add_u32 s32, s32, 128
v_add_u32 v2, s32, v254
v_lshrrev_b32 v3, 4, v2
v_and_b32 v4, 15, v2
v_and_b32 v5, 3, v3
v_bfe_u32 v2, v3, 3, 1
v_lshl_or_b32 v5, v2, 2, v5
v_lshlrev_b32 v5, 1, v5
v_xor_b32 v4, v4, v5
v_mul_lo_u32 v3, v3, s25
v_lshrrev_b32 v2, 3, v4
v_mul_lo_u32 v2, v2, s23
v_add_u32 v3, v3, v2
v_bfe_u32 v2, v4, 2, 1
v_mul_lo_u32 v2, v2, s24
v_add_u32 v3, v3, v2
v_and_b32 v2, 3, v4
v_lshl_add_u32 v3, v2, 4, v3
v_add_u32 v16, s22, v3
s_mul_i32 s32, s31, 256
s_add_u32 s32, s32, 192
v_add_u32 v2, s32, v254
v_lshrrev_b32 v3, 4, v2
v_and_b32 v4, 15, v2
v_and_b32 v5, 3, v3
v_bfe_u32 v2, v3, 3, 1
v_lshl_or_b32 v5, v2, 2, v5
v_lshlrev_b32 v5, 1, v5
v_xor_b32 v4, v4, v5
v_mul_lo_u32 v3, v3, s25
v_lshrrev_b32 v2, 3, v4
v_mul_lo_u32 v2, v2, s23
v_add_u32 v3, v3, v2
v_bfe_u32 v2, v4, 2, 1
v_mul_lo_u32 v2, v2, s24
v_add_u32 v3, v3, v2
v_and_b32 v2, 3, v4
v_lshl_add_u32 v3, v2, 4, v3
v_add_u32 v17, s22, v3
s_mul_i32 s32, s31, 32
s_add_u32 s32, s32, 0
v_lshrrev_b32 v3, 3, v254
v_add_u32 v3, s32, v3
v_bfe_u32 v5, v3, 1, 3
v_and_b32 v4, 7, v254
v_xor_b32 v4, v4, v5
v_add_u32 v3, s21, v3
v_mul_lo_u32 v3, v3, s26
v_lshl_add_u32 v10, v4, 4, v3
s_mul_i32 s32, s31, 32
s_add_u32 s32, s32, 8
v_lshrrev_b32 v3, 3, v254
v_add_u32 v3, s32, v3
v_bfe_u32 v5, v3, 1, 3
v_and_b32 v4, 7, v254
v_xor_b32 v4, v4, v5
v_add_u32 v3, s21, v3
v_mul_lo_u32 v3, v3, s26
v_lshl_add_u32 v11, v4, 4, v3
s_lshl_b32 s32, s26, 4
v_add_u32 v12, s32, v10
s_lshl_b32 s32, s26, 4
v_add_u32 v13, s32, v11
s_mul_i32 s36, s31, 4096
s_mul_i32 s37, s31, 4096
s_add_u32 s37, s37, 16384
s_mov_b32 s30, 0
s_mov_b32 s39, 0
s_mov_b32 s6, 0
s_add_u32 s7, s6, 0
s_add_u32 s4, s7, s3
s_and_b32 s4, s4, 3
s_and_b32 s7, s7, 3
s_sub_i32 s7, s4, s7
s_lshl_b32 s4, s7, 7
s_add_u32 s4, s4, s27
s_mul_i32 s5, s7, s35
s_add_u32 s5, s5, s28
s_add_u32 s32, s30, s36
s_add_u32 s33, s30, s37
s_add_u32 m0, s33, 0
s_nop 0
buffer_load_dwordx4 v14, s[12:15], s5 offen lds
s_add_u32 m0, s32, 0
s_nop 0
buffer_load_dwordx4 v10, s[8:11], s4 offen lds
s_add_u32 m0, s33, 1024
s_nop 0
buffer_load_dwordx4 v15, s[12:15], s5 offen lds
s_add_u32 m0, s32, 1024
s_nop 0
buffer_load_dwordx4 v11, s[8:11], s4 offen lds
s_add_u32 m0, s33, 2048
s_nop 0
buffer_load_dwordx4 v16, s[12:15], s5 offen lds
s_add_u32 m0, s32, 2048
s_nop 0
buffer_load_dwordx4 v12, s[8:11], s4 offen lds
s_add_u32 m0, s33, 3072
s_nop 0
buffer_load_dwordx4 v17, s[12:15], s5 offen lds
s_add_u32 m0, s32, 3072
s_nop 0
buffer_load_dwordx4 v13, s[8:11], s4 offen lds
s_add_u32 s27, s27, 128
s_add_u32 s28, s28, s35
s_add_u32 s6, s6, 1
s_add_u32 s30, s30, 32768
s_cmp_ge_u32 s30, 131072
s_cselect_b32 s30, 0, s30
s_add_u32 s7, s6, 0
s_add_u32 s4, s7, s3
s_and_b32 s4, s4, 3
s_and_b32 s7, s7, 3
s_sub_i32 s7, s4, s7
s_lshl_b32 s4, s7, 7
s_add_u32 s4, s4, s27
s_mul_i32 s5, s7, s35
s_add_u32 s5, s5, s28
s_add_u32 s32, s30, s36
s_add_u32 s33, s30, s37
s_add_u32 m0, s33, 0
s_nop 0
buffer_load_dwordx4 v14, s[12:15], s5 offen lds
s_add_u32 m0, s32, 0
s_nop 0
buffer_load_dwordx4 v10, s[8:11], s4 offen lds
s_add_u32 m0, s33, 1024
s_nop 0
buffer_load_dwordx4 v15, s[12:15], s5 offen lds
s_add_u32 m0, s32, 1024
s_nop 0
buffer_load_dwordx4 v11, s[8:11], s4 offen lds
s_add_u32 m0, s33, 2048
s_nop 0
buffer_load_dwordx4 v16, s[12:15], s5 offen lds
s_add_u32 m0, s32, 2048
s_nop 0
buffer_load_dwordx4 v12, s[8:11], s4 offen lds
s_add_u32 m0, s33, 3072
s_nop 0
buffer_load_dwordx4 v17, s[12:15], s5 offen lds
s_add_u32 m0, s32, 3072
s_nop 0
buffer_load_dwordx4 v13, s[8:11], s4 offen lds
s_add_u32 s27, s27, 128
s_add_u32 s28, s28, s35
s_add_u32 s6, s6, 1
s_add_u32 s30, s30, 32768
s_cmp_ge_u32 s30, 131072
s_cselect_b32 s30, 0, s30
s_mov_b32 s95, s27
s_mov_b32 s96, s28
s_mov_b32 s97, s6
s_bfe_u32 s5, s2, 0x20001
s_lshr_b32 s4, s2, 3
s_lshr_b32 s7, s4, 3
s_and_b32 s4, s4, 7
s_lshl_b32 s5, s5, 2
s_add_u32 s58, s5, s7
s_mov_b32 s59, s4
s_mul_i32 s3, s7, 1
s_mul_i32 s31, s4, 0
s_add_u32 s3, s3, s31
s_lshl_b32 s21, s58, 7
s_lshl_b32 s22, s59, 8
s_mov_b32 s26, 2048
s_mov_b32 s27, 0
s_mov_b32 s28, 0
s_mov_b32 s25, 2048
s_mov_b32 s23, 128
s_mov_b32 s24, 64
s_mov_b32 s35, 131072
s_add_u32 s8, s86, 4194304
s_addc_u32 s9, s87, 0
s_mov_b32 s10, 4194304
s_mov_b32 s11, 0x20000
s_mov_b32 s12, s74
s_mov_b32 s13, s75
s_mov_b32 s14, 2097152
s_mov_b32 s15, 0x20000
s_sub_u32 s31, s20, 4
s_mul_i32 s32, s31, 256
s_add_u32 s32, s32, 0
v_add_u32 v2, s32, v254
v_lshrrev_b32 v3, 4, v2
v_and_b32 v4, 15, v2
v_and_b32 v5, 3, v3
v_bfe_u32 v2, v3, 3, 1
v_lshl_or_b32 v5, v2, 2, v5
v_lshlrev_b32 v5, 1, v5
v_xor_b32 v4, v4, v5
v_mul_lo_u32 v3, v3, s25
v_lshrrev_b32 v2, 3, v4
v_mul_lo_u32 v2, v2, s23
v_add_u32 v3, v3, v2
v_bfe_u32 v2, v4, 2, 1
v_mul_lo_u32 v2, v2, s24
v_add_u32 v3, v3, v2
v_and_b32 v2, 3, v4
v_lshl_add_u32 v3, v2, 4, v3
v_add_u32 v28, s22, v3
s_mul_i32 s32, s31, 256
s_add_u32 s32, s32, 64
v_add_u32 v2, s32, v254
v_lshrrev_b32 v3, 4, v2
v_and_b32 v4, 15, v2
v_and_b32 v5, 3, v3
v_bfe_u32 v2, v3, 3, 1
v_lshl_or_b32 v5, v2, 2, v5
v_lshlrev_b32 v5, 1, v5
v_xor_b32 v4, v4, v5
v_mul_lo_u32 v3, v3, s25
v_lshrrev_b32 v2, 3, v4
v_mul_lo_u32 v2, v2, s23
v_add_u32 v3, v3, v2
v_bfe_u32 v2, v4, 2, 1
v_mul_lo_u32 v2, v2, s24
v_add_u32 v3, v3, v2
v_and_b32 v2, 3, v4
v_lshl_add_u32 v3, v2, 4, v3
v_add_u32 v29, s22, v3
s_mul_i32 s32, s31, 256
s_add_u32 s32, s32, 128
v_add_u32 v2, s32, v254
v_lshrrev_b32 v3, 4, v2
v_and_b32 v4, 15, v2
v_and_b32 v5, 3, v3
v_bfe_u32 v2, v3, 3, 1
v_lshl_or_b32 v5, v2, 2, v5
v_lshlrev_b32 v5, 1, v5
v_xor_b32 v4, v4, v5
v_mul_lo_u32 v3, v3, s25
v_lshrrev_b32 v2, 3, v4
v_mul_lo_u32 v2, v2, s23
v_add_u32 v3, v3, v2
v_bfe_u32 v2, v4, 2, 1
v_mul_lo_u32 v2, v2, s24
v_add_u32 v3, v3, v2
v_and_b32 v2, 3, v4
v_lshl_add_u32 v3, v2, 4, v3
v_add_u32 v30, s22, v3
s_mul_i32 s32, s31, 256
s_add_u32 s32, s32, 192
v_add_u32 v2, s32, v254
v_lshrrev_b32 v3, 4, v2
v_and_b32 v4, 15, v2
v_and_b32 v5, 3, v3
v_bfe_u32 v2, v3, 3, 1
v_lshl_or_b32 v5, v2, 2, v5
v_lshlrev_b32 v5, 1, v5
v_xor_b32 v4, v4, v5
v_mul_lo_u32 v3, v3, s25
v_lshrrev_b32 v2, 3, v4
v_mul_lo_u32 v2, v2, s23
v_add_u32 v3, v3, v2
v_bfe_u32 v2, v4, 2, 1
v_mul_lo_u32 v2, v2, s24
v_add_u32 v3, v3, v2
v_and_b32 v2, 3, v4
v_lshl_add_u32 v3, v2, 4, v3
v_add_u32 v31, s22, v3
s_mul_i32 s32, s31, 32
s_add_u32 s32, s32, 0
v_lshrrev_b32 v3, 3, v254
v_add_u32 v3, s32, v3
v_bfe_u32 v5, v3, 1, 3
v_and_b32 v4, 7, v254
v_xor_b32 v4, v4, v5
v_add_u32 v3, s21, v3
v_add_u32 v3, 4294967295, v3
v_mul_lo_u32 v3, v3, s26
v_lshl_add_u32 v24, v4, 4, v3
s_mul_i32 s32, s31, 32
s_add_u32 s32, s32, 8
v_lshrrev_b32 v3, 3, v254
v_add_u32 v3, s32, v3
v_bfe_u32 v5, v3, 1, 3
v_and_b32 v4, 7, v254
v_xor_b32 v4, v4, v5
v_add_u32 v3, s21, v3
v_add_u32 v3, 4294967295, v3
v_mul_lo_u32 v3, v3, s26
v_lshl_add_u32 v25, v4, 4, v3
s_lshl_b32 s32, s26, 4
v_add_u32 v26, s32, v24
s_lshl_b32 s32, s26, 4
v_add_u32 v27, s32, v25
s_bfe_u32 s5, s2, 0x20001
s_lshr_b32 s4, s2, 3
s_lshr_b32 s7, s4, 3
s_and_b32 s4, s4, 7
s_lshl_b32 s5, s5, 2
s_add_u32 s58, s5, s7
s_mov_b32 s59, s4
s_mul_i32 s3, s7, 1
s_mul_i32 s31, s4, 0
s_add_u32 s3, s3, s31
s_lshl_b32 s21, s58, 7
s_lshl_b32 s22, s59, 8
s_mov_b32 s26, 2048
s_mov_b32 s27, 0
s_mov_b32 s28, 0
s_mov_b32 s25, 2048
s_mov_b32 s23, 128
s_mov_b32 s24, 64
s_mov_b32 s35, 131072
s_mov_b32 s8, s64
s_mov_b32 s9, s65
s_mov_b32 s10, 4194304
s_mov_b32 s11, 0x20000
s_mov_b32 s12, s72
s_mov_b32 s13, s73
s_mov_b32 s14, 2097152
s_mov_b32 s15, 0x20000
s_sub_u32 s31, s20, 4
s_mov_b32 s27, s95
s_mov_b32 s28, s96
s_mov_b32 s6, s97
s_waitcnt vmcnt(8)
s_barrier
s_add_u32 s7, s6, 0
s_add_u32 s4, s7, s3
s_and_b32 s4, s4, 3
s_and_b32 s7, s7, 3
s_sub_i32 s7, s4, s7
s_lshl_b32 s4, s7, 7
s_add_u32 s4, s4, s27
s_mul_i32 s5, s7, s35
s_add_u32 s5, s5, s28
s_add_u32 s32, s30, s36
s_add_u32 s33, s30, s37
s_add_u32 m0, s33, 0
s_nop 0
buffer_load_dwordx4 v14, s[12:15], s5 offen lds
s_add_u32 m0, s32, 0
s_nop 0
buffer_load_dwordx4 v10, s[8:11], s4 offen lds
s_add_u32 m0, s33, 1024
s_nop 0
buffer_load_dwordx4 v15, s[12:15], s5 offen lds
s_add_u32 m0, s32, 1024
s_nop 0
buffer_load_dwordx4 v11, s[8:11], s4 offen lds
s_add_u32 m0, s33, 2048
s_nop 0
buffer_load_dwordx4 v16, s[12:15], s5 offen lds
s_add_u32 m0, s32, 2048
s_nop 0
buffer_load_dwordx4 v12, s[8:11], s4 offen lds
s_add_u32 m0, s33, 3072
s_nop 0
buffer_load_dwordx4 v17, s[12:15], s5 offen lds
s_add_u32 m0, s32, 3072
s_nop 0
buffer_load_dwordx4 v13, s[8:11], s4 offen lds
s_add_u32 s27, s27, 128
s_add_u32 s28, s28, s35
s_add_u32 s6, s6, 1
s_add_u32 s30, s30, 32768
s_cmp_ge_u32 s30, 131072
s_cselect_b32 s30, 0, s30
s_add_u32 s7, s6, 0
s_add_u32 s4, s7, s3
s_and_b32 s4, s4, 3
s_and_b32 s7, s7, 3
s_sub_i32 s7, s4, s7
s_lshl_b32 s4, s7, 7
s_add_u32 s4, s4, s27
s_mul_i32 s5, s7, s35
s_add_u32 s5, s5, s28
s_add_u32 s32, s30, s36
s_add_u32 s33, s30, s37
s_add_u32 m0, s33, 0
s_nop 0
buffer_load_dwordx4 v14, s[12:15], s5 offen lds
s_add_u32 m0, s32, 0
s_nop 0
buffer_load_dwordx4 v10, s[8:11], s4 offen lds
s_add_u32 m0, s33, 1024
s_nop 0
buffer_load_dwordx4 v15, s[12:15], s5 offen lds
s_add_u32 m0, s32, 1024
s_nop 0
buffer_load_dwordx4 v11, s[8:11], s4 offen lds
s_add_u32 m0, s33, 2048
s_nop 0
buffer_load_dwordx4 v16, s[12:15], s5 offen lds
s_add_u32 m0, s32, 2048
s_nop 0
buffer_load_dwordx4 v12, s[8:11], s4 offen lds
s_add_u32 m0, s33, 3072
s_nop 0
buffer_load_dwordx4 v17, s[12:15], s5 offen lds
s_add_u32 m0, s32, 3072
s_nop 0
buffer_load_dwordx4 v13, s[8:11], s4 offen lds
s_add_u32 s27, s27, 128
s_add_u32 s28, s28, s35
s_add_u32 s6, s6, 1
s_add_u32 s30, s30, 32768
s_cmp_ge_u32 s30, 131072
s_cselect_b32 s30, 0, s30
s_mov_b32 s29, 4
s_mov_b32 s93, 8480
L_h_ld_98:
s_waitcnt vmcnt(16)
s_barrier
s_add_u32 s7, s6, 0
s_add_u32 s4, s7, s3
s_and_b32 s4, s4, 3
s_and_b32 s7, s7, 3
s_sub_i32 s7, s4, s7
s_lshl_b32 s4, s7, 7
s_add_u32 s4, s4, s27
s_mul_i32 s5, s7, s35
s_add_u32 s5, s5, s28
s_add_u32 s32, s30, s36
s_add_u32 s33, s30, s37
s_add_u32 m0, s33, 0
s_nop 0
buffer_load_dwordx4 v14, s[12:15], s5 offen lds
s_add_u32 m0, s32, 0
s_nop 0
buffer_load_dwordx4 v10, s[8:11], s4 offen lds
s_add_u32 m0, s33, 1024
s_nop 0
buffer_load_dwordx4 v15, s[12:15], s5 offen lds
s_add_u32 m0, s32, 1024
s_nop 0
buffer_load_dwordx4 v11, s[8:11], s4 offen lds
s_add_u32 m0, s33, 2048
s_nop 0
buffer_load_dwordx4 v16, s[12:15], s5 offen lds
s_add_u32 m0, s32, 2048
s_nop 0
buffer_load_dwordx4 v12, s[8:11], s4 offen lds
s_add_u32 m0, s33, 3072
s_nop 0
buffer_load_dwordx4 v17, s[12:15], s5 offen lds
s_add_u32 m0, s32, 3072
s_nop 0
buffer_load_dwordx4 v13, s[8:11], s4 offen lds
s_add_u32 s27, s27, 128
s_add_u32 s28, s28, s35
s_add_u32 s6, s6, 1
s_add_u32 s30, s30, 32768
s_cmp_ge_u32 s30, 131072
s_cselect_b32 s30, 0, s30
s_bitcmp1_b32 s93, s29
s_cbranch_scc1 L_h_H_101
L_h_B_102:
s_add_u32 s29, s29, 1
s_cmp_lt_u32 s29, 16
s_cbranch_scc1 L_h_ld_98
s_waitcnt vmcnt(16)
s_barrier
v_and_b32 v42, 15, v254
s_lshl_b32 s32, s58, 10
v_lshl_add_u32 v40, v42, 6, s32
s_lshl_b32 s33, s59, 7
v_lshrrev_b32 v42, 1, v254
v_lshl_add_u32 v42, v42, 10, s33
v_and_b32 v43, 1, v254
v_or_b32 v43, 1, v43
v_lshl_add_u32 v42, v43, 6, v42
v_cmp_gt_u32 vcc, 32, v254
s_nop 1
v_cndmask_b32 v40, v40, v42, vcc
s_mov_b32 s32, 38912000
v_cmp_eq_u32 vcc, 0, v41
s_cmp_eq_u64 vcc, 0
s_cbranch_scc1 L_nbok_109
s_mov_b32 s50, 0
L_poll_110:
buffer_load_dword v41, v40, s[16:19], s32 offen sc0 sc1
s_waitcnt vmcnt(0)
v_cmp_eq_u32 vcc, 0, v41
s_cmp_eq_u64 vcc, 0
s_cbranch_scc1 L_pollx_111
s_sleep 4
s_add_u32 s50, s50, 1
s_cmp_lt_u32 s50, 100000
s_cbranch_scc1 L_poll_110
L_pollx_111:
L_nbok_109:
s_lshl_b32 s32, s31, 9
s_add_u32 m0, s32, 147456
s_lshl_b32 s33, s21, 4
s_add_u32 s33, s33, s32
s_add_u32 s33, s33, 36700160
v_lshlrev_b32 v43, 4, v254
s_mov_b32 exec_hi, 0
buffer_load_dwordx4 v43, s[16:19], s33 offen lds
s_mov_b32 exec_hi, -1
v_and_b32 v44, 7, v254
v_lshlrev_b32 v44, 4, v44
v_lshrrev_b32 v45, 3, v254
v_lshl_add_u32 v45, v45, 12, v44
s_lshl_b32 s33, s59, 9
s_lshl_b32 s32, s31, 7
s_add_u32 s33, s33, s32
s_add_u32 s33, s33, 36765696
s_add_u32 s34, s33, 32768
buffer_load_dwordx4 v[48:51], v45, s[16:19], s33 offen
buffer_load_dwordx4 v[52:55], v45, s[16:19], s34 offen
s_add_u32 s32, s32, 149504
v_add_u32 v44, s32, v44
s_waitcnt vmcnt(11)
s_barrier
s_bfe_u32 s5, s2, 0x20001
s_lshr_b32 s4, s2, 3
s_lshr_b32 s7, s4, 3
s_and_b32 s4, s4, 7
s_lshl_b32 s5, s5, 2
s_add_u32 s58, s5, s7
s_mov_b32 s59, s4
s_mul_i32 s3, s7, 1
s_mul_i32 s31, s4, 0
s_add_u32 s3, s3, s31
s_lshl_b32 s21, s58, 7
s_lshl_b32 s22, s59, 8
s_mov_b32 s26, 2048
s_mov_b32 s27, 0
s_mov_b32 s28, 0
s_mov_b32 s25, 2048
s_mov_b32 s23, 128
s_mov_b32 s24, 64
s_mov_b32 s35, 131072
s_add_u32 s8, s86, 4194304
s_addc_u32 s9, s87, 0
s_mov_b32 s10, 4194304
s_mov_b32 s11, 0x20000
s_mov_b32 s12, s74
s_mov_b32 s13, s75
s_mov_b32 s14, 2097152
s_mov_b32 s15, 0x20000
s_sub_u32 s31, s20, 4
s_mul_i32 s36, s31, 4096
s_mul_i32 s37, s31, 4096
s_add_u32 s37, s37, 16384
s_mov_b32 s30, 0
s_mov_b32 s39, 0
s_mov_b32 s6, 0
s_waitcnt vmcnt(0)
v_pk_add_f32 v[48:49], v[48:49], v[52:53]
v_pk_add_f32 v[50:51], v[50:51], v[54:55]
v_add_f32_dpp v48, v48, v48 row_ror:8 row_mask:0xf bank_mask:0xf
v_add_f32_dpp v49, v49, v49 row_ror:8 row_mask:0xf bank_mask:0xf
v_add_f32_dpp v50, v50, v50 row_ror:8 row_mask:0xf bank_mask:0xf
v_add_f32_dpp v51, v51, v51 row_ror:8 row_mask:0xf bank_mask:0xf
v_mov_b32 v52, v48
v_mov_b32 v53, v49
v_mov_b32 v54, v50
v_mov_b32 v55, v51
s_nop 1
v_permlane16_swap_b32 v48, v52
v_permlane16_swap_b32 v49, v53
v_permlane16_swap_b32 v50, v54
v_permlane16_swap_b32 v51, v55
s_nop 1
v_add_f32 v48, v48, v52
v_add_f32 v49, v49, v53
v_add_f32 v50, v50, v54
v_add_f32 v51, v51, v55
v_mov_b32 v52, v48
v_mov_b32 v53, v49
v_mov_b32 v54, v50
v_mov_b32 v55, v51
s_nop 1
v_permlane32_swap_b32 v48, v52
v_permlane32_swap_b32 v49, v53
v_permlane32_swap_b32 v50, v54
v_permlane32_swap_b32 v51, v55
s_nop 1
v_add_f32 v48, v48, v52
v_add_f32 v49, v49, v53
v_add_f32 v50, v50, v54
v_add_f32 v51, v51, v55
ds_write_b128 v44, v[48:51]
s_waitcnt lgkmcnt(0)
s_barrier
s_barrier
s_add_u32 s33, s37, 0
s_add_u32 s7, s6, 0
s_add_u32 s4, s7, s3
s_and_b32 s4, s4, 3
s_and_b32 s7, s7, 3
s_sub_i32 s7, s4, s7
s_lshl_b32 s4, s7, 7
s_add_u32 s4, s4, s27
s_mul_i32 s5, s7, s35
s_add_u32 s5, s5, s28
s_add_u32 m0, s33, 0
s_nop 0
buffer_load_dwordx4 v28, s[12:15], s5 offen lds
s_add_u32 m0, s33, 1024
s_nop 0
buffer_load_dwordx4 v29, s[12:15], s5 offen lds
s_add_u32 m0, s33, 2048
s_nop 0
buffer_load_dwordx4 v30, s[12:15], s5 offen lds
s_add_u32 m0, s33, 3072
s_nop 0
buffer_load_dwordx4 v31, s[12:15], s5 offen lds
s_add_u32 s33, s37, 32768
s_add_u32 s7, s6, 1
s_add_u32 s4, s7, s3
s_and_b32 s4, s4, 3
s_and_b32 s7, s7, 3
s_sub_i32 s7, s4, s7
s_add_i32 s7, s7, 1
s_lshl_b32 s4, s7, 7
s_add_u32 s4, s4, s27
s_mul_i32 s5, s7, s35
s_add_u32 s5, s5, s28
s_add_u32 m0, s33, 0
s_nop 0
buffer_load_dwordx4 v28, s[12:15], s5 offen lds
s_add_u32 m0, s33, 1024
s_nop 0
buffer_load_dwordx4 v29, s[12:15], s5 offen lds
s_add_u32 m0, s33, 2048
s_nop 0
buffer_load_dwordx4 v30, s[12:15], s5 offen lds
s_add_u32 m0, s33, 3072
s_nop 0
buffer_load_dwordx4 v31, s[12:15], s5 offen lds
s_bfe_u32 s5, s2, 0x10002
s_bfe_u32 s6, s2, 0x10001
s_lshr_b32 s4, s2, 3
s_lshr_b32 s7, s4, 2
s_and_b32 s4, s4, 3
s_lshl_b32 s5, s5, 3
s_add_u32 s58, s5, s7
s_lshl_b32 s6, s6, 2
s_add_u32 s59, s6, s4
s_mul_i32 s3, s7, 1
s_mul_i32 s31, s4, 0
s_add_u32 s3, s3, s31
s_lshl_b32 s21, s58, 7
s_lshl_b32 s22, s59, 8
s_lshl_b32 s22, s59, 9
s_mov_b32 s26, 2048
s_mov_b32 s27, 0
s_mov_b32 s28, 0
s_mov_b32 s25, 7168
s_mov_b32 s23, 128
s_mov_b32 s24, 64
s_mov_b32 s35, 458752
s_add_u32 s8, s86, 12582912
s_addc_u32 s9, s87, 0
s_mov_b32 s10, 4194304
s_mov_b32 s11, 0x20000
s_mov_b32 s12, s76
s_mov_b32 s13, s77
s_mov_b32 s14, 7340032
s_mov_b32 s15, 0x20000
s_sub_u32 s31, s20, 4
s_mul_i32 s32, s31, 512
s_add_u32 s32, s32, 0
v_add_u32 v2, s32, v254
v_lshrrev_b32 v3, 5, v2
v_and_b32 v4, 31, v2
v_and_b32 v5, 3, v3
v_bfe_u32 v2, v3, 3, 1
v_lshl_or_b32 v5, v2, 2, v5
v_lshlrev_b32 v5, 1, v5
v_xor_b32 v4, v4, v5
v_mul_lo_u32 v3, v3, s25
v_lshrrev_b32 v2, 3, v4
v_mul_lo_u32 v2, v2, s23
v_add_u32 v3, v3, v2
v_bfe_u32 v2, v4, 2, 1
v_mul_lo_u32 v2, v2, s24
v_add_u32 v3, v3, v2
v_and_b32 v2, 3, v4
v_lshl_add_u32 v3, v2, 4, v3
v_add_u32 v204, s22, v3
s_mul_i32 s32, s31, 512
s_add_u32 s32, s32, 64
v_add_u32 v2, s32, v254
v_lshrrev_b32 v3, 5, v2
v_and_b32 v4, 31, v2
v_and_b32 v5, 3, v3
v_bfe_u32 v2, v3, 3, 1
v_lshl_or_b32 v5, v2, 2, v5
v_lshlrev_b32 v5, 1, v5
v_xor_b32 v4, v4, v5
v_mul_lo_u32 v3, v3, s25
v_lshrrev_b32 v2, 3, v4
v_mul_lo_u32 v2, v2, s23
v_add_u32 v3, v3, v2
v_bfe_u32 v2, v4, 2, 1
v_mul_lo_u32 v2, v2, s24
v_add_u32 v3, v3, v2
v_and_b32 v2, 3, v4
v_lshl_add_u32 v3, v2, 4, v3
v_add_u32 v205, s22, v3
s_mul_i32 s32, s31, 512
s_add_u32 s32, s32, 128
v_add_u32 v2, s32, v254
v_lshrrev_b32 v3, 5, v2
v_and_b32 v4, 31, v2
v_and_b32 v5, 3, v3
v_bfe_u32 v2, v3, 3, 1
v_lshl_or_b32 v5, v2, 2, v5
v_lshlrev_b32 v5, 1, v5
v_xor_b32 v4, v4, v5
v_mul_lo_u32 v3, v3, s25
v_lshrrev_b32 v2, 3, v4
v_mul_lo_u32 v2, v2, s23
v_add_u32 v3, v3, v2
v_bfe_u32 v2, v4, 2, 1
v_mul_lo_u32 v2, v2, s24
v_add_u32 v3, v3, v2
v_and_b32 v2, 3, v4
v_lshl_add_u32 v3, v2, 4, v3
v_add_u32 v206, s22, v3
s_mul_i32 s32, s31, 512
s_add_u32 s32, s32, 192
v_add_u32 v2, s32, v254
v_lshrrev_b32 v3, 5, v2
v_and_b32 v4, 31, v2
v_and_b32 v5, 3, v3
v_bfe_u32 v2, v3, 3, 1
v_lshl_or_b32 v5, v2, 2, v5
v_lshlrev_b32 v5, 1, v5
v_xor_b32 v4, v4, v5
v_mul_lo_u32 v3, v3, s25
v_lshrrev_b32 v2, 3, v4
v_mul_lo_u32 v2, v2, s23
v_add_u32 v3, v3, v2
v_bfe_u32 v2, v4, 2, 1
v_mul_lo_u32 v2, v2, s24
v_add_u32 v3, v3, v2
v_and_b32 v2, 3, v4
v_lshl_add_u32 v3, v2, 4, v3
v_add_u32 v207, s22, v3
s_mul_i32 s32, s31, 512
s_add_u32 s32, s32, 256
v_add_u32 v2, s32, v254
v_lshrrev_b32 v3, 5, v2
v_and_b32 v4, 31, v2
v_and_b32 v5, 3, v3
v_bfe_u32 v2, v3, 3, 1
v_lshl_or_b32 v5, v2, 2, v5
v_lshlrev_b32 v5, 1, v5
v_xor_b32 v4, v4, v5
v_mul_lo_u32 v3, v3, s25
v_lshrrev_b32 v2, 3, v4
v_mul_lo_u32 v2, v2, s23
v_add_u32 v3, v3, v2
v_bfe_u32 v2, v4, 2, 1
v_mul_lo_u32 v2, v2, s24
v_add_u32 v3, v3, v2
v_and_b32 v2, 3, v4
v_lshl_add_u32 v3, v2, 4, v3
v_add_u32 v208, s22, v3
s_mul_i32 s32, s31, 512
s_add_u32 s32, s32, 320
v_add_u32 v2, s32, v254
v_lshrrev_b32 v3, 5, v2
v_and_b32 v4, 31, v2
v_and_b32 v5, 3, v3
v_bfe_u32 v2, v3, 3, 1
v_lshl_or_b32 v5, v2, 2, v5
v_lshlrev_b32 v5, 1, v5
v_xor_b32 v4, v4, v5
v_mul_lo_u32 v3, v3, s25
v_lshrrev_b32 v2, 3, v4
v_mul_lo_u32 v2, v2, s23
v_add_u32 v3, v3, v2
v_bfe_u32 v2, v4, 2, 1
v_mul_lo_u32 v2, v2, s24
v_add_u32 v3, v3, v2
v_and_b32 v2, 3, v4
v_lshl_add_u32 v3, v2, 4, v3
v_add_u32 v209, s22, v3
s_mul_i32 s32, s31, 512
s_add_u32 s32, s32, 384
v_add_u32 v2, s32, v254
v_lshrrev_b32 v3, 5, v2
v_and_b32 v4, 31, v2
v_and_b32 v5, 3, v3
v_bfe_u32 v2, v3, 3, 1
v_lshl_or_b32 v5, v2, 2, v5
v_lshlrev_b32 v5, 1, v5
v_xor_b32 v4, v4, v5
v_mul_lo_u32 v3, v3, s25
v_lshrrev_b32 v2, 3, v4
v_mul_lo_u32 v2, v2, s23
v_add_u32 v3, v3, v2
v_bfe_u32 v2, v4, 2, 1
v_mul_lo_u32 v2, v2, s24
v_add_u32 v3, v3, v2
v_and_b32 v2, 3, v4
v_lshl_add_u32 v3, v2, 4, v3
v_add_u32 v210, s22, v3
s_mul_i32 s32, s31, 512
s_add_u32 s32, s32, 448
v_add_u32 v2, s32, v254
v_lshrrev_b32 v3, 5, v2
v_and_b32 v4, 31, v2
v_and_b32 v5, 3, v3
v_bfe_u32 v2, v3, 3, 1
v_lshl_or_b32 v5, v2, 2, v5
v_lshlrev_b32 v5, 1, v5
v_xor_b32 v4, v4, v5
v_mul_lo_u32 v3, v3, s25
v_lshrrev_b32 v2, 3, v4
v_mul_lo_u32 v2, v2, s23
v_add_u32 v3, v3, v2
v_bfe_u32 v2, v4, 2, 1
v_mul_lo_u32 v2, v2, s24
v_add_u32 v3, v3, v2
v_and_b32 v2, 3, v4
v_lshl_add_u32 v3, v2, 4, v3
v_add_u32 v211, s22, v3
s_mul_i32 s32, s31, 32
s_add_u32 s32, s32, 0
v_lshrrev_b32 v3, 3, v254
v_add_u32 v3, s32, v3
v_bfe_u32 v5, v3, 1, 3
v_and_b32 v4, 7, v254
v_xor_b32 v4, v4, v5
v_add_u32 v3, s21, v3
v_mul_lo_u32 v3, v3, s26
v_lshl_add_u32 v200, v4, 4, v3
s_mul_i32 s32, s31, 32
s_add_u32 s32, s32, 8
v_lshrrev_b32 v3, 3, v254
v_add_u32 v3, s32, v3
v_bfe_u32 v5, v3, 1, 3
v_and_b32 v4, 7, v254
v_xor_b32 v4, v4, v5
v_add_u32 v3, s21, v3
v_mul_lo_u32 v3, v3, s26
v_lshl_add_u32 v201, v4, 4, v3
s_lshl_b32 s32, s26, 4
v_add_u32 v202, s32, v200
s_lshl_b32 s32, s26, 4
v_add_u32 v203, s32, v201
s_bfe_u32 s5, s2, 0x20001
s_lshr_b32 s4, s2, 3
s_lshr_b32 s7, s4, 3
s_and_b32 s4, s4, 7
s_lshl_b32 s5, s5, 2
s_add_u32 s58, s5, s7
s_mov_b32 s59, s4
s_mul_i32 s3, s7, 1
s_mul_i32 s31, s4, 0
s_add_u32 s3, s3, s31
s_lshl_b32 s21, s58, 7
s_lshl_b32 s22, s59, 8
s_mov_b32 s26, 2048
s_mov_b32 s27, 0
s_mov_b32 s28, 0
s_mov_b32 s25, 2048
s_mov_b32 s23, 128
s_mov_b32 s24, 64
s_mov_b32 s35, 131072
s_add_u32 s8, s86, 4194304
s_addc_u32 s9, s87, 0
s_mov_b32 s10, 4194304
s_mov_b32 s11, 0x20000
s_mov_b32 s12, s74
s_mov_b32 s13, s75
s_mov_b32 s14, 2097152
s_mov_b32 s15, 0x20000
s_sub_u32 s31, s20, 4
s_mul_i32 s36, s31, 4096
s_mul_i32 s37, s31, 4096
s_add_u32 s37, s37, 16384
s_mov_b32 s30, 0
s_mov_b32 s39, 0
s_mov_b32 s6, 0
s_sub_i32 s32, s58, 1
s_max_i32 s32, s32, 0
s_lshl_b32 s32, s32, 6
s_add_u32 s32, s32, 2
s_add_u32 s33, s58, 1
s_min_u32 s33, s33, 15
s_lshl_b32 s33, s33, 6
v_mov_b32 v44, s33
v_mov_b32 v41, s32
v_cmp_gt_u32 vcc, 48, v254
s_nop 1
v_cndmask_b32 v44, v44, v41, vcc
v_bfe_u32 v41, v254, 1, 3
v_lshl_add_u32 v44, v41, 2, v44
v_and_b32 v41, 1, v254
v_add_u32 v44, v41, v44
s_lshl_b32 s32, s58, 6
v_add_u32 v40, s32, v254
v_cmp_gt_u32 vcc, 32, v254
s_nop 1
v_cndmask_b32 v40, v44, v40, vcc
v_lshlrev_b32 v40, 4, v40
s_mov_b32 s32, 38797312
v_mov_b32 v42, 150024
s_cmp_lg_u32 s20, 4
s_cbranch_scc1 L_p1o_112
s_mov_b32 s50, 0
L_poll_114:
buffer_load_dword v41, v40, s[16:19], s32 offen sc0 sc1
s_waitcnt vmcnt(0)
v_cmp_eq_u32 vcc, 0, v41
s_cmp_eq_u64 vcc, 0
s_cbranch_scc1 L_pollx_115
s_sleep 4
s_add_u32 s50, s50, 1
s_cmp_lt_u32 s50, 100000
s_cbranch_scc1 L_poll_114
L_pollx_115:
v_mov_b32 v41, 1
ds_write_b32 v42, v41
s_branch L_p1x_113
L_p1o_112:
s_mov_b32 s50, 0
L_p1l_116:
ds_read_b32 v41, v42
s_waitcnt lgkmcnt(0)
v_readfirstlane_b32 s34, v41
s_cmp_ge_u32 s34, 1
s_cbranch_scc1 L_p1x_113
s_sleep 1
s_add_u32 s50, s50, 1
s_cmp_lt_u32 s50, 800000
s_cbranch_scc1 L_p1l_116
L_p1x_113:
s_add_u32 s7, s6, 0
s_add_u32 s4, s7, s3
s_and_b32 s4, s4, 3
s_and_b32 s7, s7, 3
s_sub_i32 s7, s4, s7
s_lshl_b32 s4, s7, 7
s_add_u32 s4, s4, s27
s_mul_i32 s5, s7, s35
s_add_u32 s5, s5, s28
s_add_u32 s32, s30, s36
s_add_u32 m0, s32, 0
s_nop 0
buffer_load_dwordx4 v24, s[8:11], s4 offen lds
s_add_u32 m0, s32, 1024
s_nop 0
buffer_load_dwordx4 v25, s[8:11], s4 offen lds
s_add_u32 m0, s32, 2048
s_nop 0
buffer_load_dwordx4 v26, s[8:11], s4 offen lds
s_add_u32 m0, s32, 3072
s_nop 0
buffer_load_dwordx4 v27, s[8:11], s4 offen lds
s_add_u32 s27, s27, 128
s_add_u32 s28, s28, s35
s_add_u32 s6, s6, 1
s_add_u32 s30, s30, 32768
s_cmp_ge_u32 s30, 131072
s_cselect_b32 s30, 0, s30
s_and_b32 s32, s27, 511
s_cmp_lg_u32 s32, 0
s_cbranch_scc1 L_x1_nosh_117
s_mov_b32 s32, 2
s_cmp_eq_u32 s27, 1024
s_cmov_b32 s32, 4294967293
s_cmp_eq_u32 s27, 1536
s_cmov_b32 s32, 4
s_mul_i32 s32, s32, s26
v_add_u32 v24, s32, v24
v_add_u32 v25, s32, v25
v_add_u32 v26, s32, v26
v_add_u32 v27, s32, v27
L_x1_nosh_117:
s_add_u32 s7, s6, 0
s_add_u32 s4, s7, s3
s_and_b32 s4, s4, 3
s_and_b32 s7, s7, 3
s_sub_i32 s7, s4, s7
s_lshl_b32 s4, s7, 7
s_add_u32 s4, s4, s27
s_mul_i32 s5, s7, s35
s_add_u32 s5, s5, s28
s_add_u32 s32, s30, s36
s_add_u32 m0, s32, 0
s_nop 0
buffer_load_dwordx4 v24, s[8:11], s4 offen lds
s_add_u32 m0, s32, 1024
s_nop 0
buffer_load_dwordx4 v25, s[8:11], s4 offen lds
s_add_u32 m0, s32, 2048
s_nop 0
buffer_load_dwordx4 v26, s[8:11], s4 offen lds
s_add_u32 m0, s32, 3072
s_nop 0
buffer_load_dwordx4 v27, s[8:11], s4 offen lds
s_add_u32 s27, s27, 128
s_add_u32 s28, s28, s35
s_add_u32 s6, s6, 1
s_add_u32 s30, s30, 32768
s_cmp_ge_u32 s30, 131072
s_cselect_b32 s30, 0, s30
s_and_b32 s32, s27, 511
s_cmp_lg_u32 s32, 0
s_cbranch_scc1 L_x1_nosh_118
s_mov_b32 s32, 2
s_cmp_eq_u32 s27, 1024
s_cmov_b32 s32, 4294967293
s_cmp_eq_u32 s27, 1536
s_cmov_b32 s32, 4
s_mul_i32 s32, s32, s26
v_add_u32 v24, s32, v24
v_add_u32 v25, s32, v25
v_add_u32 v26, s32, v26
v_add_u32 v27, s32, v27
L_x1_nosh_118:
s_waitcnt vmcnt(4)
s_barrier
s_add_u32 s7, s6, 0
s_add_u32 s4, s7, s3
s_and_b32 s4, s4, 3
s_and_b32 s7, s7, 3
s_sub_i32 s7, s4, s7
s_lshl_b32 s4, s7, 7
s_add_u32 s4, s4, s27
s_mul_i32 s5, s7, s35
s_add_u32 s5, s5, s28
s_add_u32 s32, s30, s36
s_add_u32 s33, s30, s37
s_add_u32 m0, s33, 0
s_nop 0
buffer_load_dwordx4 v28, s[12:15], s5 offen lds
s_add_u32 m0, s32, 0
s_nop 0
buffer_load_dwordx4 v24, s[8:11], s4 offen lds
s_add_u32 m0, s33, 1024
s_nop 0
buffer_load_dwordx4 v29, s[12:15], s5 offen lds
s_add_u32 m0, s32, 1024
s_nop 0
buffer_load_dwordx4 v25, s[8:11], s4 offen lds
s_add_u32 m0, s33, 2048
s_nop 0
buffer_load_dwordx4 v30, s[12:15], s5 offen lds
s_add_u32 m0, s32, 2048
s_nop 0
buffer_load_dwordx4 v26, s[8:11], s4 offen lds
s_add_u32 m0, s33, 3072
s_nop 0
buffer_load_dwordx4 v31, s[12:15], s5 offen lds
s_add_u32 m0, s32, 3072
s_nop 0
buffer_load_dwordx4 v27, s[8:11], s4 offen lds
s_add_u32 s27, s27, 128
s_add_u32 s28, s28, s35
s_add_u32 s6, s6, 1
s_add_u32 s30, s30, 32768
s_cmp_ge_u32 s30, 131072
s_cselect_b32 s30, 0, s30
s_and_b32 s32, s27, 511
s_cmp_lg_u32 s32, 0
s_cbranch_scc1 L_x1_nosh_119
s_mov_b32 s32, 2
s_cmp_eq_u32 s27, 1024
s_cmov_b32 s32, 4294967293
s_cmp_eq_u32 s27, 1536
s_cmov_b32 s32, 4
s_mul_i32 s32, s32, s26
v_add_u32 v24, s32, v24
v_add_u32 v25, s32, v25
v_add_u32 v26, s32, v26
v_add_u32 v27, s32, v27
L_x1_nosh_119:
s_add_u32 s7, s6, 0
s_add_u32 s4, s7, s3
s_and_b32 s4, s4, 3
s_and_b32 s7, s7, 3
s_sub_i32 s7, s4, s7
s_lshl_b32 s4, s7, 7
s_add_u32 s4, s4, s27
s_mul_i32 s5, s7, s35
s_add_u32 s5, s5, s28
s_add_u32 s32, s30, s36
s_add_u32 s33, s30, s37
s_add_u32 m0, s33, 0
s_nop 0
buffer_load_dwordx4 v28, s[12:15], s5 offen lds
s_add_u32 m0, s32, 0
s_nop 0
buffer_load_dwordx4 v24, s[8:11], s4 offen lds
s_add_u32 m0, s33, 1024
s_nop 0
buffer_load_dwordx4 v29, s[12:15], s5 offen lds
s_add_u32 m0, s32, 1024
s_nop 0
buffer_load_dwordx4 v25, s[8:11], s4 offen lds
s_add_u32 m0, s33, 2048
s_nop 0
buffer_load_dwordx4 v30, s[12:15], s5 offen lds
s_add_u32 m0, s32, 2048
s_nop 0
buffer_load_dwordx4 v26, s[8:11], s4 offen lds
s_add_u32 m0, s33, 3072
s_nop 0
buffer_load_dwordx4 v31, s[12:15], s5 offen lds
s_add_u32 m0, s32, 3072
s_nop 0
buffer_load_dwordx4 v27, s[8:11], s4 offen lds
s_add_u32 s27, s27, 128
s_add_u32 s28, s28, s35
s_add_u32 s6, s6, 1
s_add_u32 s30, s30, 32768
s_cmp_ge_u32 s30, 131072
s_cselect_b32 s30, 0, s30
s_and_b32 s32, s27, 511
s_cmp_lg_u32 s32, 0
s_cbranch_scc1 L_x1_nosh_120
s_mov_b32 s32, 2
s_cmp_eq_u32 s27, 1024
s_cmov_b32 s32, 4294967293
s_cmp_eq_u32 s27, 1536
s_cmov_b32 s32, 4
s_mul_i32 s32, s32, s26
v_add_u32 v24, s32, v24
v_add_u32 v25, s32, v25
v_add_u32 v26, s32, v26
v_add_u32 v27, s32, v27
L_x1_nosh_120:
s_mov_b32 s29, 4
L_x1_ld_121:
s_waitcnt vmcnt(16)
s_barrier
s_add_u32 s7, s6, 0
s_add_u32 s4, s7, s3
s_and_b32 s4, s4, 3
s_and_b32 s7, s7, 3
s_sub_i32 s7, s4, s7
s_lshl_b32 s4, s7, 7
s_add_u32 s4, s4, s27
s_mul_i32 s5, s7, s35
s_add_u32 s5, s5, s28
s_add_u32 s32, s30, s36
s_add_u32 s33, s30, s37
s_add_u32 m0, s33, 0
s_nop 0
buffer_load_dwordx4 v28, s[12:15], s5 offen lds
s_add_u32 m0, s32, 0
s_nop 0
buffer_load_dwordx4 v24, s[8:11], s4 offen lds
s_add_u32 m0, s33, 1024
s_nop 0
buffer_load_dwordx4 v29, s[12:15], s5 offen lds
s_add_u32 m0, s32, 1024
s_nop 0
buffer_load_dwordx4 v25, s[8:11], s4 offen lds
s_add_u32 m0, s33, 2048
s_nop 0
buffer_load_dwordx4 v30, s[12:15], s5 offen lds
s_add_u32 m0, s32, 2048
s_nop 0
buffer_load_dwordx4 v26, s[8:11], s4 offen lds
s_add_u32 m0, s33, 3072
s_nop 0
buffer_load_dwordx4 v31, s[12:15], s5 offen lds
s_add_u32 m0, s32, 3072
s_nop 0
buffer_load_dwordx4 v27, s[8:11], s4 offen lds
s_add_u32 s27, s27, 128
s_add_u32 s28, s28, s35
s_add_u32 s6, s6, 1
s_add_u32 s30, s30, 32768
s_cmp_ge_u32 s30, 131072
s_cselect_b32 s30, 0, s30
s_and_b32 s32, s27, 511
s_cmp_lg_u32 s32, 0
s_cbranch_scc1 L_x1_nosh_124
s_mov_b32 s32, 2
s_cmp_eq_u32 s27, 1024
s_cmov_b32 s32, 4294967293
s_cmp_eq_u32 s27, 1536
s_cmov_b32 s32, 4
s_mul_i32 s32, s32, s26
v_add_u32 v24, s32, v24
v_add_u32 v25, s32, v25
v_add_u32 v26, s32, v26
v_add_u32 v27, s32, v27
L_x1_nosh_124:
s_add_u32 s29, s29, 1
s_cmp_lt_u32 s29, 16
s_cbranch_scc1 L_x1_ld_121
s_bfe_u32 s5, s2, 0x10002
s_bfe_u32 s6, s2, 0x10001
s_lshr_b32 s4, s2, 3
s_lshr_b32 s7, s4, 2
s_and_b32 s4, s4, 3
s_lshl_b32 s5, s5, 3
s_add_u32 s58, s5, s7
s_lshl_b32 s6, s6, 2
s_add_u32 s59, s6, s4
s_mul_i32 s3, s7, 1
s_mul_i32 s31, s4, 0
s_add_u32 s3, s3, s31
s_lshl_b32 s21, s58, 7
s_lshl_b32 s22, s59, 8
s_lshl_b32 s22, s59, 9
s_mov_b32 s26, 2048
s_mov_b32 s27, 0
s_mov_b32 s28, 0
s_mov_b32 s25, 7168
s_mov_b32 s23, 128
s_mov_b32 s24, 64
s_mov_b32 s35, 458752
s_add_u32 s8, s86, 12582912
s_addc_u32 s9, s87, 0
s_mov_b32 s10, 4194304
s_mov_b32 s11, 0x20000
s_mov_b32 s12, s76
s_mov_b32 s13, s77
s_mov_b32 s14, 7340032
s_mov_b32 s15, 0x20000
s_sub_u32 s31, s20, 4
s_mul_i32 s36, s31, 4096
s_mul_i32 s37, s31, 8192
s_add_u32 s37, s37, 16384
s_mov_b32 s30, 0
s_mov_b32 s39, 0
s_mov_b32 s6, 0
s_waitcnt vmcnt(16)
s_barrier
s_waitcnt vmcnt(8)
s_barrier
s_waitcnt vmcnt(0)
s_barrier
s_barrier
s_add_u32 s33, s37, 0
s_add_u32 s7, s6, 0
s_add_u32 s4, s7, s3
s_and_b32 s4, s4, 3
s_and_b32 s7, s7, 3
s_sub_i32 s7, s4, s7
s_lshl_b32 s4, s7, 7
s_add_u32 s4, s4, s27
s_mul_i32 s5, s7, s35
s_add_u32 s5, s5, s28
s_add_u32 m0, s33, 0
s_nop 0
buffer_load_dwordx4 v204, s[12:15], s5 offen lds
s_add_u32 m0, s33, 1024
s_nop 0
buffer_load_dwordx4 v205, s[12:15], s5 offen lds
s_add_u32 m0, s33, 2048
s_nop 0
buffer_load_dwordx4 v206, s[12:15], s5 offen lds
s_add_u32 m0, s33, 3072
s_nop 0
buffer_load_dwordx4 v207, s[12:15], s5 offen lds
s_add_u32 m0, s33, 4096
s_nop 0
buffer_load_dwordx4 v208, s[12:15], s5 offen lds
s_add_u32 m0, s33, 5120
s_nop 0
buffer_load_dwordx4 v209, s[12:15], s5 offen lds
s_add_u32 m0, s33, 6144
s_nop 0
buffer_load_dwordx4 v210, s[12:15], s5 offen lds
s_add_u32 m0, s33, 7168
s_nop 0
buffer_load_dwordx4 v211, s[12:15], s5 offen lds
s_add_u32 s33, s37, 49152
s_add_u32 s7, s6, 1
s_add_u32 s4, s7, s3
s_and_b32 s4, s4, 3
s_and_b32 s7, s7, 3
s_sub_i32 s7, s4, s7
s_add_i32 s7, s7, 1
s_lshl_b32 s4, s7, 7
s_add_u32 s4, s4, s27
s_mul_i32 s5, s7, s35
s_add_u32 s5, s5, s28
s_add_u32 m0, s33, 0
s_nop 0
buffer_load_dwordx4 v204, s[12:15], s5 offen lds
s_add_u32 m0, s33, 1024
s_nop 0
buffer_load_dwordx4 v205, s[12:15], s5 offen lds
s_add_u32 m0, s33, 2048
s_nop 0
buffer_load_dwordx4 v206, s[12:15], s5 offen lds
s_add_u32 m0, s33, 3072
s_nop 0
buffer_load_dwordx4 v207, s[12:15], s5 offen lds
s_add_u32 m0, s33, 4096
s_nop 0
buffer_load_dwordx4 v208, s[12:15], s5 offen lds
s_add_u32 m0, s33, 5120
s_nop 0
buffer_load_dwordx4 v209, s[12:15], s5 offen lds
s_add_u32 m0, s33, 6144
s_nop 0
buffer_load_dwordx4 v210, s[12:15], s5 offen lds
s_add_u32 m0, s33, 7168
s_nop 0
buffer_load_dwordx4 v211, s[12:15], s5 offen lds
s_add_u32 s33, s37, 98304
s_add_u32 s7, s6, 2
s_add_u32 s4, s7, s3
s_and_b32 s4, s4, 3
s_and_b32 s7, s7, 3
s_sub_i32 s7, s4, s7
s_add_i32 s7, s7, 2
s_lshl_b32 s4, s7, 7
s_add_u32 s4, s4, s27
s_mul_i32 s5, s7, s35
s_add_u32 s5, s5, s28
s_add_u32 m0, s33, 0
s_nop 0
buffer_load_dwordx4 v204, s[12:15], s5 offen lds
s_add_u32 m0, s33, 1024
s_nop 0
buffer_load_dwordx4 v205, s[12:15], s5 offen lds
s_add_u32 m0, s33, 2048
s_nop 0
buffer_load_dwordx4 v206, s[12:15], s5 offen lds
s_add_u32 m0, s33, 3072
s_nop 0
buffer_load_dwordx4 v207, s[12:15], s5 offen lds
s_add_u32 m0, s33, 4096
s_nop 0
buffer_load_dwordx4 v208, s[12:15], s5 offen lds
s_add_u32 m0, s33, 5120
s_nop 0
buffer_load_dwordx4 v209, s[12:15], s5 offen lds
s_add_u32 m0, s33, 6144
s_nop 0
buffer_load_dwordx4 v210, s[12:15], s5 offen lds
s_add_u32 m0, s33, 7168
s_nop 0
buffer_load_dwordx4 v211, s[12:15], s5 offen lds
s_and_b32 s56, s2, 1
s_bfe_u32 s5, s2, 0x10002
s_bfe_u32 s6, s2, 0x10001
s_lshr_b32 s4, s2, 3
s_lshr_b32 s7, s4, 2
s_and_b32 s4, s4, 3
s_lshl_b32 s5, s5, 3
s_add_u32 s58, s5, s7
s_lshl_b32 s6, s6, 2
s_add_u32 s59, s6, s4
s_mul_i32 s3, s7, 1
s_mul_i32 s31, s4, 0
s_add_u32 s3, s3, s31
s_lshl_b32 s21, s58, 7
s_lshl_b32 s22, s59, 8
s_mov_b32 s51, 32
s_mov_b32 s57, 8
s_cmp_eq_u32 s56, 1
s_cmov_b32 s51, 28
s_cmov_b32 s57, 8
s_sub_u32 s98, s51, 1
s_mov_b32 s99, 3
s_lshl_b32 s101, s56, 5
s_mov_b32 s26, 2048
s_mov_b32 s27, 0
s_mov_b32 s28, 0
s_mov_b32 s25, 2048
s_mov_b32 s23, 128
s_mov_b32 s24, 64
s_mov_b32 s35, 131072
s_mul_i32 s27, s56, 1024
s_mul_i32 s28, s56, 1048576
s_add_u32 s8, s86, 8388608
s_addc_u32 s9, s87, 0
s_mov_b32 s10, 4194304
s_mov_b32 s11, 0x20000
s_mov_b32 s12, s68
s_mov_b32 s13, s69
s_mov_b32 s14, 2097152
s_mov_b32 s15, 0x20000
s_sub_u32 s31, s20, 4
s_mul_i32 s32, s31, 256
s_add_u32 s32, s32, 0
v_add_u32 v2, s32, v254
v_lshrrev_b32 v3, 4, v2
v_and_b32 v4, 15, v2
v_and_b32 v5, 3, v3
v_bfe_u32 v2, v3, 3, 1
v_lshl_or_b32 v5, v2, 2, v5
v_lshlrev_b32 v5, 1, v5
v_xor_b32 v4, v4, v5
v_mul_lo_u32 v3, v3, s25
v_lshrrev_b32 v2, 3, v4
v_mul_lo_u32 v2, v2, s23
v_add_u32 v3, v3, v2
v_bfe_u32 v2, v4, 2, 1
v_mul_lo_u32 v2, v2, s24
v_add_u32 v3, v3, v2
v_and_b32 v2, 3, v4
v_lshl_add_u32 v3, v2, 4, v3
v_add_u32 v216, s22, v3
s_mul_i32 s32, s31, 256
s_add_u32 s32, s32, 64
v_add_u32 v2, s32, v254
v_lshrrev_b32 v3, 4, v2
v_and_b32 v4, 15, v2
v_and_b32 v5, 3, v3
v_bfe_u32 v2, v3, 3, 1
v_lshl_or_b32 v5, v2, 2, v5
v_lshlrev_b32 v5, 1, v5
v_xor_b32 v4, v4, v5
v_mul_lo_u32 v3, v3, s25
v_lshrrev_b32 v2, 3, v4
v_mul_lo_u32 v2, v2, s23
v_add_u32 v3, v3, v2
v_bfe_u32 v2, v4, 2, 1
v_mul_lo_u32 v2, v2, s24
v_add_u32 v3, v3, v2
v_and_b32 v2, 3, v4
v_lshl_add_u32 v3, v2, 4, v3
v_add_u32 v217, s22, v3
s_mul_i32 s32, s31, 256
s_add_u32 s32, s32, 128
v_add_u32 v2, s32, v254
v_lshrrev_b32 v3, 4, v2
v_and_b32 v4, 15, v2
v_and_b32 v5, 3, v3
v_bfe_u32 v2, v3, 3, 1
v_lshl_or_b32 v5, v2, 2, v5
v_lshlrev_b32 v5, 1, v5
v_xor_b32 v4, v4, v5
v_mul_lo_u32 v3, v3, s25
v_lshrrev_b32 v2, 3, v4
v_mul_lo_u32 v2, v2, s23
v_add_u32 v3, v3, v2
v_bfe_u32 v2, v4, 2, 1
v_mul_lo_u32 v2, v2, s24
v_add_u32 v3, v3, v2
v_and_b32 v2, 3, v4
v_lshl_add_u32 v3, v2, 4, v3
v_add_u32 v218, s22, v3
s_mul_i32 s32, s31, 256
s_add_u32 s32, s32, 192
v_add_u32 v2, s32, v254
v_lshrrev_b32 v3, 4, v2
v_and_b32 v4, 15, v2
v_and_b32 v5, 3, v3
v_bfe_u32 v2, v3, 3, 1
v_lshl_or_b32 v5, v2, 2, v5
v_lshlrev_b32 v5, 1, v5
v_xor_b32 v4, v4, v5
v_mul_lo_u32 v3, v3, s25
v_lshrrev_b32 v2, 3, v4
v_mul_lo_u32 v2, v2, s23
v_add_u32 v3, v3, v2
v_bfe_u32 v2, v4, 2, 1
v_mul_lo_u32 v2, v2, s24
v_add_u32 v3, v3, v2
v_and_b32 v2, 3, v4
v_lshl_add_u32 v3, v2, 4, v3
v_add_u32 v219, s22, v3
s_mul_i32 s32, s31, 32
s_add_u32 s32, s32, 0
v_lshrrev_b32 v3, 3, v254
v_add_u32 v3, s32, v3
v_bfe_u32 v5, v3, 1, 3
v_and_b32 v4, 7, v254
v_xor_b32 v4, v4, v5
v_xor_b32 v3, s101, v3
v_add_u32 v3, s21, v3
v_mul_u32_u24 v2, 7168, v3
v_lshl_add_u32 v220, v4, 4, v2
v_mul_lo_u32 v3, v3, s26
v_lshl_add_u32 v212, v4, 4, v3
s_mul_i32 s32, s31, 32
s_add_u32 s32, s32, 8
v_lshrrev_b32 v3, 3, v254
v_add_u32 v3, s32, v3
v_bfe_u32 v5, v3, 1, 3
v_and_b32 v4, 7, v254
v_xor_b32 v4, v4, v5
v_xor_b32 v3, s101, v3
v_add_u32 v3, s21, v3
v_mul_u32_u24 v2, 7168, v3
v_lshl_add_u32 v221, v4, 4, v2
v_mul_lo_u32 v3, v3, s26
v_lshl_add_u32 v213, v4, 4, v3
s_lshl_b32 s32, s26, 4
v_add_u32 v214, s32, v212
v_add_u32 v222, 114688, v220
s_lshl_b32 s32, s26, 4
v_add_u32 v215, s32, v213
v_add_u32 v223, 114688, v221
s_bfe_u32 s5, s2, 0x10002
s_bfe_u32 s6, s2, 0x10001
s_lshr_b32 s4, s2, 3
s_lshr_b32 s7, s4, 2
s_and_b32 s4, s4, 3
s_lshl_b32 s5, s5, 3
s_add_u32 s58, s5, s7
s_lshl_b32 s6, s6, 2
s_add_u32 s59, s6, s4
s_mul_i32 s3, s7, 1
s_mul_i32 s31, s4, 0
s_add_u32 s3, s3, s31
s_lshl_b32 s21, s58, 7
s_lshl_b32 s22, s59, 8
s_lshl_b32 s22, s59, 9
s_mov_b32 s26, 2048
s_mov_b32 s27, 0
s_mov_b32 s28, 0
s_mov_b32 s25, 7168
s_mov_b32 s23, 128
s_mov_b32 s24, 64
s_mov_b32 s35, 458752
s_add_u32 s8, s86, 12582912
s_addc_u32 s9, s87, 0
s_mov_b32 s10, 4194304
s_mov_b32 s11, 0x20000
s_mov_b32 s12, s76
s_mov_b32 s13, s77
s_mov_b32 s14, 7340032
s_mov_b32 s15, 0x20000
s_sub_u32 s31, s20, 4
s_mul_i32 s36, s31, 4096
s_mul_i32 s37, s31, 8192
s_add_u32 s37, s37, 16384
s_mov_b32 s30, 0
s_mov_b32 s39, 0
s_mov_b32 s6, 0
s_lshl_b32 s32, s58, 10
s_add_u32 s32, s32, 38813696
v_and_b32 v40, 31, v254
v_lshlrev_b32 v40, 4, v40
v_mov_b32 v42, 150024
s_cmp_lg_u32 s20, 4
s_cbranch_scc1 L_p1o_125
s_mov_b32 s50, 0
L_poll_127:
buffer_load_dword v41, v40, s[16:19], s32 offen sc0 sc1
s_waitcnt vmcnt(0)
v_cmp_eq_u32 vcc, 0, v41
s_cmp_eq_u64 vcc, 0
s_cbranch_scc1 L_pollx_128
s_sleep 4
s_add_u32 s50, s50, 1
s_cmp_lt_u32 s50, 100000
s_cbranch_scc1 L_poll_127
L_pollx_128:
v_mov_b32 v41, 2
ds_write_b32 v42, v41
s_branch L_p1x_126
L_p1o_125:
s_mov_b32 s50, 0
L_p1l_129:
ds_read_b32 v41, v42
s_waitcnt lgkmcnt(0)
v_readfirstlane_b32 s34, v41
s_cmp_ge_u32 s34, 2
s_cbranch_scc1 L_p1x_126
s_sleep 1
s_add_u32 s50, s50, 1
s_cmp_lt_u32 s50, 800000
s_cbranch_scc1 L_p1l_129
L_p1x_126:
s_add_u32 s7, s6, 0
s_add_u32 s4, s7, s3
s_and_b32 s4, s4, 3
s_and_b32 s7, s7, 3
s_sub_i32 s7, s4, s7
s_lshl_b32 s4, s7, 7
s_add_u32 s4, s4, s27
s_mul_i32 s5, s7, s35
s_add_u32 s5, s5, s28
s_add_u32 s32, s30, s36
s_add_u32 m0, s32, 0
s_nop 0
buffer_load_dwordx4 v200, s[8:11], s4 offen lds
s_add_u32 m0, s32, 1024
s_nop 0
buffer_load_dwordx4 v201, s[8:11], s4 offen lds
s_add_u32 m0, s32, 2048
s_nop 0
buffer_load_dwordx4 v202, s[8:11], s4 offen lds
s_add_u32 m0, s32, 3072
s_nop 0
buffer_load_dwordx4 v203, s[8:11], s4 offen lds
s_add_u32 s27, s27, 128
s_add_u32 s28, s28, s35
s_add_u32 s6, s6, 1
s_add_u32 s30, s30, 49152
s_cmp_ge_u32 s30, 147456
s_cselect_b32 s30, 0, s30
s_add_u32 s7, s6, 0
s_add_u32 s4, s7, s3
s_and_b32 s4, s4, 3
s_and_b32 s7, s7, 3
s_sub_i32 s7, s4, s7
s_lshl_b32 s4, s7, 7
s_add_u32 s4, s4, s27
s_mul_i32 s5, s7, s35
s_add_u32 s5, s5, s28
s_add_u32 s32, s30, s36
s_add_u32 m0, s32, 0
s_nop 0
buffer_load_dwordx4 v200, s[8:11], s4 offen lds
s_add_u32 m0, s32, 1024
s_nop 0
buffer_load_dwordx4 v201, s[8:11], s4 offen lds
s_add_u32 m0, s32, 2048
s_nop 0
buffer_load_dwordx4 v202, s[8:11], s4 offen lds
s_add_u32 m0, s32, 3072
s_nop 0
buffer_load_dwordx4 v203, s[8:11], s4 offen lds
s_add_u32 s27, s27, 128
s_add_u32 s28, s28, s35
s_add_u32 s6, s6, 1
s_add_u32 s30, s30, 49152
s_cmp_ge_u32 s30, 147456
s_cselect_b32 s30, 0, s30
s_add_u32 s7, s6, 0
s_add_u32 s4, s7, s3
s_and_b32 s4, s4, 3
s_and_b32 s7, s7, 3
s_sub_i32 s7, s4, s7
s_lshl_b32 s4, s7, 7
s_add_u32 s4, s4, s27
s_mul_i32 s5, s7, s35
s_add_u32 s5, s5, s28
s_add_u32 s32, s30, s36
s_add_u32 m0, s32, 0
s_nop 0
buffer_load_dwordx4 v200, s[8:11], s4 offen lds
s_add_u32 m0, s32, 1024
s_nop 0
buffer_load_dwordx4 v201, s[8:11], s4 offen lds
s_add_u32 m0, s32, 2048
s_nop 0
buffer_load_dwordx4 v202, s[8:11], s4 offen lds
s_add_u32 m0, s32, 3072
s_nop 0
buffer_load_dwordx4 v203, s[8:11], s4 offen lds
s_add_u32 s27, s27, 128
s_add_u32 s28, s28, s35
s_add_u32 s6, s6, 1
s_add_u32 s30, s30, 49152
s_cmp_ge_u32 s30, 147456
s_cselect_b32 s30, 0, s30
s_waitcnt vmcnt(8)
s_barrier
s_waitcnt vmcnt(4)
s_barrier
s_add_u32 s7, s6, 0
s_add_u32 s4, s7, s3
s_and_b32 s4, s4, 3
s_and_b32 s7, s7, 3
s_sub_i32 s7, s4, s7
s_lshl_b32 s4, s7, 7
s_add_u32 s4, s4, s27
s_mul_i32 s5, s7, s35
s_add_u32 s5, s5, s28
s_add_u32 s32, s30, s36
s_add_u32 s33, s30, s37
s_add_u32 m0, s33, 0
s_nop 0
buffer_load_dwordx4 v204, s[12:15], s5 offen lds
s_add_u32 m0, s32, 0
s_nop 0
buffer_load_dwordx4 v200, s[8:11], s4 offen lds
s_add_u32 m0, s33, 1024
s_nop 0
buffer_load_dwordx4 v205, s[12:15], s5 offen lds
s_add_u32 m0, s32, 1024
s_nop 0
buffer_load_dwordx4 v201, s[8:11], s4 offen lds
s_add_u32 m0, s33, 2048
s_nop 0
buffer_load_dwordx4 v206, s[12:15], s5 offen lds
s_add_u32 m0, s32, 2048
s_nop 0
buffer_load_dwordx4 v202, s[8:11], s4 offen lds
s_add_u32 m0, s33, 3072
s_nop 0
buffer_load_dwordx4 v207, s[12:15], s5 offen lds
s_add_u32 m0, s32, 3072
s_nop 0
buffer_load_dwordx4 v203, s[8:11], s4 offen lds
s_add_u32 m0, s33, 4096
s_nop 0
buffer_load_dwordx4 v208, s[12:15], s5 offen lds
s_add_u32 m0, s33, 5120
s_nop 0
buffer_load_dwordx4 v209, s[12:15], s5 offen lds
s_add_u32 m0, s33, 6144
s_nop 0
buffer_load_dwordx4 v210, s[12:15], s5 offen lds
s_add_u32 m0, s33, 7168
s_nop 0
buffer_load_dwordx4 v211, s[12:15], s5 offen lds
s_add_u32 s27, s27, 128
s_add_u32 s28, s28, s35
s_add_u32 s6, s6, 1
s_add_u32 s30, s30, 49152
s_cmp_ge_u32 s30, 147456
s_cselect_b32 s30, 0, s30
s_mov_b32 s29, 4
s_mov_b32 s93, 4096
L_s5_ld_130:
s_waitcnt vmcnt(12)
s_barrier
s_add_u32 s7, s6, 0
s_add_u32 s4, s7, s3
s_and_b32 s4, s4, 3
s_and_b32 s7, s7, 3
s_sub_i32 s7, s4, s7
s_lshl_b32 s4, s7, 7
s_add_u32 s4, s4, s27
s_mul_i32 s5, s7, s35
s_add_u32 s5, s5, s28
s_add_u32 s32, s30, s36
s_add_u32 s33, s30, s37
s_add_u32 m0, s33, 0
s_nop 0
buffer_load_dwordx4 v204, s[12:15], s5 offen lds
s_add_u32 m0, s32, 0
s_nop 0
buffer_load_dwordx4 v200, s[8:11], s4 offen lds
s_add_u32 m0, s33, 1024
s_nop 0
buffer_load_dwordx4 v205, s[12:15], s5 offen lds
s_add_u32 m0, s32, 1024
s_nop 0
buffer_load_dwordx4 v201, s[8:11], s4 offen lds
s_add_u32 m0, s33, 2048
s_nop 0
buffer_load_dwordx4 v206, s[12:15], s5 offen lds
s_add_u32 m0, s32, 2048
s_nop 0
buffer_load_dwordx4 v202, s[8:11], s4 offen lds
s_add_u32 m0, s33, 3072
s_nop 0
buffer_load_dwordx4 v207, s[12:15], s5 offen lds
s_add_u32 m0, s32, 3072
s_nop 0
buffer_load_dwordx4 v203, s[8:11], s4 offen lds
s_add_u32 m0, s33, 4096
s_nop 0
buffer_load_dwordx4 v208, s[12:15], s5 offen lds
s_add_u32 m0, s33, 5120
s_nop 0
buffer_load_dwordx4 v209, s[12:15], s5 offen lds
s_add_u32 m0, s33, 6144
s_nop 0
buffer_load_dwordx4 v210, s[12:15], s5 offen lds
s_add_u32 m0, s33, 7168
s_nop 0
buffer_load_dwordx4 v211, s[12:15], s5 offen lds
s_add_u32 s27, s27, 128
s_add_u32 s28, s28, s35
s_add_u32 s6, s6, 1
s_add_u32 s30, s30, 49152
s_cmp_ge_u32 s30, 147456
s_cselect_b32 s30, 0, s30
s_bitcmp1_b32 s93, s29
s_cbranch_scc1 L_s5_H_133
L_s5_B_134:
s_add_u32 s29, s29, 1
s_cmp_lt_u32 s29, 16
s_cbranch_scc1 L_s5_ld_130
s_lshl_b32 s62, s59, 2
s_add_u32 s62, s62, s31
s_mov_b32 s61, s31
v_and_b32 v40, 15, v254
v_mul_u32_u24 v40, 896, v40
s_lshl_b32 s32, s62, 4
s_add_u32 s32, s32, 38895616
v_cmp_eq_u32 vcc, 0, v41
s_cmp_eq_u64 vcc, 0
s_cbranch_scc1 L_nbok_136
s_mov_b32 s50, 0
L_poll_137:
buffer_load_dword v41, v40, s[16:19], s32 offen sc0 sc1
s_waitcnt vmcnt(0)
v_cmp_eq_u32 vcc, 0, v41
s_cmp_eq_u64 vcc, 0
s_cbranch_scc1 L_pollx_138
s_sleep 4
s_add_u32 s50, s50, 1
s_cmp_lt_u32 s50, 100000
s_cbranch_scc1 L_poll_137
L_pollx_138:
L_nbok_136:
v_and_b32 v64, 15, v254
v_lshlrev_b32 v64, 4, v64
v_lshrrev_b32 v65, 4, v254
v_mul_u32_u24 v65, 14336, v65
v_add_u32 v65, v65, v64
s_lshl_b32 s33, s62, 8
s_add_u32 s33, s33, 36962304
buffer_load_dwordx4 v[72:75], v65, s[16:19], s33 offen
s_add_u32 s33, s33, 57344
buffer_load_dwordx4 v[76:79], v65, s[16:19], s33 offen
s_add_u32 s33, s33, 57344
buffer_load_dwordx4 v[80:83], v65, s[16:19], s33 offen
s_add_u32 s33, s33, 57344
buffer_load_dwordx4 v[84:87], v65, s[16:19], s33 offen
s_add_u32 s33, s33, 57344
s_lshl_b32 s61, s61, 8
s_add_u32 s61, s61, 155200
v_add_u32 v64, s61, v64
v_mov_b32 v90, 1015021568
s_lshl_b32 s32, s31, 5
s_add_u32 s32, s32, s21
s_lshl_b32 s32, s32, 3
s_add_u32 s32, s32, 37748736
v_and_b32 v66, 15, v254
v_lshlrev_b32 v66, 4, v66
v_lshrrev_b32 v67, 4, v254
v_lshl_add_u32 v67, v67, 16, v66
buffer_load_dwordx4 v[96:99], v67, s[16:19], s32 offen
s_add_u32 s32, s32, 16384
buffer_load_dwordx4 v[100:103], v67, s[16:19], s32 offen
s_add_u32 s32, s32, 16384
buffer_load_dwordx4 v[104:107], v67, s[16:19], s32 offen
s_add_u32 s32, s32, 16384
buffer_load_dwordx4 v[108:111], v67, s[16:19], s32 offen
s_add_u32 s32, s32, 16384
s_lshl_b32 s32, s31, 9
s_add_u32 m0, s32, 147456
s_lshl_b32 s33, s21, 4
s_add_u32 s33, s33, s32
s_add_u32 s33, s33, 36700160
v_lshlrev_b32 v43, 4, v254
s_mov_b32 exec_hi, 0
buffer_load_dwordx4 v43, s[16:19], s33 offen lds
s_mov_b32 exec_hi, -1
s_waitcnt vmcnt(21)
s_barrier
s_and_b32 s56, s2, 1
s_bfe_u32 s5, s2, 0x10002
s_bfe_u32 s6, s2, 0x10001
s_lshr_b32 s4, s2, 3
s_lshr_b32 s7, s4, 2
s_and_b32 s4, s4, 3
s_lshl_b32 s5, s5, 3
s_add_u32 s58, s5, s7
s_lshl_b32 s6, s6, 2
s_add_u32 s59, s6, s4
s_mul_i32 s3, s7, 1
s_mul_i32 s31, s4, 0
s_add_u32 s3, s3, s31
s_lshl_b32 s21, s58, 7
s_lshl_b32 s22, s59, 8
s_mov_b32 s51, 32
s_mov_b32 s57, 8
s_cmp_eq_u32 s56, 1
s_cmov_b32 s51, 28
s_cmov_b32 s57, 8
s_sub_u32 s98, s51, 1
s_mov_b32 s99, 3
s_lshl_b32 s101, s56, 5
s_mov_b32 s26, 2048
s_mov_b32 s27, 0
s_mov_b32 s28, 0
s_mov_b32 s25, 2048
s_mov_b32 s23, 128
s_mov_b32 s24, 64
s_mov_b32 s35, 131072
s_mul_i32 s27, s56, 1024
s_mul_i32 s28, s56, 1048576
s_add_u32 s8, s86, 8388608
s_addc_u32 s9, s87, 0
s_mov_b32 s10, 4194304
s_mov_b32 s11, 0x20000
s_mov_b32 s12, s68
s_mov_b32 s13, s69
s_mov_b32 s14, 2097152
s_mov_b32 s15, 0x20000
s_sub_u32 s31, s20, 4
s_mul_i32 s36, s31, 4096
s_mul_i32 s37, s31, 4096
s_add_u32 s37, s37, 16384
s_mov_b32 s30, 0
s_mov_b32 s39, 0
s_mov_b32 s6, 0
s_waitcnt vmcnt(0)
v_pk_add_f32 v[72:73], v[72:73], v[76:77]
v_pk_add_f32 v[80:81], v[80:81], v[84:85]
v_pk_add_f32 v[74:75], v[74:75], v[78:79]
v_pk_add_f32 v[82:83], v[82:83], v[86:87]
v_pk_add_f32 v[72:73], v[72:73], v[80:81]
v_pk_add_f32 v[74:75], v[74:75], v[82:83]
v_mov_b32 v76, v72
v_mov_b32 v77, v73
v_mov_b32 v78, v74
v_mov_b32 v79, v75
v_permlane16_swap_b32 v72, v76
v_permlane16_swap_b32 v73, v77
v_permlane16_swap_b32 v74, v78
v_permlane16_swap_b32 v75, v79
v_add_f32 v72, v72, v76
v_add_f32 v73, v73, v77
v_add_f32 v74, v74, v78
v_add_f32 v75, v75, v79
v_mov_b32 v76, v72
v_mov_b32 v77, v73
v_mov_b32 v78, v74
v_mov_b32 v79, v75
v_permlane32_swap_b32 v72, v76
v_permlane32_swap_b32 v73, v77
v_permlane32_swap_b32 v74, v78
v_permlane32_swap_b32 v75, v79
v_add_f32 v72, v72, v76
v_add_f32 v73, v73, v77
v_add_f32 v74, v74, v78
v_add_f32 v75, v75, v79
ds_write_b128 v64, v[72:75]
s_barrier
v_pk_add_f32 v[68:69], v[96:97], v[100:101]
v_pk_add_f32 v[112:113], v[104:105], v[108:109]
v_pk_add_f32 v[70:71], v[98:99], v[102:103]
v_pk_add_f32 v[114:115], v[106:107], v[110:111]
v_pk_add_f32 v[68:69], v[68:69], v[112:113]
v_pk_add_f32 v[70:71], v[70:71], v[114:115]
v_mov_b32 v112, v68
v_mov_b32 v113, v70
s_nop 1
v_permlane16_swap_b32 v68, v112
v_permlane16_swap_b32 v70, v113
s_nop 1
v_add_f32 v68, v68, v112
v_add_f32 v70, v70, v113
v_mov_b32 v112, v68
v_mov_b32 v113, v70
s_nop 1
v_permlane32_swap_b32 v68, v112
v_permlane32_swap_b32 v70, v113
s_nop 1
v_add_f32 v68, v68, v112
v_add_f32 v70, v70, v113
v_mul_f32 v68, 981467136, v68
v_mul_f32 v70, 981467136, v70
v_fma_f32 v112, v96, v90, -v68
v_fma_f32 v113, v98, v90, -v70
v_fma_f32 v114, v100, v90, -v68
v_fma_f32 v115, v102, v90, -v70
v_fma_f32 v116, v104, v90, -v68
v_fma_f32 v117, v106, v90, -v70
v_fma_f32 v118, v108, v90, -v68
v_fma_f32 v119, v110, v90, -v70
v_mul_f32 v112, v112, v112
v_mul_f32 v113, v113, v113
v_mul_f32 v114, v114, v114
v_mul_f32 v115, v115, v115
v_mul_f32 v116, v116, v116
v_mul_f32 v117, v117, v117
v_mul_f32 v118, v118, v118
v_mul_f32 v119, v119, v119
v_fmac_f32 v69, 1115684864, v112
v_fmac_f32 v71, 1115684864, v113
v_fmac_f32 v69, 1115684864, v114
v_fmac_f32 v71, 1115684864, v115
v_fmac_f32 v69, 1115684864, v116
v_fmac_f32 v71, 1115684864, v117
v_fmac_f32 v69, 1115684864, v118
v_fmac_f32 v71, 1115684864, v119
v_mov_b32 v112, v69
v_mov_b32 v113, v71
s_nop 1
v_permlane16_swap_b32 v69, v112
v_permlane16_swap_b32 v71, v113
s_nop 1
v_add_f32 v69, v69, v112
v_add_f32 v71, v71, v113
v_mov_b32 v112, v69
v_mov_b32 v113, v71
s_nop 1
v_permlane32_swap_b32 v69, v112
v_permlane32_swap_b32 v71, v113
s_nop 1
v_add_f32 v69, v69, v112
v_add_f32 v71, v71, v113
v_mov_b32 v112, 925353388
v_fmac_f32 v112, 981467136, v69
v_rsq_f32 v112, v112
v_mov_b32 v114, 925353388
v_fmac_f32 v114, 981467136, v71
v_rsq_f32 v114, v114
s_nop 0
v_mov_b32 v113, v68
v_mov_b32 v115, v70
s_lshl_b32 s32, s31, 8
s_add_u32 s32, s32, 154176
v_add_u32 v66, s32, v66
ds_write_b128 v66, v[112:115]
s_waitcnt lgkmcnt(0)
s_barrier
s_branch L_l_s5_97
L_l_att_96:
s_sub_u32 s31, s20, 4
s_mul_i32 s32, s31, 512
s_add_u32 s32, s32, 0
v_add_u32 v2, s32, v254
v_lshrrev_b32 v3, 5, v2
v_and_b32 v4, 31, v2
v_and_b32 v5, 3, v3
v_bfe_u32 v2, v3, 3, 1
v_lshl_or_b32 v5, v2, 2, v5
v_lshlrev_b32 v5, 1, v5
v_xor_b32 v4, v4, v5
v_mul_lo_u32 v3, v3, s25
v_lshrrev_b32 v2, 4, v4
v_mul_u32_u24 v2, 2048, v2
v_add_u32 v3, v3, v2
v_and_b32 v2, 15, v4
v_lshl_add_u32 v3, v2, 4, v3
v_add_u32 v14, s22, v3
s_mul_i32 s32, s31, 512
s_add_u32 s32, s32, 64
v_add_u32 v2, s32, v254
v_lshrrev_b32 v3, 5, v2
v_and_b32 v4, 31, v2
v_and_b32 v5, 3, v3
v_bfe_u32 v2, v3, 3, 1
v_lshl_or_b32 v5, v2, 2, v5
v_lshlrev_b32 v5, 1, v5
v_xor_b32 v4, v4, v5
v_mul_lo_u32 v3, v3, s25
v_lshrrev_b32 v2, 4, v4
v_mul_u32_u24 v2, 2048, v2
v_add_u32 v3, v3, v2
v_and_b32 v2, 15, v4
v_lshl_add_u32 v3, v2, 4, v3
v_add_u32 v15, s22, v3
s_mul_i32 s32, s31, 512
s_add_u32 s32, s32, 128
v_add_u32 v2, s32, v254
v_lshrrev_b32 v3, 5, v2
v_and_b32 v4, 31, v2
v_and_b32 v5, 3, v3
v_bfe_u32 v2, v3, 3, 1
v_lshl_or_b32 v5, v2, 2, v5
v_lshlrev_b32 v5, 1, v5
v_xor_b32 v4, v4, v5
v_mul_lo_u32 v3, v3, s25
v_lshrrev_b32 v2, 4, v4
v_mul_u32_u24 v2, 2048, v2
v_add_u32 v3, v3, v2
v_and_b32 v2, 15, v4
v_lshl_add_u32 v3, v2, 4, v3
v_add_u32 v16, s22, v3
s_mul_i32 s32, s31, 512
s_add_u32 s32, s32, 192
v_add_u32 v2, s32, v254
v_lshrrev_b32 v3, 5, v2
v_and_b32 v4, 31, v2
v_and_b32 v5, 3, v3
v_bfe_u32 v2, v3, 3, 1
v_lshl_or_b32 v5, v2, 2, v5
v_lshlrev_b32 v5, 1, v5
v_xor_b32 v4, v4, v5
v_mul_lo_u32 v3, v3, s25
v_lshrrev_b32 v2, 4, v4
v_mul_u32_u24 v2, 2048, v2
v_add_u32 v3, v3, v2
v_and_b32 v2, 15, v4
v_lshl_add_u32 v3, v2, 4, v3
v_add_u32 v17, s22, v3
s_mul_i32 s32, s31, 512
s_add_u32 s32, s32, 256
v_add_u32 v2, s32, v254
v_lshrrev_b32 v3, 5, v2
v_and_b32 v4, 31, v2
v_and_b32 v5, 3, v3
v_bfe_u32 v2, v3, 3, 1
v_lshl_or_b32 v5, v2, 2, v5
v_lshlrev_b32 v5, 1, v5
v_xor_b32 v4, v4, v5
v_mul_lo_u32 v3, v3, s25
v_lshrrev_b32 v2, 4, v4
v_mul_u32_u24 v2, 2048, v2
v_add_u32 v3, v3, v2
v_and_b32 v2, 15, v4
v_lshl_add_u32 v3, v2, 4, v3
v_add_u32 v18, s22, v3
s_mul_i32 s32, s31, 512
s_add_u32 s32, s32, 320
v_add_u32 v2, s32, v254
v_lshrrev_b32 v3, 5, v2
v_and_b32 v4, 31, v2
v_and_b32 v5, 3, v3
v_bfe_u32 v2, v3, 3, 1
v_lshl_or_b32 v5, v2, 2, v5
v_lshlrev_b32 v5, 1, v5
v_xor_b32 v4, v4, v5
v_mul_lo_u32 v3, v3, s25
v_lshrrev_b32 v2, 4, v4
v_mul_u32_u24 v2, 2048, v2
v_add_u32 v3, v3, v2
v_and_b32 v2, 15, v4
v_lshl_add_u32 v3, v2, 4, v3
v_add_u32 v19, s22, v3
s_mul_i32 s32, s31, 512
s_add_u32 s32, s32, 384
v_add_u32 v2, s32, v254
v_lshrrev_b32 v3, 5, v2
v_and_b32 v4, 31, v2
v_and_b32 v5, 3, v3
v_bfe_u32 v2, v3, 3, 1
v_lshl_or_b32 v5, v2, 2, v5
v_lshlrev_b32 v5, 1, v5
v_xor_b32 v4, v4, v5
v_mul_lo_u32 v3, v3, s25
v_lshrrev_b32 v2, 4, v4
v_mul_u32_u24 v2, 2048, v2
v_add_u32 v3, v3, v2
v_and_b32 v2, 15, v4
v_lshl_add_u32 v3, v2, 4, v3
v_add_u32 v20, s22, v3
s_mul_i32 s32, s31, 512
s_add_u32 s32, s32, 448
v_add_u32 v2, s32, v254
v_lshrrev_b32 v3, 5, v2
v_and_b32 v4, 31, v2
v_and_b32 v5, 3, v3
v_bfe_u32 v2, v3, 3, 1
v_lshl_or_b32 v5, v2, 2, v5
v_lshlrev_b32 v5, 1, v5
v_xor_b32 v4, v4, v5
v_mul_lo_u32 v3, v3, s25
v_lshrrev_b32 v2, 4, v4
v_mul_u32_u24 v2, 2048, v2
v_add_u32 v3, v3, v2
v_and_b32 v2, 15, v4
v_lshl_add_u32 v3, v2, 4, v3
v_add_u32 v21, s22, v3
s_mul_i32 s32, s31, 32
s_add_u32 s32, s32, 0
v_lshrrev_b32 v3, 3, v254
v_add_u32 v3, s32, v3
v_bfe_u32 v5, v3, 1, 3
v_and_b32 v4, 7, v254
v_xor_b32 v4, v4, v5
v_add_u32 v3, s21, v3
v_mul_lo_u32 v3, v3, s26
v_lshl_add_u32 v10, v4, 4, v3
s_mul_i32 s32, s31, 32
s_add_u32 s32, s32, 8
v_lshrrev_b32 v3, 3, v254
v_add_u32 v3, s32, v3
v_bfe_u32 v5, v3, 1, 3
v_and_b32 v4, 7, v254
v_xor_b32 v4, v4, v5
v_add_u32 v3, s21, v3
v_mul_lo_u32 v3, v3, s26
v_lshl_add_u32 v11, v4, 4, v3
s_lshl_b32 s32, s26, 4
v_add_u32 v12, s32, v10
s_lshl_b32 s32, s26, 4
v_add_u32 v13, s32, v11
s_mul_i32 s36, s31, 4096
s_mul_i32 s37, s31, 8192
s_add_u32 s37, s37, 16384
s_mov_b32 s30, 0
s_mov_b32 s39, 0
s_mov_b32 s6, 0
s_add_u32 s7, s6, 0
s_add_u32 s4, s7, s3
s_and_b32 s4, s4, 3
s_and_b32 s7, s7, 3
s_sub_i32 s7, s4, s7
s_lshl_b32 s4, s7, 7
s_add_u32 s4, s4, s27
s_mul_i32 s5, s7, s35
s_add_u32 s5, s5, s28
s_add_u32 s32, s30, s36
s_add_u32 s33, s30, s37
s_add_u32 m0, s33, 0
s_nop 0
buffer_load_dwordx4 v14, s[12:15], s5 offen lds
s_add_u32 m0, s32, 0
s_nop 0
buffer_load_dwordx4 v10, s[8:11], s4 offen lds
s_add_u32 m0, s33, 1024
s_nop 0
buffer_load_dwordx4 v15, s[12:15], s5 offen lds
s_add_u32 m0, s32, 1024
s_nop 0
buffer_load_dwordx4 v11, s[8:11], s4 offen lds
s_add_u32 m0, s33, 2048
s_nop 0
buffer_load_dwordx4 v16, s[12:15], s5 offen lds
s_add_u32 m0, s32, 2048
s_nop 0
buffer_load_dwordx4 v12, s[8:11], s4 offen lds
s_add_u32 m0, s33, 3072
s_nop 0
buffer_load_dwordx4 v17, s[12:15], s5 offen lds
s_add_u32 m0, s32, 3072
s_nop 0
buffer_load_dwordx4 v13, s[8:11], s4 offen lds
s_add_u32 m0, s33, 4096
s_nop 0
buffer_load_dwordx4 v18, s[12:15], s5 offen lds
s_add_u32 m0, s33, 5120
s_nop 0
buffer_load_dwordx4 v19, s[12:15], s5 offen lds
s_add_u32 m0, s33, 6144
s_nop 0
buffer_load_dwordx4 v20, s[12:15], s5 offen lds
s_add_u32 m0, s33, 7168
s_nop 0
buffer_load_dwordx4 v21, s[12:15], s5 offen lds
s_add_u32 s27, s27, 128
s_add_u32 s28, s28, s35
s_add_u32 s6, s6, 1
s_add_u32 s30, s30, 49152
s_cmp_ge_u32 s30, 147456
s_cselect_b32 s30, 0, s30
s_add_u32 s7, s6, 0
s_add_u32 s4, s7, s3
s_and_b32 s4, s4, 3
s_and_b32 s7, s7, 3
s_sub_i32 s7, s4, s7
s_lshl_b32 s4, s7, 7
s_add_u32 s4, s4, s27
s_mul_i32 s5, s7, s35
s_add_u32 s5, s5, s28
s_add_u32 s32, s30, s36
s_add_u32 s33, s30, s37
s_add_u32 m0, s33, 0
s_nop 0
buffer_load_dwordx4 v14, s[12:15], s5 offen lds
s_add_u32 m0, s32, 0
s_nop 0
buffer_load_dwordx4 v10, s[8:11], s4 offen lds
s_add_u32 m0, s33, 1024
s_nop 0
buffer_load_dwordx4 v15, s[12:15], s5 offen lds
s_add_u32 m0, s32, 1024
s_nop 0
buffer_load_dwordx4 v11, s[8:11], s4 offen lds
s_add_u32 m0, s33, 2048
s_nop 0
buffer_load_dwordx4 v16, s[12:15], s5 offen lds
s_add_u32 m0, s32, 2048
s_nop 0
buffer_load_dwordx4 v12, s[8:11], s4 offen lds
s_add_u32 m0, s33, 3072
s_nop 0
buffer_load_dwordx4 v17, s[12:15], s5 offen lds
s_add_u32 m0, s32, 3072
s_nop 0
buffer_load_dwordx4 v13, s[8:11], s4 offen lds
s_add_u32 m0, s33, 4096
s_nop 0
buffer_load_dwordx4 v18, s[12:15], s5 offen lds
s_add_u32 m0, s33, 5120
s_nop 0
buffer_load_dwordx4 v19, s[12:15], s5 offen lds
s_add_u32 m0, s33, 6144
s_nop 0
buffer_load_dwordx4 v20, s[12:15], s5 offen lds
s_add_u32 m0, s33, 7168
s_nop 0
buffer_load_dwordx4 v21, s[12:15], s5 offen lds
s_add_u32 s27, s27, 128
s_add_u32 s28, s28, s35
s_add_u32 s6, s6, 1
s_add_u32 s30, s30, 49152
s_cmp_ge_u32 s30, 147456
s_cselect_b32 s30, 0, s30
s_mov_b32 s95, s27
s_mov_b32 s96, s28
s_mov_b32 s97, s6
s_bfe_u32 s5, s2, 0x10002
s_bfe_u32 s6, s2, 0x10001
s_lshr_b32 s4, s2, 3
s_lshr_b32 s7, s4, 2
s_and_b32 s4, s4, 3
s_lshl_b32 s5, s5, 3
s_add_u32 s58, s5, s7
s_lshl_b32 s6, s6, 2
s_add_u32 s59, s6, s4
s_mul_i32 s3, s7, 1
s_mul_i32 s31, s4, 0
s_add_u32 s3, s3, s31
s_lshl_b32 s21, s58, 7
s_lshl_b32 s22, s59, 8
s_mov_b32 s26, 2048
s_mov_b32 s27, 0
s_mov_b32 s28, 0
s_mov_b32 s25, 6144
s_mov_b32 s23, 128
s_mov_b32 s24, 64
s_mov_b32 s35, 393216
s_mov_b32 s8, s64
s_mov_b32 s9, s65
s_mov_b32 s10, 4194304
s_mov_b32 s11, 0x20000
s_mov_b32 s12, s66
s_mov_b32 s13, s67
s_mov_b32 s14, 6291456
s_mov_b32 s15, 0x20000
s_sub_u32 s31, s20, 4
s_mul_i32 s32, s31, 256
s_add_u32 s32, s32, 0
v_add_u32 v2, s32, v254
v_lshrrev_b32 v3, 4, v2
v_and_b32 v4, 15, v2
v_and_b32 v5, 3, v3
v_bfe_u32 v2, v3, 3, 1
v_lshl_or_b32 v5, v2, 2, v5
v_lshlrev_b32 v5, 1, v5
v_xor_b32 v4, v4, v5
v_mul_lo_u32 v3, v3, s25
v_lshrrev_b32 v2, 3, v4
v_mul_lo_u32 v2, v2, s23
v_add_u32 v3, v3, v2
v_bfe_u32 v2, v4, 2, 1
v_mul_lo_u32 v2, v2, s24
v_add_u32 v3, v3, v2
v_and_b32 v2, 3, v4
v_lshl_add_u32 v3, v2, 4, v3
v_add_u32 v28, s22, v3
s_mul_i32 s32, s31, 256
s_add_u32 s32, s32, 64
v_add_u32 v2, s32, v254
v_lshrrev_b32 v3, 4, v2
v_and_b32 v4, 15, v2
v_and_b32 v5, 3, v3
v_bfe_u32 v2, v3, 3, 1
v_lshl_or_b32 v5, v2, 2, v5
v_lshlrev_b32 v5, 1, v5
v_xor_b32 v4, v4, v5
v_mul_lo_u32 v3, v3, s25
v_lshrrev_b32 v2, 3, v4
v_mul_lo_u32 v2, v2, s23
v_add_u32 v3, v3, v2
v_bfe_u32 v2, v4, 2, 1
v_mul_lo_u32 v2, v2, s24
v_add_u32 v3, v3, v2
v_and_b32 v2, 3, v4
v_lshl_add_u32 v3, v2, 4, v3
v_add_u32 v29, s22, v3
s_mul_i32 s32, s31, 256
s_add_u32 s32, s32, 128
v_add_u32 v2, s32, v254
v_lshrrev_b32 v3, 4, v2
v_and_b32 v4, 15, v2
v_and_b32 v5, 3, v3
v_bfe_u32 v2, v3, 3, 1
v_lshl_or_b32 v5, v2, 2, v5
v_lshlrev_b32 v5, 1, v5
v_xor_b32 v4, v4, v5
v_mul_lo_u32 v3, v3, s25
v_lshrrev_b32 v2, 3, v4
v_mul_lo_u32 v2, v2, s23
v_add_u32 v3, v3, v2
v_bfe_u32 v2, v4, 2, 1
v_mul_lo_u32 v2, v2, s24
v_add_u32 v3, v3, v2
v_and_b32 v2, 3, v4
v_lshl_add_u32 v3, v2, 4, v3
v_add_u32 v30, s22, v3
s_mul_i32 s32, s31, 256
s_add_u32 s32, s32, 192
v_add_u32 v2, s32, v254
v_lshrrev_b32 v3, 4, v2
v_and_b32 v4, 15, v2
v_and_b32 v5, 3, v3
v_bfe_u32 v2, v3, 3, 1
v_lshl_or_b32 v5, v2, 2, v5
v_lshlrev_b32 v5, 1, v5
v_xor_b32 v4, v4, v5
v_mul_lo_u32 v3, v3, s25
v_lshrrev_b32 v2, 3, v4
v_mul_lo_u32 v2, v2, s23
v_add_u32 v3, v3, v2
v_bfe_u32 v2, v4, 2, 1
v_mul_lo_u32 v2, v2, s24
v_add_u32 v3, v3, v2
v_and_b32 v2, 3, v4
v_lshl_add_u32 v3, v2, 4, v3
v_add_u32 v31, s22, v3
s_mul_i32 s32, s31, 32
s_add_u32 s32, s32, 0
v_lshrrev_b32 v3, 3, v254
v_add_u32 v3, s32, v3
v_bfe_u32 v5, v3, 1, 3
v_and_b32 v4, 7, v254
v_xor_b32 v4, v4, v5
v_add_u32 v3, s21, v3
v_mul_lo_u32 v3, v3, s26
v_lshl_add_u32 v24, v4, 4, v3
s_mul_i32 s32, s31, 32
s_add_u32 s32, s32, 8
v_lshrrev_b32 v3, 3, v254
v_add_u32 v3, s32, v3
v_bfe_u32 v5, v3, 1, 3
v_and_b32 v4, 7, v254
v_xor_b32 v4, v4, v5
v_add_u32 v3, s21, v3
v_mul_lo_u32 v3, v3, s26
v_lshl_add_u32 v25, v4, 4, v3
s_lshl_b32 s32, s26, 4
v_add_u32 v26, s32, v24
s_lshl_b32 s32, s26, 4
v_add_u32 v27, s32, v25
s_bfe_u32 s5, s2, 0x10002
s_bfe_u32 s6, s2, 0x10001
s_lshr_b32 s4, s2, 3
s_lshr_b32 s7, s4, 2
s_and_b32 s4, s4, 3
s_lshl_b32 s5, s5, 3
s_add_u32 s58, s5, s7
s_lshl_b32 s6, s6, 2
s_add_u32 s59, s6, s4
s_mul_i32 s3, s7, 1
s_mul_i32 s31, s4, 0
s_add_u32 s3, s3, s31
s_lshl_b32 s21, s58, 7
s_lshl_b32 s22, s59, 8
s_mov_b32 s26, 2048
s_mov_b32 s27, 0
s_mov_b32 s28, 0
s_mov_b32 s25, 6144
s_mov_b32 s23, 128
s_mov_b32 s24, 64
s_mov_b32 s35, 393216
s_mov_b32 s8, s64
s_mov_b32 s9, s65
s_mov_b32 s10, 4194304
s_mov_b32 s11, 0x20000
s_mov_b32 s12, s66
s_mov_b32 s13, s67
s_mov_b32 s14, 6291456
s_mov_b32 s15, 0x20000
s_mov_b32 s28, 2048
s_sub_u32 s31, s20, 4
s_mov_b32 s27, s95
s_mov_b32 s28, s96
s_mov_b32 s6, s97
s_waitcnt vmcnt(12)
s_barrier
s_add_u32 s7, s6, 0
s_add_u32 s4, s7, s3
s_and_b32 s4, s4, 3
s_and_b32 s7, s7, 3
s_sub_i32 s7, s4, s7
s_lshl_b32 s4, s7, 7
s_add_u32 s4, s4, s27
s_mul_i32 s5, s7, s35
s_add_u32 s5, s5, s28
s_add_u32 s32, s30, s36
s_add_u32 s33, s30, s37
s_add_u32 m0, s33, 0
s_nop 0
buffer_load_dwordx4 v14, s[12:15], s5 offen lds
s_add_u32 m0, s32, 0
s_nop 0
buffer_load_dwordx4 v10, s[8:11], s4 offen lds
s_add_u32 m0, s33, 1024
s_nop 0
buffer_load_dwordx4 v15, s[12:15], s5 offen lds
s_add_u32 m0, s32, 1024
s_nop 0
buffer_load_dwordx4 v11, s[8:11], s4 offen lds
s_add_u32 m0, s33, 2048
s_nop 0
buffer_load_dwordx4 v16, s[12:15], s5 offen lds
s_add_u32 m0, s32, 2048
s_nop 0
buffer_load_dwordx4 v12, s[8:11], s4 offen lds
s_add_u32 m0, s33, 3072
s_nop 0
buffer_load_dwordx4 v17, s[12:15], s5 offen lds
s_add_u32 m0, s32, 3072
s_nop 0
buffer_load_dwordx4 v13, s[8:11], s4 offen lds
s_add_u32 m0, s33, 4096
s_nop 0
buffer_load_dwordx4 v18, s[12:15], s5 offen lds
s_add_u32 m0, s33, 5120
s_nop 0
buffer_load_dwordx4 v19, s[12:15], s5 offen lds
s_add_u32 m0, s33, 6144
s_nop 0
buffer_load_dwordx4 v20, s[12:15], s5 offen lds
s_add_u32 m0, s33, 7168
s_nop 0
buffer_load_dwordx4 v21, s[12:15], s5 offen lds
s_add_u32 s27, s27, 128
s_add_u32 s28, s28, s35
s_add_u32 s6, s6, 1
s_add_u32 s30, s30, 49152
s_cmp_ge_u32 s30, 147456
s_cselect_b32 s30, 0, s30
s_mov_b32 s29, 3
s_mov_b32 s93, 40
L_kv_ld_139:
s_waitcnt vmcnt(12)
s_barrier
s_add_u32 s7, s6, 0
s_add_u32 s4, s7, s3
s_and_b32 s4, s4, 3
s_and_b32 s7, s7, 3
s_sub_i32 s7, s4, s7
s_lshl_b32 s4, s7, 7
s_add_u32 s4, s4, s27
s_mul_i32 s5, s7, s35
s_add_u32 s5, s5, s28
s_add_u32 s32, s30, s36
s_add_u32 s33, s30, s37
s_add_u32 m0, s33, 0
s_nop 0
buffer_load_dwordx4 v14, s[12:15], s5 offen lds
s_add_u32 m0, s32, 0
s_nop 0
buffer_load_dwordx4 v10, s[8:11], s4 offen lds
s_add_u32 m0, s33, 1024
s_nop 0
buffer_load_dwordx4 v15, s[12:15], s5 offen lds
s_add_u32 m0, s32, 1024
s_nop 0
buffer_load_dwordx4 v11, s[8:11], s4 offen lds
s_add_u32 m0, s33, 2048
s_nop 0
buffer_load_dwordx4 v16, s[12:15], s5 offen lds
s_add_u32 m0, s32, 2048
s_nop 0
buffer_load_dwordx4 v12, s[8:11], s4 offen lds
s_add_u32 m0, s33, 3072
s_nop 0
buffer_load_dwordx4 v17, s[12:15], s5 offen lds
s_add_u32 m0, s32, 3072
s_nop 0
buffer_load_dwordx4 v13, s[8:11], s4 offen lds
s_add_u32 m0, s33, 4096
s_nop 0
buffer_load_dwordx4 v18, s[12:15], s5 offen lds
s_add_u32 m0, s33, 5120
s_nop 0
buffer_load_dwordx4 v19, s[12:15], s5 offen lds
s_add_u32 m0, s33, 6144
s_nop 0
buffer_load_dwordx4 v20, s[12:15], s5 offen lds
s_add_u32 m0, s33, 7168
s_nop 0
buffer_load_dwordx4 v21, s[12:15], s5 offen lds
s_add_u32 s27, s27, 128
s_add_u32 s28, s28, s35
s_add_u32 s6, s6, 1
s_add_u32 s30, s30, 49152
s_cmp_ge_u32 s30, 147456
s_cselect_b32 s30, 0, s30
s_bitcmp1_b32 s93, s29
s_cbranch_scc1 L_kv_H_142
L_kv_B_143:
s_add_u32 s29, s29, 1
s_cmp_lt_u32 s29, 16
s_cbranch_scc1 L_kv_ld_139
s_bfe_u32 s5, s2, 0x10002
s_bfe_u32 s6, s2, 0x10001
s_lshr_b32 s4, s2, 3
s_lshr_b32 s7, s4, 2
s_and_b32 s4, s4, 3
s_lshl_b32 s5, s5, 3
s_add_u32 s58, s5, s7
s_lshl_b32 s6, s6, 2
s_add_u32 s59, s6, s4
s_mul_i32 s3, s7, 1
s_mul_i32 s31, s4, 0
s_add_u32 s3, s3, s31
s_lshl_b32 s21, s58, 7
s_lshl_b32 s22, s59, 8
s_mov_b32 s26, 2048
s_mov_b32 s27, 0
s_mov_b32 s28, 0
s_mov_b32 s25, 6144
s_mov_b32 s23, 128
s_mov_b32 s24, 64
s_mov_b32 s35, 393216
s_mov_b32 s8, s64
s_mov_b32 s9, s65
s_mov_b32 s10, 4194304
s_mov_b32 s11, 0x20000
s_mov_b32 s12, s66
s_mov_b32 s13, s67
s_mov_b32 s14, 6291456
s_mov_b32 s15, 0x20000
s_sub_u32 s31, s20, 4
s_mul_i32 s36, s31, 4096
s_mul_i32 s37, s31, 4096
s_add_u32 s37, s37, 16384
s_mov_b32 s30, 0
s_mov_b32 s39, 0
s_mov_b32 s6, 0
s_waitcnt vmcnt(12)
s_barrier
s_waitcnt vmcnt(0)
s_barrier
s_barrier
s_add_u32 s7, s6, 0
s_add_u32 s4, s7, s3
s_and_b32 s4, s4, 3
s_and_b32 s7, s7, 3
s_sub_i32 s7, s4, s7
s_lshl_b32 s4, s7, 7
s_add_u32 s4, s4, s27
s_mul_i32 s5, s7, s35
s_add_u32 s5, s5, s28
s_add_u32 s32, s30, s36
s_add_u32 s33, s30, s37
s_add_u32 m0, s33, 0
s_nop 0
buffer_load_dwordx4 v28, s[12:15], s5 offen lds
s_add_u32 m0, s32, 0
s_nop 0
buffer_load_dwordx4 v24, s[8:11], s4 offen lds
s_add_u32 m0, s33, 1024
s_nop 0
buffer_load_dwordx4 v29, s[12:15], s5 offen lds
s_add_u32 m0, s32, 1024
s_nop 0
buffer_load_dwordx4 v25, s[8:11], s4 offen lds
s_add_u32 m0, s33, 2048
s_nop 0
buffer_load_dwordx4 v30, s[12:15], s5 offen lds
s_add_u32 m0, s32, 2048
s_nop 0
buffer_load_dwordx4 v26, s[8:11], s4 offen lds
s_add_u32 m0, s33, 3072
s_nop 0
buffer_load_dwordx4 v31, s[12:15], s5 offen lds
s_add_u32 m0, s32, 3072
s_nop 0
buffer_load_dwordx4 v27, s[8:11], s4 offen lds
s_add_u32 s27, s27, 128
s_add_u32 s28, s28, s35
s_add_u32 s6, s6, 1
s_add_u32 s30, s30, 32768
s_cmp_ge_u32 s30, 131072
s_cselect_b32 s30, 0, s30
s_add_u32 s7, s6, 0
s_add_u32 s4, s7, s3
s_and_b32 s4, s4, 3
s_and_b32 s7, s7, 3
s_sub_i32 s7, s4, s7
s_lshl_b32 s4, s7, 7
s_add_u32 s4, s4, s27
s_mul_i32 s5, s7, s35
s_add_u32 s5, s5, s28
s_add_u32 s32, s30, s36
s_add_u32 s33, s30, s37
s_add_u32 m0, s33, 0
s_nop 0
buffer_load_dwordx4 v28, s[12:15], s5 offen lds
s_add_u32 m0, s32, 0
s_nop 0
buffer_load_dwordx4 v24, s[8:11], s4 offen lds
s_add_u32 m0, s33, 1024
s_nop 0
buffer_load_dwordx4 v29, s[12:15], s5 offen lds
s_add_u32 m0, s32, 1024
s_nop 0
buffer_load_dwordx4 v25, s[8:11], s4 offen lds
s_add_u32 m0, s33, 2048
s_nop 0
buffer_load_dwordx4 v30, s[12:15], s5 offen lds
s_add_u32 m0, s32, 2048
s_nop 0
buffer_load_dwordx4 v26, s[8:11], s4 offen lds
s_add_u32 m0, s33, 3072
s_nop 0
buffer_load_dwordx4 v31, s[12:15], s5 offen lds
s_add_u32 m0, s32, 3072
s_nop 0
buffer_load_dwordx4 v27, s[8:11], s4 offen lds
s_add_u32 s27, s27, 128
s_add_u32 s28, s28, s35
s_add_u32 s6, s6, 1
s_add_u32 s30, s30, 32768
s_cmp_ge_u32 s30, 131072
s_cselect_b32 s30, 0, s30
s_add_u32 s7, s6, 0
s_add_u32 s4, s7, s3
s_and_b32 s4, s4, 3
s_and_b32 s7, s7, 3
s_sub_i32 s7, s4, s7
s_lshl_b32 s4, s7, 7
s_add_u32 s4, s4, s27
s_mul_i32 s5, s7, s35
s_add_u32 s5, s5, s28
s_add_u32 s32, s30, s36
s_add_u32 s33, s30, s37
s_add_u32 m0, s33, 0
s_nop 0
buffer_load_dwordx4 v28, s[12:15], s5 offen lds
s_add_u32 m0, s32, 0
s_nop 0
buffer_load_dwordx4 v24, s[8:11], s4 offen lds
s_add_u32 m0, s33, 1024
s_nop 0
buffer_load_dwordx4 v29, s[12:15], s5 offen lds
s_add_u32 m0, s32, 1024
s_nop 0
buffer_load_dwordx4 v25, s[8:11], s4 offen lds
s_add_u32 m0, s33, 2048
s_nop 0
buffer_load_dwordx4 v30, s[12:15], s5 offen lds
s_add_u32 m0, s32, 2048
s_nop 0
buffer_load_dwordx4 v26, s[8:11], s4 offen lds
s_add_u32 m0, s33, 3072
s_nop 0
buffer_load_dwordx4 v31, s[12:15], s5 offen lds
s_add_u32 m0, s32, 3072
s_nop 0
buffer_load_dwordx4 v27, s[8:11], s4 offen lds
s_add_u32 s27, s27, 128
s_add_u32 s28, s28, s35
s_add_u32 s6, s6, 1
s_add_u32 s30, s30, 32768
s_cmp_ge_u32 s30, 131072
s_cselect_b32 s30, 0, s30
s_mov_b32 s95, s27
s_mov_b32 s96, s28
s_mov_b32 s97, s6
s_bfe_u32 s5, s2, 0x10002
s_bfe_u32 s6, s2, 0x10001
s_lshr_b32 s4, s2, 3
s_lshr_b32 s7, s4, 2
s_and_b32 s4, s4, 3
s_lshl_b32 s5, s5, 3
s_add_u32 s58, s5, s7
s_lshl_b32 s6, s6, 2
s_add_u32 s59, s6, s4
s_mul_i32 s3, s7, 1
s_mul_i32 s31, s4, 0
s_add_u32 s3, s3, s31
s_lshl_b32 s21, s58, 7
s_lshl_b32 s22, s59, 8
s_mul_i32 s22, s59, 384
s_add_u32 s22, s22, 4096
s_mov_b32 s26, 2048
s_mov_b32 s27, 0
s_mov_b32 s28, 0
s_mov_b32 s25, 7168
s_mov_b32 s23, 128
s_mov_b32 s24, 64
s_mov_b32 s35, 458752
s_add_u32 s8, s86, 12582912
s_addc_u32 s9, s87, 0
s_mov_b32 s10, 4194304
s_mov_b32 s11, 0x20000
s_mov_b32 s12, s76
s_mov_b32 s13, s77
s_mov_b32 s14, 7340032
s_mov_b32 s15, 0x20000
s_sub_u32 s31, s20, 4
s_mul_i32 s32, s31, 384
s_add_u32 s32, s32, 0
v_add_u32 v2, s32, v254
s_mov_b32 s33, 43691
v_mul_lo_u32 v3, v2, s33
v_lshrrev_b32 v3, 20, v3
v_mul_u32_u24 v4, 24, v3
v_sub_u32 v4, v2, v4
v_bfe_u32 v5, v3, 1, 1
v_bfe_u32 v2, v3, 3, 1
v_lshl_or_b32 v5, v2, 1, v5
v_lshlrev_b32 v5, 1, v5
v_xor_b32 v4, v4, v5
v_mul_lo_u32 v3, v3, s25
v_lshrrev_b32 v2, 3, v4
v_mul_lo_u32 v2, v2, s23
v_add_u32 v3, v3, v2
v_bfe_u32 v2, v4, 2, 1
v_mul_lo_u32 v2, v2, s24
v_add_u32 v3, v3, v2
v_and_b32 v2, 3, v4
v_lshl_add_u32 v3, v2, 4, v3
v_add_u32 v204, s22, v3
s_mul_i32 s32, s31, 384
s_add_u32 s32, s32, 64
v_add_u32 v2, s32, v254
s_mov_b32 s33, 43691
v_mul_lo_u32 v3, v2, s33
v_lshrrev_b32 v3, 20, v3
v_mul_u32_u24 v4, 24, v3
v_sub_u32 v4, v2, v4
v_bfe_u32 v5, v3, 1, 1
v_bfe_u32 v2, v3, 3, 1
v_lshl_or_b32 v5, v2, 1, v5
v_lshlrev_b32 v5, 1, v5
v_xor_b32 v4, v4, v5
v_mul_lo_u32 v3, v3, s25
v_lshrrev_b32 v2, 3, v4
v_mul_lo_u32 v2, v2, s23
v_add_u32 v3, v3, v2
v_bfe_u32 v2, v4, 2, 1
v_mul_lo_u32 v2, v2, s24
v_add_u32 v3, v3, v2
v_and_b32 v2, 3, v4
v_lshl_add_u32 v3, v2, 4, v3
v_add_u32 v205, s22, v3
s_mul_i32 s32, s31, 384
s_add_u32 s32, s32, 128
v_add_u32 v2, s32, v254
s_mov_b32 s33, 43691
v_mul_lo_u32 v3, v2, s33
v_lshrrev_b32 v3, 20, v3
v_mul_u32_u24 v4, 24, v3
v_sub_u32 v4, v2, v4
v_bfe_u32 v5, v3, 1, 1
v_bfe_u32 v2, v3, 3, 1
v_lshl_or_b32 v5, v2, 1, v5
v_lshlrev_b32 v5, 1, v5
v_xor_b32 v4, v4, v5
v_mul_lo_u32 v3, v3, s25
v_lshrrev_b32 v2, 3, v4
v_mul_lo_u32 v2, v2, s23
v_add_u32 v3, v3, v2
v_bfe_u32 v2, v4, 2, 1
v_mul_lo_u32 v2, v2, s24
v_add_u32 v3, v3, v2
v_and_b32 v2, 3, v4
v_lshl_add_u32 v3, v2, 4, v3
v_add_u32 v206, s22, v3
s_mul_i32 s32, s31, 384
s_add_u32 s32, s32, 192
v_add_u32 v2, s32, v254
s_mov_b32 s33, 43691
v_mul_lo_u32 v3, v2, s33
v_lshrrev_b32 v3, 20, v3
v_mul_u32_u24 v4, 24, v3
v_sub_u32 v4, v2, v4
v_bfe_u32 v5, v3, 1, 1
v_bfe_u32 v2, v3, 3, 1
v_lshl_or_b32 v5, v2, 1, v5
v_lshlrev_b32 v5, 1, v5
v_xor_b32 v4, v4, v5
v_mul_lo_u32 v3, v3, s25
v_lshrrev_b32 v2, 3, v4
v_mul_lo_u32 v2, v2, s23
v_add_u32 v3, v3, v2
v_bfe_u32 v2, v4, 2, 1
v_mul_lo_u32 v2, v2, s24
v_add_u32 v3, v3, v2
v_and_b32 v2, 3, v4
v_lshl_add_u32 v3, v2, 4, v3
v_add_u32 v207, s22, v3
s_mul_i32 s32, s31, 384
s_add_u32 s32, s32, 256
v_add_u32 v2, s32, v254
s_mov_b32 s33, 43691
v_mul_lo_u32 v3, v2, s33
v_lshrrev_b32 v3, 20, v3
v_mul_u32_u24 v4, 24, v3
v_sub_u32 v4, v2, v4
v_bfe_u32 v5, v3, 1, 1
v_bfe_u32 v2, v3, 3, 1
v_lshl_or_b32 v5, v2, 1, v5
v_lshlrev_b32 v5, 1, v5
v_xor_b32 v4, v4, v5
v_mul_lo_u32 v3, v3, s25
v_lshrrev_b32 v2, 3, v4
v_mul_lo_u32 v2, v2, s23
v_add_u32 v3, v3, v2
v_bfe_u32 v2, v4, 2, 1
v_mul_lo_u32 v2, v2, s24
v_add_u32 v3, v3, v2
v_and_b32 v2, 3, v4
v_lshl_add_u32 v3, v2, 4, v3
v_add_u32 v208, s22, v3
s_mul_i32 s32, s31, 384
s_add_u32 s32, s32, 320
v_add_u32 v2, s32, v254
s_mov_b32 s33, 43691
v_mul_lo_u32 v3, v2, s33
v_lshrrev_b32 v3, 20, v3
v_mul_u32_u24 v4, 24, v3
v_sub_u32 v4, v2, v4
v_bfe_u32 v5, v3, 1, 1
v_bfe_u32 v2, v3, 3, 1
v_lshl_or_b32 v5, v2, 1, v5
v_lshlrev_b32 v5, 1, v5
v_xor_b32 v4, v4, v5
v_mul_lo_u32 v3, v3, s25
v_lshrrev_b32 v2, 3, v4
v_mul_lo_u32 v2, v2, s23
v_add_u32 v3, v3, v2
v_bfe_u32 v2, v4, 2, 1
v_mul_lo_u32 v2, v2, s24
v_add_u32 v3, v3, v2
v_and_b32 v2, 3, v4
v_lshl_add_u32 v3, v2, 4, v3
v_add_u32 v209, s22, v3
s_mul_i32 s32, s31, 32
s_add_u32 s32, s32, 0
v_lshrrev_b32 v3, 3, v254
v_add_u32 v3, s32, v3
v_bfe_u32 v5, v3, 1, 3
v_and_b32 v4, 7, v254
v_xor_b32 v4, v4, v5
v_add_u32 v3, s21, v3
v_mul_lo_u32 v3, v3, s26
v_lshl_add_u32 v200, v4, 4, v3
s_mul_i32 s32, s31, 32
s_add_u32 s32, s32, 8
v_lshrrev_b32 v3, 3, v254
v_add_u32 v3, s32, v3
v_bfe_u32 v5, v3, 1, 3
v_and_b32 v4, 7, v254
v_xor_b32 v4, v4, v5
v_add_u32 v3, s21, v3
v_mul_lo_u32 v3, v3, s26
v_lshl_add_u32 v201, v4, 4, v3
s_lshl_b32 s32, s26, 4
v_add_u32 v202, s32, v200
s_lshl_b32 s32, s26, 4
v_add_u32 v203, s32, v201
s_bfe_u32 s5, s2, 0x10002
s_bfe_u32 s6, s2, 0x10001
s_lshr_b32 s4, s2, 3
s_lshr_b32 s7, s4, 2
s_and_b32 s4, s4, 3
s_lshl_b32 s5, s5, 3
s_add_u32 s58, s5, s7
s_lshl_b32 s6, s6, 2
s_add_u32 s59, s6, s4
s_mul_i32 s3, s7, 1
s_mul_i32 s31, s4, 0
s_add_u32 s3, s3, s31
s_lshl_b32 s21, s58, 7
s_lshl_b32 s22, s59, 8
s_mov_b32 s26, 2048
s_mov_b32 s27, 0
s_mov_b32 s28, 0
s_mov_b32 s25, 6144
s_mov_b32 s23, 128
s_mov_b32 s24, 64
s_mov_b32 s35, 393216
s_mov_b32 s8, s64
s_mov_b32 s9, s65
s_mov_b32 s10, 4194304
s_mov_b32 s11, 0x20000
s_mov_b32 s12, s66
s_mov_b32 s13, s67
s_mov_b32 s14, 6291456
s_mov_b32 s15, 0x20000
s_sub_u32 s31, s20, 4
s_mov_b32 s27, s95
s_mov_b32 s28, s96
s_mov_b32 s6, s97
s_waitcnt vmcnt(16)
s_barrier
s_add_u32 s7, s6, 0
s_add_u32 s4, s7, s3
s_and_b32 s4, s4, 3
s_and_b32 s7, s7, 3
s_sub_i32 s7, s4, s7
s_lshl_b32 s4, s7, 7
s_add_u32 s4, s4, s27
s_mul_i32 s5, s7, s35
s_add_u32 s5, s5, s28
s_add_u32 s32, s30, s36
s_add_u32 s33, s30, s37
s_add_u32 m0, s33, 0
s_nop 0
buffer_load_dwordx4 v28, s[12:15], s5 offen lds
s_add_u32 m0, s32, 0
s_nop 0
buffer_load_dwordx4 v24, s[8:11], s4 offen lds
s_add_u32 m0, s33, 1024
s_nop 0
buffer_load_dwordx4 v29, s[12:15], s5 offen lds
s_add_u32 m0, s32, 1024
s_nop 0
buffer_load_dwordx4 v25, s[8:11], s4 offen lds
s_add_u32 m0, s33, 2048
s_nop 0
buffer_load_dwordx4 v30, s[12:15], s5 offen lds
s_add_u32 m0, s32, 2048
s_nop 0
buffer_load_dwordx4 v26, s[8:11], s4 offen lds
s_add_u32 m0, s33, 3072
s_nop 0
buffer_load_dwordx4 v31, s[12:15], s5 offen lds
s_add_u32 m0, s32, 3072
s_nop 0
buffer_load_dwordx4 v27, s[8:11], s4 offen lds
s_add_u32 s27, s27, 128
s_add_u32 s28, s28, s35
s_add_u32 s6, s6, 1
s_add_u32 s30, s30, 32768
s_cmp_ge_u32 s30, 131072
s_cselect_b32 s30, 0, s30
s_mov_b32 s29, 4
s_mov_b32 s93, 576
L_q_ld_149:
s_waitcnt vmcnt(16)
s_barrier
s_add_u32 s7, s6, 0
s_add_u32 s4, s7, s3
s_and_b32 s4, s4, 3
s_and_b32 s7, s7, 3
s_sub_i32 s7, s4, s7
s_lshl_b32 s4, s7, 7
s_add_u32 s4, s4, s27
s_mul_i32 s5, s7, s35
s_add_u32 s5, s5, s28
s_add_u32 s32, s30, s36
s_add_u32 s33, s30, s37
s_add_u32 m0, s33, 0
s_nop 0
buffer_load_dwordx4 v28, s[12:15], s5 offen lds
s_add_u32 m0, s32, 0
s_nop 0
buffer_load_dwordx4 v24, s[8:11], s4 offen lds
s_add_u32 m0, s33, 1024
s_nop 0
buffer_load_dwordx4 v29, s[12:15], s5 offen lds
s_add_u32 m0, s32, 1024
s_nop 0
buffer_load_dwordx4 v25, s[8:11], s4 offen lds
s_add_u32 m0, s33, 2048
s_nop 0
buffer_load_dwordx4 v30, s[12:15], s5 offen lds
s_add_u32 m0, s32, 2048
s_nop 0
buffer_load_dwordx4 v26, s[8:11], s4 offen lds
s_add_u32 m0, s33, 3072
s_nop 0
buffer_load_dwordx4 v31, s[12:15], s5 offen lds
s_add_u32 m0, s32, 3072
s_nop 0
buffer_load_dwordx4 v27, s[8:11], s4 offen lds
s_add_u32 s27, s27, 128
s_add_u32 s28, s28, s35
s_add_u32 s6, s6, 1
s_add_u32 s30, s30, 32768
s_cmp_ge_u32 s30, 131072
s_cselect_b32 s30, 0, s30
s_bitcmp1_b32 s93, s29
s_cbranch_scc1 L_q_H_152
L_q_B_153:
s_add_u32 s29, s29, 1
s_cmp_lt_u32 s29, 16
s_cbranch_scc1 L_q_ld_149
s_bfe_u32 s5, s2, 0x10002
s_bfe_u32 s6, s2, 0x10001
s_lshr_b32 s4, s2, 3
s_lshr_b32 s7, s4, 2
s_and_b32 s4, s4, 3
s_lshl_b32 s5, s5, 3
s_add_u32 s58, s5, s7
s_lshl_b32 s6, s6, 2
s_add_u32 s59, s6, s4
s_mul_i32 s3, s7, 1
s_mul_i32 s31, s4, 0
s_add_u32 s3, s3, s31
s_lshl_b32 s21, s58, 7
s_lshl_b32 s22, s59, 8
s_mul_i32 s22, s59, 384
s_add_u32 s22, s22, 4096
s_mov_b32 s26, 2048
s_mov_b32 s27, 0
s_mov_b32 s28, 0
s_mov_b32 s25, 7168
s_mov_b32 s23, 128
s_mov_b32 s24, 64
s_mov_b32 s35, 458752
s_add_u32 s8, s86, 12582912
s_addc_u32 s9, s87, 0
s_mov_b32 s10, 4194304
s_mov_b32 s11, 0x20000
s_mov_b32 s12, s76
s_mov_b32 s13, s77
s_mov_b32 s14, 7340032
s_mov_b32 s15, 0x20000
s_sub_u32 s31, s20, 4
s_mul_i32 s36, s31, 4096
s_mul_i32 s37, s31, 6144
s_add_u32 s37, s37, 16384
s_mov_b32 s30, 0
s_mov_b32 s39, 0
s_mov_b32 s6, 0
s_waitcnt vmcnt(16)
s_barrier
s_waitcnt vmcnt(8)
s_barrier
s_waitcnt vmcnt(0)
s_barrier
s_barrier
s_add_u32 s33, s37, 0
s_add_u32 s7, s6, 0
s_add_u32 s4, s7, s3
s_and_b32 s4, s4, 3
s_and_b32 s7, s7, 3
s_sub_i32 s7, s4, s7
s_lshl_b32 s4, s7, 7
s_add_u32 s4, s4, s27
s_mul_i32 s5, s7, s35
s_add_u32 s5, s5, s28
s_add_u32 m0, s33, 0
s_nop 0
buffer_load_dwordx4 v204, s[12:15], s5 offen lds
s_add_u32 m0, s33, 1024
s_nop 0
buffer_load_dwordx4 v205, s[12:15], s5 offen lds
s_add_u32 m0, s33, 2048
s_nop 0
buffer_load_dwordx4 v206, s[12:15], s5 offen lds
s_add_u32 m0, s33, 3072
s_nop 0
buffer_load_dwordx4 v207, s[12:15], s5 offen lds
s_add_u32 m0, s33, 4096
s_nop 0
buffer_load_dwordx4 v208, s[12:15], s5 offen lds
s_add_u32 m0, s33, 5120
s_nop 0
buffer_load_dwordx4 v209, s[12:15], s5 offen lds
s_add_u32 s33, s37, 40960
s_add_u32 s7, s6, 1
s_add_u32 s4, s7, s3
s_and_b32 s4, s4, 3
s_and_b32 s7, s7, 3
s_sub_i32 s7, s4, s7
s_add_i32 s7, s7, 1
s_lshl_b32 s4, s7, 7
s_add_u32 s4, s4, s27
s_mul_i32 s5, s7, s35
s_add_u32 s5, s5, s28
s_add_u32 m0, s33, 0
s_nop 0
buffer_load_dwordx4 v204, s[12:15], s5 offen lds
s_add_u32 m0, s33, 1024
s_nop 0
buffer_load_dwordx4 v205, s[12:15], s5 offen lds
s_add_u32 m0, s33, 2048
s_nop 0
buffer_load_dwordx4 v206, s[12:15], s5 offen lds
s_add_u32 m0, s33, 3072
s_nop 0
buffer_load_dwordx4 v207, s[12:15], s5 offen lds
s_add_u32 m0, s33, 4096
s_nop 0
buffer_load_dwordx4 v208, s[12:15], s5 offen lds
s_add_u32 m0, s33, 5120
s_nop 0
buffer_load_dwordx4 v209, s[12:15], s5 offen lds
s_add_u32 s33, s37, 81920
s_add_u32 s7, s6, 2
s_add_u32 s4, s7, s3
s_and_b32 s4, s4, 3
s_and_b32 s7, s7, 3
s_sub_i32 s7, s4, s7
s_add_i32 s7, s7, 2
s_lshl_b32 s4, s7, 7
s_add_u32 s4, s4, s27
s_mul_i32 s5, s7, s35
s_add_u32 s5, s5, s28
s_add_u32 m0, s33, 0
s_nop 0
buffer_load_dwordx4 v204, s[12:15], s5 offen lds
s_add_u32 m0, s33, 1024
s_nop 0
buffer_load_dwordx4 v205, s[12:15], s5 offen lds
s_add_u32 m0, s33, 2048
s_nop 0
buffer_load_dwordx4 v206, s[12:15], s5 offen lds
s_add_u32 m0, s33, 3072
s_nop 0
buffer_load_dwordx4 v207, s[12:15], s5 offen lds
s_add_u32 m0, s33, 4096
s_nop 0
buffer_load_dwordx4 v208, s[12:15], s5 offen lds
s_add_u32 m0, s33, 5120
s_nop 0
buffer_load_dwordx4 v209, s[12:15], s5 offen lds
s_and_b32 s56, s2, 1
s_bfe_u32 s5, s2, 0x10002
s_bfe_u32 s6, s2, 0x10001
s_lshr_b32 s4, s2, 3
s_lshr_b32 s7, s4, 2
s_and_b32 s4, s4, 3
s_lshl_b32 s5, s5, 3
s_add_u32 s58, s5, s7
s_lshl_b32 s6, s6, 2
s_add_u32 s59, s6, s4
s_mul_i32 s3, s7, 1
s_mul_i32 s31, s4, 0
s_add_u32 s3, s3, s31
s_lshl_b32 s21, s58, 7
s_lshl_b32 s22, s59, 8
s_mov_b32 s51, 32
s_mov_b32 s57, 8
s_cmp_eq_u32 s56, 1
s_cmov_b32 s51, 28
s_cmov_b32 s57, 8
s_sub_u32 s98, s51, 1
s_mov_b32 s99, 3
s_lshl_b32 s101, s56, 5
s_mov_b32 s26, 2048
s_mov_b32 s27, 0
s_mov_b32 s28, 0
s_mov_b32 s25, 2048
s_mov_b32 s23, 128
s_mov_b32 s24, 64
s_mov_b32 s35, 131072
s_mul_i32 s27, s56, 1024
s_mul_i32 s28, s56, 1048576
s_add_u32 s8, s86, 8388608
s_addc_u32 s9, s87, 0
s_mov_b32 s10, 4194304
s_mov_b32 s11, 0x20000
s_mov_b32 s12, s68
s_mov_b32 s13, s69
s_mov_b32 s14, 2097152
s_mov_b32 s15, 0x20000
s_sub_u32 s31, s20, 4
s_mul_i32 s32, s31, 256
s_add_u32 s32, s32, 0
v_add_u32 v2, s32, v254
v_lshrrev_b32 v3, 4, v2
v_and_b32 v4, 15, v2
v_and_b32 v5, 3, v3
v_bfe_u32 v2, v3, 3, 1
v_lshl_or_b32 v5, v2, 2, v5
v_lshlrev_b32 v5, 1, v5
v_xor_b32 v4, v4, v5
v_mul_lo_u32 v3, v3, s25
v_lshrrev_b32 v2, 3, v4
v_mul_lo_u32 v2, v2, s23
v_add_u32 v3, v3, v2
v_bfe_u32 v2, v4, 2, 1
v_mul_lo_u32 v2, v2, s24
v_add_u32 v3, v3, v2
v_and_b32 v2, 3, v4
v_lshl_add_u32 v3, v2, 4, v3
v_add_u32 v216, s22, v3
s_mul_i32 s32, s31, 256
s_add_u32 s32, s32, 64
v_add_u32 v2, s32, v254
v_lshrrev_b32 v3, 4, v2
v_and_b32 v4, 15, v2
v_and_b32 v5, 3, v3
v_bfe_u32 v2, v3, 3, 1
v_lshl_or_b32 v5, v2, 2, v5
v_lshlrev_b32 v5, 1, v5
v_xor_b32 v4, v4, v5
v_mul_lo_u32 v3, v3, s25
v_lshrrev_b32 v2, 3, v4
v_mul_lo_u32 v2, v2, s23
v_add_u32 v3, v3, v2
v_bfe_u32 v2, v4, 2, 1
v_mul_lo_u32 v2, v2, s24
v_add_u32 v3, v3, v2
v_and_b32 v2, 3, v4
v_lshl_add_u32 v3, v2, 4, v3
v_add_u32 v217, s22, v3
s_mul_i32 s32, s31, 256
s_add_u32 s32, s32, 128
v_add_u32 v2, s32, v254
v_lshrrev_b32 v3, 4, v2
v_and_b32 v4, 15, v2
v_and_b32 v5, 3, v3
v_bfe_u32 v2, v3, 3, 1
v_lshl_or_b32 v5, v2, 2, v5
v_lshlrev_b32 v5, 1, v5
v_xor_b32 v4, v4, v5
v_mul_lo_u32 v3, v3, s25
v_lshrrev_b32 v2, 3, v4
v_mul_lo_u32 v2, v2, s23
v_add_u32 v3, v3, v2
v_bfe_u32 v2, v4, 2, 1
v_mul_lo_u32 v2, v2, s24
v_add_u32 v3, v3, v2
v_and_b32 v2, 3, v4
v_lshl_add_u32 v3, v2, 4, v3
v_add_u32 v218, s22, v3
s_mul_i32 s32, s31, 256
s_add_u32 s32, s32, 192
v_add_u32 v2, s32, v254
v_lshrrev_b32 v3, 4, v2
v_and_b32 v4, 15, v2
v_and_b32 v5, 3, v3
v_bfe_u32 v2, v3, 3, 1
v_lshl_or_b32 v5, v2, 2, v5
v_lshlrev_b32 v5, 1, v5
v_xor_b32 v4, v4, v5
v_mul_lo_u32 v3, v3, s25
v_lshrrev_b32 v2, 3, v4
v_mul_lo_u32 v2, v2, s23
v_add_u32 v3, v3, v2
v_bfe_u32 v2, v4, 2, 1
v_mul_lo_u32 v2, v2, s24
v_add_u32 v3, v3, v2
v_and_b32 v2, 3, v4
v_lshl_add_u32 v3, v2, 4, v3
v_add_u32 v219, s22, v3
s_mul_i32 s32, s31, 32
s_add_u32 s32, s32, 0
v_lshrrev_b32 v3, 3, v254
v_add_u32 v3, s32, v3
v_bfe_u32 v5, v3, 1, 3
v_and_b32 v4, 7, v254
v_xor_b32 v4, v4, v5
v_xor_b32 v3, s101, v3
v_add_u32 v3, s21, v3
v_mul_u32_u24 v2, 7168, v3
v_lshl_add_u32 v220, v4, 4, v2
v_mul_lo_u32 v3, v3, s26
v_lshl_add_u32 v212, v4, 4, v3
s_mul_i32 s32, s31, 32
s_add_u32 s32, s32, 8
v_lshrrev_b32 v3, 3, v254
v_add_u32 v3, s32, v3
v_bfe_u32 v5, v3, 1, 3
v_and_b32 v4, 7, v254
v_xor_b32 v4, v4, v5
v_xor_b32 v3, s101, v3
v_add_u32 v3, s21, v3
v_mul_u32_u24 v2, 7168, v3
v_lshl_add_u32 v221, v4, 4, v2
v_mul_lo_u32 v3, v3, s26
v_lshl_add_u32 v213, v4, 4, v3
s_lshl_b32 s32, s26, 4
v_add_u32 v214, s32, v212
v_add_u32 v222, 114688, v220
s_lshl_b32 s32, s26, 4
v_add_u32 v215, s32, v213
v_add_u32 v223, 114688, v221
s_bfe_u32 s5, s2, 0x10002
s_bfe_u32 s6, s2, 0x10001
s_lshr_b32 s4, s2, 3
s_lshr_b32 s7, s4, 2
s_and_b32 s4, s4, 3
s_lshl_b32 s5, s5, 3
s_add_u32 s58, s5, s7
s_lshl_b32 s6, s6, 2
s_add_u32 s59, s6, s4
s_mul_i32 s3, s7, 1
s_mul_i32 s31, s4, 0
s_add_u32 s3, s3, s31
s_lshl_b32 s21, s58, 7
s_lshl_b32 s22, s59, 8
s_mul_i32 s22, s59, 384
s_add_u32 s22, s22, 4096
s_mov_b32 s26, 2048
s_mov_b32 s27, 0
s_mov_b32 s28, 0
s_mov_b32 s25, 7168
s_mov_b32 s23, 128
s_mov_b32 s24, 64
s_mov_b32 s35, 458752
s_add_u32 s8, s86, 12582912
s_addc_u32 s9, s87, 0
s_mov_b32 s10, 4194304
s_mov_b32 s11, 0x20000
s_mov_b32 s12, s76
s_mov_b32 s13, s77
s_mov_b32 s14, 7340032
s_mov_b32 s15, 0x20000
s_sub_u32 s31, s20, 4
s_mul_i32 s36, s31, 4096
s_mul_i32 s37, s31, 6144
s_add_u32 s37, s37, 16384
s_mov_b32 s30, 0
s_mov_b32 s39, 0
s_mov_b32 s6, 0
s_lshl_b32 s32, s58, 10
s_add_u32 s32, s32, 38813696
v_and_b32 v40, 31, v254
v_lshlrev_b32 v40, 4, v40
v_mov_b32 v42, 150024
s_cmp_lg_u32 s20, 4
s_cbranch_scc1 L_p1o_159
s_mov_b32 s50, 0
L_poll_161:
buffer_load_dword v41, v40, s[16:19], s32 offen sc0 sc1
s_waitcnt vmcnt(0)
v_cmp_eq_u32 vcc, 0, v41
s_cmp_eq_u64 vcc, 0
s_cbranch_scc1 L_pollx_162
s_sleep 4
s_add_u32 s50, s50, 1
s_cmp_lt_u32 s50, 100000
s_cbranch_scc1 L_poll_161
L_pollx_162:
v_mov_b32 v41, 3
ds_write_b32 v42, v41
s_branch L_p1x_160
L_p1o_159:
s_mov_b32 s50, 0
L_p1l_163:
ds_read_b32 v41, v42
s_waitcnt lgkmcnt(0)
v_readfirstlane_b32 s34, v41
s_cmp_ge_u32 s34, 3
s_cbranch_scc1 L_p1x_160
s_sleep 1
s_add_u32 s50, s50, 1
s_cmp_lt_u32 s50, 800000
s_cbranch_scc1 L_p1l_163
L_p1x_160:
s_add_u32 s7, s6, 0
s_add_u32 s4, s7, s3
s_and_b32 s4, s4, 3
s_and_b32 s7, s7, 3
s_sub_i32 s7, s4, s7
s_lshl_b32 s4, s7, 7
s_add_u32 s4, s4, s27
s_mul_i32 s5, s7, s35
s_add_u32 s5, s5, s28
s_add_u32 s32, s30, s36
s_add_u32 m0, s32, 0
s_nop 0
buffer_load_dwordx4 v200, s[8:11], s4 offen lds
s_add_u32 m0, s32, 1024
s_nop 0
buffer_load_dwordx4 v201, s[8:11], s4 offen lds
s_add_u32 m0, s32, 2048
s_nop 0
buffer_load_dwordx4 v202, s[8:11], s4 offen lds
s_add_u32 m0, s32, 3072
s_nop 0
buffer_load_dwordx4 v203, s[8:11], s4 offen lds
s_add_u32 s27, s27, 128
s_add_u32 s28, s28, s35
s_add_u32 s6, s6, 1
s_add_u32 s30, s30, 40960
s_cmp_ge_u32 s30, 122880
s_cselect_b32 s30, 0, s30
s_add_u32 s7, s6, 0
s_add_u32 s4, s7, s3
s_and_b32 s4, s4, 3
s_and_b32 s7, s7, 3
s_sub_i32 s7, s4, s7
s_lshl_b32 s4, s7, 7
s_add_u32 s4, s4, s27
s_mul_i32 s5, s7, s35
s_add_u32 s5, s5, s28
s_add_u32 s32, s30, s36
s_add_u32 m0, s32, 0
s_nop 0
buffer_load_dwordx4 v200, s[8:11], s4 offen lds
s_add_u32 m0, s32, 1024
s_nop 0
buffer_load_dwordx4 v201, s[8:11], s4 offen lds
s_add_u32 m0, s32, 2048
s_nop 0
buffer_load_dwordx4 v202, s[8:11], s4 offen lds
s_add_u32 m0, s32, 3072
s_nop 0
buffer_load_dwordx4 v203, s[8:11], s4 offen lds
s_add_u32 s27, s27, 128
s_add_u32 s28, s28, s35
s_add_u32 s6, s6, 1
s_add_u32 s30, s30, 40960
s_cmp_ge_u32 s30, 122880
s_cselect_b32 s30, 0, s30
s_add_u32 s7, s6, 0
s_add_u32 s4, s7, s3
s_and_b32 s4, s4, 3
s_and_b32 s7, s7, 3
s_sub_i32 s7, s4, s7
s_lshl_b32 s4, s7, 7
s_add_u32 s4, s4, s27
s_mul_i32 s5, s7, s35
s_add_u32 s5, s5, s28
s_add_u32 s32, s30, s36
s_add_u32 m0, s32, 0
s_nop 0
buffer_load_dwordx4 v200, s[8:11], s4 offen lds
s_add_u32 m0, s32, 1024
s_nop 0
buffer_load_dwordx4 v201, s[8:11], s4 offen lds
s_add_u32 m0, s32, 2048
s_nop 0
buffer_load_dwordx4 v202, s[8:11], s4 offen lds
s_add_u32 m0, s32, 3072
s_nop 0
buffer_load_dwordx4 v203, s[8:11], s4 offen lds
s_add_u32 s27, s27, 128
s_add_u32 s28, s28, s35
s_add_u32 s6, s6, 1
s_add_u32 s30, s30, 40960
s_cmp_ge_u32 s30, 122880
s_cselect_b32 s30, 0, s30
s_waitcnt vmcnt(8)
s_barrier
s_waitcnt vmcnt(4)
s_barrier
s_add_u32 s7, s6, 0
s_add_u32 s4, s7, s3
s_and_b32 s4, s4, 3
s_and_b32 s7, s7, 3
s_sub_i32 s7, s4, s7
s_lshl_b32 s4, s7, 7
s_add_u32 s4, s4, s27
s_mul_i32 s5, s7, s35
s_add_u32 s5, s5, s28
s_add_u32 s32, s30, s36
s_add_u32 s33, s30, s37
s_add_u32 m0, s33, 0
s_nop 0
buffer_load_dwordx4 v204, s[12:15], s5 offen lds
s_add_u32 m0, s32, 0
s_nop 0
buffer_load_dwordx4 v200, s[8:11], s4 offen lds
s_add_u32 m0, s33, 1024
s_nop 0
buffer_load_dwordx4 v205, s[12:15], s5 offen lds
s_add_u32 m0, s32, 1024
s_nop 0
buffer_load_dwordx4 v201, s[8:11], s4 offen lds
s_add_u32 m0, s33, 2048
s_nop 0
buffer_load_dwordx4 v206, s[12:15], s5 offen lds
s_add_u32 m0, s32, 2048
s_nop 0
buffer_load_dwordx4 v202, s[8:11], s4 offen lds
s_add_u32 m0, s33, 3072
s_nop 0
buffer_load_dwordx4 v207, s[12:15], s5 offen lds
s_add_u32 m0, s32, 3072
s_nop 0
buffer_load_dwordx4 v203, s[8:11], s4 offen lds
s_add_u32 m0, s33, 4096
s_nop 0
buffer_load_dwordx4 v208, s[12:15], s5 offen lds
s_add_u32 m0, s33, 5120
s_nop 0
buffer_load_dwordx4 v209, s[12:15], s5 offen lds
s_add_u32 s27, s27, 128
s_add_u32 s28, s28, s35
s_add_u32 s6, s6, 1
s_add_u32 s30, s30, 40960
s_cmp_ge_u32 s30, 122880
s_cselect_b32 s30, 0, s30
s_mov_b32 s29, 4
s_mov_b32 s93, 4096
L_s7_ld_164:
s_waitcnt vmcnt(10)
s_barrier
s_add_u32 s7, s6, 0
s_add_u32 s4, s7, s3
s_and_b32 s4, s4, 3
s_and_b32 s7, s7, 3
s_sub_i32 s7, s4, s7
s_lshl_b32 s4, s7, 7
s_add_u32 s4, s4, s27
s_mul_i32 s5, s7, s35
s_add_u32 s5, s5, s28
s_add_u32 s32, s30, s36
s_add_u32 s33, s30, s37
s_add_u32 m0, s33, 0
s_nop 0
buffer_load_dwordx4 v204, s[12:15], s5 offen lds
s_add_u32 m0, s32, 0
s_nop 0
buffer_load_dwordx4 v200, s[8:11], s4 offen lds
s_add_u32 m0, s33, 1024
s_nop 0
buffer_load_dwordx4 v205, s[12:15], s5 offen lds
s_add_u32 m0, s32, 1024
s_nop 0
buffer_load_dwordx4 v201, s[8:11], s4 offen lds
s_add_u32 m0, s33, 2048
s_nop 0
buffer_load_dwordx4 v206, s[12:15], s5 offen lds
s_add_u32 m0, s32, 2048
s_nop 0
buffer_load_dwordx4 v202, s[8:11], s4 offen lds
s_add_u32 m0, s33, 3072
s_nop 0
buffer_load_dwordx4 v207, s[12:15], s5 offen lds
s_add_u32 m0, s32, 3072
s_nop 0
buffer_load_dwordx4 v203, s[8:11], s4 offen lds
s_add_u32 m0, s33, 4096
s_nop 0
buffer_load_dwordx4 v208, s[12:15], s5 offen lds
s_add_u32 m0, s33, 5120
s_nop 0
buffer_load_dwordx4 v209, s[12:15], s5 offen lds
s_add_u32 s27, s27, 128
s_add_u32 s28, s28, s35
s_add_u32 s6, s6, 1
s_add_u32 s30, s30, 40960
s_cmp_ge_u32 s30, 122880
s_cselect_b32 s30, 0, s30
s_bitcmp1_b32 s93, s29
s_cbranch_scc1 L_s7_H_167
L_s7_B_168:
s_add_u32 s29, s29, 1
s_cmp_lt_u32 s29, 16
s_cbranch_scc1 L_s7_ld_164
s_min_u32 s61, s31, 2
s_mul_i32 s62, s59, 3
s_add_u32 s62, s62, s61
s_add_u32 s62, s62, 32
v_and_b32 v40, 15, v254
v_mul_u32_u24 v40, 896, v40
s_lshl_b32 s32, s62, 4
s_add_u32 s32, s32, 38895616
v_cmp_eq_u32 vcc, 0, v41
s_cmp_eq_u64 vcc, 0
s_cbranch_scc1 L_nbok_170
s_mov_b32 s50, 0
L_poll_171:
buffer_load_dword v41, v40, s[16:19], s32 offen sc0 sc1
s_waitcnt vmcnt(0)
v_cmp_eq_u32 vcc, 0, v41
s_cmp_eq_u64 vcc, 0
s_cbranch_scc1 L_pollx_172
s_sleep 4
s_add_u32 s50, s50, 1
s_cmp_lt_u32 s50, 100000
s_cbranch_scc1 L_poll_171
L_pollx_172:
L_nbok_170:
v_and_b32 v64, 15, v254
v_lshlrev_b32 v64, 4, v64
v_lshrrev_b32 v65, 4, v254
v_mul_u32_u24 v65, 14336, v65
v_add_u32 v65, v65, v64
s_lshl_b32 s33, s62, 8
s_add_u32 s33, s33, 36962304
buffer_load_dwordx4 v[72:75], v65, s[16:19], s33 offen
s_add_u32 s33, s33, 57344
buffer_load_dwordx4 v[76:79], v65, s[16:19], s33 offen
s_add_u32 s33, s33, 57344
buffer_load_dwordx4 v[80:83], v65, s[16:19], s33 offen
s_add_u32 s33, s33, 57344
buffer_load_dwordx4 v[84:87], v65, s[16:19], s33 offen
s_add_u32 s33, s33, 57344
s_lshl_b32 s61, s61, 8
s_add_u32 s61, s61, 155200
v_add_u32 v64, s61, v64
v_mov_b32 v90, 1015021568
s_lshl_b32 s32, s31, 5
s_add_u32 s32, s32, s21
s_lshl_b32 s32, s32, 3
s_add_u32 s32, s32, 37748736
v_and_b32 v66, 15, v254
v_lshlrev_b32 v66, 4, v66
v_lshrrev_b32 v67, 4, v254
v_lshl_add_u32 v67, v67, 16, v66
buffer_load_dwordx4 v[96:99], v67, s[16:19], s32 offen
s_add_u32 s32, s32, 16384
buffer_load_dwordx4 v[100:103], v67, s[16:19], s32 offen
s_add_u32 s32, s32, 16384
buffer_load_dwordx4 v[104:107], v67, s[16:19], s32 offen
s_add_u32 s32, s32, 16384
buffer_load_dwordx4 v[108:111], v67, s[16:19], s32 offen
s_add_u32 s32, s32, 16384
s_lshl_b32 s32, s31, 9
s_add_u32 m0, s32, 147456
s_lshl_b32 s33, s21, 4
s_add_u32 s33, s33, s32
s_add_u32 s33, s33, 36700160
v_lshlrev_b32 v43, 4, v254
s_mov_b32 exec_hi, 0
buffer_load_dwordx4 v43, s[16:19], s33 offen lds
s_mov_b32 exec_hi, -1
s_waitcnt vmcnt(19)
s_barrier
s_and_b32 s56, s2, 1
s_bfe_u32 s5, s2, 0x10002
s_bfe_u32 s6, s2, 0x10001
s_lshr_b32 s4, s2, 3
s_lshr_b32 s7, s4, 2
s_and_b32 s4, s4, 3
s_lshl_b32 s5, s5, 3
s_add_u32 s58, s5, s7
s_lshl_b32 s6, s6, 2
s_add_u32 s59, s6, s4
s_mul_i32 s3, s7, 1
s_mul_i32 s31, s4, 0
s_add_u32 s3, s3, s31
s_lshl_b32 s21, s58, 7
s_lshl_b32 s22, s59, 8
s_mov_b32 s51, 32
s_mov_b32 s57, 8
s_cmp_eq_u32 s56, 1
s_cmov_b32 s51, 28
s_cmov_b32 s57, 8
s_sub_u32 s98, s51, 1
s_mov_b32 s99, 3
s_lshl_b32 s101, s56, 5
s_mov_b32 s26, 2048
s_mov_b32 s27, 0
s_mov_b32 s28, 0
s_mov_b32 s25, 2048
s_mov_b32 s23, 128
s_mov_b32 s24, 64
s_mov_b32 s35, 131072
s_mul_i32 s27, s56, 1024
s_mul_i32 s28, s56, 1048576
s_add_u32 s8, s86, 8388608
s_addc_u32 s9, s87, 0
s_mov_b32 s10, 4194304
s_mov_b32 s11, 0x20000
s_mov_b32 s12, s68
s_mov_b32 s13, s69
s_mov_b32 s14, 2097152
s_mov_b32 s15, 0x20000
s_sub_u32 s31, s20, 4
s_mul_i32 s36, s31, 4096
s_mul_i32 s37, s31, 4096
s_add_u32 s37, s37, 16384
s_mov_b32 s30, 0
s_mov_b32 s39, 0
s_mov_b32 s6, 0
s_waitcnt vmcnt(0)
v_pk_add_f32 v[72:73], v[72:73], v[76:77]
v_pk_add_f32 v[80:81], v[80:81], v[84:85]
v_pk_add_f32 v[74:75], v[74:75], v[78:79]
v_pk_add_f32 v[82:83], v[82:83], v[86:87]
v_pk_add_f32 v[72:73], v[72:73], v[80:81]
v_pk_add_f32 v[74:75], v[74:75], v[82:83]
v_mov_b32 v76, v72
v_mov_b32 v77, v73
v_mov_b32 v78, v74
v_mov_b32 v79, v75
v_permlane16_swap_b32 v72, v76
v_permlane16_swap_b32 v73, v77
v_permlane16_swap_b32 v74, v78
v_permlane16_swap_b32 v75, v79
v_add_f32 v72, v72, v76
v_add_f32 v73, v73, v77
v_add_f32 v74, v74, v78
v_add_f32 v75, v75, v79
v_mov_b32 v76, v72
v_mov_b32 v77, v73
v_mov_b32 v78, v74
v_mov_b32 v79, v75
v_permlane32_swap_b32 v72, v76
v_permlane32_swap_b32 v73, v77
v_permlane32_swap_b32 v74, v78
v_permlane32_swap_b32 v75, v79
v_add_f32 v72, v72, v76
v_add_f32 v73, v73, v77
v_add_f32 v74, v74, v78
v_add_f32 v75, v75, v79
ds_write_b128 v64, v[72:75]
s_barrier
v_pk_add_f32 v[68:69], v[96:97], v[100:101]
v_pk_add_f32 v[112:113], v[104:105], v[108:109]
v_pk_add_f32 v[70:71], v[98:99], v[102:103]
v_pk_add_f32 v[114:115], v[106:107], v[110:111]
v_pk_add_f32 v[68:69], v[68:69], v[112:113]
v_pk_add_f32 v[70:71], v[70:71], v[114:115]
v_mov_b32 v112, v68
v_mov_b32 v113, v70
s_nop 1
v_permlane16_swap_b32 v68, v112
v_permlane16_swap_b32 v70, v113
s_nop 1
v_add_f32 v68, v68, v112
v_add_f32 v70, v70, v113
v_mov_b32 v112, v68
v_mov_b32 v113, v70
s_nop 1
v_permlane32_swap_b32 v68, v112
v_permlane32_swap_b32 v70, v113
s_nop 1
v_add_f32 v68, v68, v112
v_add_f32 v70, v70, v113
v_mul_f32 v68, 981467136, v68
v_mul_f32 v70, 981467136, v70
v_fma_f32 v112, v96, v90, -v68
v_fma_f32 v113, v98, v90, -v70
v_fma_f32 v114, v100, v90, -v68
v_fma_f32 v115, v102, v90, -v70
v_fma_f32 v116, v104, v90, -v68
v_fma_f32 v117, v106, v90, -v70
v_fma_f32 v118, v108, v90, -v68
v_fma_f32 v119, v110, v90, -v70
v_mul_f32 v112, v112, v112
v_mul_f32 v113, v113, v113
v_mul_f32 v114, v114, v114
v_mul_f32 v115, v115, v115
v_mul_f32 v116, v116, v116
v_mul_f32 v117, v117, v117
v_mul_f32 v118, v118, v118
v_mul_f32 v119, v119, v119
v_fmac_f32 v69, 1115684864, v112
v_fmac_f32 v71, 1115684864, v113
v_fmac_f32 v69, 1115684864, v114
v_fmac_f32 v71, 1115684864, v115
v_fmac_f32 v69, 1115684864, v116
v_fmac_f32 v71, 1115684864, v117
v_fmac_f32 v69, 1115684864, v118
v_fmac_f32 v71, 1115684864, v119
v_mov_b32 v112, v69
v_mov_b32 v113, v71
s_nop 1
v_permlane16_swap_b32 v69, v112
v_permlane16_swap_b32 v71, v113
s_nop 1
v_add_f32 v69, v69, v112
v_add_f32 v71, v71, v113
v_mov_b32 v112, v69
v_mov_b32 v113, v71
s_nop 1
v_permlane32_swap_b32 v69, v112
v_permlane32_swap_b32 v71, v113
s_nop 1
v_add_f32 v69, v69, v112
v_add_f32 v71, v71, v113
v_mov_b32 v112, 925353388
v_fmac_f32 v112, 981467136, v69
v_rsq_f32 v112, v112
v_mov_b32 v114, 925353388
v_fmac_f32 v114, 981467136, v71
v_rsq_f32 v114, v114
s_nop 0
v_mov_b32 v113, v68
v_mov_b32 v115, v70
s_lshl_b32 s32, s31, 8
s_add_u32 s32, s32, 154176
v_add_u32 v66, s32, v66
ds_write_b128 v66, v[112:115]
s_waitcnt lgkmcnt(0)
s_barrier
L_l_s5_97:
v_mov_b32 v43, 0
s_add_u32 s33, s37, 0
s_add_u32 s7, s6, 0
s_add_u32 s4, s7, s3
s_and_b32 s4, s4, s99
s_and_b32 s7, s7, s99
s_sub_i32 s7, s4, s7
s_lshl_b32 s4, s7, 7
s_add_u32 s4, s4, s27
s_mul_i32 s5, s7, s35
s_add_u32 s5, s5, s28
s_add_u32 m0, s33, 0
s_nop 0
buffer_load_dwordx4 v216, s[12:15], s5 offen lds
s_add_u32 m0, s33, 1024
s_nop 0
buffer_load_dwordx4 v217, s[12:15], s5 offen lds
s_add_u32 m0, s33, 2048
s_nop 0
buffer_load_dwordx4 v218, s[12:15], s5 offen lds
s_add_u32 m0, s33, 3072
s_nop 0
buffer_load_dwordx4 v219, s[12:15], s5 offen lds
s_add_u32 s33, s37, 32768
s_add_u32 s7, s6, 1
s_add_u32 s4, s7, s3
s_and_b32 s4, s4, s99
s_and_b32 s7, s7, s99
s_sub_i32 s7, s4, s7
s_add_i32 s7, s7, 1
s_lshl_b32 s4, s7, 7
s_add_u32 s4, s4, s27
s_mul_i32 s5, s7, s35
s_add_u32 s5, s5, s28
s_add_u32 m0, s33, 0
s_nop 0
buffer_load_dwordx4 v216, s[12:15], s5 offen lds
s_add_u32 m0, s33, 1024
s_nop 0
buffer_load_dwordx4 v217, s[12:15], s5 offen lds
s_add_u32 m0, s33, 2048
s_nop 0
buffer_load_dwordx4 v218, s[12:15], s5 offen lds
s_add_u32 m0, s33, 3072
s_nop 0
buffer_load_dwordx4 v219, s[12:15], s5 offen lds
s_lshl_b32 s32, s58, 10
s_add_u32 s32, s32, 38830080
v_and_b32 v40, 31, v254
v_lshlrev_b32 v40, 4, v40
v_mov_b32 v43, 0
v_mov_b32 v42, 150024
s_cmp_lg_u32 s20, 4
s_cbranch_scc1 L_p1o_173
s_mov_b32 s50, 0
L_poll_175:
buffer_load_dword v41, v40, s[16:19], s32 offen sc0 sc1
s_waitcnt vmcnt(0)
v_cmp_eq_u32 vcc, 0, v41
s_cmp_eq_u64 vcc, 0
s_cbranch_scc1 L_pollx_176
s_sleep 4
s_add_u32 s50, s50, 1
s_cmp_lt_u32 s50, 100000
s_cbranch_scc1 L_poll_175
L_pollx_176:
v_mov_b32 v41, 4
ds_write_b32 v42, v41
s_branch L_p1x_174
L_p1o_173:
s_mov_b32 s50, 0
L_p1l_177:
ds_read_b32 v41, v42
s_waitcnt lgkmcnt(0)
v_readfirstlane_b32 s34, v41
s_cmp_ge_u32 s34, 4
s_cbranch_scc1 L_p1x_174
s_sleep 1
s_add_u32 s50, s50, 1
s_cmp_lt_u32 s50, 800000
s_cbranch_scc1 L_p1l_177
L_p1x_174:
s_add_u32 s7, s6, 0
s_add_u32 s4, s7, s3
s_and_b32 s4, s4, s99
s_and_b32 s7, s7, s99
s_sub_i32 s7, s4, s7
s_lshl_b32 s4, s7, 7
s_add_u32 s4, s4, s27
s_mul_i32 s5, s7, s35
s_add_u32 s5, s5, s28
s_add_u32 s32, s30, s36
s_add_u32 m0, s32, 0
s_nop 0
buffer_load_dwordx4 v212, s[8:11], s4 offen lds
s_add_u32 m0, s32, 1024
s_nop 0
buffer_load_dwordx4 v213, s[8:11], s4 offen lds
s_add_u32 m0, s32, 2048
s_nop 0
buffer_load_dwordx4 v214, s[8:11], s4 offen lds
s_add_u32 m0, s32, 3072
s_nop 0
buffer_load_dwordx4 v215, s[8:11], s4 offen lds
s_add_u32 s27, s27, 128
s_add_u32 s28, s28, s35
s_add_u32 s6, s6, 1
s_add_u32 s30, s30, 32768
s_cmp_ge_u32 s30, 131072
s_cselect_b32 s30, 0, s30
s_add_u32 s39, s39, 1
s_add_u32 s7, s6, 0
s_add_u32 s4, s7, s3
s_and_b32 s4, s4, s99
s_and_b32 s7, s7, s99
s_sub_i32 s7, s4, s7
s_lshl_b32 s4, s7, 7
s_add_u32 s4, s4, s27
s_mul_i32 s5, s7, s35
s_add_u32 s5, s5, s28
s_add_u32 s32, s30, s36
s_add_u32 m0, s32, 0
s_nop 0
buffer_load_dwordx4 v212, s[8:11], s4 offen lds
s_add_u32 m0, s32, 1024
s_nop 0
buffer_load_dwordx4 v213, s[8:11], s4 offen lds
s_add_u32 m0, s32, 2048
s_nop 0
buffer_load_dwordx4 v214, s[8:11], s4 offen lds
s_add_u32 m0, s32, 3072
s_nop 0
buffer_load_dwordx4 v215, s[8:11], s4 offen lds
s_add_u32 s27, s27, 128
s_add_u32 s28, s28, s35
s_add_u32 s6, s6, 1
s_add_u32 s30, s30, 32768
s_cmp_ge_u32 s30, 131072
s_cselect_b32 s30, 0, s30
s_add_u32 s39, s39, 1
s_lshr_b32 s60, s31, 1
s_lshl_b32 s60, s60, 6
s_and_b32 s32, s31, 1
s_lshl_b32 s32, s32, 4
s_add_u32 s60, s60, s32
s_add_u32 s61, s21, s101
s_add_u32 s32, s60, 0
v_lshrrev_b32 v44, 3, v254
v_add_u32 v44, s32, v44
v_bfe_u32 v45, v44, 1, 3
v_and_b32 v46, 7, v254
v_xor_b32 v46, v46, v45
v_lshlrev_b32 v46, 4, v46
v_add_u32 v44, s61, v44
v_lshl_add_u32 v48, v44, 11, v46
v_mul_u32_u24 v44, 7168, v44
v_add_u32 v50, v44, v46
s_add_u32 s32, s60, 8
v_lshrrev_b32 v44, 3, v254
v_add_u32 v44, s32, v44
v_bfe_u32 v45, v44, 1, 3
v_and_b32 v46, 7, v254
v_xor_b32 v46, v46, v45
v_lshlrev_b32 v46, 4, v46
v_add_u32 v44, s61, v44
v_lshl_add_u32 v49, v44, 11, v46
v_mul_u32_u24 v44, 7168, v44
v_add_u32 v51, v44, v46
s_lshl_b32 s60, s60, 7
s_waitcnt vmcnt(4)
s_barrier
s_cmp_lg_u32 s39, s57
s_cbranch_scc1 L_s6_nosw_178
s_waitcnt vmcnt(8)
s_cmp_lg_u32 s56, 0
s_cbranch_scc1 L_sw_b_179
s_lshl_b32 s32, s58, 10
s_add_u32 s32, s32, 38846464
v_max_u32 v40, 0, v254
v_min_u32 v40, 23, v40
v_lshlrev_b32 v40, 4, v40
v_cmp_eq_u32 vcc, 0, v43
s_cmp_eq_u64 vcc, 0
s_cbranch_scc1 L_nbok_181
s_mov_b32 s50, 0
L_poll_182:
buffer_load_dword v43, v40, s[16:19], s32 offen sc0 sc1
s_waitcnt vmcnt(0)
v_cmp_eq_u32 vcc, 0, v43
s_cmp_eq_u64 vcc, 0
s_cbranch_scc1 L_pollx_183
s_sleep 4
s_add_u32 s50, s50, 1
s_cmp_lt_u32 s50, 100000
s_cbranch_scc1 L_poll_182
L_pollx_183:
L_nbok_181:
s_branch L_sw_x_180
L_sw_b_179:
s_lshl_b32 s32, s58, 10
s_add_u32 s32, s32, 38846464
v_max_u32 v40, 36, v254
v_min_u32 v40, 63, v40
v_lshlrev_b32 v40, 4, v40
v_cmp_eq_u32 vcc, 0, v43
s_cmp_eq_u64 vcc, 0
s_cbranch_scc1 L_nbok_184
s_mov_b32 s50, 0
L_poll_185:
buffer_load_dword v43, v40, s[16:19], s32 offen sc0 sc1
s_waitcnt vmcnt(0)
v_cmp_eq_u32 vcc, 0, v43
s_cmp_eq_u64 vcc, 0
s_cbranch_scc1 L_pollx_186
s_sleep 4
s_add_u32 s50, s50, 1
s_cmp_lt_u32 s50, 100000
s_cbranch_scc1 L_poll_185
L_pollx_186:
L_nbok_184:
L_sw_x_180:
s_add_u32 s8, s86, 16777216
s_addc_u32 s9, s87, 0
s_mov_b32 s10, 14680064
s_mov_b32 s11, 0x20000
s_mov_b32 s12, s78
s_mov_b32 s13, s79
s_mov_b32 s14, 7340032
s_mov_b32 s15, 0x20000
s_mul_i32 s27, s56, 4608
s_mul_i32 s28, s56, 4718592
s_mov_b32 s6, 0
s_mov_b32 s99, 3
v_mov_b32 v212, v220
v_mov_b32 v213, v221
v_mov_b32 v214, v222
v_mov_b32 v215, v223
L_s6_nosw_178:
s_add_u32 s7, s6, 0
s_add_u32 s4, s7, s3
s_and_b32 s4, s4, s99
s_and_b32 s7, s7, s99
s_sub_i32 s7, s4, s7
s_lshl_b32 s4, s7, 7
s_add_u32 s4, s4, s27
s_mul_i32 s5, s7, s35
s_add_u32 s5, s5, s28
s_add_u32 s32, s30, s36
s_add_u32 s33, s30, s37
s_add_u32 m0, s33, 0
s_nop 0
buffer_load_dwordx4 v216, s[12:15], s5 offen lds
s_add_u32 m0, s32, 0
s_nop 0
buffer_load_dwordx4 v212, s[8:11], s4 offen lds
s_add_u32 m0, s33, 1024
s_nop 0
buffer_load_dwordx4 v217, s[12:15], s5 offen lds
s_add_u32 m0, s32, 1024
s_nop 0
buffer_load_dwordx4 v213, s[8:11], s4 offen lds
s_add_u32 m0, s33, 2048
s_nop 0
buffer_load_dwordx4 v218, s[12:15], s5 offen lds
s_add_u32 m0, s32, 2048
s_nop 0
buffer_load_dwordx4 v214, s[8:11], s4 offen lds
s_add_u32 m0, s33, 3072
s_nop 0
buffer_load_dwordx4 v219, s[12:15], s5 offen lds
s_add_u32 m0, s32, 3072
s_nop 0
buffer_load_dwordx4 v215, s[8:11], s4 offen lds
s_add_u32 s27, s27, 128
s_add_u32 s28, s28, s35
s_add_u32 s6, s6, 1
s_add_u32 s30, s30, 32768
s_cmp_ge_u32 s30, 131072
s_cselect_b32 s30, 0, s30
s_add_u32 s39, s39, 1
s_cmp_lg_u32 s39, s57
s_cbranch_scc1 L_s6_nosw_187
s_waitcnt vmcnt(8)
s_cmp_lg_u32 s56, 0
s_cbranch_scc1 L_sw_b_188
s_lshl_b32 s32, s58, 10
s_add_u32 s32, s32, 38846464
v_max_u32 v40, 0, v254
v_min_u32 v40, 23, v40
v_lshlrev_b32 v40, 4, v40
v_cmp_eq_u32 vcc, 0, v43
s_cmp_eq_u64 vcc, 0
s_cbranch_scc1 L_nbok_190
s_mov_b32 s50, 0
L_poll_191:
buffer_load_dword v43, v40, s[16:19], s32 offen sc0 sc1
s_waitcnt vmcnt(0)
v_cmp_eq_u32 vcc, 0, v43
s_cmp_eq_u64 vcc, 0
s_cbranch_scc1 L_pollx_192
s_sleep 4
s_add_u32 s50, s50, 1
s_cmp_lt_u32 s50, 100000
s_cbranch_scc1 L_poll_191
L_pollx_192:
L_nbok_190:
s_branch L_sw_x_189
L_sw_b_188:
s_lshl_b32 s32, s58, 10
s_add_u32 s32, s32, 38846464
v_max_u32 v40, 36, v254
v_min_u32 v40, 63, v40
v_lshlrev_b32 v40, 4, v40
v_cmp_eq_u32 vcc, 0, v43
s_cmp_eq_u64 vcc, 0
s_cbranch_scc1 L_nbok_193
s_mov_b32 s50, 0
L_poll_194:
buffer_load_dword v43, v40, s[16:19], s32 offen sc0 sc1
s_waitcnt vmcnt(0)
v_cmp_eq_u32 vcc, 0, v43
s_cmp_eq_u64 vcc, 0
s_cbranch_scc1 L_pollx_195
s_sleep 4
s_add_u32 s50, s50, 1
s_cmp_lt_u32 s50, 100000
s_cbranch_scc1 L_poll_194
L_pollx_195:
L_nbok_193:
L_sw_x_189:
s_add_u32 s8, s86, 16777216
s_addc_u32 s9, s87, 0
s_mov_b32 s10, 14680064
s_mov_b32 s11, 0x20000
s_mov_b32 s12, s78
s_mov_b32 s13, s79
s_mov_b32 s14, 7340032
s_mov_b32 s15, 0x20000
s_mul_i32 s27, s56, 4608
s_mul_i32 s28, s56, 4718592
s_mov_b32 s6, 0
s_mov_b32 s99, 3
v_mov_b32 v212, v220
v_mov_b32 v213, v221
v_mov_b32 v214, v222
v_mov_b32 v215, v223
L_s6_nosw_187:
s_add_u32 s7, s6, 0
s_add_u32 s4, s7, s3
s_and_b32 s4, s4, s99
s_and_b32 s7, s7, s99
s_sub_i32 s7, s4, s7
s_lshl_b32 s4, s7, 7
s_add_u32 s4, s4, s27
s_mul_i32 s5, s7, s35
s_add_u32 s5, s5, s28
s_add_u32 s32, s30, s36
s_add_u32 s33, s30, s37
s_add_u32 m0, s33, 0
s_nop 0
buffer_load_dwordx4 v216, s[12:15], s5 offen lds
s_add_u32 m0, s32, 0
s_nop 0
buffer_load_dwordx4 v212, s[8:11], s4 offen lds
s_add_u32 m0, s33, 1024
s_nop 0
buffer_load_dwordx4 v217, s[12:15], s5 offen lds
s_add_u32 m0, s32, 1024
s_nop 0
buffer_load_dwordx4 v213, s[8:11], s4 offen lds
s_add_u32 m0, s33, 2048
s_nop 0
buffer_load_dwordx4 v218, s[12:15], s5 offen lds
s_add_u32 m0, s32, 2048
s_nop 0
buffer_load_dwordx4 v214, s[8:11], s4 offen lds
s_add_u32 m0, s33, 3072
s_nop 0
buffer_load_dwordx4 v219, s[12:15], s5 offen lds
s_add_u32 m0, s32, 3072
s_nop 0
buffer_load_dwordx4 v215, s[8:11], s4 offen lds
s_add_u32 s27, s27, 128
s_add_u32 s28, s28, s35
s_add_u32 s6, s6, 1
s_add_u32 s30, s30, 32768
s_cmp_ge_u32 s30, 131072
s_cselect_b32 s30, 0, s30
s_add_u32 s39, s39, 1
s_mov_b32 s29, 4
s_mov_b32 s93, 1048640
L_s6_ld_196:
s_waitcnt vmcnt(16)
s_barrier
s_cmp_lg_u32 s39, s57
s_cbranch_scc1 L_s6_nosw_199
s_waitcnt vmcnt(8)
s_cmp_lg_u32 s56, 0
s_cbranch_scc1 L_sw_b_200
s_lshl_b32 s32, s58, 10
s_add_u32 s32, s32, 38846464
v_max_u32 v40, 0, v254
v_min_u32 v40, 23, v40
v_lshlrev_b32 v40, 4, v40
v_cmp_eq_u32 vcc, 0, v43
s_cmp_eq_u64 vcc, 0
s_cbranch_scc1 L_nbok_202
s_mov_b32 s50, 0
L_poll_203:
buffer_load_dword v43, v40, s[16:19], s32 offen sc0 sc1
s_waitcnt vmcnt(0)
v_cmp_eq_u32 vcc, 0, v43
s_cmp_eq_u64 vcc, 0
s_cbranch_scc1 L_pollx_204
s_sleep 4
s_add_u32 s50, s50, 1
s_cmp_lt_u32 s50, 100000
s_cbranch_scc1 L_poll_203
L_pollx_204:
L_nbok_202:
s_branch L_sw_x_201
L_sw_b_200:
s_lshl_b32 s32, s58, 10
s_add_u32 s32, s32, 38846464
v_max_u32 v40, 36, v254
v_min_u32 v40, 63, v40
v_lshlrev_b32 v40, 4, v40
v_cmp_eq_u32 vcc, 0, v43
s_cmp_eq_u64 vcc, 0
s_cbranch_scc1 L_nbok_205
s_mov_b32 s50, 0
L_poll_206:
buffer_load_dword v43, v40, s[16:19], s32 offen sc0 sc1
s_waitcnt vmcnt(0)
v_cmp_eq_u32 vcc, 0, v43
s_cmp_eq_u64 vcc, 0
s_cbranch_scc1 L_pollx_207
s_sleep 4
s_add_u32 s50, s50, 1
s_cmp_lt_u32 s50, 100000
s_cbranch_scc1 L_poll_206
L_pollx_207:
L_nbok_205:
L_sw_x_201:
s_add_u32 s8, s86, 16777216
s_addc_u32 s9, s87, 0
s_mov_b32 s10, 14680064
s_mov_b32 s11, 0x20000
s_mov_b32 s12, s78
s_mov_b32 s13, s79
s_mov_b32 s14, 7340032
s_mov_b32 s15, 0x20000
s_mul_i32 s27, s56, 4608
s_mul_i32 s28, s56, 4718592
s_mov_b32 s6, 0
s_mov_b32 s99, 3
v_mov_b32 v212, v220
v_mov_b32 v213, v221
v_mov_b32 v214, v222
v_mov_b32 v215, v223
L_s6_nosw_199:
s_add_u32 s7, s6, 0
s_add_u32 s4, s7, s3
s_and_b32 s4, s4, s99
s_and_b32 s7, s7, s99
s_sub_i32 s7, s4, s7
s_lshl_b32 s4, s7, 7
s_add_u32 s4, s4, s27
s_mul_i32 s5, s7, s35
s_add_u32 s5, s5, s28
s_add_u32 s32, s30, s36
s_add_u32 s33, s30, s37
s_add_u32 m0, s33, 0
s_nop 0
buffer_load_dwordx4 v216, s[12:15], s5 offen lds
s_add_u32 m0, s32, 0
s_nop 0
buffer_load_dwordx4 v212, s[8:11], s4 offen lds
s_add_u32 m0, s33, 1024
s_nop 0
buffer_load_dwordx4 v217, s[12:15], s5 offen lds
s_add_u32 m0, s32, 1024
s_nop 0
buffer_load_dwordx4 v213, s[8:11], s4 offen lds
s_add_u32 m0, s33, 2048
s_nop 0
buffer_load_dwordx4 v218, s[12:15], s5 offen lds
s_add_u32 m0, s32, 2048
s_nop 0
buffer_load_dwordx4 v214, s[8:11], s4 offen lds
s_add_u32 m0, s33, 3072
s_nop 0
buffer_load_dwordx4 v219, s[12:15], s5 offen lds
s_add_u32 m0, s32, 3072
s_nop 0
buffer_load_dwordx4 v215, s[8:11], s4 offen lds
s_add_u32 s27, s27, 128
s_add_u32 s28, s28, s35
s_add_u32 s6, s6, 1
s_add_u32 s30, s30, 32768
s_cmp_ge_u32 s30, 131072
s_cselect_b32 s30, 0, s30
s_add_u32 s39, s39, 1
s_bitcmp1_b32 s93, s29
s_cbranch_scc1 L_s6_H_208
L_s6_B_209:
s_add_u32 s29, s29, 1
s_cmp_lt_u32 s29, s51
s_cbranch_scc1 L_s6_ld_196
s_lshl_b32 s32, s58, 10
s_add_u32 s32, s32, 38846464
v_max_u32 v40, 24, v254
v_min_u32 v40, 39, v40
v_lshlrev_b32 v40, 4, v40
v_cmp_eq_u32 vcc, 0, v43
s_cmp_eq_u64 vcc, 0
s_cbranch_scc1 L_nbok_215
s_mov_b32 s50, 0
L_poll_216:
buffer_load_dword v43, v40, s[16:19], s32 offen sc0 sc1
s_waitcnt vmcnt(0)
v_cmp_eq_u32 vcc, 0, v43
s_cmp_eq_u64 vcc, 0
s_cbranch_scc1 L_pollx_217
s_sleep 4
s_add_u32 s50, s50, 1
s_cmp_lt_u32 s50, 100000
s_cbranch_scc1 L_poll_216
L_pollx_217:
L_nbok_215:
s_mov_b32 s27, 3072
s_mov_b32 s28, 3145728
s_mov_b32 s6, 0
s_waitcnt vmcnt(16)
s_barrier
s_add_u32 s7, s6, 0
s_add_u32 s4, s7, s3
s_and_b32 s4, s4, s99
s_and_b32 s7, s7, s99
s_sub_i32 s7, s4, s7
s_lshl_b32 s4, s7, 7
s_add_u32 s4, s4, s27
s_mul_i32 s5, s7, s35
s_add_u32 s5, s5, s28
s_add_u32 s32, s30, s60
s_add_u32 s33, s30, s37
s_add_u32 m0, s33, 0
s_nop 0
buffer_load_dwordx4 v216, s[12:15], s5 offen lds
s_add_u32 m0, s32, 0
s_nop 0
buffer_load_dwordx4 v50, s[8:11], s4 offen lds
s_add_u32 m0, s33, 1024
s_nop 0
buffer_load_dwordx4 v217, s[12:15], s5 offen lds
s_add_u32 m0, s32, 1024
s_nop 0
buffer_load_dwordx4 v51, s[8:11], s4 offen lds
s_add_u32 m0, s33, 2048
s_nop 0
buffer_load_dwordx4 v218, s[12:15], s5 offen lds
s_add_u32 m0, s33, 3072
s_nop 0
buffer_load_dwordx4 v219, s[12:15], s5 offen lds
s_add_u32 s27, s27, 128
s_add_u32 s28, s28, s35
s_add_u32 s6, s6, 1
s_add_u32 s30, s30, 32768
s_cmp_ge_u32 s30, 131072
s_cselect_b32 s30, 0, s30
s_waitcnt vmcnt(14)
s_barrier
s_add_u32 s7, s6, 0
s_add_u32 s4, s7, s3
s_and_b32 s4, s4, s99
s_and_b32 s7, s7, s99
s_sub_i32 s7, s4, s7
s_lshl_b32 s4, s7, 7
s_add_u32 s4, s4, s27
s_mul_i32 s5, s7, s35
s_add_u32 s5, s5, s28
s_add_u32 s32, s30, s60
s_add_u32 s33, s30, s37
s_add_u32 m0, s33, 0
s_nop 0
buffer_load_dwordx4 v216, s[12:15], s5 offen lds
s_add_u32 m0, s32, 0
s_nop 0
buffer_load_dwordx4 v50, s[8:11], s4 offen lds
s_add_u32 m0, s33, 1024
s_nop 0
buffer_load_dwordx4 v217, s[12:15], s5 offen lds
s_add_u32 m0, s32, 1024
s_nop 0
buffer_load_dwordx4 v51, s[8:11], s4 offen lds
s_add_u32 m0, s33, 2048
s_nop 0
buffer_load_dwordx4 v218, s[12:15], s5 offen lds
s_add_u32 m0, s33, 3072
s_nop 0
buffer_load_dwordx4 v219, s[12:15], s5 offen lds
s_add_u32 s27, s27, 128
s_add_u32 s28, s28, s35
s_add_u32 s6, s6, 1
s_add_u32 s30, s30, 32768
s_cmp_ge_u32 s30, 131072
s_cselect_b32 s30, 0, s30
s_waitcnt vmcnt(12)
s_barrier
s_add_u32 s7, s6, 0
s_add_u32 s4, s7, s3
s_and_b32 s4, s4, s99
s_and_b32 s7, s7, s99
s_sub_i32 s7, s4, s7
s_lshl_b32 s4, s7, 7
s_add_u32 s4, s4, s27
s_mul_i32 s5, s7, s35
s_add_u32 s5, s5, s28
s_add_u32 s32, s30, s60
s_add_u32 s33, s30, s37
s_add_u32 m0, s33, 0
s_nop 0
buffer_load_dwordx4 v216, s[12:15], s5 offen lds
s_add_u32 m0, s32, 0
s_nop 0
buffer_load_dwordx4 v50, s[8:11], s4 offen lds
s_add_u32 m0, s33, 1024
s_nop 0
buffer_load_dwordx4 v217, s[12:15], s5 offen lds
s_add_u32 m0, s32, 1024
s_nop 0
buffer_load_dwordx4 v51, s[8:11], s4 offen lds
s_add_u32 m0, s33, 2048
s_nop 0
buffer_load_dwordx4 v218, s[12:15], s5 offen lds
s_add_u32 m0, s33, 3072
s_nop 0
buffer_load_dwordx4 v219, s[12:15], s5 offen lds
s_add_u32 s27, s27, 128
s_add_u32 s28, s28, s35
s_add_u32 s6, s6, 1
s_add_u32 s30, s30, 32768
s_cmp_ge_u32 s30, 131072
s_cselect_b32 s30, 0, s30
s_waitcnt vmcnt(12)
s_barrier
s_add_u32 s7, s6, 0
s_add_u32 s4, s7, s3
s_and_b32 s4, s4, s99
s_and_b32 s7, s7, s99
s_sub_i32 s7, s4, s7
s_lshl_b32 s4, s7, 7
s_add_u32 s4, s4, s27
s_mul_i32 s5, s7, s35
s_add_u32 s5, s5, s28
s_add_u32 s32, s30, s60
s_add_u32 s33, s30, s37
s_add_u32 m0, s33, 0
s_nop 0
buffer_load_dwordx4 v216, s[12:15], s5 offen lds
s_add_u32 m0, s32, 0
s_nop 0
buffer_load_dwordx4 v50, s[8:11], s4 offen lds
s_add_u32 m0, s33, 1024
s_nop 0
buffer_load_dwordx4 v217, s[12:15], s5 offen lds
s_add_u32 m0, s32, 1024
s_nop 0
buffer_load_dwordx4 v51, s[8:11], s4 offen lds
s_add_u32 m0, s33, 2048
s_nop 0
buffer_load_dwordx4 v218, s[12:15], s5 offen lds
s_add_u32 m0, s33, 3072
s_nop 0
buffer_load_dwordx4 v219, s[12:15], s5 offen lds
s_add_u32 s27, s27, 128
s_add_u32 s28, s28, s35
s_add_u32 s6, s6, 1
s_add_u32 s30, s30, 32768
s_cmp_ge_u32 s30, 131072
s_cselect_b32 s30, 0, s30
s_waitcnt vmcnt(12)
s_barrier
s_add_u32 s7, s6, 0
s_add_u32 s4, s7, s3
s_and_b32 s4, s4, s99
s_and_b32 s7, s7, s99
s_sub_i32 s7, s4, s7
s_lshl_b32 s4, s7, 7
s_add_u32 s4, s4, s27
s_mul_i32 s5, s7, s35
s_add_u32 s5, s5, s28
s_add_u32 s32, s30, s60
s_add_u32 s33, s30, s37
s_add_u32 m0, s33, 0
s_nop 0
buffer_load_dwordx4 v216, s[12:15], s5 offen lds
s_add_u32 m0, s32, 0
s_nop 0
buffer_load_dwordx4 v50, s[8:11], s4 offen lds
s_add_u32 m0, s33, 1024
s_nop 0
buffer_load_dwordx4 v217, s[12:15], s5 offen lds
s_add_u32 m0, s32, 1024
s_nop 0
buffer_load_dwordx4 v51, s[8:11], s4 offen lds
s_add_u32 m0, s33, 2048
s_nop 0
buffer_load_dwordx4 v218, s[12:15], s5 offen lds
s_add_u32 m0, s33, 3072
s_nop 0
buffer_load_dwordx4 v219, s[12:15], s5 offen lds
s_add_u32 s27, s27, 128
s_add_u32 s28, s28, s35
s_add_u32 s6, s6, 1
s_add_u32 s30, s30, 32768
s_cmp_ge_u32 s30, 131072
s_cselect_b32 s30, 0, s30
s_waitcnt vmcnt(12)
s_barrier
s_add_u32 s7, s6, 0
s_add_u32 s4, s7, s3
s_and_b32 s4, s4, s99
s_and_b32 s7, s7, s99
s_sub_i32 s7, s4, s7
s_lshl_b32 s4, s7, 7
s_add_u32 s4, s4, s27
s_mul_i32 s5, s7, s35
s_add_u32 s5, s5, s28
s_add_u32 s32, s30, s60
s_add_u32 s33, s30, s37
s_add_u32 m0, s33, 0
s_nop 0
buffer_load_dwordx4 v216, s[12:15], s5 offen lds
s_add_u32 m0, s32, 0
s_nop 0
buffer_load_dwordx4 v50, s[8:11], s4 offen lds
s_add_u32 m0, s33, 1024
s_nop 0
buffer_load_dwordx4 v217, s[12:15], s5 offen lds
s_add_u32 m0, s32, 1024
s_nop 0
buffer_load_dwordx4 v51, s[8:11], s4 offen lds
s_add_u32 m0, s33, 2048
s_nop 0
buffer_load_dwordx4 v218, s[12:15], s5 offen lds
s_add_u32 m0, s33, 3072
s_nop 0
buffer_load_dwordx4 v219, s[12:15], s5 offen lds
s_add_u32 s27, s27, 128
s_add_u32 s28, s28, s35
s_add_u32 s6, s6, 1
s_add_u32 s30, s30, 32768
s_cmp_ge_u32 s30, 131072
s_cselect_b32 s30, 0, s30
s_waitcnt vmcnt(12)
s_barrier
s_add_u32 s7, s6, 0
s_add_u32 s4, s7, s3
s_and_b32 s4, s4, s99
s_and_b32 s7, s7, s99
s_sub_i32 s7, s4, s7
s_lshl_b32 s4, s7, 7
s_add_u32 s4, s4, s27
s_mul_i32 s5, s7, s35
s_add_u32 s5, s5, s28
s_add_u32 s32, s30, s60
s_add_u32 s33, s30, s37
s_add_u32 m0, s33, 0
s_nop 0
buffer_load_dwordx4 v216, s[12:15], s5 offen lds
s_add_u32 m0, s32, 0
s_nop 0
buffer_load_dwordx4 v50, s[8:11], s4 offen lds
s_add_u32 m0, s33, 1024
s_nop 0
buffer_load_dwordx4 v217, s[12:15], s5 offen lds
s_add_u32 m0, s32, 1024
s_nop 0
buffer_load_dwordx4 v51, s[8:11], s4 offen lds
s_add_u32 m0, s33, 2048
s_nop 0
buffer_load_dwordx4 v218, s[12:15], s5 offen lds
s_add_u32 m0, s33, 3072
s_nop 0
buffer_load_dwordx4 v219, s[12:15], s5 offen lds
s_add_u32 s27, s27, 128
s_add_u32 s28, s28, s35
s_add_u32 s6, s6, 1
s_add_u32 s30, s30, 32768
s_cmp_ge_u32 s30, 131072
s_cselect_b32 s30, 0, s30
s_waitcnt vmcnt(12)
s_barrier
s_add_u32 s7, s6, 0
s_add_u32 s4, s7, s3
s_and_b32 s4, s4, s99
s_and_b32 s7, s7, s99
s_sub_i32 s7, s4, s7
s_lshl_b32 s4, s7, 7
s_add_u32 s4, s4, s27
s_mul_i32 s5, s7, s35
s_add_u32 s5, s5, s28
s_add_u32 s32, s30, s60
s_add_u32 s33, s30, s37
s_add_u32 m0, s33, 0
s_nop 0
buffer_load_dwordx4 v216, s[12:15], s5 offen lds
s_add_u32 m0, s32, 0
s_nop 0
buffer_load_dwordx4 v50, s[8:11], s4 offen lds
s_add_u32 m0, s33, 1024
s_nop 0
buffer_load_dwordx4 v217, s[12:15], s5 offen lds
s_add_u32 m0, s32, 1024
s_nop 0
buffer_load_dwordx4 v51, s[8:11], s4 offen lds
s_add_u32 m0, s33, 2048
s_nop 0
buffer_load_dwordx4 v218, s[12:15], s5 offen lds
s_add_u32 m0, s33, 3072
s_nop 0
buffer_load_dwordx4 v219, s[12:15], s5 offen lds
s_add_u32 s27, s27, 128
s_add_u32 s28, s28, s35
s_add_u32 s6, s6, 1
s_add_u32 s30, s30, 32768
s_cmp_ge_u32 s30, 131072
s_cselect_b32 s30, 0, s30
s_waitcnt vmcnt(12)
s_barrier
s_add_u32 s7, s6, 0
s_add_u32 s4, s7, s3
s_and_b32 s4, s4, s99
s_and_b32 s7, s7, s99
s_sub_i32 s7, s4, s7
s_lshl_b32 s4, s7, 7
s_add_u32 s4, s4, s27
s_mul_i32 s5, s7, s35
s_add_u32 s5, s5, s28
s_add_u32 s32, s30, s60
s_add_u32 s33, s30, s37
s_add_u32 m0, s33, 0
s_nop 0
buffer_load_dwordx4 v216, s[12:15], s5 offen lds
s_add_u32 m0, s32, 0
s_nop 0
buffer_load_dwordx4 v50, s[8:11], s4 offen lds
s_add_u32 m0, s33, 1024
s_nop 0
buffer_load_dwordx4 v217, s[12:15], s5 offen lds
s_add_u32 m0, s32, 1024
s_nop 0
buffer_load_dwordx4 v51, s[8:11], s4 offen lds
s_add_u32 m0, s33, 2048
s_nop 0
buffer_load_dwordx4 v218, s[12:15], s5 offen lds
s_add_u32 m0, s33, 3072
s_nop 0
buffer_load_dwordx4 v219, s[12:15], s5 offen lds
s_add_u32 s27, s27, 128
s_add_u32 s28, s28, s35
s_add_u32 s6, s6, 1
s_add_u32 s30, s30, 32768
s_cmp_ge_u32 s30, 131072
s_cselect_b32 s30, 0, s30
s_waitcnt vmcnt(12)
s_barrier
s_add_u32 s7, s6, 0
s_add_u32 s4, s7, s3
s_and_b32 s4, s4, s99
s_and_b32 s7, s7, s99
s_sub_i32 s7, s4, s7
s_lshl_b32 s4, s7, 7
s_add_u32 s4, s4, s27
s_mul_i32 s5, s7, s35
s_add_u32 s5, s5, s28
s_add_u32 s32, s30, s60
s_add_u32 s33, s30, s37
s_add_u32 m0, s33, 0
s_nop 0
buffer_load_dwordx4 v216, s[12:15], s5 offen lds
s_add_u32 m0, s32, 0
s_nop 0
buffer_load_dwordx4 v50, s[8:11], s4 offen lds
s_add_u32 m0, s33, 1024
s_nop 0
buffer_load_dwordx4 v217, s[12:15], s5 offen lds
s_add_u32 m0, s32, 1024
s_nop 0
buffer_load_dwordx4 v51, s[8:11], s4 offen lds
s_add_u32 m0, s33, 2048
s_nop 0
buffer_load_dwordx4 v218, s[12:15], s5 offen lds
s_add_u32 m0, s33, 3072
s_nop 0
buffer_load_dwordx4 v219, s[12:15], s5 offen lds
s_add_u32 s27, s27, 128
s_add_u32 s28, s28, s35
s_add_u32 s6, s6, 1
s_add_u32 s30, s30, 32768
s_cmp_ge_u32 s30, 131072
s_cselect_b32 s30, 0, s30
s_waitcnt vmcnt(12)
s_barrier
s_add_u32 s7, s6, 0
s_add_u32 s4, s7, s3
s_and_b32 s4, s4, s99
s_and_b32 s7, s7, s99
s_sub_i32 s7, s4, s7
s_lshl_b32 s4, s7, 7
s_add_u32 s4, s4, s27
s_mul_i32 s5, s7, s35
s_add_u32 s5, s5, s28
s_add_u32 s32, s30, s60
s_add_u32 s33, s30, s37
s_add_u32 m0, s33, 0
s_nop 0
buffer_load_dwordx4 v216, s[12:15], s5 offen lds
s_add_u32 m0, s32, 0
s_nop 0
buffer_load_dwordx4 v50, s[8:11], s4 offen lds
s_add_u32 m0, s33, 1024
s_nop 0
buffer_load_dwordx4 v217, s[12:15], s5 offen lds
s_add_u32 m0, s32, 1024
s_nop 0
buffer_load_dwordx4 v51, s[8:11], s4 offen lds
s_add_u32 m0, s33, 2048
s_nop 0
buffer_load_dwordx4 v218, s[12:15], s5 offen lds
s_add_u32 m0, s33, 3072
s_nop 0
buffer_load_dwordx4 v219, s[12:15], s5 offen lds
s_add_u32 s27, s27, 128
s_add_u32 s28, s28, s35
s_add_u32 s6, s6, 1
s_add_u32 s30, s30, 32768
s_cmp_ge_u32 s30, 131072
s_cselect_b32 s30, 0, s30
s_waitcnt vmcnt(12)
s_barrier
s_add_u32 s7, s6, 0
s_add_u32 s4, s7, s3
s_and_b32 s4, s4, s99
s_and_b32 s7, s7, s99
s_sub_i32 s7, s4, s7
s_lshl_b32 s4, s7, 7
s_add_u32 s4, s4, s27
s_mul_i32 s5, s7, s35
s_add_u32 s5, s5, s28
s_add_u32 s32, s30, s60
s_add_u32 s33, s30, s37
s_add_u32 m0, s33, 0
s_nop 0
buffer_load_dwordx4 v216, s[12:15], s5 offen lds
s_add_u32 m0, s32, 0
s_nop 0
buffer_load_dwordx4 v50, s[8:11], s4 offen lds
s_add_u32 m0, s33, 1024
s_nop 0
buffer_load_dwordx4 v217, s[12:15], s5 offen lds
s_add_u32 m0, s32, 1024
s_nop 0
buffer_load_dwordx4 v51, s[8:11], s4 offen lds
s_add_u32 m0, s33, 2048
s_nop 0
buffer_load_dwordx4 v218, s[12:15], s5 offen lds
s_add_u32 m0, s33, 3072
s_nop 0
buffer_load_dwordx4 v219, s[12:15], s5 offen lds
s_add_u32 s27, s27, 128
s_add_u32 s28, s28, s35
s_add_u32 s6, s6, 1
s_add_u32 s30, s30, 32768
s_cmp_ge_u32 s30, 131072
s_cselect_b32 s30, 0, s30
s_add_u32 s32, s30, s60
s_add_u32 s33, s22, 12582912
s_add_u32 s34, s33, 128
s_xor_b32 s60, s2, 1
s_lshl_b32 s60, s60, 2
s_add_u32 s60, s60, s31
s_lshl_b32 s62, s60, 13
s_add_u32 s62, s62, 41943040
s_lshl_b32 s63, s60, 4
s_add_u32 s63, s63, 38862848
v_mov_b32 v40, 0
v_lshlrev_b32 v42, 4, v254
s_waitcnt vmcnt(12)
s_barrier
buffer_load_dword v41, v40, s[16:19], s63 offen sc0 sc1
s_add_u32 m0, s32, 0
s_nop 0
buffer_load_dwordx4 v48, s[16:19], s33 offen lds
s_add_u32 m0, s32, 1024
s_nop 0
buffer_load_dwordx4 v49, s[16:19], s33 offen lds
s_add_u32 m0, s32, 16384
s_nop 0
buffer_load_dwordx4 v48, s[16:19], s34 offen lds
s_add_u32 m0, s32, 17408
s_nop 0
buffer_load_dwordx4 v49, s[16:19], s34 offen lds
s_add_u32 s33, s51, 1
s_and_b32 s33, s33, 3
s_lshl_b32 s33, s33, 15
s_lshl_b32 s32, s31, 13
s_add_u32 s32, s32, s33
s_waitcnt vmcnt(11)
s_barrier
s_waitcnt vmcnt(4)
v_readfirstlane_b32 s60, v41
s_cmp_eq_u32 s60, 0
s_cbranch_scc1 L_t6_late_218
s_add_u32 m0, s32, 0
s_nop 0
buffer_load_dwordx4 v42, s[16:19], s62 offen offset:0  lds
s_add_u32 m0, s32, 0
s_nop 0
buffer_load_dwordx4 v42, s[16:19], s62 offen offset:1024  lds
s_add_u32 m0, s32, 0
s_nop 0
buffer_load_dwordx4 v42, s[16:19], s62 offen offset:2048  lds
s_add_u32 m0, s32, 0
s_nop 0
buffer_load_dwordx4 v42, s[16:19], s62 offen offset:3072  lds
s_add_u32 s62, s62, 4096
s_barrier
s_waitcnt vmcnt(4)
s_barrier
s_waitcnt vmcnt(0)
s_barrier
s_endpgm
L_t6_late_218:
s_barrier
s_waitcnt vmcnt(0)
s_barrier
s_mov_b32 s50, 0
L_poll_219:
buffer_load_dword v41, v40, s[16:19], s63 offen sc0 sc1
s_waitcnt vmcnt(0)
v_cmp_eq_u32 vcc, 0, v41
s_cmp_eq_u64 vcc, 0
s_cbranch_scc1 L_pollx_220
s_sleep 4
s_add_u32 s50, s50, 1
s_cmp_lt_u32 s50, 100000
s_cbranch_scc1 L_poll_219
L_pollx_220:
s_add_u32 m0, s32, 0
s_nop 0
buffer_load_dwordx4 v42, s[16:19], s62 offen offset:0  lds
s_add_u32 m0, s32, 0
s_nop 0
buffer_load_dwordx4 v42, s[16:19], s62 offen offset:1024  lds
s_add_u32 m0, s32, 0
s_nop 0
buffer_load_dwordx4 v42, s[16:19], s62 offen offset:2048  lds
s_add_u32 m0, s32, 0
s_nop 0
buffer_load_dwordx4 v42, s[16:19], s62 offen offset:3072  lds
s_add_u32 s62, s62, 4096
s_waitcnt vmcnt(0)
s_barrier
s_endpgm
L_h_H_101:
s_cmp_lg_u32 s29, 5
s_cbranch_scc1 L_h_hk_103
v_and_b32 v40, 15, v254
v_lshlrev_b32 v40, 4, v40
buffer_load_dword v41, v40, s[40:43], 0 offen sc0 sc1
s_branch L_h_B_102
L_h_hk_103:
s_cmp_lg_u32 s29, 8
s_cbranch_scc1 L_h_hk_104
s_cmp_lg_u32 s31, 0
s_cbranch_scc1 L_m1_zx_107
s_mov_b32 s50, 0
v_and_b32 v40, 15, v254
v_lshlrev_b32 v40, 4, v40
L_m1_zp_105:
v_cmp_eq_u32 vcc, 0, v41
s_cmp_eq_u64 vcc, 0
s_cbranch_scc1 L_m1_zok_106
s_sleep 8
buffer_load_dword v41, v40, s[40:43], 0 offen sc0 sc1
s_waitcnt vmcnt(0)
s_add_u32 s50, s50, 1
s_cmp_lt_u32 s50, 100000
s_cbranch_scc1 L_m1_zp_105
L_m1_zok_106:
s_lshl_b32 s32, s2, 6
s_add_u32 s32, s32, 38912000
v_mov_b32 v40, 1
v_mov_b32 v41, 0
s_mov_b64 exec, 1
buffer_store_dword v40, v41, s[16:19], s32 offen sc0 sc1
s_mov_b64 exec, -1
L_m1_zx_107:
s_branch L_h_B_102
L_h_hk_104:
s_cmp_lg_u32 s29, 13
s_cbranch_scc1 L_h_hk_108
v_and_b32 v42, 15, v254
s_lshl_b32 s32, s58, 10
v_lshl_add_u32 v40, v42, 6, s32
s_lshl_b32 s33, s59, 7
v_lshrrev_b32 v42, 1, v254
v_lshl_add_u32 v42, v42, 10, s33
v_and_b32 v43, 1, v254
v_or_b32 v43, 1, v43
v_lshl_add_u32 v42, v43, 6, v42
v_cmp_gt_u32 vcc, 32, v254
s_nop 1
v_cndmask_b32 v40, v40, v42, vcc
s_mov_b32 s32, 38912000
buffer_load_dword v41, v40, s[16:19], s32 offen sc0 sc1
s_branch L_h_B_102
L_h_hk_108:
s_branch L_h_B_102
L_s5_H_133:
s_cmp_lg_u32 s29, 12
s_cbranch_scc1 L_s5_hk_135
s_lshl_b32 s62, s59, 2
s_add_u32 s62, s62, s31
s_mov_b32 s61, s31
v_and_b32 v40, 15, v254
v_mul_u32_u24 v40, 896, v40
s_lshl_b32 s32, s62, 4
s_add_u32 s32, s32, 38895616
buffer_load_dword v41, v40, s[16:19], s32 offen sc0 sc1
s_branch L_s5_B_134
L_s5_hk_135:
s_branch L_s5_B_134
L_kv_H_142:
s_cmp_lg_u32 s29, 3
s_cbranch_scc1 L_kv_hk_144
v_and_b32 v40, 15, v254
v_lshlrev_b32 v40, 4, v40
buffer_load_dword v41, v40, s[40:43], 0 offen sc0 sc1
s_branch L_kv_B_143
L_kv_hk_144:
s_cmp_lg_u32 s29, 5
s_cbranch_scc1 L_kv_hk_145
s_cmp_lg_u32 s31, 0
s_cbranch_scc1 L_m1_zx_148
s_mov_b32 s50, 0
v_and_b32 v40, 15, v254
v_lshlrev_b32 v40, 4, v40
L_m1_zp_146:
v_cmp_eq_u32 vcc, 0, v41
s_cmp_eq_u64 vcc, 0
s_cbranch_scc1 L_m1_zok_147
s_sleep 8
buffer_load_dword v41, v40, s[40:43], 0 offen sc0 sc1
s_waitcnt vmcnt(0)
s_add_u32 s50, s50, 1
s_cmp_lt_u32 s50, 100000
s_cbranch_scc1 L_m1_zp_146
L_m1_zok_147:
s_lshl_b32 s32, s2, 6
s_add_u32 s32, s32, 38912000
v_mov_b32 v40, 1
v_mov_b32 v41, 0
s_mov_b64 exec, 1
buffer_store_dword v40, v41, s[16:19], s32 offen sc0 sc1
s_mov_b64 exec, -1
L_m1_zx_148:
s_branch L_kv_B_143
L_kv_hk_145:
s_branch L_kv_B_143
L_q_H_152:
s_cmp_lg_u32 s29, 6
s_cbranch_scc1 L_q_hk_154
v_and_b32 v40, 15, v254
v_lshlrev_b32 v40, 6, v40
s_lshl_b32 s32, s58, 10
s_add_u32 s32, s32, 38912000
buffer_load_dword v41, v40, s[16:19], s32 offen sc0 sc1
s_branch L_q_B_153
L_q_hk_154:
s_cmp_lg_u32 s29, 9
s_cbranch_scc1 L_q_hk_155
v_and_b32 v40, 15, v254
v_lshlrev_b32 v40, 6, v40
s_lshl_b32 s32, s58, 10
s_add_u32 s32, s32, 38912000
v_cmp_eq_u32 vcc, 0, v41
s_cmp_eq_u64 vcc, 0
s_cbranch_scc1 L_nbok_156
s_mov_b32 s50, 0
L_poll_157:
buffer_load_dword v41, v40, s[16:19], s32 offen sc0 sc1
s_waitcnt vmcnt(0)
v_cmp_eq_u32 vcc, 0, v41
s_cmp_eq_u64 vcc, 0
s_cbranch_scc1 L_pollx_158
s_sleep 4
s_add_u32 s50, s50, 1
s_cmp_lt_u32 s50, 100000
s_cbranch_scc1 L_poll_157
L_pollx_158:
L_nbok_156:
s_lshl_b32 s32, s31, 9
s_add_u32 m0, s32, 147456
s_lshl_b32 s33, s21, 4
s_add_u32 s33, s33, s32
s_add_u32 s33, s33, 36700160
v_lshlrev_b32 v43, 4, v254
s_mov_b32 exec_hi, 0
buffer_load_dwordx4 v43, s[16:19], s33 offen lds
s_mov_b32 exec_hi, -1
s_branch L_q_B_153
L_q_hk_155:
s_branch L_q_B_153
L_s7_H_167:
s_cmp_lg_u32 s29, 12
s_cbranch_scc1 L_s7_hk_169
s_min_u32 s61, s31, 2
s_mul_i32 s62, s59, 3
s_add_u32 s62, s62, s61
s_add_u32 s62, s62, 32
v_and_b32 v40, 15, v254
v_mul_u32_u24 v40, 896, v40
s_lshl_b32 s32, s62, 4
s_add_u32 s32, s32, 38895616
buffer_load_dword v41, v40, s[16:19], s32 offen sc0 sc1
s_branch L_s7_B_168
L_s7_hk_169:
s_branch L_s7_B_168
L_s6_H_208:
s_cmp_lg_u32 s29, 20
s_cbranch_scc1 L_s6_hk_210
s_lshl_b32 s32, s58, 10
s_add_u32 s32, s32, 38846464
v_max_u32 v40, 24, v254
v_min_u32 v40, 39, v40
v_lshlrev_b32 v40, 4, v40
buffer_load_dword v43, v40, s[16:19], s32 offen sc0 sc1
s_branch L_s6_B_209
L_s6_hk_210:
s_cmp_lg_u32 s29, 6
s_cbranch_scc1 L_s6_hk_211
s_add_u32 s32, s29, 2
s_cmp_lg_u32 s32, s57
s_cbranch_scc1 L_f3e_x_212
s_cmp_lg_u32 s56, 0
s_cbranch_scc1 L_sw_b_213
s_lshl_b32 s32, s58, 10
s_add_u32 s32, s32, 38846464
v_max_u32 v40, 0, v254
v_min_u32 v40, 23, v40
v_lshlrev_b32 v40, 4, v40
buffer_load_dword v43, v40, s[16:19], s32 offen sc0 sc1
s_branch L_sw_x_214
L_sw_b_213:
s_lshl_b32 s32, s58, 10
s_add_u32 s32, s32, 38846464
v_max_u32 v40, 36, v254
v_min_u32 v40, 63, v40
v_lshlrev_b32 v40, 4, v40
buffer_load_dword v43, v40, s[16:19], s32 offen sc0 sc1
L_sw_x_214:
L_f3e_x_212:
s_branch L_s6_B_209
L_s6_hk_211:
s_branch L_s6_B_209
L_end:
s_endpgm
L_text_end:
s_endpgm
.section .rodata,"a"
.p2align 6
.amdhsa_kernel gated_mix__linear_attn_block__mixer_s_mlp__prompt_kernel
  .amdhsa_next_free_vgpr 256
  .amdhsa_next_free_sgpr 102
  .amdhsa_accum_offset 256
  .amdhsa_group_segment_fixed_size 0
  .amdhsa_kernarg_size 96
  .amdhsa_user_sgpr_count 2
  .amdhsa_user_sgpr_kernarg_segment_ptr 1
  .amdhsa_system_sgpr_workgroup_id_x 1
.end_amdhsa_kernel
.text
```
